```python
import torch

def _softmax(x, axis=-1):
    return torch.softmax(x, dim=axis)
def _gelu(x):
    return torch.nn.functional.gelu(x, approximate="tanh")
def _silu(x):
    return torch.nn.functional.silu(x)
def _sigmoid(x):
    return torch.sigmoid(x)
def _layernorm(x, axis=-1, eps=1e-5):
    m = x.mean(dim=axis, keepdim=True)
    v = x.var(dim=axis, keepdim=True, unbiased=False)
    return (x - m) / torch.sqrt(v + eps)
def _scatter_add(tgt, idx, src, axis=0):
    return tgt.clone().index_add_(axis, idx, src)
def _segment_sum(src, seg, n):
    out = torch.zeros((n,) + src.shape[1:], dtype=src.dtype)
    return out.index_add_(0, seg, src)
def _pad(x, pw):
    flat = tuple(v for pair in reversed(pw) for v in pair)
    return torch.nn.functional.pad(x, flat)

kernel_name = 'standalone__mha_block_cached__near_ridge'

def setup_inputs():

    _w = (lambda a: (lambda t: t.to(torch.bfloat16) if t.is_floating_point() else t)(torch.as_tensor(a)))
    B, Sq, D = 8, 256, 640
    H, Sk, Dh = 32, 1024, 128
    return {
        "x": _w((lambda *s: torch.randn(*s, dtype=torch.bfloat16) * 0.8)(B, Sq, D)),
        "k_cache": _w((lambda *s: torch.randn(*s, dtype=torch.bfloat16) * 0.8)(B, H, Sk, Dh)),
        "v_cache": _w((lambda *s: torch.randn(*s, dtype=torch.bfloat16) * 0.05)(B, H, Sk, Dh)),
        "wq": _w((lambda *s: torch.randn(*s, dtype=torch.bfloat16) * 0.8)(D, H * Dh) * (D ** -0.5)),
        "wo": _w((lambda *s: torch.randn(*s, dtype=torch.bfloat16) * 0.05)(H * Dh, D) * ((H * Dh) ** -0.5)),
    }

def reference(x, k_cache, v_cache, wq, wo):
    B, Sq, D = x.shape
    H, Dh = 32, 128
    q = (lambda x, *d: x.permute(*d))((x @ wq).reshape(B, Sq, H, Dh), 0, 2, 1, 3)
    scores = torch.einsum("bhqd,bhkd->bhqk", q, k_cache) * (Dh ** -0.5)
    p = _softmax(scores, axis=-1)
    o = torch.einsum("bhqk,bhkd->bhqd", p, v_cache)
    return (lambda x, *d: x.permute(*d))(o, 0, 2, 1, 3).reshape(B, Sq, H * Dh) @ wo
```

```asm
; @launch grid=(256,1,1) block=(256,1,1) lds=163840
.amdgcn_target "amdgcn-amd-amdhsa--gfx950"
.text
.globl standalone__mha_block_cached__near_ridge_kernel
.p2align 12
.p2align 8
.type standalone__mha_block_cached__near_ridge_kernel,@function
standalone__mha_block_cached__near_ridge_kernel:
  s_cmp_ge_u32 s2, 256
  s_cbranch_scc1 L_end
  s_load_dwordx8 s[4:11], s[0:1], 0
  s_load_dwordx8 s[12:19], s[0:1], 32
  s_getpc_b64 s[96:97]
L_pc:
  s_lshr_b32 s65, s2, 3
  s_lshl_b32 s65, s65, 2
  v_lshrrev_b32 v2, 6, v0
  v_add_u32 v2, s65, v2
  v_and_b32 v3, 7, v0
  v_lshl_add_u32 v2, v3, 7, v2
  v_lshlrev_b32 v2, 7, v2
  v_min_u32 v2, L_slow-L_pc, v2
  global_load_dword a251, v2, s[96:97]
  v_lshrrev_b32 v1, 6, v0
  v_and_b32 v0, 63, v0
  s_and_b32 s65, s2, 7
  v_readfirstlane_b32 s62, v1
  s_lshr_b32 s66, s2, 3
  s_and_b32 s60, s65, 1
  s_lshl_b32 s60, s60, 2
  s_and_b32 s3, s66, 3
  s_add_u32 s60, s60, s3
  s_lshr_b32 s61, s65, 1
  s_lshl_b32 s61, s61, 3
  s_lshr_b32 s92, s66, 2
  s_add_u32 s61, s61, s92
  s_add_u32 s3, s3, s92
  s_lshl_b32 s63, s62, 12
  s_lshl_b32 s64, s62, 13
  s_mov_b32 s96, 811796016
  s_mov_b32 s97, 774
  s_lshl_b32 s3, s3, 2
  s_lshr_b64 s[96:97], s[96:97], s3
  s_and_b32 s3, s96, 15
  s_lshl_b32 s65, s65, 2
  s_lshr_b32 s65, 538050848, s65
  s_and_b32 s65, s65, 15
  s_add_u32 s3, s3, s65
  s_add_u32 s94, s65, 9
  s_sub_u32 s69, s94, 10
  s_cselect_b32 s94, s94, s69
  s_sub_u32 s65, s3, 10
  s_cselect_b32 s3, s3, s65
  s_lshl_b32 s70, s3, 7
  s_lshl_b32 s80, s3, 19
  s_add_u32 s3, s3, 1
  s_cmp_eq_u32 s3, 10
  s_cselect_b32 s3, 0, s3
  s_cmp_eq_u32 s3, s94
  s_addc_u32 s3, s3, 0
  s_cmp_eq_u32 s3, 10
  s_cselect_b32 s3, 0, s3
  s_lshl_b32 s71, s3, 7
  s_lshl_b32 s81, s3, 19
  s_add_u32 s3, s3, 1
  s_cmp_eq_u32 s3, 10
  s_cselect_b32 s3, 0, s3
  s_cmp_eq_u32 s3, s94
  s_addc_u32 s3, s3, 0
  s_cmp_eq_u32 s3, 10
  s_cselect_b32 s3, 0, s3
  v_lshrrev_b32 v2, 4, v0
  v_and_b32 v3, 15, v0
  v_lshlrev_b32 v4, 2, v2
  v_xor_b32 v4, v4, v3
  v_lshlrev_b32 v4, 4, v4
  v_lshl_add_u32 v5, v1, 4, v2
  v_lshl_add_u32 v40, v5, 13, v4
  v_add_u32 v41, 31744, v40
  v_add_u32 v42, 63488, v40
  v_add_u32 v43, 95232, v40
  v_lshrrev_b32 v6, 3, v0
  v_and_b32 v7, 2, v1
  v_lshl_add_u32 v6, v7, 6, v6
  v_and_b32 v7, 1, v1
  v_lshl_add_u32 v6, v7, 4, v6
  v_mul_u32_u24 v6, 1280, v6
  v_and_b32 v7, 7, v0
  v_xor_b32 v7, v7, v2
  v_lshl_add_u32 v9, v7, 4, v6
  v_xor_b32 v7, 4, v7
  v_lshl_add_u32 v8, v7, 4, v6
  v_add_u32 v8, 9216, v8
  s_lshr_b32 s66, s61, 3
  s_add_u32 s65, s66, 1
  s_and_b32 s65, s65, 3
  s_mul_i32 s65, s65, 40960
  v_add_u32 v32, s65, v9
  v_add_u32 v33, s65, v8
  s_add_u32 s65, s66, 2
  s_and_b32 s65, s65, 3
  s_mul_i32 s65, s65, 40960
  v_add_u32 v34, s65, v9
  v_add_u32 v35, s65, v8
  s_add_u32 s65, s66, 3
  s_and_b32 s65, s65, 3
  s_mul_i32 s65, s65, 40960
  v_add_u32 v36, s65, v9
  v_add_u32 v37, s65, v8
  s_add_u32 s65, s66, 4
  s_and_b32 s65, s65, 3
  s_mul_i32 s65, s65, 40960
  v_add_u32 v38, s65, v9
  v_add_u32 v39, s65, v8
  s_mul_i32 s65, s60, 327680
  s_lshl_b32 s66, s61, 8
  s_waitcnt lgkmcnt(0)
  s_add_u32 s24, s10, s66
  s_addc_u32 s25, s11, 0
  s_mov_b32 s26, 5242880
  s_mov_b32 s27, 0x20000
  s_sub_u32 s26, s26, s66
  s_add_u32 s20, s4, s65
  s_addc_u32 s21, s5, 0
  s_mov_b32 s22, 327680
  s_mov_b32 s23, 0x20000
  s_add_u32 m0, s63, 114688
  s_nop 0
  buffer_load_dwordx4 v40, s[24:27], s80 offen offset:0 lds
  buffer_load_dwordx4 v41, s[24:27], s80 offen offset:1024 lds
  buffer_load_dwordx4 v42, s[24:27], s80 offen offset:2048 lds
  buffer_load_dwordx4 v43, s[24:27], s80 offen offset:3072 lds
  s_add_u32 m0, s64, 131072
  s_nop 0
  buffer_load_dwordx4 v32, s[20:23], s70 offen offset:0 lds
  buffer_load_dwordx4 v33, s[20:23], s70 offen offset:1024 lds
  s_add_u32 m0, s64, 133120
  s_nop 0
  buffer_load_dwordx4 v34, s[20:23], s70 offen offset:0 lds
  buffer_load_dwordx4 v35, s[20:23], s70 offen offset:1024 lds
  s_lshl_b32 s72, s3, 7
  s_lshl_b32 s82, s3, 19
  s_add_u32 s3, s3, 1
  s_cmp_eq_u32 s3, 10
  s_cselect_b32 s3, 0, s3
  s_cmp_eq_u32 s3, s94
  s_addc_u32 s3, s3, 0
  s_cmp_eq_u32 s3, 10
  s_cselect_b32 s3, 0, s3
  s_lshl_b32 s73, s3, 7
  s_lshl_b32 s83, s3, 19
  s_add_u32 s3, s3, 1
  s_cmp_eq_u32 s3, 10
  s_cselect_b32 s3, 0, s3
  s_cmp_eq_u32 s3, s94
  s_addc_u32 s3, s3, 0
  s_cmp_eq_u32 s3, 10
  s_cselect_b32 s3, 0, s3
  v_lshrrev_b32 v4, 1, v3
  v_xor_b32 v4, v4, v2
  v_lshlrev_b32 v5, 7, v3
  v_lshl_add_u32 v5, v1, 13, v5
  v_lshl_add_u32 v6, v4, 4, v5
  v_xor_b32 v4, 4, v4
  v_lshl_add_u32 v7, v4, 4, v5
  v_add_u32 v44, 131072, v6
  v_add_u32 v45, 131072, v7
  v_add_u32 v46, 32768, v6
  v_add_u32 v47, 32768, v7
  v_bfe_u32 v4, v0, 2, 2
  v_and_b32 v5, 3, v0
  v_lshl_add_u32 v6, v2, 3, v4
  v_lshlrev_b32 v6, 8, v6
  v_lshl_add_u32 v6, v5, 4, v6
  v_add_u32 v6, 81920, v6
  v_xor_b32 v7, 0, v4
  v_lshl_add_u32 v48, v7, 6, v6
  v_xor_b32 v7, 1, v4
  v_lshl_add_u32 v49, v7, 6, v6
  v_xor_b32 v7, 2, v4
  v_lshl_add_u32 v50, v7, 6, v6
  v_xor_b32 v7, 3, v4
  v_lshl_add_u32 v51, v7, 6, v6
  s_mov_b64 exec, 0
  s_cmp_eq_u32 s62, 0
  s_cbranch_scc1 L_hop0
  s_cmp_eq_u32 s62, 1
  s_cbranch_scc1 L_hop1
  s_cmp_eq_u32 s62, 2
  s_cbranch_scc1 L_hop2
  s_branch L_hop3
.p2align 12
L_body:
L_hopback:
  s_mov_b64 exec, -1
  s_add_u32 m0, s63, 81920
  s_nop 0
  buffer_load_dwordx4 v40, s[24:27], s81 offen offset:0 lds
  buffer_load_dwordx4 v41, s[24:27], s81 offen offset:1024 lds
  buffer_load_dwordx4 v42, s[24:27], s81 offen offset:2048 lds
  buffer_load_dwordx4 v43, s[24:27], s81 offen offset:3072 lds
  s_waitcnt vmcnt(8)
  s_barrier
  ds_read_b64_tr_b16 a[140:141], v48 offset:32768
  ds_read_b64_tr_b16 a[142:143], v48 offset:33792
  ds_read_b64_tr_b16 a[144:145], v48 offset:40960
  ds_read_b64_tr_b16 a[146:147], v48 offset:41984
  ds_read_b64_tr_b16 a[148:149], v48 offset:32776
  ds_read_b64_tr_b16 a[150:151], v48 offset:33800
  ds_read_b64_tr_b16 a[152:153], v48 offset:40968
  ds_read_b64_tr_b16 a[154:155], v48 offset:41992
  ds_read_b64_tr_b16 a[156:157], v49 offset:32768
  ds_read_b64_tr_b16 a[158:159], v49 offset:33792
  ds_read_b64_tr_b16 a[160:161], v49 offset:40960
  ds_read_b64_tr_b16 a[162:163], v49 offset:41984
  s_add_u32 m0, s64, 135168
  s_nop 0
  buffer_load_dwordx4 v36, s[20:23], s70 offen offset:0 lds
  buffer_load_dwordx4 v37, s[20:23], s70 offen offset:1024 lds
  s_waitcnt vmcnt(8)
  ds_read_b128 a[96:99], v44 offset:0
  ds_read_b128 a[100:103], v45 offset:0
  ds_read_b64_tr_b16 a[164:165], v49 offset:32776
  ds_read_b64_tr_b16 a[166:167], v49 offset:33800
  ds_read_b64_tr_b16 a[168:169], v49 offset:40968
  ds_read_b64_tr_b16 a[170:171], v49 offset:41992
  ds_read_b64_tr_b16 a[172:173], v50 offset:32768
  ds_read_b64_tr_b16 a[174:175], v50 offset:33792
  ds_read_b64_tr_b16 a[176:177], v50 offset:40960
  ds_read_b64_tr_b16 a[178:179], v50 offset:41984
  s_waitcnt lgkmcnt(8)
  v_mfma_f32_16x16x32_bf16 v[128:131], a[140:143], a[96:99], 0
  s_lshl_b32 s74, s3, 7
  ds_read_b64_tr_b16 a[180:181], v50 offset:32776
  ds_read_b64_tr_b16 a[182:183], v50 offset:33800
  v_mfma_f32_16x16x32_bf16 v[128:131], a[144:147], a[100:103], v[128:131]
  s_add_u32 m0, s64, 137216
  ds_read_b64_tr_b16 a[184:185], v50 offset:40968
  ds_read_b64_tr_b16 a[186:187], v50 offset:41992
  v_mfma_f32_16x16x32_bf16 v[144:147], a[152:155], a[100:103], 0
  s_lshl_b32 s84, s3, 19
  buffer_load_dwordx4 v38, s[20:23], s70 offen offset:0 lds
  v_mfma_f32_16x16x32_bf16 v[144:147], a[148:151], a[96:99], v[144:147]
  s_add_u32 s3, s3, 1
  ds_read_b64_tr_b16 a[188:189], v51 offset:32768
  ds_read_b64_tr_b16 a[190:191], v51 offset:33792
  v_mfma_f32_16x16x32_bf16 v[160:163], a[156:159], a[96:99], 0
  ds_read_b64_tr_b16 a[192:193], v51 offset:40960
  ds_read_b64_tr_b16 a[194:195], v51 offset:41984
  v_mfma_f32_16x16x32_bf16 v[160:163], a[160:163], a[100:103], v[160:163]
  s_waitcnt lgkmcnt(12)
  ds_read_b64_tr_b16 a[196:197], v51 offset:32776
  ds_read_b64_tr_b16 a[198:199], v51 offset:33800
  v_mfma_f32_16x16x32_bf16 v[176:179], a[168:171], a[100:103], 0
  buffer_load_dwordx4 v39, s[20:23], s70 offen offset:1024 lds
  v_mfma_f32_16x16x32_bf16 v[176:179], a[164:167], a[96:99], v[176:179]
  s_waitcnt vmcnt(8)
  s_waitcnt lgkmcnt(10)
  ds_read_b64_tr_b16 a[200:201], v51 offset:40968
  ds_read_b64_tr_b16 a[202:203], v51 offset:41992
  v_mfma_f32_16x16x32_bf16 v[192:195], a[172:175], a[96:99], 0
  ds_read_b128 a[104:107], v44 offset:2048
  ds_read_b128 a[108:111], v45 offset:2048
  v_mfma_f32_16x16x32_bf16 v[192:195], a[176:179], a[100:103], v[192:195]
  s_waitcnt lgkmcnt(10)
  s_cmp_eq_u32 s3, 10
  s_cselect_b32 s3, 0, s3
  s_cmp_eq_u32 s3, s94
  s_addc_u32 s3, s3, 0
  s_cmp_eq_u32 s3, 10
  s_cselect_b32 s3, 0, s3
  v_mfma_f32_16x16x32_bf16 v[208:211], a[184:187], a[100:103], 0
  s_add_u32 m0, s64, 32768
  s_lshl_b32 s75, s3, 7
  s_lshl_b32 s85, s3, 19
  s_add_u32 s3, s3, 1
  s_cmp_eq_u32 s3, 10
  s_cselect_b32 s3, 0, s3
  v_mfma_f32_16x16x32_bf16 v[208:211], a[180:183], a[96:99], v[208:211]
  s_waitcnt lgkmcnt(6)
  buffer_load_dwordx4 v32, s[20:23], s71 offen offset:0 lds
  v_mfma_f32_16x16x32_bf16 v[224:227], a[188:191], a[96:99], 0
  s_cmp_eq_u32 s3, s94
  s_addc_u32 s3, s3, 0
  s_cmp_eq_u32 s3, 10
  s_cselect_b32 s3, 0, s3
  s_lshl_b32 s76, s3, 7
  s_lshl_b32 s86, s3, 19
  s_add_u32 s3, s3, 1
  v_mfma_f32_16x16x32_bf16 v[224:227], a[192:195], a[100:103], v[224:227]
  s_waitcnt lgkmcnt(2)
  s_cmp_eq_u32 s3, 10
  s_cselect_b32 s3, 0, s3
  s_cmp_eq_u32 s3, s94
  s_addc_u32 s3, s3, 0
  s_cmp_eq_u32 s3, 10
  s_cselect_b32 s3, 0, s3
  v_mfma_f32_16x16x32_bf16 v[240:243], a[200:203], a[100:103], 0
  s_lshl_b32 s77, s3, 7
  buffer_load_dwordx4 v33, s[20:23], s71 offen offset:1024 lds
  v_mfma_f32_16x16x32_bf16 v[240:243], a[196:199], a[96:99], v[240:243]
  s_waitcnt vmcnt(6) lgkmcnt(0)
  s_lshl_b32 s87, s3, 19
  s_add_u32 s3, s3, 1
  s_cmp_eq_u32 s3, 10
  s_cselect_b32 s3, 0, s3
  s_cmp_eq_u32 s3, s94
  s_addc_u32 s3, s3, 0
  v_mfma_f32_16x16x32_bf16 v[132:135], a[140:143], a[104:107], 0
  s_barrier
  ds_read_b64_tr_b16 a[0:1], v48 offset:0
  ds_read_b64_tr_b16 a[2:3], v48 offset:1024
  v_mfma_f32_16x16x32_bf16 v[132:135], a[144:147], a[108:111], v[132:135]
  s_add_u32 m0, s64, 34816
  s_cmp_eq_u32 s3, 10
  s_cselect_b32 s3, 0, s3
  s_lshl_b32 s78, s3, 7
  s_lshl_b32 s88, s3, 19
  s_add_u32 s3, s3, 1
  v_mfma_f32_16x16x32_bf16 v[148:151], a[152:155], a[108:111], 0
  buffer_load_dwordx4 v34, s[20:23], s71 offen offset:0 lds
  v_mfma_f32_16x16x32_bf16 v[148:151], a[148:151], a[104:107], v[148:151]
  ds_read_b64_tr_b16 a[4:5], v48 offset:8192
  ds_read_b64_tr_b16 a[6:7], v48 offset:9216
  v_mfma_f32_16x16x32_bf16 v[164:167], a[156:159], a[104:107], 0
  s_cmp_eq_u32 s3, 10
  s_cselect_b32 s3, 0, s3
  s_mov_b32 s3, s94
  s_lshl_b32 s79, s3, 7
  s_lshl_b32 s89, s3, 19
  s_add_u32 s3, s3, 1
  v_mfma_f32_16x16x32_bf16 v[164:167], a[160:163], a[108:111], v[164:167]
  ds_read_b64_tr_b16 a[8:9], v48 offset:8
  ds_read_b64_tr_b16 a[10:11], v48 offset:1032
  v_mfma_f32_16x16x32_bf16 v[180:183], a[168:171], a[108:111], 0
  buffer_load_dwordx4 v35, s[20:23], s71 offen offset:1024 lds
  v_mfma_f32_16x16x32_bf16 v[180:183], a[164:167], a[104:107], v[180:183]
  s_waitcnt vmcnt(6)
  s_cmp_eq_u32 s3, 10
  s_cselect_b32 s3, 0, s3
  s_mov_b32 s36, s12
  s_mov_b32 s37, s13
  s_mov_b32 s38, 5242880
  s_mov_b32 s39, 0x20000
  v_mfma_f32_16x16x32_bf16 v[196:199], a[172:175], a[104:107], 0
  s_lshr_b32 s65, s2, 1
  ds_read_b128 a[112:115], v44 offset:4096
  ds_read_b128 a[116:119], v45 offset:4096
  v_mfma_f32_16x16x32_bf16 v[196:199], a[176:179], a[108:111], v[196:199]
  s_and_b32 s66, s2, 1
  s_lshl_b32 s66, s66, 2
  s_add_u32 s66, s66, s62
  s_lshl_b32 s91, s66, 7
  s_add_u32 s91, s91, s65
  s_mul_i32 s65, s65, 40960
  s_and_b32 s66, s2, 1
  v_mfma_f32_16x16x32_bf16 v[212:215], a[184:187], a[108:111], 0
  s_add_u32 m0, s63, 98304
  ds_read_b64_tr_b16 a[12:13], v48 offset:8200
  ds_read_b64_tr_b16 a[14:15], v48 offset:9224
  v_mfma_f32_16x16x32_bf16 v[212:215], a[180:183], a[104:107], v[212:215]
  s_mul_i32 s66, s66, 640
  buffer_load_dwordx4 v40, s[24:27], s82 offen offset:0 lds
  v_mfma_f32_16x16x32_bf16 v[228:231], a[188:191], a[104:107], 0
  s_add_u32 s65, s65, s66
  s_mul_i32 s66, s62, 10240
  s_add_u32 s65, s65, s66
  s_mul_i32 s11, s62, 5120
  v_add_u32 v6, 0, v0
  v_mul_u32_u24 v7, 1639, v6
  v_lshrrev_b32 v7, 16, v7
  v_mfma_f32_16x16x32_bf16 v[228:231], a[192:195], a[108:111], v[228:231]
  ds_read_b64_tr_b16 a[16:17], v49 offset:0
  ds_read_b64_tr_b16 a[18:19], v49 offset:1024
  v_mfma_f32_16x16x32_bf16 v[244:247], a[200:203], a[108:111], 0
  buffer_load_dwordx4 v41, s[24:27], s82 offen offset:1024 lds
  v_mfma_f32_16x16x32_bf16 v[244:247], a[196:199], a[104:107], v[244:247]
  s_waitcnt lgkmcnt(4)
  ds_read_b64_tr_b16 a[20:21], v49 offset:8192
  ds_read_b64_tr_b16 a[22:23], v49 offset:9216
  v_mfma_f32_16x16x32_bf16 v[136:139], a[140:143], a[112:115], 0
  ds_read_b64_tr_b16 a[24:25], v49 offset:8
  ds_read_b64_tr_b16 a[26:27], v49 offset:1032
  v_mfma_f32_16x16x32_bf16 v[136:139], a[144:147], a[116:119], v[136:139]
  v_mul_u32_u24 v8, 640, v7
  v_lshl_add_u32 v8, v6, 4, v8
  v_add_u32 v8, s65, v8
  v_subrev_u32 v9, 0, v8
  v_add_u32 v6, 64, v0
  v_mul_u32_u24 v7, 1639, v6
  v_mfma_f32_16x16x32_bf16 v[152:155], a[152:155], a[116:119], 0
  buffer_load_dwordx4 v42, s[24:27], s82 offen offset:2048 lds
  v_mfma_f32_16x16x32_bf16 v[152:155], a[148:151], a[112:115], v[152:155]
  ds_read_b64_tr_b16 a[28:29], v49 offset:8200
  ds_read_b64_tr_b16 a[30:31], v49 offset:9224
  v_mfma_f32_16x16x32_bf16 v[168:171], a[156:159], a[112:115], 0
  v_lshrrev_b32 v7, 16, v7
  v_mul_u32_u24 v8, 640, v7
  v_lshl_add_u32 v8, v6, 4, v8
  v_add_u32 v8, s65, v8
  v_subrev_u32 v10, 1024, v8
  v_add_u32 v6, 128, v0
  v_mfma_f32_16x16x32_bf16 v[168:171], a[160:163], a[116:119], v[168:171]
  ds_read_b64_tr_b16 a[32:33], v50 offset:0
  ds_read_b64_tr_b16 a[34:35], v50 offset:1024
  v_mfma_f32_16x16x32_bf16 v[184:187], a[168:171], a[116:119], 0
  buffer_load_dwordx4 v43, s[24:27], s82 offen offset:3072 lds
  v_mfma_f32_16x16x32_bf16 v[184:187], a[164:167], a[112:115], v[184:187]
  s_waitcnt vmcnt(8)
  v_mul_u32_u24 v7, 1639, v6
  v_lshrrev_b32 v7, 16, v7
  v_mul_u32_u24 v8, 640, v7
  v_lshl_add_u32 v8, v6, 4, v8
  v_add_u32 v8, s65, v8
  v_subrev_u32 v11, 2048, v8
  v_mfma_f32_16x16x32_bf16 v[200:203], a[172:175], a[112:115], 0
  ds_read_b128 a[120:123], v44 offset:6144
  ds_read_b128 a[124:127], v45 offset:6144
  v_mfma_f32_16x16x32_bf16 v[200:203], a[176:179], a[116:119], v[200:203]
  v_add_u32 v6, 192, v0
  v_mul_u32_u24 v7, 1639, v6
  v_lshrrev_b32 v7, 16, v7
  v_mul_u32_u24 v8, 640, v7
  v_lshl_add_u32 v8, v6, 4, v8
  v_add_u32 v8, s65, v8
  v_mfma_f32_16x16x32_bf16 v[216:219], a[184:187], a[116:119], 0
  s_add_u32 m0, s64, 36864
  ds_read_b64_tr_b16 a[36:37], v50 offset:8192
  ds_read_b64_tr_b16 a[38:39], v50 offset:9216
  v_mfma_f32_16x16x32_bf16 v[216:219], a[180:183], a[112:115], v[216:219]
  buffer_load_dwordx4 v36, s[20:23], s71 offen offset:0 lds
  v_mfma_f32_16x16x32_bf16 v[232:235], a[188:191], a[112:115], 0
  v_subrev_u32 v12, 3072, v8
  v_add_u32 v6, 256, v0
  v_mul_u32_u24 v7, 1639, v6
  v_lshrrev_b32 v7, 16, v7
  v_mul_u32_u24 v8, 640, v7
  v_lshl_add_u32 v8, v6, 4, v8
  v_mfma_f32_16x16x32_bf16 v[232:235], a[192:195], a[116:119], v[232:235]
  ds_read_b64_tr_b16 a[40:41], v50 offset:8
  ds_read_b64_tr_b16 a[42:43], v50 offset:1032
  v_mfma_f32_16x16x32_bf16 v[248:251], a[200:203], a[116:119], 0
  buffer_load_dwordx4 v37, s[20:23], s71 offen offset:1024 lds
  v_mfma_f32_16x16x32_bf16 v[248:251], a[196:199], a[112:115], v[248:251]
  s_waitcnt lgkmcnt(4)
  ds_read_b64_tr_b16 a[44:45], v50 offset:8200
  ds_read_b64_tr_b16 a[46:47], v50 offset:9224
  v_mfma_f32_16x16x32_bf16 v[140:143], a[140:143], a[120:123], 0
  ds_read_b64_tr_b16 a[48:49], v51 offset:0
  ds_read_b64_tr_b16 a[50:51], v51 offset:1024
  v_mfma_f32_16x16x32_bf16 v[140:143], a[144:147], a[124:127], v[140:143]
  s_add_u32 m0, s64, 38912
  v_add_u32 v8, s65, v8
  v_subrev_u32 v13, 0, v8
  v_lshl_add_u32 v6, v2, 2, v4
  v_mul_u32_u24 v6, 640, v6
  v_lshl_add_u32 v6, v5, 3, v6
  v_mul_u32_u24 v7, 160, v1
  v_mfma_f32_16x16x32_bf16 v[156:159], a[152:155], a[124:127], 0
  buffer_load_dwordx4 v38, s[20:23], s71 offen offset:0 lds
  v_mfma_f32_16x16x32_bf16 v[156:159], a[148:151], a[120:123], v[156:159]
  ds_read_b64_tr_b16 a[52:53], v51 offset:8192
  ds_read_b64_tr_b16 a[54:55], v51 offset:9216
  v_mfma_f32_16x16x32_bf16 v[172:175], a[156:159], a[120:123], 0
  v_add_u32 v14, v6, v7
  v_and_b32 v6, 1, v2
  v_mul_u32_u24 v6, 10240, v6
  v_sub_u32 v7, 10240, v6
  v_add_u32 v79, v7, v14
  v_add_u32 v14, v6, v14
  v_mfma_f32_16x16x32_bf16 v[172:175], a[160:163], a[124:127], v[172:175]
  s_lshl_b32 s65, s60, 5
  ds_read_b64_tr_b16 a[56:57], v51 offset:8
  ds_read_b64_tr_b16 a[58:59], v51 offset:1032
  v_mfma_f32_16x16x32_bf16 v[188:191], a[168:171], a[124:127], 0
  s_add_u32 s65, s65, s61
  buffer_load_dwordx4 v39, s[20:23], s71 offen offset:1024 lds
  v_mfma_f32_16x16x32_bf16 v[188:191], a[164:167], a[120:123], v[188:191]
  s_waitcnt vmcnt(10)
  s_lshl_b32 s65, s65, 18
  s_add_u32 s28, s6, s65
  s_addc_u32 s29, s7, 0
  s_mov_b32 s30, 262144
  s_mov_b32 s31, 0x20000
  v_mfma_f32_16x16x32_bf16 v[204:207], a[172:175], a[120:123], 0
  ds_read_b128 a[96:99], v46 offset:0
  ds_read_b128 a[100:103], v47 offset:0
  v_mfma_f32_16x16x32_bf16 v[204:207], a[176:179], a[124:127], v[204:207]
  s_add_u32 s32, s8, s65
  s_addc_u32 s33, s9, 0
  s_mov_b32 s34, 262144
  s_mov_b32 s35, 0x20000
  s_mul_i32 s10, s2, 0x9e3779b1
  s_lshr_b32 s10, s10, 14
  s_and_b32 s10, s10, 184320
  v_mfma_f32_16x16x32_bf16 v[220:223], a[184:187], a[124:127], 0
  s_add_u32 m0, s64, 131072
  ds_read_b64_tr_b16 a[60:61], v51 offset:8200
  ds_read_b64_tr_b16 a[62:63], v51 offset:9224
  v_mfma_f32_16x16x32_bf16 v[220:223], a[180:183], a[120:123], v[220:223]
  s_mov_b32 s48, s14
  buffer_load_dwordx4 v32, s[20:23], s72 offen offset:0 lds
  v_mfma_f32_16x16x32_bf16 v[236:239], a[188:191], a[120:123], 0
  s_mov_b32 s49, s15
  s_mov_b32 s50, 2621440
  s_mov_b32 s51, 0x20000
  s_mov_b32 s52, s16
  s_mov_b32 s53, s17
  s_mov_b32 s54, 256
  s_mov_b32 s55, 0x20000
  v_mfma_f32_16x16x32_bf16 v[236:239], a[192:195], a[124:127], v[236:239]
  s_mov_b32 s40, s18
  s_mov_b32 s41, s19
  s_mov_b32 s42, 16777216
  s_mov_b32 s43, 0x20000
  s_add_u32 s44, s18, 16777216
  s_addc_u32 s45, s19, 0
  s_mov_b32 s46, 5242880
  v_mfma_f32_16x16x32_bf16 v[252:255], a[200:203], a[124:127], 0
  s_mov_b32 s47, 0x20000
  buffer_load_dwordx4 v33, s[20:23], s72 offen offset:1024 lds
  v_mfma_f32_16x16x32_bf16 v[252:255], a[196:199], a[120:123], v[252:255]
  s_waitcnt lgkmcnt(0)
  s_add_u32 s56, s18, 23068672
  s_addc_u32 s57, s19, 0
  s_mov_b32 s58, 4194304
  s_mov_b32 s59, 0x20000
  s_lshl_b32 s90, s60, 2
  s_add_u32 s90, s90, s62
  v_mfma_f32_16x16x32_bf16 v[128:131], a[0:3], a[96:99], v[128:131]
  s_lshl_b32 s90, s90, 5
  s_add_u32 s90, s90, s61
  s_lshl_b32 s90, s90, 14
  s_mov_b32 s69, 0x3e0293ee
  s_mov_b32 s94, 0x53800000
  v_lshl_add_u32 v6, v2, 4, v4
  v_lshlrev_b32 v6, 8, v6
  v_mfma_f32_16x16x32_bf16 v[128:131], a[4:7], a[100:103], v[128:131]
  s_add_u32 m0, s64, 133120
  v_lshl_add_u32 v6, v5, 3, v6
  v_add_u32 v6, 65536, v6
  v_and_b32 v8, 1, v2
  v_lshl_add_u32 v8, v8, 2, v4
  v_xor_b32 v7, 0, v8
  v_lshl_add_u32 v20, v7, 5, v6
  v_mfma_f32_16x16x32_bf16 v[144:147], a[12:15], a[100:103], v[144:147]
  buffer_load_dwordx4 v34, s[20:23], s72 offen offset:0 lds
  v_mfma_f32_16x16x32_bf16 v[144:147], a[8:11], a[96:99], v[144:147]
  v_xor_b32 v7, 1, v8
  v_lshl_add_u32 v21, v7, 5, v6
  v_xor_b32 v7, 2, v8
  v_lshl_add_u32 v22, v7, 5, v6
  v_xor_b32 v7, 3, v8
  v_lshl_add_u32 v23, v7, 5, v6
  v_mfma_f32_16x16x32_bf16 v[160:163], a[16:19], a[96:99], v[160:163]
  v_xor_b32 v7, 4, v8
  v_lshl_add_u32 v24, v7, 5, v6
  v_xor_b32 v7, 5, v8
  v_lshl_add_u32 v25, v7, 5, v6
  v_xor_b32 v7, 6, v8
  v_lshl_add_u32 v26, v7, 5, v6
  v_mfma_f32_16x16x32_bf16 v[160:163], a[20:23], a[100:103], v[160:163]
  v_xor_b32 v7, 7, v8
  v_lshl_add_u32 v27, v7, 5, v6
  v_lshl_add_u32 v6, v4, 4, v5
  v_lshlrev_b32 v6, 8, v6
  v_xor_b32 v8, v2, v3
  v_xor_b32 v7, 0, v8
  v_mfma_f32_16x16x32_bf16 v[176:179], a[28:31], a[100:103], v[176:179]
  buffer_load_dwordx4 v35, s[20:23], s72 offen offset:1024 lds
  v_mfma_f32_16x16x32_bf16 v[176:179], a[24:27], a[96:99], v[176:179]
  s_waitcnt vmcnt(12)
  v_lshl_add_u32 v16, v7, 4, v6
  v_xor_b32 v7, 4, v8
  v_lshl_add_u32 v17, v7, 4, v6
  v_xor_b32 v7, 8, v8
  v_lshl_add_u32 v18, v7, 4, v6
  v_xor_b32 v7, 12, v8
  v_mfma_f32_16x16x32_bf16 v[192:195], a[32:35], a[96:99], v[192:195]
  ds_read_b128 a[104:107], v46 offset:2048
  ds_read_b128 a[108:111], v47 offset:2048
  v_mfma_f32_16x16x32_bf16 v[192:195], a[36:39], a[100:103], v[192:195]
  v_lshl_add_u32 v19, v7, 4, v6
  v_and_b32 v7, 1, v2
  v_lshlrev_b32 v6, 8, v7
  v_lshrrev_b32 v7, 1, v2
  v_lshl_add_u32 v6, v7, 9, v6
  v_and_b32 v7, 1, v1
  v_mfma_f32_16x16x32_bf16 v[208:211], a[44:47], a[100:103], v[208:211]
  s_add_u32 m0, s63, 114688
  v_lshl_add_u32 v6, v7, 13, v6
  v_lshrrev_b32 v7, 1, v1
  v_lshl_add_u32 v6, v7, 16, v6
  v_lshl_add_u32 v7, v1, 2, v2
  v_xor_b32 v7, v7, v3
  v_lshl_add_u32 v28, v7, 4, v6
  v_mfma_f32_16x16x32_bf16 v[208:211], a[40:43], a[96:99], v[208:211]
  buffer_load_dwordx4 v40, s[24:27], s83 offen offset:0 lds
  v_mfma_f32_16x16x32_bf16 v[224:227], a[48:51], a[96:99], v[224:227]
  v_and_b32 v7, 1, v1
  v_lshl_add_u32 v7, v7, 2, v2
  v_lshlrev_b32 v7, 1, v7
  v_xor_b32 v7, v7, v3
  v_lshl_add_u32 v29, v7, 4, v6
  v_mov_b32 v6, 0x3f803f80
  v_mfma_f32_16x16x32_bf16 v[224:227], a[52:55], a[100:103], v[224:227]
  v_lshrrev_b32 v7, 1, v3
  v_cmp_eq_u32 vcc, 0, v7
  s_nop 1
  v_cndmask_b32 v8, 0, v6, vcc
  v_accvgpr_write_b32 a252, v8
  v_accvgpr_write_b32 a253, v8
  v_mfma_f32_16x16x32_bf16 v[240:243], a[60:63], a[100:103], v[240:243]
  buffer_load_dwordx4 v41, s[24:27], s83 offen offset:1024 lds
  v_mfma_f32_16x16x32_bf16 v[240:243], a[56:59], a[96:99], v[240:243]
  s_waitcnt vmcnt(10) lgkmcnt(0)
  v_accvgpr_write_b32 a254, v8
  v_accvgpr_write_b32 a255, v8
  v_and_b32 v8, 0x3f003f00, v8
  v_accvgpr_write_b32 a240, v8
  v_accvgpr_write_b32 a241, v8
  v_accvgpr_write_b32 a242, v8
  v_mfma_f32_16x16x32_bf16 v[132:135], a[0:3], a[104:107], v[132:135]
  s_barrier
  ds_read_b64_tr_b16 a[140:141], v48 offset:16384
  ds_read_b64_tr_b16 a[142:143], v48 offset:17408
  v_mfma_f32_16x16x32_bf16 v[132:135], a[4:7], a[108:111], v[132:135]
  v_accvgpr_write_b32 a243, v8
  v_cmp_eq_u32 vcc, 2, v7
  v_mfma_f32_16x16x32_bf16 v[148:151], a[12:15], a[108:111], v[148:151]
  s_nop 1
  buffer_load_dwordx4 v42, s[24:27], s83 offen offset:2048 lds
  v_mfma_f32_16x16x32_bf16 v[148:151], a[8:11], a[104:107], v[148:151]
  ds_read_b64_tr_b16 a[144:145], v48 offset:24576
  ds_read_b64_tr_b16 a[146:147], v48 offset:25600
  v_mfma_f32_16x16x32_bf16 v[164:167], a[16:19], a[104:107], v[164:167]
  v_cndmask_b32 v8, 0, v6, vcc
  v_accvgpr_write_b32 a136, v8
  v_mfma_f32_16x16x32_bf16 v[164:167], a[20:23], a[108:111], v[164:167]
  ds_read_b64_tr_b16 a[148:149], v48 offset:16392
  ds_read_b64_tr_b16 a[150:151], v48 offset:17416
  v_mfma_f32_16x16x32_bf16 v[180:183], a[28:31], a[108:111], v[180:183]
  buffer_load_dwordx4 v43, s[24:27], s83 offen offset:3072 lds
  v_mfma_f32_16x16x32_bf16 v[180:183], a[24:27], a[104:107], v[180:183]
  s_waitcnt vmcnt(10)
  v_accvgpr_write_b32 a137, v8
  v_accvgpr_write_b32 a138, v8
  v_mfma_f32_16x16x32_bf16 v[196:199], a[32:35], a[104:107], v[196:199]
  ds_read_b128 a[112:115], v46 offset:4096
  ds_read_b128 a[116:119], v47 offset:4096
  v_mfma_f32_16x16x32_bf16 v[196:199], a[36:39], a[108:111], v[196:199]
  v_accvgpr_write_b32 a139, v8
  v_and_b32 v8, 0x3f003f00, v8
  v_mfma_f32_16x16x32_bf16 v[212:215], a[44:47], a[108:111], v[212:215]
  s_add_u32 m0, s64, 135168
  ds_read_b64_tr_b16 a[152:153], v48 offset:24584
  ds_read_b64_tr_b16 a[154:155], v48 offset:25608
  v_mfma_f32_16x16x32_bf16 v[212:215], a[40:43], a[104:107], v[212:215]
  buffer_load_dwordx4 v36, s[20:23], s72 offen offset:0 lds
  v_mfma_f32_16x16x32_bf16 v[228:231], a[48:51], a[104:107], v[228:231]
  v_accvgpr_write_b32 a244, v8
  v_accvgpr_write_b32 a245, v8
  v_mfma_f32_16x16x32_bf16 v[228:231], a[52:55], a[108:111], v[228:231]
  ds_read_b64_tr_b16 a[156:157], v49 offset:16384
  ds_read_b64_tr_b16 a[158:159], v49 offset:17408
  v_mfma_f32_16x16x32_bf16 v[244:247], a[60:63], a[108:111], v[244:247]
  buffer_load_dwordx4 v37, s[20:23], s72 offen offset:1024 lds
  v_mfma_f32_16x16x32_bf16 v[244:247], a[56:59], a[104:107], v[244:247]
  s_waitcnt lgkmcnt(4)
  ds_read_b64_tr_b16 a[160:161], v49 offset:24576
  ds_read_b64_tr_b16 a[162:163], v49 offset:25600
  v_mfma_f32_16x16x32_bf16 v[136:139], a[0:3], a[112:115], v[136:139]
  ds_read_b64_tr_b16 a[164:165], v49 offset:16392
  ds_read_b64_tr_b16 a[166:167], v49 offset:17416
  v_mfma_f32_16x16x32_bf16 v[136:139], a[4:7], a[116:119], v[136:139]
  s_add_u32 m0, s64, 137216
  v_accvgpr_write_b32 a246, v8
  v_accvgpr_write_b32 a247, v8
  v_mfma_f32_16x16x32_bf16 v[152:155], a[12:15], a[116:119], v[152:155]
  buffer_load_dwordx4 v38, s[20:23], s72 offen offset:0 lds
  v_mfma_f32_16x16x32_bf16 v[152:155], a[8:11], a[112:115], v[152:155]
  ds_read_b64_tr_b16 a[168:169], v49 offset:24584
  ds_read_b64_tr_b16 a[170:171], v49 offset:25608
  v_mfma_f32_16x16x32_bf16 v[168:171], a[16:19], a[112:115], v[168:171]
  v_and_b32 v7, 1, v0
  v_mul_u32_u24 v7, 0xaaaa, v7
  v_mfma_f32_16x16x32_bf16 v[168:171], a[20:23], a[116:119], v[168:171]
  ds_read_b64_tr_b16 a[172:173], v50 offset:16384
  ds_read_b64_tr_b16 a[174:175], v50 offset:17408
  v_mfma_f32_16x16x32_bf16 v[184:187], a[28:31], a[116:119], v[184:187]
  buffer_load_dwordx4 v39, s[20:23], s72 offen offset:1024 lds
  v_mfma_f32_16x16x32_bf16 v[184:187], a[24:27], a[112:115], v[184:187]
  s_waitcnt vmcnt(12)
  v_add_u32 v7, 0x4444, v7
  v_lshl_add_u32 v30, v7, 16, v7
  v_mfma_f32_16x16x32_bf16 v[200:203], a[32:35], a[112:115], v[200:203]
  ds_read_b128 a[120:123], v46 offset:6144
  ds_read_b128 a[124:127], v47 offset:6144
  v_mfma_f32_16x16x32_bf16 v[200:203], a[36:39], a[116:119], v[200:203]
  v_accvgpr_write_b32 a128, 0
  v_accvgpr_write_b32 a129, 0
  v_mfma_f32_16x16x32_bf16 v[216:219], a[44:47], a[116:119], v[216:219]
  s_add_u32 m0, s64, 32768
  ds_read_b64_tr_b16 a[176:177], v50 offset:24576
  ds_read_b64_tr_b16 a[178:179], v50 offset:25600
  v_mfma_f32_16x16x32_bf16 v[216:219], a[40:43], a[112:115], v[216:219]
  buffer_load_dwordx4 v32, s[20:23], s73 offen offset:0 lds
  v_mfma_f32_16x16x32_bf16 v[232:235], a[48:51], a[112:115], v[232:235]
  v_accvgpr_write_b32 a130, 0
  v_accvgpr_write_b32 a131, 0
  v_mfma_f32_16x16x32_bf16 v[232:235], a[52:55], a[116:119], v[232:235]
  ds_read_b64_tr_b16 a[180:181], v50 offset:16392
  ds_read_b64_tr_b16 a[182:183], v50 offset:17416
  v_mfma_f32_16x16x32_bf16 v[248:251], a[60:63], a[116:119], v[248:251]
  buffer_load_dwordx4 v33, s[20:23], s73 offen offset:1024 lds
  v_mfma_f32_16x16x32_bf16 v[248:251], a[56:59], a[112:115], v[248:251]
  s_waitcnt lgkmcnt(4)
  ds_read_b64_tr_b16 a[184:185], v50 offset:24584
  ds_read_b64_tr_b16 a[186:187], v50 offset:25608
  v_mfma_f32_16x16x32_bf16 v[140:143], a[0:3], a[120:123], v[140:143]
  ds_read_b64_tr_b16 a[188:189], v51 offset:16384
  ds_read_b64_tr_b16 a[190:191], v51 offset:17408
  v_mfma_f32_16x16x32_bf16 v[140:143], a[4:7], a[124:127], v[140:143]
  s_add_u32 m0, s64, 34816
  v_accvgpr_write_b32 a132, 0
  v_accvgpr_write_b32 a133, 0
  v_mfma_f32_16x16x32_bf16 v[156:159], a[12:15], a[124:127], v[156:159]
  buffer_load_dwordx4 v34, s[20:23], s73 offen offset:0 lds
  v_mfma_f32_16x16x32_bf16 v[156:159], a[8:11], a[120:123], v[156:159]
  ds_read_b64_tr_b16 a[192:193], v51 offset:24576
  ds_read_b64_tr_b16 a[194:195], v51 offset:25600
  v_mfma_f32_16x16x32_bf16 v[172:175], a[16:19], a[120:123], v[172:175]
  v_accvgpr_write_b32 a134, 0
  v_accvgpr_write_b32 a135, 0
  v_mfma_f32_16x16x32_bf16 v[172:175], a[20:23], a[124:127], v[172:175]
  ds_read_b64_tr_b16 a[196:197], v51 offset:16392
  ds_read_b64_tr_b16 a[198:199], v51 offset:17416
  v_mfma_f32_16x16x32_bf16 v[188:191], a[28:31], a[124:127], v[188:191]
  buffer_load_dwordx4 v35, s[20:23], s73 offen offset:1024 lds
  v_mfma_f32_16x16x32_bf16 v[188:191], a[24:27], a[120:123], v[188:191]
  s_waitcnt vmcnt(14)
  v_lshlrev_b32 v1, 4, v0
  v_mfma_f32_16x16x32_bf16 v[204:207], a[32:35], a[120:123], v[204:207]
  ds_read_b128 a[96:99], v44 offset:0
  ds_read_b128 a[100:103], v45 offset:0
  v_mfma_f32_16x16x32_bf16 v[204:207], a[36:39], a[124:127], v[204:207]
  s_add_u32 s4, s18, 28311552
  s_addc_u32 s5, s19, 0
  s_mov_b32 s6, 15728640
  v_mfma_f32_16x16x32_bf16 v[220:223], a[44:47], a[124:127], v[220:223]
  s_add_u32 m0, s63, 81920
  ds_read_b64_tr_b16 a[200:201], v51 offset:24584
  ds_read_b64_tr_b16 a[202:203], v51 offset:25608
  v_mfma_f32_16x16x32_bf16 v[220:223], a[40:43], a[120:123], v[220:223]
  s_mov_b32 s7, 0x20000
  buffer_load_dwordx4 v40, s[24:27], s84 offen offset:0 lds
  v_mfma_f32_16x16x32_bf16 v[236:239], a[48:51], a[120:123], v[236:239]
  s_lshr_b32 s65, s2, 3
  s_lshl_b32 s65, s65, 2
  s_add_u32 s65, s65, s62
  v_mfma_f32_16x16x32_bf16 v[236:239], a[52:55], a[124:127], v[236:239]
  v_and_b32 v6, 1, v0
  v_lshl_add_u32 v6, v6, 7, s65
  v_mfma_f32_16x16x32_bf16 v[252:255], a[60:63], a[124:127], v[252:255]
  buffer_load_dwordx4 v41, s[24:27], s84 offen offset:1024 lds
  v_mfma_f32_16x16x32_bf16 v[252:255], a[56:59], a[120:123], v[252:255]
  s_waitcnt lgkmcnt(0)
  v_lshlrev_b32 v6, 7, v6
  v_min_u32 v66, L_slow-L_tail, v6
  v_mfma_f32_16x16x32_bf16 v[128:131], a[140:143], a[96:99], v[128:131]
  s_add_u32 s65, s2, s63
  s_lshl_b32 s66, s2, 10
  v_mfma_f32_16x16x32_bf16 v[128:131], a[144:147], a[100:103], v[128:131]
  s_cmp_lt_u32 s65, 16
  s_cselect_b32 s66, s66, 2147483392
  v_add_u32 v64, s66, v1
  v_mfma_f32_16x16x32_bf16 v[144:147], a[152:155], a[100:103], v[144:147]
  buffer_load_dwordx4 v42, s[24:27], s84 offen offset:2048 lds
  v_mfma_f32_16x16x32_bf16 v[144:147], a[148:151], a[96:99], v[144:147]
  v_add_u32 v64, 16384, v64
  s_lshr_b32 s66, s66, 8
  v_mfma_f32_16x16x32_bf16 v[160:163], a[156:159], a[96:99], v[160:163]
  v_mov_b32 v7, 2147483392
  v_cmp_eq_u32 vcc, 0, v0
  v_mfma_f32_16x16x32_bf16 v[160:163], a[160:163], a[100:103], v[160:163]
  v_mov_b32 v6, s66
  v_mov_b32 v67, 1
  v_mfma_f32_16x16x32_bf16 v[176:179], a[168:171], a[100:103], v[176:179]
  buffer_load_dwordx4 v43, s[24:27], s84 offen offset:3072 lds
  v_mfma_f32_16x16x32_bf16 v[176:179], a[164:167], a[96:99], v[176:179]
  s_waitcnt vmcnt(16)
  v_cndmask_b32 v65, v7, v6, vcc
  v_cndmask_b32 v74, v7, 0, vcc
  v_mfma_f32_16x16x32_bf16 v[192:195], a[172:175], a[96:99], v[192:195]
  ds_read_b128 a[104:107], v44 offset:2048
  ds_read_b128 a[108:111], v45 offset:2048
  v_mfma_f32_16x16x32_bf16 v[192:195], a[176:179], a[100:103], v[192:195]
L_hop0:
  s_cbranch_execz L_hop4
  v_min_u32 v72, 15, v0
  v_lshlrev_b32 v72, 2, v72
  v_mfma_f32_16x16x32_bf16 v[208:211], a[184:187], a[100:103], v[208:211]
  s_add_u32 m0, s64, 36864
  v_mov_b32 v68, 0
  v_mov_b32 v69, 0
  v_mfma_f32_16x16x32_bf16 v[208:211], a[180:183], a[96:99], v[208:211]
  buffer_load_dwordx4 v36, s[20:23], s73 offen offset:0 lds
  v_mfma_f32_16x16x32_bf16 v[224:227], a[188:191], a[96:99], v[224:227]
  v_mov_b32 v70, 0
  v_mov_b32 v71, 0
  v_mfma_f32_16x16x32_bf16 v[224:227], a[192:195], a[100:103], v[224:227]
  s_lshr_b32 s13, s61, 3
  s_and_b32 s65, s61, 7
  s_xor_b32 s66, s60, 4
  v_mfma_f32_16x16x32_bf16 v[240:243], a[200:203], a[100:103], v[240:243]
  s_lshl_b32 s12, s66, 3
  buffer_load_dwordx4 v37, s[20:23], s73 offen offset:1024 lds
  v_mfma_f32_16x16x32_bf16 v[240:243], a[196:199], a[96:99], v[240:243]
  s_waitcnt vmcnt(14) lgkmcnt(0)
  s_add_u32 s12, s12, s65
  s_lshl_b32 s12, s12, 2
  v_mfma_f32_16x16x32_bf16 v[132:135], a[140:143], a[104:107], v[132:135]
  s_barrier
  ds_read_b64_tr_b16 a[0:1], v48 offset:32768
  ds_read_b64_tr_b16 a[2:3], v48 offset:33792
  v_mfma_f32_16x16x32_bf16 v[132:135], a[144:147], a[108:111], v[132:135]
  s_add_u32 m0, s64, 38912
  s_and_b32 s93, s65, 6
  s_and_b32 s65, s65, 1
  v_mfma_f32_16x16x32_bf16 v[148:151], a[152:155], a[108:111], v[148:151]
  s_lshl_b32 s92, s66, 1
  buffer_load_dwordx4 v38, s[20:23], s73 offen offset:0 lds
  v_mfma_f32_16x16x32_bf16 v[148:151], a[148:151], a[104:107], v[148:151]
  s_add_u32 s92, s92, s65
  ds_read_b64_tr_b16 a[4:5], v48 offset:40960
  ds_read_b64_tr_b16 a[6:7], v48 offset:41984
  v_mfma_f32_16x16x32_bf16 v[164:167], a[156:159], a[104:107], v[164:167]
  s_mul_i32 s19, s13, 8
  s_mul_i32 s65, s62, 2
  s_add_u32 s19, s19, s65
  v_mfma_f32_16x16x32_bf16 v[164:167], a[160:163], a[108:111], v[164:167]
  s_lshl_b32 s18, s93, 1
  ds_read_b64_tr_b16 a[8:9], v48 offset:32776
  ds_read_b64_tr_b16 a[10:11], v48 offset:33800
  v_mfma_f32_16x16x32_bf16 v[180:183], a[168:171], a[108:111], v[180:183]
  s_add_u32 s18, s18, s62
  buffer_load_dwordx4 v39, s[20:23], s73 offen offset:1024 lds
  v_mfma_f32_16x16x32_bf16 v[180:183], a[164:167], a[104:107], v[180:183]
  s_waitcnt vmcnt(14)
  s_lshl_b32 s18, s18, 2
  s_add_u32 s18, s18, s13
  v_mfma_f32_16x16x32_bf16 v[196:199], a[172:175], a[104:107], v[196:199]
  s_mul_i32 s18, s18, 81920
  ds_read_b128 a[112:115], v44 offset:4096
  ds_read_b128 a[116:119], v45 offset:4096
  v_mfma_f32_16x16x32_bf16 v[196:199], a[176:179], a[108:111], v[196:199]
  s_add_u32 s65, s13, 1
  s_and_b32 s65, s65, 3
  s_add_u32 s66, s12, s65
  v_mfma_f32_16x16x32_bf16 v[212:215], a[184:187], a[108:111], v[212:215]
  s_add_u32 m0, s64, 131072
  ds_read_b64_tr_b16 a[12:13], v48 offset:40968
  ds_read_b64_tr_b16 a[14:15], v48 offset:41992
  v_mfma_f32_16x16x32_bf16 v[212:215], a[180:183], a[104:107], v[212:215]
  s_lshl_b32 s3, s66, 2
  buffer_load_dwordx4 v32, s[20:23], s74 offen offset:0 lds
  v_mfma_f32_16x16x32_bf16 v[228:231], a[188:191], a[104:107], v[228:231]
  s_add_u32 s3, s3, s62
  s_lshl_b32 s3, s3, 9
  s_add_u32 s0, s3, 3145728
  v_mfma_f32_16x16x32_bf16 v[228:231], a[192:195], a[108:111], v[228:231]
  s_mul_i32 s66, s66, 3
  ds_read_b64_tr_b16 a[16:17], v49 offset:32768
  ds_read_b64_tr_b16 a[18:19], v49 offset:33792
  v_mfma_f32_16x16x32_bf16 v[244:247], a[200:203], a[108:111], v[244:247]
  s_add_u32 s66, s66, 0
  buffer_load_dwordx4 v33, s[20:23], s74 offen offset:1024 lds
  v_mfma_f32_16x16x32_bf16 v[244:247], a[196:199], a[104:107], v[244:247]
  s_waitcnt lgkmcnt(4)
  ds_read_b64_tr_b16 a[20:21], v49 offset:40960
  ds_read_b64_tr_b16 a[22:23], v49 offset:41984
  v_mfma_f32_16x16x32_bf16 v[136:139], a[140:143], a[112:115], v[136:139]
  s_lshl_b32 s66, s66, 2
  ds_read_b64_tr_b16 a[24:25], v49 offset:32776
  ds_read_b64_tr_b16 a[26:27], v49 offset:33800
  v_mfma_f32_16x16x32_bf16 v[136:139], a[144:147], a[116:119], v[136:139]
  s_add_u32 m0, s64, 133120
  s_add_u32 s66, s66, s62
  s_mul_i32 s14, s66, 3072
  v_mfma_f32_16x16x32_bf16 v[152:155], a[152:155], a[116:119], v[152:155]
  s_add_u32 s65, s13, 2
  buffer_load_dwordx4 v34, s[20:23], s74 offen offset:0 lds
  v_mfma_f32_16x16x32_bf16 v[152:155], a[148:151], a[112:115], v[152:155]
  s_and_b32 s65, s65, 3
  ds_read_b64_tr_b16 a[28:29], v49 offset:40968
  ds_read_b64_tr_b16 a[30:31], v49 offset:41992
  v_mfma_f32_16x16x32_bf16 v[168:171], a[156:159], a[112:115], v[168:171]
  s_add_u32 s66, s12, s65
  s_lshl_b32 s3, s66, 2
  s_add_u32 s3, s3, s62
  v_mfma_f32_16x16x32_bf16 v[168:171], a[160:163], a[116:119], v[168:171]
  s_lshl_b32 s3, s3, 9
  ds_read_b64_tr_b16 a[32:33], v50 offset:32768
  ds_read_b64_tr_b16 a[34:35], v50 offset:33792
  v_mfma_f32_16x16x32_bf16 v[184:187], a[168:171], a[116:119], v[184:187]
  s_add_u32 s1, s3, 3145856
  buffer_load_dwordx4 v35, s[20:23], s74 offen offset:1024 lds
  v_mfma_f32_16x16x32_bf16 v[184:187], a[164:167], a[112:115], v[184:187]
  s_waitcnt vmcnt(16)
  s_mul_i32 s66, s66, 3
  s_add_u32 s66, s66, 1
  v_mfma_f32_16x16x32_bf16 v[200:203], a[172:175], a[112:115], v[200:203]
  s_lshl_b32 s66, s66, 2
  ds_read_b128 a[120:123], v44 offset:6144
  ds_read_b128 a[124:127], v45 offset:6144
  v_mfma_f32_16x16x32_bf16 v[200:203], a[176:179], a[116:119], v[200:203]
  s_add_u32 s66, s66, s62
  s_mul_i32 s15, s66, 3072
  s_add_u32 s65, s13, 3
  v_mfma_f32_16x16x32_bf16 v[216:219], a[184:187], a[116:119], v[216:219]
  s_add_u32 m0, s63, 98304
  ds_read_b64_tr_b16 a[36:37], v50 offset:40960
  ds_read_b64_tr_b16 a[38:39], v50 offset:41984
  v_mfma_f32_16x16x32_bf16 v[216:219], a[180:183], a[112:115], v[216:219]
  s_and_b32 s65, s65, 3
  buffer_load_dwordx4 v40, s[24:27], s85 offen offset:0 lds
  v_mfma_f32_16x16x32_bf16 v[232:235], a[188:191], a[112:115], v[232:235]
  s_add_u32 s66, s12, s65
  s_lshl_b32 s3, s66, 2
  s_add_u32 s3, s3, s62
  v_mfma_f32_16x16x32_bf16 v[232:235], a[192:195], a[116:119], v[232:235]
  s_lshl_b32 s3, s3, 9
  ds_read_b64_tr_b16 a[40:41], v50 offset:32776
  ds_read_b64_tr_b16 a[42:43], v50 offset:33800
  v_mfma_f32_16x16x32_bf16 v[248:251], a[200:203], a[116:119], v[248:251]
  s_add_u32 s2, s3, 3145984
  buffer_load_dwordx4 v41, s[24:27], s85 offen offset:1024 lds
  v_mfma_f32_16x16x32_bf16 v[248:251], a[196:199], a[112:115], v[248:251]
  s_waitcnt lgkmcnt(4)
  ds_read_b64_tr_b16 a[44:45], v50 offset:40968
  ds_read_b64_tr_b16 a[46:47], v50 offset:41992
  v_mfma_f32_16x16x32_bf16 v[140:143], a[140:143], a[120:123], v[140:143]
  s_mul_i32 s66, s66, 3
  ds_read_b64_tr_b16 a[48:49], v51 offset:32768
  ds_read_b64_tr_b16 a[50:51], v51 offset:33792
  v_mfma_f32_16x16x32_bf16 v[140:143], a[144:147], a[124:127], v[140:143]
  s_add_u32 s66, s66, 2
  s_lshl_b32 s66, s66, 2
  s_add_u32 s66, s66, s62
  v_mfma_f32_16x16x32_bf16 v[156:159], a[152:155], a[124:127], v[156:159]
  s_mul_i32 s16, s66, 3072
  buffer_load_dwordx4 v42, s[24:27], s85 offen offset:2048 lds
  v_mfma_f32_16x16x32_bf16 v[156:159], a[148:151], a[120:123], v[156:159]
  s_add_u32 s65, s13, 4
  ds_read_b64_tr_b16 a[52:53], v51 offset:40960
  ds_read_b64_tr_b16 a[54:55], v51 offset:41984
  v_mfma_f32_16x16x32_bf16 v[172:175], a[156:159], a[120:123], v[172:175]
  s_and_b32 s65, s65, 3
  s_lshl_b32 s8, s92, 6
  s_add_u32 s8, s8, s19
  v_mfma_f32_16x16x32_bf16 v[172:175], a[160:163], a[124:127], v[172:175]
  s_lshl_b32 s8, s8, 14
  ds_read_b64_tr_b16 a[56:57], v51 offset:32776
  ds_read_b64_tr_b16 a[58:59], v51 offset:33800
  v_mfma_f32_16x16x32_bf16 v[188:191], a[168:171], a[124:127], v[188:191]
  s_add_u32 s12, s12, s13
  buffer_load_dwordx4 v43, s[24:27], s85 offen offset:3072 lds
  v_mfma_f32_16x16x32_bf16 v[188:191], a[164:167], a[120:123], v[188:191]
  s_waitcnt vmcnt(18)
  s_lshl_b32 s65, s92, 7
  s_mul_i32 s66, s13, 32
  v_mfma_f32_16x16x32_bf16 v[204:207], a[172:175], a[120:123], v[204:207]
  s_add_u32 s65, s65, s66
  ds_read_b128 a[96:99], v46 offset:0
  ds_read_b128 a[100:103], v47 offset:0
  v_mfma_f32_16x16x32_bf16 v[204:207], a[176:179], a[124:127], v[204:207]
  s_mov_b32 s3, s93
  s_lshl_b32 s66, s62, 3
  s_add_u32 s65, s65, s66
  v_mfma_f32_16x16x32_bf16 v[220:223], a[184:187], a[124:127], v[220:223]
  s_add_u32 m0, s64, 135168
  ds_read_b64_tr_b16 a[60:61], v51 offset:40968
  ds_read_b64_tr_b16 a[62:63], v51 offset:41992
  v_mfma_f32_16x16x32_bf16 v[220:223], a[180:183], a[120:123], v[220:223]
  s_mul_i32 s65, s65, 1280
  buffer_load_dwordx4 v36, s[20:23], s74 offen offset:0 lds
  v_mfma_f32_16x16x32_bf16 v[236:239], a[188:191], a[120:123], v[236:239]
  s_mul_i32 s3, s3, 160
  s_add_u32 s17, s65, s3
  s_lshr_b32 s65, s62, 1
  v_mfma_f32_16x16x32_bf16 v[236:239], a[192:195], a[124:127], v[236:239]
  s_lshl_b32 s95, s60, 1
  s_add_u32 s95, s95, s65
  s_lshl_b32 s95, s95, 5
  v_mfma_f32_16x16x32_bf16 v[252:255], a[200:203], a[124:127], v[252:255]
  s_add_u32 s95, s95, s61
  buffer_load_dwordx4 v37, s[20:23], s74 offen offset:1024 lds
  v_mfma_f32_16x16x32_bf16 v[252:255], a[196:199], a[120:123], v[252:255]
  s_waitcnt lgkmcnt(0)
  s_lshl_b32 s95, s95, 1
  s_and_b32 s65, s62, 1
  v_mfma_f32_16x16x32_bf16 v[128:131], a[0:3], a[96:99], v[128:131]
  s_add_u32 s95, s95, s65
  s_lshl_b32 s95, s95, 9
  s_add_u32 s95, s95, 2097152
  v_mfma_f32_16x16x32_bf16 v[128:131], a[4:7], a[100:103], v[128:131]
  s_add_u32 m0, s64, 137216
  s_lshr_b32 s65, s62, 1
  s_add_u32 s65, s65, s93
  v_mfma_f32_16x16x32_bf16 v[144:147], a[12:15], a[100:103], v[144:147]
  s_lshl_b32 s65, s65, 2
  buffer_load_dwordx4 v38, s[20:23], s74 offen offset:0 lds
  v_mfma_f32_16x16x32_bf16 v[144:147], a[8:11], a[96:99], v[144:147]
  s_add_u32 s65, s65, s13
  s_lshl_b32 s65, s65, 9
  s_add_u32 s65, s65, 16384
  v_mfma_f32_16x16x32_bf16 v[160:163], a[16:19], a[96:99], v[160:163]
  v_and_b32 v6, 31, v0
  v_lshl_add_u32 v75, v6, 4, s65
  v_mfma_f32_16x16x32_bf16 v[160:163], a[20:23], a[100:103], v[160:163]
  s_lshl_b32 s13, s91, 4
  s_add_u32 s13, s13, 16384
  s_lshl_b32 s65, s12, 2
  v_mfma_f32_16x16x32_bf16 v[176:179], a[28:31], a[100:103], v[176:179]
  s_add_u32 s65, s65, s62
  buffer_load_dwordx4 v39, s[20:23], s74 offen offset:1024 lds
  v_mfma_f32_16x16x32_bf16 v[176:179], a[24:27], a[96:99], v[176:179]
  s_waitcnt vmcnt(20)
  s_lshl_b32 s65, s65, 9
  s_add_u32 s65, s65, 3145728
  v_mfma_f32_16x16x32_bf16 v[192:195], a[32:35], a[96:99], v[192:195]
  ds_read_b128 a[104:107], v46 offset:2048
  ds_read_b128 a[108:111], v47 offset:2048
  v_mfma_f32_16x16x32_bf16 v[192:195], a[36:39], a[100:103], v[192:195]
  v_cmp_gt_u32 vcc, 32, v0
  v_mov_b32 v6, s65
  v_mfma_f32_16x16x32_bf16 v[208:211], a[44:47], a[100:103], v[208:211]
  s_add_u32 m0, s11, 0
  v_mov_b32 v7, s95
  v_cndmask_b32 v6, v6, v7, vcc
  v_mfma_f32_16x16x32_bf16 v[208:211], a[40:43], a[96:99], v[208:211]
  buffer_load_dwordx4 v9, s[36:39], 0 offen offset:0 lds
  v_mfma_f32_16x16x32_bf16 v[224:227], a[48:51], a[96:99], v[224:227]
  v_and_b32 v7, 31, v0
  v_lshl_add_u32 v76, v7, 4, v6
  v_mfma_f32_16x16x32_bf16 v[224:227], a[52:55], a[100:103], v[224:227]
  s_lshr_b32 s65, s92, 3
  s_lshl_b32 s65, s65, 1
  s_and_b32 s66, s92, 1
  v_mfma_f32_16x16x32_bf16 v[240:243], a[60:63], a[100:103], v[240:243]
  s_add_u32 s65, s65, s66
  buffer_load_dwordx4 v10, s[36:39], 0 offen offset:1024 lds
  v_mfma_f32_16x16x32_bf16 v[240:243], a[56:59], a[96:99], v[240:243]
  s_waitcnt vmcnt(18) lgkmcnt(0)
  s_lshl_b32 s65, s65, 3
  s_add_u32 s65, s65, s62
  v_mfma_f32_16x16x32_bf16 v[132:135], a[0:3], a[104:107], v[132:135]
  s_barrier
  ds_read_b64_tr_b16 a[140:141], v48 offset:0
  ds_read_b64_tr_b16 a[142:143], v48 offset:1024
  v_mfma_f32_16x16x32_bf16 v[132:135], a[4:7], a[108:111], v[132:135]
  s_lshl_b32 s65, s65, 3
  s_bfe_u32 s66, s92, 0x20001
  s_add_u32 s65, s65, s66
  v_mfma_f32_16x16x32_bf16 v[148:151], a[12:15], a[108:111], v[148:151]
  s_lshl_b32 s65, s65, 2
  buffer_load_dwordx4 v11, s[36:39], 0 offen offset:2048 lds
  v_mfma_f32_16x16x32_bf16 v[148:151], a[8:11], a[104:107], v[148:151]
  s_lshr_b32 s66, s19, 3
  ds_read_b64_tr_b16 a[144:145], v48 offset:8192
  ds_read_b64_tr_b16 a[146:147], v48 offset:9216
  v_mfma_f32_16x16x32_bf16 v[164:167], a[16:19], a[104:107], v[164:167]
  s_add_u32 s65, s65, s66
  s_lshl_b32 s65, s65, 4
  s_add_u32 s65, s65, 16384
  v_mfma_f32_16x16x32_bf16 v[164:167], a[20:23], a[108:111], v[164:167]
  ds_read_b64_tr_b16 a[148:149], v48 offset:8
  ds_read_b64_tr_b16 a[150:151], v48 offset:1032
  v_mfma_f32_16x16x32_bf16 v[180:183], a[28:31], a[108:111], v[180:183]
  buffer_load_dwordx4 v12, s[36:39], 0 offen offset:3072 lds
  v_mfma_f32_16x16x32_bf16 v[180:183], a[24:27], a[104:107], v[180:183]
  s_waitcnt vmcnt(18)
  v_and_b32 v6, 1, v0
  v_lshl_add_u32 v6, v6, 11, s65
  v_mfma_f32_16x16x32_bf16 v[196:199], a[32:35], a[104:107], v[196:199]
  ds_read_b128 a[112:115], v46 offset:4096
  ds_read_b128 a[116:119], v47 offset:4096
  v_mfma_f32_16x16x32_bf16 v[196:199], a[36:39], a[108:111], v[196:199]
  v_bfe_u32 v7, v0, 1, 1
  v_lshl_add_u32 v6, v7, 8, v6
  v_mfma_f32_16x16x32_bf16 v[212:215], a[44:47], a[108:111], v[212:215]
  s_add_u32 m0, s11, 4096
  ds_read_b64_tr_b16 a[152:153], v48 offset:8200
  ds_read_b64_tr_b16 a[154:155], v48 offset:9224
  v_mfma_f32_16x16x32_bf16 v[212:215], a[40:43], a[104:107], v[212:215]
  buffer_load_dwordx4 v13, s[36:39], 0 offen offset:0 lds
  v_mfma_f32_16x16x32_bf16 v[228:231], a[48:51], a[104:107], v[228:231]
  v_cndmask_b32 v6, v6, v75, vcc
  s_andn2_b32 s65, s13, 63
  v_mfma_f32_16x16x32_bf16 v[228:231], a[52:55], a[108:111], v[228:231]
  s_add_u32 m0, s64, 32768
  ds_read_b64_tr_b16 a[156:157], v49 offset:0
  ds_read_b64_tr_b16 a[158:159], v49 offset:1024
  v_mfma_f32_16x16x32_bf16 v[244:247], a[60:63], a[108:111], v[244:247]
  buffer_load_dwordx4 v32, s[20:23], s75 offen offset:0 lds
  v_mfma_f32_16x16x32_bf16 v[244:247], a[56:59], a[104:107], v[244:247]
  s_waitcnt lgkmcnt(4)
  ds_read_b64_tr_b16 a[160:161], v49 offset:8192
  ds_read_b64_tr_b16 a[162:163], v49 offset:9216
  v_mfma_f32_16x16x32_bf16 v[136:139], a[0:3], a[112:115], v[136:139]
  ds_read_b64_tr_b16 a[164:165], v49 offset:8
  ds_read_b64_tr_b16 a[166:167], v49 offset:1032
  v_mfma_f32_16x16x32_bf16 v[136:139], a[4:7], a[116:119], v[136:139]
  v_cmp_gt_u32 vcc, 36, v0
  v_and_b32 v7, 3, v0
  v_mfma_f32_16x16x32_bf16 v[152:155], a[12:15], a[116:119], v[152:155]
  buffer_load_dwordx4 v33, s[20:23], s75 offen offset:1024 lds
  v_mfma_f32_16x16x32_bf16 v[152:155], a[8:11], a[112:115], v[152:155]
  ds_read_b64_tr_b16 a[168:169], v49 offset:8200
  ds_read_b64_tr_b16 a[170:171], v49 offset:9224
  v_mfma_f32_16x16x32_bf16 v[168:171], a[16:19], a[112:115], v[168:171]
  v_lshl_add_u32 v7, v7, 4, s65
  v_cndmask_b32 v75, v7, v6, vcc
  v_mfma_f32_16x16x32_bf16 v[168:171], a[20:23], a[116:119], v[168:171]
  s_add_u32 m0, s64, 34816
  ds_read_b64_tr_b16 a[172:173], v50 offset:0
  ds_read_b64_tr_b16 a[174:175], v50 offset:1024
  v_mfma_f32_16x16x32_bf16 v[184:187], a[28:31], a[116:119], v[184:187]
  s_lshr_b32 s65, s91, 7
  buffer_load_dwordx4 v34, s[20:23], s75 offen offset:0 lds
  v_mfma_f32_16x16x32_bf16 v[184:187], a[24:27], a[112:115], v[184:187]
  s_waitcnt vmcnt(20)
  s_lshl_b32 s65, s65, 3
  s_bfe_u32 s66, s91, 0x20005
  v_mfma_f32_16x16x32_bf16 v[200:203], a[32:35], a[112:115], v[200:203]
  s_add_u32 s65, s65, s66
  ds_read_b128 a[120:123], v46 offset:6144
  ds_read_b128 a[124:127], v47 offset:6144
  v_mfma_f32_16x16x32_bf16 v[200:203], a[36:39], a[116:119], v[200:203]
  s_lshl_b32 s65, s65, 3
  s_and_b32 s66, s91, 4
  s_add_u32 s65, s65, s66
  v_mfma_f32_16x16x32_bf16 v[216:219], a[44:47], a[116:119], v[216:219]
  s_bfe_u32 s66, s91, 0x20003
  ds_read_b64_tr_b16 a[176:177], v50 offset:8192
  ds_read_b64_tr_b16 a[178:179], v50 offset:9216
  v_mfma_f32_16x16x32_bf16 v[216:219], a[40:43], a[112:115], v[216:219]
  s_add_u32 s65, s65, s66
  s_mul_i32 s65, s65, 10240
  s_bfe_u32 s66, s91, 0x10001
  v_mfma_f32_16x16x32_bf16 v[232:235], a[48:51], a[112:115], v[232:235]
  s_mul_i32 s61, s66, 327680
  s_add_u32 s61, s61, s65
  s_and_b32 s66, s91, 1
  v_mfma_f32_16x16x32_bf16 v[232:235], a[52:55], a[116:119], v[232:235]
  s_lshl_b32 s66, s66, 10
  ds_read_b64_tr_b16 a[180:181], v50 offset:8
  ds_read_b64_tr_b16 a[182:183], v50 offset:1032
  v_mfma_f32_16x16x32_bf16 v[248:251], a[60:63], a[116:119], v[248:251]
  s_add_u32 s61, s61, s66
  s_add_u32 s61, s61, 8192
  s_and_b32 s66, s91, 3
  v_mfma_f32_16x16x32_bf16 v[248:251], a[56:59], a[112:115], v[248:251]
  s_waitcnt lgkmcnt(4)
  ds_read_b64_tr_b16 a[184:185], v50 offset:8200
  ds_read_b64_tr_b16 a[186:187], v50 offset:9224
  v_mfma_f32_16x16x32_bf16 v[140:143], a[0:3], a[120:123], v[140:143]
  s_lshl_b32 s66, s66, 11
  ds_read_b64_tr_b16 a[188:189], v51 offset:0
  ds_read_b64_tr_b16 a[190:191], v51 offset:1024
  v_mfma_f32_16x16x32_bf16 v[140:143], a[4:7], a[124:127], v[140:143]
  s_add_u32 s91, s65, s66
  s_xor_b32 s66, s66, 4096
  s_add_u32 s93, s65, s66
  v_mfma_f32_16x16x32_bf16 v[156:159], a[12:15], a[124:127], v[156:159]
  s_add_u32 s93, s93, 327680
  v_mfma_f32_16x16x32_bf16 v[156:159], a[8:11], a[120:123], v[156:159]
  ds_read_b64_tr_b16 a[192:193], v51 offset:8192
  ds_read_b64_tr_b16 a[194:195], v51 offset:9216
  v_mfma_f32_16x16x32_bf16 v[172:175], a[16:19], a[120:123], v[172:175]
  v_mfma_f32_16x16x32_bf16 v[172:175], a[20:23], a[124:127], v[172:175]
  ds_read_b64_tr_b16 a[196:197], v51 offset:8
  ds_read_b64_tr_b16 a[198:199], v51 offset:1032
  v_mfma_f32_16x16x32_bf16 v[188:191], a[28:31], a[124:127], v[188:191]
  v_mfma_f32_16x16x32_bf16 v[188:191], a[24:27], a[120:123], v[188:191]
  s_waitcnt vmcnt(18)
  v_mfma_f32_16x16x32_bf16 v[204:207], a[32:35], a[120:123], v[204:207]
  ds_read_b128 a[96:99], v44 offset:0
  ds_read_b128 a[100:103], v45 offset:0
  v_mfma_f32_16x16x32_bf16 v[204:207], a[36:39], a[124:127], v[204:207]
  v_mfma_f32_16x16x32_bf16 v[220:223], a[44:47], a[124:127], v[220:223]
  ds_read_b64_tr_b16 a[200:201], v51 offset:8200
  ds_read_b64_tr_b16 a[202:203], v51 offset:9224
  v_mfma_f32_16x16x32_bf16 v[220:223], a[40:43], a[120:123], v[220:223]
  v_mfma_f32_16x16x32_bf16 v[236:239], a[48:51], a[120:123], v[236:239]
  v_mfma_f32_16x16x32_bf16 v[236:239], a[52:55], a[124:127], v[236:239]
  v_mfma_f32_16x16x32_bf16 v[252:255], a[60:63], a[124:127], v[252:255]
  v_mfma_f32_16x16x32_bf16 v[252:255], a[56:59], a[120:123], v[252:255]
  s_waitcnt lgkmcnt(0)
  v_mfma_f32_16x16x32_bf16 v[128:131], a[140:143], a[96:99], v[128:131]
  v_mfma_f32_16x16x32_bf16 v[128:131], a[144:147], a[100:103], v[128:131]
  v_mfma_f32_16x16x32_bf16 v[144:147], a[152:155], a[100:103], v[144:147]
  v_mfma_f32_16x16x32_bf16 v[144:147], a[148:151], a[96:99], v[144:147]
  v_mfma_f32_16x16x32_bf16 v[160:163], a[156:159], a[96:99], v[160:163]
  buffer_store_dwordx4 v[68:71], v64, s[56:59], 0 offen sc1
  v_mfma_f32_16x16x32_bf16 v[160:163], a[160:163], a[100:103], v[160:163]
  v_mfma_f32_16x16x32_bf16 v[176:179], a[168:171], a[100:103], v[176:179]
  v_mfma_f32_16x16x32_bf16 v[176:179], a[164:167], a[96:99], v[176:179]
  s_waitcnt vmcnt(17)
  v_mfma_f32_16x16x32_bf16 v[192:195], a[172:175], a[96:99], v[192:195]
  ds_read_b128 a[104:107], v44 offset:2048
  ds_read_b128 a[108:111], v45 offset:2048
  v_mfma_f32_16x16x32_bf16 v[192:195], a[176:179], a[100:103], v[192:195]
  buffer_store_dwordx4 v[68:71], v76, s[56:59], 0 offen sc1
  v_mfma_f32_16x16x32_bf16 v[208:211], a[184:187], a[100:103], v[208:211]
  v_mfma_f32_16x16x32_bf16 v[208:211], a[180:183], a[96:99], v[208:211]
  v_mfma_f32_16x16x32_bf16 v[224:227], a[188:191], a[96:99], v[224:227]
  v_mfma_f32_16x16x32_bf16 v[224:227], a[192:195], a[100:103], v[224:227]
  v_mfma_f32_16x16x32_bf16 v[240:243], a[200:203], a[100:103], v[240:243]
  buffer_load_dwordx4 v35, s[20:23], s75 offen offset:1024 lds
  v_mfma_f32_16x16x32_bf16 v[240:243], a[196:199], a[96:99], v[240:243]
  s_waitcnt vmcnt(15) lgkmcnt(0)
  v_mfma_f32_16x16x32_bf16 v[132:135], a[140:143], a[104:107], v[132:135]
  s_barrier
  ds_read_b64_tr_b16 a[0:1], v48 offset:16384
  ds_read_b64_tr_b16 a[2:3], v48 offset:17408
  v_mfma_f32_16x16x32_bf16 v[132:135], a[144:147], a[108:111], v[132:135]
  s_add_u32 m0, s63, 114688
  v_mfma_f32_16x16x32_bf16 v[148:151], a[152:155], a[108:111], v[148:151]
  buffer_load_dwordx4 v40, s[24:27], s86 offen offset:0 lds
  v_mfma_f32_16x16x32_bf16 v[148:151], a[148:151], a[104:107], v[148:151]
  ds_read_b64_tr_b16 a[4:5], v48 offset:24576
  ds_read_b64_tr_b16 a[6:7], v48 offset:25600
  v_mfma_f32_16x16x32_bf16 v[164:167], a[156:159], a[104:107], v[164:167]
  v_mfma_f32_16x16x32_bf16 v[164:167], a[160:163], a[108:111], v[164:167]
  ds_read_b64_tr_b16 a[8:9], v48 offset:16392
  ds_read_b64_tr_b16 a[10:11], v48 offset:17416
  v_mfma_f32_16x16x32_bf16 v[180:183], a[168:171], a[108:111], v[180:183]
  buffer_load_dwordx4 v41, s[24:27], s86 offen offset:1024 lds
  v_mfma_f32_16x16x32_bf16 v[180:183], a[164:167], a[104:107], v[180:183]
  s_waitcnt vmcnt(15)
  v_mfma_f32_16x16x32_bf16 v[196:199], a[172:175], a[104:107], v[196:199]
  ds_read_b128 a[112:115], v44 offset:4096
  ds_read_b128 a[116:119], v45 offset:4096
  v_mfma_f32_16x16x32_bf16 v[196:199], a[176:179], a[108:111], v[196:199]
  v_mfma_f32_16x16x32_bf16 v[212:215], a[184:187], a[108:111], v[212:215]
  ds_read_b64_tr_b16 a[12:13], v48 offset:24584
  ds_read_b64_tr_b16 a[14:15], v48 offset:25608
  v_mfma_f32_16x16x32_bf16 v[212:215], a[180:183], a[104:107], v[212:215]
  buffer_load_dwordx4 v42, s[24:27], s86 offen offset:2048 lds
  v_mfma_f32_16x16x32_bf16 v[228:231], a[188:191], a[104:107], v[228:231]
  v_mfma_f32_16x16x32_bf16 v[228:231], a[192:195], a[108:111], v[228:231]
  ds_read_b64_tr_b16 a[16:17], v49 offset:16384
  ds_read_b64_tr_b16 a[18:19], v49 offset:17408
  v_mfma_f32_16x16x32_bf16 v[244:247], a[200:203], a[108:111], v[244:247]
  buffer_load_dwordx4 v43, s[24:27], s86 offen offset:3072 lds
  v_mfma_f32_16x16x32_bf16 v[244:247], a[196:199], a[104:107], v[244:247]
  s_waitcnt lgkmcnt(4)
  ds_read_b64_tr_b16 a[20:21], v49 offset:24576
  ds_read_b64_tr_b16 a[22:23], v49 offset:25600
  v_mfma_f32_16x16x32_bf16 v[136:139], a[140:143], a[112:115], v[136:139]
  ds_read_b64_tr_b16 a[24:25], v49 offset:16392
  ds_read_b64_tr_b16 a[26:27], v49 offset:17416
  v_mfma_f32_16x16x32_bf16 v[136:139], a[144:147], a[116:119], v[136:139]
  s_add_u32 m0, s64, 36864
  v_mfma_f32_16x16x32_bf16 v[152:155], a[152:155], a[116:119], v[152:155]
  buffer_load_dwordx4 v36, s[20:23], s75 offen offset:0 lds
  v_mfma_f32_16x16x32_bf16 v[152:155], a[148:151], a[112:115], v[152:155]
  ds_read_b64_tr_b16 a[28:29], v49 offset:24584
  ds_read_b64_tr_b16 a[30:31], v49 offset:25608
  v_mfma_f32_16x16x32_bf16 v[168:171], a[156:159], a[112:115], v[168:171]
  v_mfma_f32_16x16x32_bf16 v[168:171], a[160:163], a[116:119], v[168:171]
  ds_read_b64_tr_b16 a[32:33], v50 offset:16384
  ds_read_b64_tr_b16 a[34:35], v50 offset:17408
  v_mfma_f32_16x16x32_bf16 v[184:187], a[168:171], a[116:119], v[184:187]
  buffer_load_dwordx4 v37, s[20:23], s75 offen offset:1024 lds
  v_mfma_f32_16x16x32_bf16 v[184:187], a[164:167], a[112:115], v[184:187]
  s_waitcnt vmcnt(17)
  v_mfma_f32_16x16x32_bf16 v[200:203], a[172:175], a[112:115], v[200:203]
  ds_read_b128 a[120:123], v44 offset:6144
  ds_read_b128 a[124:127], v45 offset:6144
  v_mfma_f32_16x16x32_bf16 v[200:203], a[176:179], a[116:119], v[200:203]
  v_mfma_f32_16x16x32_bf16 v[216:219], a[184:187], a[116:119], v[216:219]
  s_add_u32 m0, s64, 38912
  ds_read_b64_tr_b16 a[36:37], v50 offset:24576
  ds_read_b64_tr_b16 a[38:39], v50 offset:25600
  v_mfma_f32_16x16x32_bf16 v[216:219], a[180:183], a[112:115], v[216:219]
  buffer_load_dwordx4 v38, s[20:23], s75 offen offset:0 lds
  v_mfma_f32_16x16x32_bf16 v[232:235], a[188:191], a[112:115], v[232:235]
  v_mfma_f32_16x16x32_bf16 v[232:235], a[192:195], a[116:119], v[232:235]
  ds_read_b64_tr_b16 a[40:41], v50 offset:16392
  ds_read_b64_tr_b16 a[42:43], v50 offset:17416
  v_mfma_f32_16x16x32_bf16 v[248:251], a[200:203], a[116:119], v[248:251]
  buffer_load_dwordx4 v39, s[20:23], s75 offen offset:1024 lds
  v_mfma_f32_16x16x32_bf16 v[248:251], a[196:199], a[112:115], v[248:251]
  s_waitcnt lgkmcnt(4)
  ds_read_b64_tr_b16 a[44:45], v50 offset:24584
  ds_read_b64_tr_b16 a[46:47], v50 offset:25608
  v_mfma_f32_16x16x32_bf16 v[140:143], a[140:143], a[120:123], v[140:143]
  ds_read_b64_tr_b16 a[48:49], v51 offset:16384
  ds_read_b64_tr_b16 a[50:51], v51 offset:17408
  v_mfma_f32_16x16x32_bf16 v[140:143], a[144:147], a[124:127], v[140:143]
  s_add_u32 m0, s64, 131072
  v_mfma_f32_16x16x32_bf16 v[156:159], a[152:155], a[124:127], v[156:159]
  buffer_load_dwordx4 v32, s[20:23], s76 offen offset:0 lds
  v_mfma_f32_16x16x32_bf16 v[156:159], a[148:151], a[120:123], v[156:159]
  ds_read_b64_tr_b16 a[52:53], v51 offset:24576
  ds_read_b64_tr_b16 a[54:55], v51 offset:25600
  v_mfma_f32_16x16x32_bf16 v[172:175], a[156:159], a[120:123], v[172:175]
  v_mfma_f32_16x16x32_bf16 v[172:175], a[160:163], a[124:127], v[172:175]
  ds_read_b64_tr_b16 a[56:57], v51 offset:16392
  ds_read_b64_tr_b16 a[58:59], v51 offset:17416
  v_mfma_f32_16x16x32_bf16 v[188:191], a[168:171], a[124:127], v[188:191]
  buffer_load_dwordx4 v33, s[20:23], s76 offen offset:1024 lds
  v_mfma_f32_16x16x32_bf16 v[188:191], a[164:167], a[120:123], v[188:191]
  s_waitcnt vmcnt(14)
  v_mfma_f32_16x16x32_bf16 v[204:207], a[172:175], a[120:123], v[204:207]
  ds_read_b128 a[96:99], v46 offset:0
  ds_read_b128 a[100:103], v47 offset:0
  v_mfma_f32_16x16x32_bf16 v[204:207], a[176:179], a[124:127], v[204:207]
  v_mfma_f32_16x16x32_bf16 v[220:223], a[184:187], a[124:127], v[220:223]
  s_add_u32 m0, s64, 133120
  ds_read_b64_tr_b16 a[60:61], v51 offset:24584
  ds_read_b64_tr_b16 a[62:63], v51 offset:25608
  v_mfma_f32_16x16x32_bf16 v[220:223], a[180:183], a[120:123], v[220:223]
  buffer_load_dwordx4 v34, s[20:23], s76 offen offset:0 lds
  v_mfma_f32_16x16x32_bf16 v[236:239], a[188:191], a[120:123], v[236:239]
  v_mfma_f32_16x16x32_bf16 v[236:239], a[192:195], a[124:127], v[236:239]
  v_mfma_f32_16x16x32_bf16 v[252:255], a[200:203], a[124:127], v[252:255]
  buffer_load_dwordx4 v35, s[20:23], s76 offen offset:1024 lds
  v_mfma_f32_16x16x32_bf16 v[252:255], a[196:199], a[120:123], v[252:255]
  s_waitcnt lgkmcnt(0)
  v_mfma_f32_16x16x32_bf16 v[128:131], a[0:3], a[96:99], v[128:131]
  v_mfma_f32_16x16x32_bf16 v[128:131], a[4:7], a[100:103], v[128:131]
  s_add_u32 m0, s63, 81920
  v_mfma_f32_16x16x32_bf16 v[144:147], a[12:15], a[100:103], v[144:147]
  buffer_load_dwordx4 v40, s[24:27], s87 offen offset:0 lds
  v_mfma_f32_16x16x32_bf16 v[144:147], a[8:11], a[96:99], v[144:147]
  v_mfma_f32_16x16x32_bf16 v[160:163], a[16:19], a[96:99], v[160:163]
  v_mfma_f32_16x16x32_bf16 v[160:163], a[20:23], a[100:103], v[160:163]
  v_mfma_f32_16x16x32_bf16 v[176:179], a[28:31], a[100:103], v[176:179]
  buffer_load_dwordx4 v41, s[24:27], s87 offen offset:1024 lds
  v_mfma_f32_16x16x32_bf16 v[176:179], a[24:27], a[96:99], v[176:179]
  s_waitcnt vmcnt(14)
  v_mfma_f32_16x16x32_bf16 v[192:195], a[32:35], a[96:99], v[192:195]
  ds_read_b128 a[104:107], v46 offset:2048
  ds_read_b128 a[108:111], v47 offset:2048
  v_mfma_f32_16x16x32_bf16 v[192:195], a[36:39], a[100:103], v[192:195]
  v_mfma_f32_16x16x32_bf16 v[208:211], a[44:47], a[100:103], v[208:211]
  v_mfma_f32_16x16x32_bf16 v[208:211], a[40:43], a[96:99], v[208:211]
  buffer_load_dwordx4 v42, s[24:27], s87 offen offset:2048 lds
  v_mfma_f32_16x16x32_bf16 v[224:227], a[48:51], a[96:99], v[224:227]
  v_mfma_f32_16x16x32_bf16 v[224:227], a[52:55], a[100:103], v[224:227]
  v_mfma_f32_16x16x32_bf16 v[240:243], a[60:63], a[100:103], v[240:243]
  s_waitcnt vmcnt(21)
  buffer_load_dwordx4 v43, s[24:27], s87 offen offset:3072 lds
  v_mfma_f32_16x16x32_bf16 v[240:243], a[56:59], a[96:99], v[240:243]
  s_waitcnt vmcnt(12) lgkmcnt(0)
  v_mfma_f32_16x16x32_bf16 v[132:135], a[0:3], a[104:107], v[132:135]
  s_barrier
  ds_read_b64_tr_b16 a[140:141], v48 offset:32768
  ds_read_b64_tr_b16 a[142:143], v48 offset:33792
  v_mfma_f32_16x16x32_bf16 v[132:135], a[4:7], a[108:111], v[132:135]
  s_add_u32 m0, s64, 135168
  v_mfma_f32_16x16x32_bf16 v[148:151], a[12:15], a[108:111], v[148:151]
  buffer_load_dwordx4 v36, s[20:23], s76 offen offset:0 lds
  v_mfma_f32_16x16x32_bf16 v[148:151], a[8:11], a[104:107], v[148:151]
  ds_read_b64_tr_b16 a[144:145], v48 offset:40960
  ds_read_b64_tr_b16 a[146:147], v48 offset:41984
  v_mfma_f32_16x16x32_bf16 v[164:167], a[16:19], a[104:107], v[164:167]
  ds_read_b64_tr_b16 a[204:205], v14 offset:0
  ds_read_b64_tr_b16 a[206:207], v79 offset:0
  v_mfma_f32_16x16x32_bf16 v[164:167], a[20:23], a[108:111], v[164:167]
  ds_read_b64_tr_b16 a[148:149], v48 offset:32776
  ds_read_b64_tr_b16 a[150:151], v48 offset:33800
  v_mfma_f32_16x16x32_bf16 v[180:183], a[28:31], a[108:111], v[180:183]
  buffer_load_dwordx4 v37, s[20:23], s76 offen offset:1024 lds
  v_mfma_f32_16x16x32_bf16 v[180:183], a[24:27], a[104:107], v[180:183]
  s_waitcnt vmcnt(12)
  v_mfma_f32_16x16x32_bf16 v[196:199], a[32:35], a[104:107], v[196:199]
  ds_read_b128 a[112:115], v46 offset:4096
  ds_read_b128 a[116:119], v47 offset:4096
  v_mfma_f32_16x16x32_bf16 v[196:199], a[36:39], a[108:111], v[196:199]
  ds_read_b64_tr_b16 a[208:209], v14 offset:32
  ds_read_b64_tr_b16 a[210:211], v79 offset:32
  v_mfma_f32_16x16x32_bf16 v[212:215], a[44:47], a[108:111], v[212:215]
  s_add_u32 m0, s64, 137216
  ds_read_b64_tr_b16 a[152:153], v48 offset:40968
  ds_read_b64_tr_b16 a[154:155], v48 offset:41992
  v_mfma_f32_16x16x32_bf16 v[212:215], a[40:43], a[104:107], v[212:215]
L_hop1:
  s_cbranch_execz L_hop5
  buffer_load_dwordx4 v38, s[20:23], s76 offen offset:0 lds
  v_mfma_f32_16x16x32_bf16 v[228:231], a[48:51], a[104:107], v[228:231]
  v_mfma_f32_16x16x32_bf16 v[228:231], a[52:55], a[108:111], v[228:231]
  ds_read_b64_tr_b16 a[156:157], v49 offset:32768
  ds_read_b64_tr_b16 a[158:159], v49 offset:33792
  v_mfma_f32_16x16x32_bf16 v[244:247], a[60:63], a[108:111], v[244:247]
  buffer_load_dwordx4 v39, s[20:23], s76 offen offset:1024 lds
  v_mfma_f32_16x16x32_bf16 v[244:247], a[56:59], a[104:107], v[244:247]
  s_waitcnt lgkmcnt(6)
  ds_read_b64_tr_b16 a[160:161], v49 offset:40960
  ds_read_b64_tr_b16 a[162:163], v49 offset:41984
  v_mfma_f32_16x16x32_bf16 v[136:139], a[0:3], a[112:115], v[136:139]
  ds_read_b64_tr_b16 a[164:165], v49 offset:32776
  ds_read_b64_tr_b16 a[166:167], v49 offset:33800
  v_mfma_f32_16x16x32_bf16 v[136:139], a[4:7], a[116:119], v[136:139]
  s_add_u32 m0, s64, 32768
  v_mfma_f32_16x16x32_bf16 v[152:155], a[12:15], a[116:119], v[152:155]
  buffer_load_dwordx4 v32, s[20:23], s77 offen offset:0 lds
  v_mfma_f32_16x16x32_bf16 v[152:155], a[8:11], a[112:115], v[152:155]
  s_waitcnt vmcnt(23)
  ds_read_b64_tr_b16 a[168:169], v49 offset:40968
  ds_read_b64_tr_b16 a[170:171], v49 offset:41992
  v_mfma_f32_16x16x32_bf16 v[168:171], a[16:19], a[112:115], v[168:171]
  ds_read_b64_tr_b16 a[212:213], v14 offset:64
  ds_read_b64_tr_b16 a[214:215], v79 offset:64
  buffer_store_dword v67, v65, s[52:55], 0 offen sc1
  v_mfma_f32_16x16x32_bf16 v[168:171], a[20:23], a[116:119], v[168:171]
  ds_read_b64_tr_b16 a[172:173], v50 offset:32768
  ds_read_b64_tr_b16 a[174:175], v50 offset:33792
  v_mfma_f32_16x16x32_bf16 v[184:187], a[28:31], a[116:119], v[184:187]
  buffer_load_dwordx4 v33, s[20:23], s77 offen offset:1024 lds
  v_mfma_f32_16x16x32_bf16 v[184:187], a[24:27], a[112:115], v[184:187]
  s_waitcnt vmcnt(15)
  v_mfma_f32_16x16x32_bf16 v[200:203], a[32:35], a[112:115], v[200:203]
  ds_read_b128 a[120:123], v46 offset:6144
  ds_read_b128 a[124:127], v47 offset:6144
  v_mfma_f32_16x16x32_bf16 v[200:203], a[36:39], a[116:119], v[200:203]
  ds_read_b64_tr_b16 a[216:217], v14 offset:96
  ds_read_b64_tr_b16 a[218:219], v79 offset:96
  v_mfma_f32_16x16x32_bf16 v[216:219], a[44:47], a[116:119], v[216:219]
  s_add_u32 m0, s64, 34816
  ds_read_b64_tr_b16 a[176:177], v50 offset:40960
  ds_read_b64_tr_b16 a[178:179], v50 offset:41984
  v_mfma_f32_16x16x32_bf16 v[216:219], a[40:43], a[112:115], v[216:219]
  buffer_load_dwordx4 v34, s[20:23], s77 offen offset:0 lds
  v_mfma_f32_16x16x32_bf16 v[232:235], a[48:51], a[112:115], v[232:235]
  v_mfma_f32_16x16x32_bf16 v[232:235], a[52:55], a[116:119], v[232:235]
  ds_read_b64_tr_b16 a[180:181], v50 offset:32776
  ds_read_b64_tr_b16 a[182:183], v50 offset:33800
  v_mfma_f32_16x16x32_bf16 v[248:251], a[60:63], a[116:119], v[248:251]
  buffer_load_dwordx4 v35, s[20:23], s77 offen offset:1024 lds
  v_mfma_f32_16x16x32_bf16 v[248:251], a[56:59], a[112:115], v[248:251]
  s_waitcnt lgkmcnt(6)
  ds_read_b64_tr_b16 a[184:185], v50 offset:40968
  ds_read_b64_tr_b16 a[186:187], v50 offset:41992
  v_mfma_f32_16x16x32_bf16 v[140:143], a[0:3], a[120:123], v[140:143]
  ds_read_b64_tr_b16 a[188:189], v51 offset:32768
  ds_read_b64_tr_b16 a[190:191], v51 offset:33792
  v_mfma_f32_16x16x32_bf16 v[140:143], a[4:7], a[124:127], v[140:143]
  s_add_u32 m0, s63, 98304
  v_mfma_f32_16x16x32_bf16 v[156:159], a[12:15], a[124:127], v[156:159]
  buffer_load_dwordx4 v40, s[24:27], s88 offen offset:0 lds
  v_mfma_f32_16x16x32_bf16 v[156:159], a[8:11], a[120:123], v[156:159]
  ds_read_b64_tr_b16 a[192:193], v51 offset:40960
  ds_read_b64_tr_b16 a[194:195], v51 offset:41984
  v_mfma_f32_16x16x32_bf16 v[172:175], a[16:19], a[120:123], v[172:175]
  ds_read_b64_tr_b16 a[220:221], v14 offset:128
  ds_read_b64_tr_b16 a[222:223], v79 offset:128
  v_mfma_f32_16x16x32_bf16 v[172:175], a[20:23], a[124:127], v[172:175]
  ds_read_b64_tr_b16 a[196:197], v51 offset:32776
  ds_read_b64_tr_b16 a[198:199], v51 offset:33800
  v_mfma_f32_16x16x32_bf16 v[188:191], a[28:31], a[124:127], v[188:191]
  buffer_load_dwordx4 v41, s[24:27], s88 offen offset:1024 lds
  v_mfma_f32_16x16x32_bf16 v[188:191], a[24:27], a[120:123], v[188:191]
  s_waitcnt vmcnt(17)
  v_mfma_f32_16x16x32_bf16 v[204:207], a[32:35], a[120:123], v[204:207]
  ds_read_b128 a[96:99], v44 offset:0
  ds_read_b128 a[100:103], v45 offset:0
  v_mfma_f32_16x16x32_bf16 v[204:207], a[36:39], a[124:127], v[204:207]
  v_mfma_f32_16x16x32_bf16 v[220:223], a[44:47], a[124:127], v[220:223]
  ds_read_b64_tr_b16 a[200:201], v51 offset:40968
  ds_read_b64_tr_b16 a[202:203], v51 offset:41992
  v_mfma_f32_16x16x32_bf16 v[220:223], a[40:43], a[120:123], v[220:223]
  buffer_load_dwordx4 v42, s[24:27], s88 offen offset:2048 lds
  v_mfma_f32_16x16x32_bf16 v[236:239], a[48:51], a[120:123], v[236:239]
  v_mfma_f32_16x16x32_bf16 v[236:239], a[52:55], a[124:127], v[236:239]
  v_mfma_f32_16x16x32_bf16 v[252:255], a[60:63], a[124:127], v[252:255]
  s_waitcnt lgkmcnt(6)
  buffer_load_dwordx4 v43, s[24:27], s88 offen offset:3072 lds
  v_mfma_f32_16x16x32_bf16 v[252:255], a[56:59], a[120:123], v[252:255]
  s_waitcnt lgkmcnt(0)
  v_mfma_f32_16x16x32_bf16 v[128:131], a[140:143], a[96:99], v[128:131]
  buffer_store_dwordx4 a[204:207], v1, s[44:47], s91 offen offset:0 sc1
  v_mfma_f32_16x16x32_bf16 v[128:131], a[144:147], a[100:103], v[128:131]
  s_add_u32 m0, s64, 36864
  v_mfma_f32_16x16x32_bf16 v[144:147], a[152:155], a[100:103], v[144:147]
  buffer_load_dwordx4 v36, s[20:23], s77 offen offset:0 lds
  v_mfma_f32_16x16x32_bf16 v[144:147], a[148:151], a[96:99], v[144:147]
  v_mfma_f32_16x16x32_bf16 v[160:163], a[156:159], a[96:99], v[160:163]
  v_mfma_f32_16x16x32_bf16 v[160:163], a[160:163], a[100:103], v[160:163]
  v_mfma_f32_16x16x32_bf16 v[176:179], a[168:171], a[100:103], v[176:179]
  buffer_load_dwordx4 v37, s[20:23], s77 offen offset:1024 lds
  v_mfma_f32_16x16x32_bf16 v[176:179], a[164:167], a[96:99], v[176:179]
  s_waitcnt vmcnt(20)
  v_mfma_f32_16x16x32_bf16 v[192:195], a[172:175], a[96:99], v[192:195]
  ds_read_b128 a[104:107], v44 offset:2048
  ds_read_b128 a[108:111], v45 offset:2048
  v_mfma_f32_16x16x32_bf16 v[192:195], a[176:179], a[100:103], v[192:195]
  v_mfma_f32_16x16x32_bf16 v[208:211], a[184:187], a[100:103], v[208:211]
  s_add_u32 m0, s64, 38912
  v_mfma_f32_16x16x32_bf16 v[208:211], a[180:183], a[96:99], v[208:211]
  buffer_load_dwordx4 v38, s[20:23], s77 offen offset:0 lds
  v_mfma_f32_16x16x32_bf16 v[224:227], a[188:191], a[96:99], v[224:227]
  v_mfma_f32_16x16x32_bf16 v[224:227], a[192:195], a[100:103], v[224:227]
  v_mfma_f32_16x16x32_bf16 v[240:243], a[200:203], a[100:103], v[240:243]
  buffer_load_dwordx4 v39, s[20:23], s77 offen offset:1024 lds
  v_mfma_f32_16x16x32_bf16 v[240:243], a[196:199], a[96:99], v[240:243]
  s_waitcnt vmcnt(18) lgkmcnt(0)
  v_mfma_f32_16x16x32_bf16 v[132:135], a[140:143], a[104:107], v[132:135]
  s_barrier
  ds_read_b64_tr_b16 a[0:1], v48 offset:0
  ds_read_b64_tr_b16 a[2:3], v48 offset:1024
  v_mfma_f32_16x16x32_bf16 v[132:135], a[144:147], a[108:111], v[132:135]
  s_add_u32 m0, s64, 131072
  v_mfma_f32_16x16x32_bf16 v[148:151], a[152:155], a[108:111], v[148:151]
  buffer_load_dwordx4 v32, s[20:23], s78 offen offset:0 lds
  v_mfma_f32_16x16x32_bf16 v[148:151], a[148:151], a[104:107], v[148:151]
  ds_read_b64_tr_b16 a[4:5], v48 offset:8192
  ds_read_b64_tr_b16 a[6:7], v48 offset:9216
  v_mfma_f32_16x16x32_bf16 v[164:167], a[156:159], a[104:107], v[164:167]
  v_mfma_f32_16x16x32_bf16 v[164:167], a[160:163], a[108:111], v[164:167]
  ds_read_b64_tr_b16 a[8:9], v48 offset:8
  ds_read_b64_tr_b16 a[10:11], v48 offset:1032
  v_mfma_f32_16x16x32_bf16 v[180:183], a[168:171], a[108:111], v[180:183]
  buffer_load_dwordx4 v33, s[20:23], s78 offen offset:1024 lds
  v_mfma_f32_16x16x32_bf16 v[180:183], a[164:167], a[104:107], v[180:183]
  s_waitcnt vmcnt(18)
  v_mfma_f32_16x16x32_bf16 v[196:199], a[172:175], a[104:107], v[196:199]
  ds_read_b128 a[112:115], v44 offset:4096
  ds_read_b128 a[116:119], v45 offset:4096
  v_mfma_f32_16x16x32_bf16 v[196:199], a[176:179], a[108:111], v[196:199]
  buffer_store_dwordx4 a[208:211], v1, s[44:47], s91 offen offset:1024 sc1
  v_mfma_f32_16x16x32_bf16 v[212:215], a[184:187], a[108:111], v[212:215]
  s_add_u32 m0, s64, 133120
  ds_read_b64_tr_b16 a[12:13], v48 offset:8200
  ds_read_b64_tr_b16 a[14:15], v48 offset:9224
  v_mfma_f32_16x16x32_bf16 v[212:215], a[180:183], a[104:107], v[212:215]
  buffer_load_dwordx4 v34, s[20:23], s78 offen offset:0 lds
  v_mfma_f32_16x16x32_bf16 v[228:231], a[188:191], a[104:107], v[228:231]
  v_mfma_f32_16x16x32_bf16 v[228:231], a[192:195], a[108:111], v[228:231]
  ds_read_b64_tr_b16 a[16:17], v49 offset:0
  ds_read_b64_tr_b16 a[18:19], v49 offset:1024
  v_mfma_f32_16x16x32_bf16 v[244:247], a[200:203], a[108:111], v[244:247]
  buffer_load_dwordx4 v35, s[20:23], s78 offen offset:1024 lds
  v_mfma_f32_16x16x32_bf16 v[244:247], a[196:199], a[104:107], v[244:247]
  s_waitcnt lgkmcnt(4)
  ds_read_b64_tr_b16 a[20:21], v49 offset:8192
  ds_read_b64_tr_b16 a[22:23], v49 offset:9216
  v_mfma_f32_16x16x32_bf16 v[136:139], a[140:143], a[112:115], v[136:139]
  ds_read_b64_tr_b16 a[24:25], v49 offset:8
  ds_read_b64_tr_b16 a[26:27], v49 offset:1032
  v_mfma_f32_16x16x32_bf16 v[136:139], a[144:147], a[116:119], v[136:139]
  s_add_u32 m0, s63, 114688
  v_mfma_f32_16x16x32_bf16 v[152:155], a[152:155], a[116:119], v[152:155]
  buffer_load_dwordx4 v40, s[24:27], s89 offen offset:0 lds
  v_mfma_f32_16x16x32_bf16 v[152:155], a[148:151], a[112:115], v[152:155]
  ds_read_b64_tr_b16 a[28:29], v49 offset:8200
  ds_read_b64_tr_b16 a[30:31], v49 offset:9224
  v_mfma_f32_16x16x32_bf16 v[168:171], a[156:159], a[112:115], v[168:171]
  v_mfma_f32_16x16x32_bf16 v[168:171], a[160:163], a[116:119], v[168:171]
  ds_read_b64_tr_b16 a[32:33], v50 offset:0
  ds_read_b64_tr_b16 a[34:35], v50 offset:1024
  v_mfma_f32_16x16x32_bf16 v[184:187], a[168:171], a[116:119], v[184:187]
  buffer_load_dwordx4 v41, s[24:27], s89 offen offset:1024 lds
  v_mfma_f32_16x16x32_bf16 v[184:187], a[164:167], a[112:115], v[184:187]
  s_waitcnt vmcnt(21)
  v_mfma_f32_16x16x32_bf16 v[200:203], a[172:175], a[112:115], v[200:203]
  ds_read_b128 a[120:123], v44 offset:6144
  ds_read_b128 a[124:127], v45 offset:6144
  v_mfma_f32_16x16x32_bf16 v[200:203], a[176:179], a[116:119], v[200:203]
  v_mfma_f32_16x16x32_bf16 v[216:219], a[184:187], a[116:119], v[216:219]
  ds_read_b64_tr_b16 a[36:37], v50 offset:8192
  ds_read_b64_tr_b16 a[38:39], v50 offset:9216
  v_mfma_f32_16x16x32_bf16 v[216:219], a[180:183], a[112:115], v[216:219]
  buffer_load_dwordx4 v42, s[24:27], s89 offen offset:2048 lds
  v_mfma_f32_16x16x32_bf16 v[232:235], a[188:191], a[112:115], v[232:235]
  v_mfma_f32_16x16x32_bf16 v[232:235], a[192:195], a[116:119], v[232:235]
  ds_read_b64_tr_b16 a[40:41], v50 offset:8
  ds_read_b64_tr_b16 a[42:43], v50 offset:1032
  v_mfma_f32_16x16x32_bf16 v[248:251], a[200:203], a[116:119], v[248:251]
  buffer_load_dwordx4 v43, s[24:27], s89 offen offset:3072 lds
  v_mfma_f32_16x16x32_bf16 v[248:251], a[196:199], a[112:115], v[248:251]
  s_waitcnt lgkmcnt(4)
  ds_read_b64_tr_b16 a[44:45], v50 offset:8200
  ds_read_b64_tr_b16 a[46:47], v50 offset:9224
  v_mfma_f32_16x16x32_bf16 v[140:143], a[140:143], a[120:123], v[140:143]
  ds_read_b64_tr_b16 a[48:49], v51 offset:0
  ds_read_b64_tr_b16 a[50:51], v51 offset:1024
  v_mfma_f32_16x16x32_bf16 v[140:143], a[144:147], a[124:127], v[140:143]
  s_add_u32 m0, s64, 135168
  buffer_store_dwordx4 a[212:215], v1, s[44:47], s61 offen offset:0 sc1
  v_mfma_f32_16x16x32_bf16 v[156:159], a[152:155], a[124:127], v[156:159]
  buffer_load_dwordx4 v36, s[20:23], s78 offen offset:0 lds
  v_mfma_f32_16x16x32_bf16 v[156:159], a[148:151], a[120:123], v[156:159]
  ds_read_b64_tr_b16 a[52:53], v51 offset:8192
  ds_read_b64_tr_b16 a[54:55], v51 offset:9216
  v_mfma_f32_16x16x32_bf16 v[172:175], a[156:159], a[120:123], v[172:175]
  v_mfma_f32_16x16x32_bf16 v[172:175], a[160:163], a[124:127], v[172:175]
  ds_read_b64_tr_b16 a[56:57], v51 offset:8
  ds_read_b64_tr_b16 a[58:59], v51 offset:1032
  v_mfma_f32_16x16x32_bf16 v[188:191], a[168:171], a[124:127], v[188:191]
  buffer_load_dwordx4 v37, s[20:23], s78 offen offset:1024 lds
  v_mfma_f32_16x16x32_bf16 v[188:191], a[164:167], a[120:123], v[188:191]
  s_waitcnt vmcnt(23)
  v_mfma_f32_16x16x32_bf16 v[204:207], a[172:175], a[120:123], v[204:207]
  ds_read_b128 a[96:99], v46 offset:0
  ds_read_b128 a[100:103], v47 offset:0
  v_mfma_f32_16x16x32_bf16 v[204:207], a[176:179], a[124:127], v[204:207]
  v_mfma_f32_16x16x32_bf16 v[220:223], a[184:187], a[124:127], v[220:223]
  s_add_u32 m0, s64, 137216
  ds_read_b64_tr_b16 a[60:61], v51 offset:8200
  ds_read_b64_tr_b16 a[62:63], v51 offset:9224
  v_mfma_f32_16x16x32_bf16 v[220:223], a[180:183], a[120:123], v[220:223]
  buffer_load_dwordx4 v38, s[20:23], s78 offen offset:0 lds
  v_mfma_f32_16x16x32_bf16 v[236:239], a[188:191], a[120:123], v[236:239]
  v_mfma_f32_16x16x32_bf16 v[236:239], a[192:195], a[124:127], v[236:239]
  v_mfma_f32_16x16x32_bf16 v[252:255], a[200:203], a[124:127], v[252:255]
  buffer_load_dwordx4 v39, s[20:23], s78 offen offset:1024 lds
  v_mfma_f32_16x16x32_bf16 v[252:255], a[196:199], a[120:123], v[252:255]
  s_waitcnt lgkmcnt(0)
  v_mfma_f32_16x16x32_bf16 v[128:131], a[0:3], a[96:99], v[128:131]
  v_mfma_f32_16x16x32_bf16 v[128:131], a[4:7], a[100:103], v[128:131]
  v_mfma_f32_16x16x32_bf16 v[144:147], a[12:15], a[100:103], v[144:147]
  v_mfma_f32_16x16x32_bf16 v[144:147], a[8:11], a[96:99], v[144:147]
  v_mfma_f32_16x16x32_bf16 v[160:163], a[16:19], a[96:99], v[160:163]
  v_mfma_f32_16x16x32_bf16 v[160:163], a[20:23], a[100:103], v[160:163]
  s_add_u32 m0, s64, 32768
  v_mfma_f32_16x16x32_bf16 v[176:179], a[28:31], a[100:103], v[176:179]
  buffer_load_dwordx4 v32, s[20:23], s79 offen offset:0 lds
  v_mfma_f32_16x16x32_bf16 v[176:179], a[24:27], a[96:99], v[176:179]
  s_waitcnt vmcnt(24)
  v_mfma_f32_16x16x32_bf16 v[192:195], a[32:35], a[96:99], v[192:195]
  ds_read_b128 a[104:107], v46 offset:2048
  ds_read_b128 a[108:111], v47 offset:2048
  v_mfma_f32_16x16x32_bf16 v[192:195], a[36:39], a[100:103], v[192:195]
  buffer_store_dwordx4 a[216:219], v1, s[44:47], s93 offen offset:0 sc1
  v_mfma_f32_16x16x32_bf16 v[208:211], a[44:47], a[100:103], v[208:211]
  v_mfma_f32_16x16x32_bf16 v[208:211], a[40:43], a[96:99], v[208:211]
  buffer_load_dwordx4 v33, s[20:23], s79 offen offset:1024 lds
  v_mfma_f32_16x16x32_bf16 v[224:227], a[48:51], a[96:99], v[224:227]
  v_mfma_f32_16x16x32_bf16 v[224:227], a[52:55], a[100:103], v[224:227]
  v_mfma_f32_16x16x32_bf16 v[240:243], a[60:63], a[100:103], v[240:243]
  v_mfma_f32_16x16x32_bf16 v[240:243], a[56:59], a[96:99], v[240:243]
  s_waitcnt vmcnt(22) lgkmcnt(0)
  v_mfma_f32_16x16x32_bf16 v[132:135], a[0:3], a[104:107], v[132:135]
  s_barrier
  ds_read_b64_tr_b16 a[140:141], v48 offset:16384
  ds_read_b64_tr_b16 a[142:143], v48 offset:17408
  v_mfma_f32_16x16x32_bf16 v[132:135], a[4:7], a[108:111], v[132:135]
  v_mfma_f32_16x16x32_bf16 v[148:151], a[12:15], a[108:111], v[148:151]
  v_mfma_f32_16x16x32_bf16 v[148:151], a[8:11], a[104:107], v[148:151]
  ds_read_b64_tr_b16 a[144:145], v48 offset:24576
  ds_read_b64_tr_b16 a[146:147], v48 offset:25600
  v_mfma_f32_16x16x32_bf16 v[164:167], a[16:19], a[104:107], v[164:167]
  v_mfma_f32_16x16x32_bf16 v[164:167], a[20:23], a[108:111], v[164:167]
  s_add_u32 m0, s64, 34816
  ds_read_b64_tr_b16 a[148:149], v48 offset:16392
  ds_read_b64_tr_b16 a[150:151], v48 offset:17416
  v_mfma_f32_16x16x32_bf16 v[180:183], a[28:31], a[108:111], v[180:183]
  buffer_load_dwordx4 v34, s[20:23], s79 offen offset:0 lds
  v_mfma_f32_16x16x32_bf16 v[180:183], a[24:27], a[104:107], v[180:183]
  s_waitcnt vmcnt(20)
  v_mfma_f32_16x16x32_bf16 v[196:199], a[32:35], a[104:107], v[196:199]
  ds_read_b128 a[112:115], v46 offset:4096
  ds_read_b128 a[116:119], v47 offset:4096
  v_mfma_f32_16x16x32_bf16 v[196:199], a[36:39], a[108:111], v[196:199]
  v_mfma_f32_16x16x32_bf16 v[212:215], a[44:47], a[108:111], v[212:215]
  ds_read_b64_tr_b16 a[152:153], v48 offset:24584
  ds_read_b64_tr_b16 a[154:155], v48 offset:25608
  v_mfma_f32_16x16x32_bf16 v[212:215], a[40:43], a[104:107], v[212:215]
  buffer_load_dwordx4 v35, s[20:23], s79 offen offset:1024 lds
  v_mfma_f32_16x16x32_bf16 v[228:231], a[48:51], a[104:107], v[228:231]
  v_mfma_f32_16x16x32_bf16 v[228:231], a[52:55], a[108:111], v[228:231]
  ds_read_b64_tr_b16 a[156:157], v49 offset:16384
  ds_read_b64_tr_b16 a[158:159], v49 offset:17408
  v_mfma_f32_16x16x32_bf16 v[244:247], a[60:63], a[108:111], v[244:247]
  v_mfma_f32_16x16x32_bf16 v[244:247], a[56:59], a[104:107], v[244:247]
  s_waitcnt lgkmcnt(4)
  ds_read_b64_tr_b16 a[160:161], v49 offset:24576
  ds_read_b64_tr_b16 a[162:163], v49 offset:25600
  v_mfma_f32_16x16x32_bf16 v[136:139], a[0:3], a[112:115], v[136:139]
  ds_read_b64_tr_b16 a[164:165], v49 offset:16392
  ds_read_b64_tr_b16 a[166:167], v49 offset:17416
  v_mfma_f32_16x16x32_bf16 v[136:139], a[4:7], a[116:119], v[136:139]
  buffer_store_dwordx4 a[220:223], v1, s[44:47], s93 offen offset:1024 sc1
  v_mfma_f32_16x16x32_bf16 v[152:155], a[12:15], a[116:119], v[152:155]
  v_mfma_f32_16x16x32_bf16 v[152:155], a[8:11], a[112:115], v[152:155]
  ds_read_b64_tr_b16 a[168:169], v49 offset:24584
  ds_read_b64_tr_b16 a[170:171], v49 offset:25608
  v_mfma_f32_16x16x32_bf16 v[168:171], a[16:19], a[112:115], v[168:171]
  v_mfma_f32_16x16x32_bf16 v[168:171], a[20:23], a[116:119], v[168:171]
  s_add_u32 m0, s64, 36864
  ds_read_b64_tr_b16 a[172:173], v50 offset:16384
  ds_read_b64_tr_b16 a[174:175], v50 offset:17408
  v_mfma_f32_16x16x32_bf16 v[184:187], a[28:31], a[116:119], v[184:187]
  buffer_load_dwordx4 v36, s[20:23], s79 offen offset:0 lds
  v_mfma_f32_16x16x32_bf16 v[184:187], a[24:27], a[112:115], v[184:187]
  s_waitcnt vmcnt(21)
  v_mfma_f32_16x16x32_bf16 v[200:203], a[32:35], a[112:115], v[200:203]
  ds_read_b128 a[120:123], v46 offset:6144
  ds_read_b128 a[124:127], v47 offset:6144
  v_mfma_f32_16x16x32_bf16 v[200:203], a[36:39], a[116:119], v[200:203]
  v_mfma_f32_16x16x32_bf16 v[216:219], a[44:47], a[116:119], v[216:219]
  ds_read_b64_tr_b16 a[176:177], v50 offset:24576
  ds_read_b64_tr_b16 a[178:179], v50 offset:25600
  v_mfma_f32_16x16x32_bf16 v[216:219], a[40:43], a[112:115], v[216:219]
  buffer_load_dwordx4 v37, s[20:23], s79 offen offset:1024 lds
  v_mfma_f32_16x16x32_bf16 v[232:235], a[48:51], a[112:115], v[232:235]
  v_mfma_f32_16x16x32_bf16 v[232:235], a[52:55], a[116:119], v[232:235]
  ds_read_b64_tr_b16 a[180:181], v50 offset:16392
  ds_read_b64_tr_b16 a[182:183], v50 offset:17416
  v_mfma_f32_16x16x32_bf16 v[248:251], a[60:63], a[116:119], v[248:251]
  v_mfma_f32_16x16x32_bf16 v[248:251], a[56:59], a[112:115], v[248:251]
  s_waitcnt lgkmcnt(4)
  ds_read_b64_tr_b16 a[184:185], v50 offset:24584
  ds_read_b64_tr_b16 a[186:187], v50 offset:25608
  v_mfma_f32_16x16x32_bf16 v[140:143], a[0:3], a[120:123], v[140:143]
  ds_read_b64_tr_b16 a[188:189], v51 offset:16384
  ds_read_b64_tr_b16 a[190:191], v51 offset:17408
  v_mfma_f32_16x16x32_bf16 v[140:143], a[4:7], a[124:127], v[140:143]
  v_mfma_f32_16x16x32_bf16 v[156:159], a[12:15], a[124:127], v[156:159]
  v_mfma_f32_16x16x32_bf16 v[156:159], a[8:11], a[120:123], v[156:159]
  ds_read_b64_tr_b16 a[192:193], v51 offset:24576
  ds_read_b64_tr_b16 a[194:195], v51 offset:25600
  v_mfma_f32_16x16x32_bf16 v[172:175], a[16:19], a[120:123], v[172:175]
  buffer_load_dword v73, v72, s[52:55], 0 offen sc1
  v_mfma_f32_16x16x32_bf16 v[172:175], a[20:23], a[124:127], v[172:175]
  s_add_u32 m0, s64, 38912
  ds_read_b64_tr_b16 a[196:197], v51 offset:16392
  ds_read_b64_tr_b16 a[198:199], v51 offset:17416
  v_mfma_f32_16x16x32_bf16 v[188:191], a[28:31], a[124:127], v[188:191]
  buffer_load_dwordx4 v38, s[20:23], s79 offen offset:0 lds
  v_mfma_f32_16x16x32_bf16 v[188:191], a[24:27], a[120:123], v[188:191]
  s_waitcnt vmcnt(22)
  v_mfma_f32_16x16x32_bf16 v[204:207], a[32:35], a[120:123], v[204:207]
  ds_read_b128 a[96:99], v44 offset:0
  ds_read_b128 a[100:103], v45 offset:0
  v_mfma_f32_16x16x32_bf16 v[204:207], a[36:39], a[124:127], v[204:207]
  v_mfma_f32_16x16x32_bf16 v[220:223], a[44:47], a[124:127], v[220:223]
  ds_read_b64_tr_b16 a[200:201], v51 offset:24584
  ds_read_b64_tr_b16 a[202:203], v51 offset:25608
  v_mfma_f32_16x16x32_bf16 v[220:223], a[40:43], a[120:123], v[220:223]
  buffer_load_dwordx4 v39, s[20:23], s79 offen offset:1024 lds
  v_mfma_f32_16x16x32_bf16 v[236:239], a[48:51], a[120:123], v[236:239]
  s_xor_b32 s67, s10, 0
  v_mfma_f32_16x16x32_bf16 v[236:239], a[52:55], a[124:127], v[236:239]
  s_add_u32 m0, s63, 0
  v_mfma_f32_16x16x32_bf16 v[252:255], a[60:63], a[124:127], v[252:255]
  buffer_load_dwordx4 v28, s[28:31], s67 offen offset:0 nt lds
  v_mfma_f32_16x16x32_bf16 v[252:255], a[56:59], a[120:123], v[252:255]
  s_waitcnt lgkmcnt(0)
  v_mfma_f32_16x16x32_bf16 v[128:131], a[140:143], a[96:99], v[128:131]
  v_mfma_f32_16x16x32_bf16 v[128:131], a[144:147], a[100:103], v[128:131]
  v_mfma_f32_16x16x32_bf16 v[144:147], a[152:155], a[100:103], v[144:147]
  buffer_load_dwordx4 v28, s[28:31], s67 offen offset:1024 nt lds
  v_mfma_f32_16x16x32_bf16 v[144:147], a[148:151], a[96:99], v[144:147]
  v_mfma_f32_16x16x32_bf16 v[160:163], a[156:159], a[96:99], v[160:163]
  v_mfma_f32_16x16x32_bf16 v[160:163], a[160:163], a[100:103], v[160:163]
  v_mfma_f32_16x16x32_bf16 v[176:179], a[168:171], a[100:103], v[176:179]
  buffer_load_dwordx4 v28, s[28:31], s67 offen offset:2048 nt lds
  v_mfma_f32_16x16x32_bf16 v[176:179], a[164:167], a[96:99], v[176:179]
  s_waitcnt vmcnt(23)
  v_mfma_f32_16x16x32_bf16 v[192:195], a[172:175], a[96:99], v[192:195]
  ds_read_b128 a[104:107], v44 offset:2048
  ds_read_b128 a[108:111], v45 offset:2048
  v_mfma_f32_16x16x32_bf16 v[192:195], a[176:179], a[100:103], v[192:195]
  v_mfma_f32_16x16x32_bf16 v[208:211], a[184:187], a[100:103], v[208:211]
  v_mfma_f32_16x16x32_bf16 v[208:211], a[180:183], a[96:99], v[208:211]
  buffer_load_dwordx4 v28, s[28:31], s67 offen offset:3072 nt lds
  v_mfma_f32_16x16x32_bf16 v[224:227], a[188:191], a[96:99], v[224:227]
  v_mfma_f32_16x16x32_bf16 v[224:227], a[192:195], a[100:103], v[224:227]
  v_mfma_f32_16x16x32_bf16 v[240:243], a[200:203], a[100:103], v[240:243]
  v_mfma_f32_16x16x32_bf16 v[240:243], a[196:199], a[96:99], v[240:243]
  s_waitcnt vmcnt(20) lgkmcnt(0)
  v_mfma_f32_16x16x32_bf16 v[132:135], a[140:143], a[104:107], v[132:135]
  s_barrier
  ds_read_b64_tr_b16 a[0:1], v48 offset:32768
  ds_read_b64_tr_b16 a[2:3], v48 offset:33792
  v_mfma_f32_16x16x32_bf16 v[132:135], a[144:147], a[108:111], v[132:135]
  v_mfma_f32_16x16x32_bf16 v[148:151], a[152:155], a[108:111], v[148:151]
  v_mfma_f32_16x16x32_bf16 v[148:151], a[148:151], a[104:107], v[148:151]
  ds_read_b64_tr_b16 a[4:5], v48 offset:40960
  ds_read_b64_tr_b16 a[6:7], v48 offset:41984
  v_mfma_f32_16x16x32_bf16 v[164:167], a[156:159], a[104:107], v[164:167]
  v_mfma_f32_16x16x32_bf16 v[164:167], a[160:163], a[108:111], v[164:167]
  ds_read_b64_tr_b16 a[8:9], v48 offset:32776
  ds_read_b64_tr_b16 a[10:11], v48 offset:33800
  v_mfma_f32_16x16x32_bf16 v[180:183], a[168:171], a[108:111], v[180:183]
  v_mfma_f32_16x16x32_bf16 v[180:183], a[164:167], a[104:107], v[180:183]
  s_waitcnt vmcnt(17)
  v_mfma_f32_16x16x32_bf16 v[196:199], a[172:175], a[104:107], v[196:199]
  ds_read_b128 a[112:115], v44 offset:4096
  ds_read_b128 a[116:119], v45 offset:4096
  v_mfma_f32_16x16x32_bf16 v[196:199], a[176:179], a[108:111], v[196:199]
  s_xor_b32 s68, s10, 0
  v_mfma_f32_16x16x32_bf16 v[212:215], a[184:187], a[108:111], v[212:215]
  s_add_u32 m0, s63, 65536
  ds_read_b64_tr_b16 a[12:13], v48 offset:40968
  ds_read_b64_tr_b16 a[14:15], v48 offset:41992
  v_mfma_f32_16x16x32_bf16 v[212:215], a[180:183], a[104:107], v[212:215]
  buffer_load_dwordx4 v29, s[32:35], s68 offen offset:0 nt lds
  v_mfma_f32_16x16x32_bf16 v[228:231], a[188:191], a[104:107], v[228:231]
  v_mfma_f32_16x16x32_bf16 v[228:231], a[192:195], a[108:111], v[228:231]
  ds_read_b64_tr_b16 a[16:17], v49 offset:32768
  ds_read_b64_tr_b16 a[18:19], v49 offset:33792
  v_mfma_f32_16x16x32_bf16 v[244:247], a[200:203], a[108:111], v[244:247]
  v_mfma_f32_16x16x32_bf16 v[244:247], a[196:199], a[104:107], v[244:247]
  s_waitcnt lgkmcnt(4)
  ds_read_b64_tr_b16 a[20:21], v49 offset:40960
  ds_read_b64_tr_b16 a[22:23], v49 offset:41984
  v_mfma_f32_16x16x32_bf16 v[136:139], a[140:143], a[112:115], v[136:139]
  ds_read_b64_tr_b16 a[24:25], v49 offset:32776
  ds_read_b64_tr_b16 a[26:27], v49 offset:33800
  v_mfma_f32_16x16x32_bf16 v[136:139], a[144:147], a[116:119], v[136:139]
  v_mfma_f32_16x16x32_bf16 v[152:155], a[152:155], a[116:119], v[152:155]
  v_mfma_f32_16x16x32_bf16 v[152:155], a[148:151], a[112:115], v[152:155]
  ds_read_b64_tr_b16 a[28:29], v49 offset:40968
  ds_read_b64_tr_b16 a[30:31], v49 offset:41992
  v_mfma_f32_16x16x32_bf16 v[168:171], a[156:159], a[112:115], v[168:171]
  v_mfma_f32_16x16x32_bf16 v[168:171], a[160:163], a[116:119], v[168:171]
  ds_read_b64_tr_b16 a[32:33], v50 offset:32768
  ds_read_b64_tr_b16 a[34:35], v50 offset:33792
  v_mfma_f32_16x16x32_bf16 v[184:187], a[168:171], a[116:119], v[184:187]
  v_mfma_f32_16x16x32_bf16 v[184:187], a[164:167], a[112:115], v[184:187]
  s_waitcnt vmcnt(16)
  v_mfma_f32_16x16x32_bf16 v[200:203], a[172:175], a[112:115], v[200:203]
  ds_read_b128 a[120:123], v44 offset:6144
  ds_read_b128 a[124:127], v45 offset:6144
  v_mfma_f32_16x16x32_bf16 v[200:203], a[176:179], a[116:119], v[200:203]
  v_mfma_f32_16x16x32_bf16 v[216:219], a[184:187], a[116:119], v[216:219]
  ds_read_b64_tr_b16 a[36:37], v50 offset:40960
  ds_read_b64_tr_b16 a[38:39], v50 offset:41984
  v_mfma_f32_16x16x32_bf16 v[216:219], a[180:183], a[112:115], v[216:219]
  buffer_load_dwordx4 v29, s[32:35], s68 offen offset:1024 nt lds
  v_mfma_f32_16x16x32_bf16 v[232:235], a[188:191], a[112:115], v[232:235]
  v_mfma_f32_16x16x32_bf16 v[232:235], a[192:195], a[116:119], v[232:235]
  ds_read_b64_tr_b16 a[40:41], v50 offset:32776
  ds_read_b64_tr_b16 a[42:43], v50 offset:33800
  v_mfma_f32_16x16x32_bf16 v[248:251], a[200:203], a[116:119], v[248:251]
  v_mfma_f32_16x16x32_bf16 v[248:251], a[196:199], a[112:115], v[248:251]
  s_waitcnt lgkmcnt(4)
  ds_read_b64_tr_b16 a[44:45], v50 offset:40968
  ds_read_b64_tr_b16 a[46:47], v50 offset:41992
  v_mfma_f32_16x16x32_bf16 v[140:143], a[140:143], a[120:123], v[140:143]
  ds_read_b64_tr_b16 a[48:49], v51 offset:32768
  ds_read_b64_tr_b16 a[50:51], v51 offset:33792
  v_mfma_f32_16x16x32_bf16 v[140:143], a[144:147], a[124:127], v[140:143]
  v_mfma_f32_16x16x32_bf16 v[156:159], a[152:155], a[124:127], v[156:159]
  v_mfma_f32_16x16x32_bf16 v[156:159], a[148:151], a[120:123], v[156:159]
  ds_read_b64_tr_b16 a[52:53], v51 offset:40960
  ds_read_b64_tr_b16 a[54:55], v51 offset:41984
  v_mfma_f32_16x16x32_bf16 v[172:175], a[156:159], a[120:123], v[172:175]
  v_mfma_f32_16x16x32_bf16 v[172:175], a[160:163], a[124:127], v[172:175]
  ds_read_b64_tr_b16 a[56:57], v51 offset:32776
  ds_read_b64_tr_b16 a[58:59], v51 offset:33800
  v_mfma_f32_16x16x32_bf16 v[188:191], a[168:171], a[124:127], v[188:191]
  v_mfma_f32_16x16x32_bf16 v[188:191], a[164:167], a[120:123], v[188:191]
  s_waitcnt vmcnt(14)
  v_mfma_f32_16x16x32_bf16 v[204:207], a[172:175], a[120:123], v[204:207]
  ds_read_b128 a[96:99], v46 offset:0
  ds_read_b128 a[100:103], v47 offset:0
  v_mfma_f32_16x16x32_bf16 v[204:207], a[176:179], a[124:127], v[204:207]
  v_mfma_f32_16x16x32_bf16 v[220:223], a[184:187], a[124:127], v[220:223]
  ds_read_b64_tr_b16 a[60:61], v51 offset:40968
  ds_read_b64_tr_b16 a[62:63], v51 offset:41992
  v_mfma_f32_16x16x32_bf16 v[220:223], a[180:183], a[120:123], v[220:223]
  buffer_load_dwordx4 v29, s[32:35], s68 offen offset:2048 nt lds
  v_mfma_f32_16x16x32_bf16 v[236:239], a[188:191], a[120:123], v[236:239]
  v_mfma_f32_16x16x32_bf16 v[236:239], a[192:195], a[124:127], v[236:239]
  v_mfma_f32_16x16x32_bf16 v[252:255], a[200:203], a[124:127], v[252:255]
  v_mfma_f32_16x16x32_bf16 v[252:255], a[196:199], a[120:123], v[252:255]
  s_waitcnt lgkmcnt(0)
  v_mfma_f32_16x16x32_bf16 v[128:131], a[0:3], a[96:99], v[128:131]
  v_mfma_f32_16x16x32_bf16 v[128:131], a[4:7], a[100:103], v[128:131]
  v_mfma_f32_16x16x32_bf16 v[144:147], a[12:15], a[100:103], v[144:147]
  v_mfma_f32_16x16x32_bf16 v[144:147], a[8:11], a[96:99], v[144:147]
  s_waitcnt vmcnt(9)
  v_mfma_f32_16x16x32_bf16 v[160:163], a[16:19], a[96:99], v[160:163]
  v_cmp_ne_u32 vcc, 1, v73
  v_mfma_f32_16x16x32_bf16 v[160:163], a[20:23], a[100:103], v[160:163]
  v_mfma_f32_16x16x32_bf16 v[176:179], a[28:31], a[100:103], v[176:179]
  v_mfma_f32_16x16x32_bf16 v[176:179], a[24:27], a[96:99], v[176:179]
  s_waitcnt vmcnt(13)
  v_mfma_f32_16x16x32_bf16 v[192:195], a[32:35], a[96:99], v[192:195]
  s_cmp_eq_u64 vcc, 0
  ds_read_b128 a[104:107], v46 offset:2048
  ds_read_b128 a[108:111], v47 offset:2048
  v_mfma_f32_16x16x32_bf16 v[192:195], a[36:39], a[100:103], v[192:195]
  s_cbranch_scc0 L_spin_ini
L_back_ini:
  v_mfma_f32_16x16x32_bf16 v[208:211], a[44:47], a[100:103], v[208:211]
  v_mfma_f32_16x16x32_bf16 v[208:211], a[40:43], a[96:99], v[208:211]
  buffer_load_dwordx4 v29, s[32:35], s68 offen offset:3072 nt lds
  v_mfma_f32_16x16x32_bf16 v[224:227], a[48:51], a[96:99], v[224:227]
  v_mul_f32 v128, s69, v128
  v_mul_f32 v144, s69, v144
  v_mul_f32 v129, s69, v129
  v_mul_f32 v145, s69, v145
  v_mfma_f32_16x16x32_bf16 v[224:227], a[52:55], a[100:103], v[224:227]
  v_mul_f32 v130, s69, v130
  v_mul_f32 v146, s69, v146
  v_mul_f32 v131, s69, v131
  v_mul_f32 v147, s69, v147
  v_mfma_f32_16x16x32_bf16 v[240:243], a[60:63], a[100:103], v[240:243]
  v_cvt_pk_bf16_f32 v128, v128, v129
  v_cvt_pk_bf16_f32 v129, v130, v131
  v_cvt_pk_bf16_f32 v130, v144, v145
  v_cvt_pk_bf16_f32 v131, v146, v147
  v_mfma_f32_16x16x32_bf16 v[240:243], a[56:59], a[96:99], v[240:243]
  s_waitcnt lgkmcnt(0)
  v_mul_f32 v160, s69, v160
  v_mul_f32 v176, s69, v176
  v_mul_f32 v161, s69, v161
  v_mul_f32 v177, s69, v177
  v_mfma_f32_16x16x32_bf16 v[132:135], a[0:3], a[104:107], v[132:135]
  v_mul_f32 v162, s69, v162
  v_mul_f32 v178, s69, v178
  v_mul_f32 v163, s69, v163
  v_mul_f32 v179, s69, v179
  v_mfma_f32_16x16x32_bf16 v[132:135], a[4:7], a[108:111], v[132:135]
  v_cvt_pk_bf16_f32 v160, v160, v161
  v_cvt_pk_bf16_f32 v161, v162, v163
  v_cvt_pk_bf16_f32 v162, v176, v177
  v_cvt_pk_bf16_f32 v163, v178, v179
  v_mfma_f32_16x16x32_bf16 v[148:151], a[12:15], a[108:111], v[148:151]
  v_mul_f32 v192, s69, v192
  v_mul_f32 v208, s69, v208
  v_mul_f32 v193, s69, v193
  v_mul_f32 v209, s69, v209
  v_mfma_f32_16x16x32_bf16 v[148:151], a[8:11], a[104:107], v[148:151]
L_hop2:
  s_cbranch_execz L_hop6
  v_mul_f32 v194, s69, v194
  v_mul_f32 v210, s69, v210
  v_mul_f32 v195, s69, v195
  v_mul_f32 v211, s69, v211
  v_mfma_f32_16x16x32_bf16 v[164:167], a[16:19], a[104:107], v[164:167]
  v_cvt_pk_bf16_f32 v192, v192, v193
  v_cvt_pk_bf16_f32 v193, v194, v195
  v_cvt_pk_bf16_f32 v194, v208, v209
  v_cvt_pk_bf16_f32 v195, v210, v211
  v_mfma_f32_16x16x32_bf16 v[164:167], a[20:23], a[108:111], v[164:167]
  v_mul_f32 v224, s69, v224
  v_mul_f32 v240, s69, v240
  v_mul_f32 v225, s69, v225
  v_mul_f32 v241, s69, v241
  v_mfma_f32_16x16x32_bf16 v[180:183], a[28:31], a[108:111], v[180:183]
  v_mul_f32 v226, s69, v226
  v_mul_f32 v242, s69, v242
  v_mul_f32 v227, s69, v227
  v_mul_f32 v243, s69, v243
  v_mfma_f32_16x16x32_bf16 v[180:183], a[24:27], a[104:107], v[180:183]
  s_waitcnt vmcnt(11)
  v_cvt_pk_bf16_f32 v224, v224, v225
  v_cvt_pk_bf16_f32 v225, v226, v227
  v_cvt_pk_bf16_f32 v226, v240, v241
  v_cvt_pk_bf16_f32 v227, v242, v243
  v_mfma_f32_16x16x32_bf16 v[196:199], a[32:35], a[104:107], v[196:199]
  ds_read_b128 a[112:115], v46 offset:4096
  ds_read_b128 a[116:119], v47 offset:4096
  v_mfma_f32_16x16x32_bf16 v[196:199], a[36:39], a[108:111], v[196:199]
  s_xor_b32 s67, s10, 4096
  v_mfma_f32_16x16x32_bf16 v[212:215], a[44:47], a[108:111], v[212:215]
  s_add_u32 m0, s63, 16384
  v_mfma_f32_16x16x32_bf16 v[212:215], a[40:43], a[104:107], v[212:215]
  buffer_load_dwordx4 v28, s[28:31], s67 offen offset:0 nt lds
  v_mfma_f32_16x16x32_bf16 v[228:231], a[48:51], a[104:107], v[228:231]
  v_mul_f32 v132, s69, v132
  v_mul_f32 v148, s69, v148
  v_mul_f32 v133, s69, v133
  v_mul_f32 v149, s69, v149
  v_mfma_f32_16x16x32_bf16 v[228:231], a[52:55], a[108:111], v[228:231]
  v_mul_f32 v134, s69, v134
  v_mul_f32 v150, s69, v150
  v_mul_f32 v135, s69, v135
  v_mul_f32 v151, s69, v151
  v_mfma_f32_16x16x32_bf16 v[244:247], a[60:63], a[108:111], v[244:247]
  v_cvt_pk_bf16_f32 v132, v132, v133
  v_cvt_pk_bf16_f32 v133, v134, v135
  v_cvt_pk_bf16_f32 v134, v148, v149
  v_cvt_pk_bf16_f32 v135, v150, v151
  v_mfma_f32_16x16x32_bf16 v[244:247], a[56:59], a[104:107], v[244:247]
  s_waitcnt lgkmcnt(0)
  v_mul_f32 v164, s69, v164
  v_mul_f32 v180, s69, v180
  v_mul_f32 v165, s69, v165
  v_mul_f32 v181, s69, v181
  v_mfma_f32_16x16x32_bf16 v[136:139], a[0:3], a[112:115], v[136:139]
  v_mul_f32 v166, s69, v166
  v_mul_f32 v182, s69, v182
  v_mul_f32 v167, s69, v167
  v_mul_f32 v183, s69, v183
  v_mfma_f32_16x16x32_bf16 v[136:139], a[4:7], a[116:119], v[136:139]
  v_cvt_pk_bf16_f32 v164, v164, v165
  v_cvt_pk_bf16_f32 v165, v166, v167
  v_cvt_pk_bf16_f32 v166, v180, v181
  v_cvt_pk_bf16_f32 v167, v182, v183
  v_mfma_f32_16x16x32_bf16 v[152:155], a[12:15], a[116:119], v[152:155]
  v_mul_f32 v196, s69, v196
  v_mul_f32 v212, s69, v212
  v_mul_f32 v197, s69, v197
  v_mul_f32 v213, s69, v213
  v_mfma_f32_16x16x32_bf16 v[152:155], a[8:11], a[112:115], v[152:155]
  v_mul_f32 v198, s69, v198
  v_mul_f32 v214, s69, v214
  v_mul_f32 v199, s69, v199
  v_mul_f32 v215, s69, v215
  v_mfma_f32_16x16x32_bf16 v[168:171], a[16:19], a[112:115], v[168:171]
  v_cvt_pk_bf16_f32 v196, v196, v197
  v_cvt_pk_bf16_f32 v197, v198, v199
  v_cvt_pk_bf16_f32 v198, v212, v213
  v_cvt_pk_bf16_f32 v199, v214, v215
  v_mfma_f32_16x16x32_bf16 v[168:171], a[20:23], a[116:119], v[168:171]
  v_mul_f32 v228, s69, v228
  v_mul_f32 v244, s69, v244
  v_mul_f32 v229, s69, v229
  v_mul_f32 v245, s69, v245
  v_mfma_f32_16x16x32_bf16 v[184:187], a[28:31], a[116:119], v[184:187]
  v_mul_f32 v230, s69, v230
  v_mul_f32 v246, s69, v246
  v_mul_f32 v231, s69, v231
  v_mul_f32 v247, s69, v247
  v_mfma_f32_16x16x32_bf16 v[184:187], a[24:27], a[112:115], v[184:187]
  s_waitcnt vmcnt(9)
  v_cvt_pk_bf16_f32 v228, v228, v229
  v_cvt_pk_bf16_f32 v229, v230, v231
  v_cvt_pk_bf16_f32 v230, v244, v245
  v_cvt_pk_bf16_f32 v231, v246, v247
  v_mfma_f32_16x16x32_bf16 v[200:203], a[32:35], a[112:115], v[200:203]
  ds_read_b128 a[120:123], v46 offset:6144
  ds_read_b128 a[124:127], v47 offset:6144
  v_mfma_f32_16x16x32_bf16 v[200:203], a[36:39], a[116:119], v[200:203]
  v_mfma_f32_16x16x32_bf16 v[216:219], a[44:47], a[116:119], v[216:219]
  v_mfma_f32_16x16x32_bf16 v[216:219], a[40:43], a[112:115], v[216:219]
  buffer_load_dwordx4 v28, s[28:31], s67 offen offset:1024 nt lds
  v_mfma_f32_16x16x32_bf16 v[232:235], a[48:51], a[112:115], v[232:235]
  v_mul_f32 v136, s69, v136
  v_mul_f32 v152, s69, v152
  v_mul_f32 v137, s69, v137
  v_mul_f32 v153, s69, v153
  v_mfma_f32_16x16x32_bf16 v[232:235], a[52:55], a[116:119], v[232:235]
  v_mul_f32 v138, s69, v138
  v_mul_f32 v154, s69, v154
  v_mul_f32 v139, s69, v139
  v_mul_f32 v155, s69, v155
  v_mfma_f32_16x16x32_bf16 v[248:251], a[60:63], a[116:119], v[248:251]
  s_waitcnt vmcnt(6)
  v_cvt_pk_bf16_f32 v136, v136, v137
  v_cvt_pk_bf16_f32 v137, v138, v139
  v_cvt_pk_bf16_f32 v138, v152, v153
  v_cvt_pk_bf16_f32 v139, v154, v155
  v_mfma_f32_16x16x32_bf16 v[248:251], a[56:59], a[112:115], v[248:251]
  s_waitcnt lgkmcnt(0)
  v_mul_f32 v168, s69, v168
  v_mul_f32 v184, s69, v184
  v_mul_f32 v169, s69, v169
  v_mul_f32 v185, s69, v185
  v_mfma_f32_16x16x32_bf16 v[140:143], a[0:3], a[120:123], v[140:143]
  s_barrier
  ds_read_b128 a[64:67], v16 offset:0
  v_mul_f32 v170, s69, v170
  v_mul_f32 v186, s69, v186
  v_mul_f32 v171, s69, v171
  v_mul_f32 v187, s69, v187
  v_mfma_f32_16x16x32_bf16 v[140:143], a[4:7], a[124:127], v[140:143]
  ds_read_b128 a[68:71], v17 offset:0
  v_cvt_pk_bf16_f32 v168, v168, v169
  v_cvt_pk_bf16_f32 v169, v170, v171
  v_cvt_pk_bf16_f32 v170, v184, v185
  v_cvt_pk_bf16_f32 v171, v186, v187
  v_mfma_f32_16x16x32_bf16 v[156:159], a[12:15], a[124:127], v[156:159]
  ds_read_b128 a[72:75], v18 offset:0
  v_mul_f32 v200, s69, v200
  v_mul_f32 v216, s69, v216
  v_mul_f32 v201, s69, v201
  v_mul_f32 v217, s69, v217
  v_mfma_f32_16x16x32_bf16 v[156:159], a[8:11], a[120:123], v[156:159]
  ds_read_b128 a[76:79], v19 offset:0
  v_mul_f32 v202, s69, v202
  v_mul_f32 v218, s69, v218
  v_mul_f32 v203, s69, v203
  v_mul_f32 v219, s69, v219
  v_mfma_f32_16x16x32_bf16 v[172:175], a[16:19], a[120:123], v[172:175]
  ds_read_b128 a[80:83], v16 offset:1024
  v_cvt_pk_bf16_f32 v200, v200, v201
  v_cvt_pk_bf16_f32 v201, v202, v203
  v_cvt_pk_bf16_f32 v202, v216, v217
  v_cvt_pk_bf16_f32 v203, v218, v219
  v_mfma_f32_16x16x32_bf16 v[172:175], a[20:23], a[124:127], v[172:175]
  ds_read_b128 a[84:87], v17 offset:1024
  v_mul_f32 v232, s69, v232
  v_mul_f32 v248, s69, v248
  v_mul_f32 v233, s69, v233
  v_mul_f32 v249, s69, v249
  v_mfma_f32_16x16x32_bf16 v[188:191], a[28:31], a[124:127], v[188:191]
  ds_read_b128 a[88:91], v18 offset:1024
  v_mul_f32 v234, s69, v234
  v_mul_f32 v250, s69, v250
  v_mul_f32 v235, s69, v235
  v_mul_f32 v251, s69, v251
  v_mfma_f32_16x16x32_bf16 v[188:191], a[24:27], a[120:123], v[188:191]
  ds_read_b128 a[92:95], v19 offset:1024
  v_cvt_pk_bf16_f32 v232, v232, v233
  v_cvt_pk_bf16_f32 v233, v234, v235
  v_cvt_pk_bf16_f32 v234, v248, v249
  v_cvt_pk_bf16_f32 v235, v250, v251
  v_mfma_f32_16x16x32_bf16 v[204:207], a[32:35], a[120:123], v[204:207]
  v_mfma_f32_16x16x32_bf16 v[204:207], a[36:39], a[124:127], v[204:207]
  v_mfma_f32_16x16x32_bf16 v[220:223], a[44:47], a[124:127], v[220:223]
  v_mfma_f32_16x16x32_bf16 v[220:223], a[40:43], a[120:123], v[220:223]
  buffer_load_dwordx4 v28, s[28:31], s67 offen offset:2048 nt lds
  v_mfma_f32_16x16x32_bf16 v[236:239], a[48:51], a[120:123], v[236:239]
  v_mul_f32 v140, s69, v140
  v_mul_f32 v156, s69, v156
  v_mul_f32 v141, s69, v141
  v_mfma_f32_16x16x32_bf16 v[236:239], a[52:55], a[124:127], v[236:239]
  v_mul_f32 v157, s69, v157
  v_mul_f32 v142, s69, v142
  v_mul_f32 v158, s69, v158
  v_mfma_f32_16x16x32_bf16 v[252:255], a[60:63], a[124:127], v[252:255]
  v_mul_f32 v143, s69, v143
  v_mul_f32 v159, s69, v159
  v_cvt_pk_bf16_f32 v140, v140, v141
  v_mfma_f32_16x16x32_bf16 v[252:255], a[56:59], a[120:123], v[252:255]
  v_cvt_pk_bf16_f32 v141, v142, v143
  v_cvt_pk_bf16_f32 v142, v156, v157
  v_cvt_pk_bf16_f32 v143, v158, v159
  s_waitcnt lgkmcnt(0)
  v_mfma_f32_16x16x32_bf16 v[96:99], a[64:67], v[128:131], 0
  v_mul_f32 v172, s69, v172
  v_mul_f32 v188, s69, v188
  v_mfma_f32_16x16x32_bf16 v[96:99], a[68:71], v[160:163], v[96:99]
  v_mul_f32 v173, s69, v173
  v_mul_f32 v189, s69, v189
  v_mul_f32 v174, s69, v174
  v_mfma_f32_16x16x32_bf16 v[96:99], a[72:75], v[192:195], v[96:99]
  v_mul_f32 v190, s69, v190
  v_mul_f32 v175, s69, v175
  v_mfma_f32_16x16x32_bf16 v[96:99], a[76:79], v[224:227], v[96:99]
  v_mul_f32 v191, s69, v191
  v_cvt_pk_bf16_f32 v172, v172, v173
  v_cvt_pk_bf16_f32 v173, v174, v175
  v_mfma_f32_16x16x32_bf16 v[100:103], a[64:67], v[132:135], 0
  v_cvt_pk_bf16_f32 v174, v188, v189
  v_cvt_pk_bf16_f32 v175, v190, v191
  v_mfma_f32_16x16x32_bf16 v[100:103], a[68:71], v[164:167], v[100:103]
  buffer_load_dwordx4 v28, s[28:31], s67 offen offset:3072 nt lds
  v_mul_f32 v204, s69, v204
  v_mul_f32 v220, s69, v220
  v_mul_f32 v205, s69, v205
  v_mfma_f32_16x16x32_bf16 v[100:103], a[72:75], v[196:199], v[100:103]
  v_mul_f32 v221, s69, v221
  v_mul_f32 v206, s69, v206
  v_mfma_f32_16x16x32_bf16 v[100:103], a[76:79], v[228:231], v[100:103]
  v_mul_f32 v222, s69, v222
  v_mul_f32 v207, s69, v207
  v_mul_f32 v223, s69, v223
  v_mfma_f32_16x16x32_bf16 v[104:107], a[64:67], v[136:139], 0
  v_cvt_pk_bf16_f32 v204, v204, v205
  v_cvt_pk_bf16_f32 v205, v206, v207
  v_mfma_f32_16x16x32_bf16 v[104:107], a[68:71], v[168:171], v[104:107]
  v_cvt_pk_bf16_f32 v206, v220, v221
  v_cvt_pk_bf16_f32 v207, v222, v223
  v_mul_f32 v236, s69, v236
  v_mfma_f32_16x16x32_bf16 v[104:107], a[72:75], v[200:203], v[104:107]
  v_mul_f32 v252, s69, v252
  v_mul_f32 v237, s69, v237
  v_mfma_f32_16x16x32_bf16 v[104:107], a[76:79], v[232:235], v[104:107]
  s_xor_b32 s68, s10, 4096
  s_add_u32 m0, s63, 81920
  s_nop 0
  buffer_load_dwordx4 v29, s[32:35], s68 offen offset:0 nt lds
  v_mul_f32 v253, s69, v253
  v_mul_f32 v238, s69, v238
  v_mul_f32 v254, s69, v254
  v_mul_f32 v239, s69, v239
  v_mul_f32 v255, s69, v255
  v_cvt_pk_bf16_f32 v236, v236, v237
  v_cvt_pk_bf16_f32 v237, v238, v239
  v_cvt_pk_bf16_f32 v238, v252, v253
  v_cvt_pk_bf16_f32 v239, v254, v255
  v_max3_f32 v2, v96, v97, v98
  v_max3_f32 v4, v100, v101, v102
  v_mfma_f32_16x16x32_bf16 v[108:111], a[64:67], v[140:143], 0
  v_max3_f32 v6, v104, v105, v106
  v_max_f32 v2, v2, v99
  v_max_f32 v4, v4, v103
  v_max_f32 v6, v6, v107
  v_max_f32 v3, v2, v2
  v_max_f32 v5, v4, v4
  v_max_f32 v7, v6, v6
  v_permlane32_swap_b32 v2, v3
  v_permlane32_swap_b32 v4, v5
  v_permlane32_swap_b32 v6, v7
  v_max_f32 v2, v2, v3
  v_max_f32 v4, v4, v5
  v_max_f32 v6, v6, v7
  v_mfma_f32_16x16x32_bf16 v[108:111], a[68:71], v[172:175], v[108:111]
  buffer_load_dwordx4 v29, s[32:35], s68 offen offset:1024 nt lds
  v_max_f32 v3, v2, v2
  v_max_f32 v5, v4, v4
  v_max_f32 v7, v6, v6
  v_permlane16_swap_b32 v2, v3
  v_permlane16_swap_b32 v4, v5
  v_permlane16_swap_b32 v6, v7
  v_max_f32 v2, v2, v3
  v_sub_f32 v112, -4.0, v2
  v_sub_f32 v113, -4.0, v2
  v_sub_f32 v114, -4.0, v2
  v_sub_f32 v115, -4.0, v2
  v_max_f32 v4, v4, v5
  v_sub_f32 v116, -4.0, v4
  v_mfma_f32_16x16x32_bf16 v[108:111], a[72:75], v[204:207], v[108:111]
  v_sub_f32 v117, -4.0, v4
  v_sub_f32 v118, -4.0, v4
  v_sub_f32 v119, -4.0, v4
  v_max_f32 v6, v6, v7
  v_sub_f32 v120, -4.0, v6
  v_sub_f32 v121, -4.0, v6
  v_sub_f32 v122, -4.0, v6
  v_sub_f32 v123, -4.0, v6
  v_add_f32 v96, v96, v112
  v_add_f32 v97, v97, v112
  v_add_f32 v98, v98, v112
  v_add_f32 v99, v99, v112
  v_add_f32 v100, v100, v116
  v_mfma_f32_16x16x32_bf16 v[108:111], a[76:79], v[236:239], v[108:111]
  buffer_load_dwordx4 v29, s[32:35], s68 offen offset:2048 nt lds
  v_add_f32 v101, v101, v116
  v_add_f32 v102, v102, v116
  v_add_f32 v103, v103, v116
  v_add_f32 v104, v104, v120
  v_add_f32 v105, v105, v120
  v_add_f32 v106, v106, v120
  v_add_f32 v107, v107, v120
  v_exp_f32 v96, v96
  v_exp_f32 v97, v97
  v_exp_f32 v98, v98
  v_exp_f32 v99, v99
  v_cvt_pk_bf16_f32 v32, v96, v97
  v_cvt_pk_bf16_f32 v33, v98, v99
  s_getpc_b64 s[74:75]
L_pc2:
  s_add_u32 s74, s74, L_tail-L_pc2
  s_addc_u32 s75, s75, 0
  v_mfma_f32_16x16x32_bf16 v[96:99], a[80:83], v[128:131], v[112:115]
  ds_read_b128 a[64:67], v16 offset:2048
  v_exp_f32 v100, v100
  v_exp_f32 v101, v101
  v_mfma_f32_16x16x32_bf16 v[96:99], a[84:87], v[160:163], v[96:99]
  v_exp_f32 v102, v102
  v_exp_f32 v103, v103
  v_mfma_f32_16x16x32_bf16 v[96:99], a[88:91], v[192:195], v[96:99]
  v_cvt_pk_bf16_f32 v40, v100, v101
  v_cvt_pk_bf16_f32 v41, v102, v103
  v_mfma_f32_16x16x32_bf16 v[96:99], a[92:95], v[224:227], v[96:99]
  v_mfma_f32_16x16x32_bf16 v[100:103], a[80:83], v[132:135], v[116:119]
  ds_read_b128 a[68:71], v17 offset:2048
  v_max3_f32 v2, v108, v109, v110
  v_max_f32 v2, v2, v111
  v_max_f32 v3, v2, v2
  s_nop 1
  v_permlane32_swap_b32 v2, v3
  v_max_f32 v2, v2, v3
  v_mfma_f32_16x16x32_bf16 v[100:103], a[84:87], v[164:167], v[100:103]
  v_max_f32 v3, v2, v2
  s_nop 1
  v_permlane16_swap_b32 v2, v3
  v_max_f32 v2, v2, v3
  v_sub_f32 v124, -4.0, v2
  v_sub_f32 v125, -4.0, v2
  v_mfma_f32_16x16x32_bf16 v[100:103], a[88:91], v[196:199], v[100:103]
  v_sub_f32 v126, -4.0, v2
  v_sub_f32 v127, -4.0, v2
  v_add_f32 v108, v108, v124
  v_add_f32 v109, v109, v124
  v_add_f32 v110, v110, v124
  v_add_f32 v111, v111, v124
  v_mfma_f32_16x16x32_bf16 v[100:103], a[92:95], v[228:231], v[100:103]
  v_exp_f32 v104, v104
  v_exp_f32 v105, v105
  v_exp_f32 v106, v106
  v_exp_f32 v107, v107
  v_cvt_pk_bf16_f32 v48, v104, v105
  v_cvt_pk_bf16_f32 v49, v106, v107
  v_mfma_f32_16x16x32_bf16 v[104:107], a[80:83], v[136:139], v[120:123]
  ds_read_b128 a[72:75], v18 offset:2048
  v_exp_f32 v108, v108
  v_exp_f32 v109, v109
  v_mfma_f32_16x16x32_bf16 v[104:107], a[84:87], v[168:171], v[104:107]
  buffer_load_dwordx4 v29, s[32:35], s68 offen offset:3072 nt lds
  v_exp_f32 v110, v110
  v_exp_f32 v111, v111
  v_mfma_f32_16x16x32_bf16 v[104:107], a[88:91], v[200:203], v[104:107]
  v_cvt_pk_bf16_f32 v56, v108, v109
  v_cvt_pk_bf16_f32 v57, v110, v111
  v_mfma_f32_16x16x32_bf16 v[104:107], a[92:95], v[232:235], v[104:107]
  v_mfma_f32_16x16x32_bf16 v[108:111], a[80:83], v[140:143], v[124:127]
  ds_read_b128 a[76:79], v19 offset:2048
  v_exp_f32 v96, v96
  v_exp_f32 v97, v97
  v_mfma_f32_16x16x32_bf16 v[108:111], a[84:87], v[172:175], v[108:111]
  v_exp_f32 v98, v98
  v_exp_f32 v99, v99
  v_mfma_f32_16x16x32_bf16 v[108:111], a[88:91], v[204:207], v[108:111]
  v_cvt_pk_bf16_f32 v34, v96, v97
  v_cvt_pk_bf16_f32 v35, v98, v99
  v_mfma_f32_16x16x32_bf16 v[108:111], a[92:95], v[236:239], v[108:111]
  s_waitcnt lgkmcnt(0)
  v_mfma_f32_16x16x32_bf16 v[96:99], a[64:67], v[128:131], v[112:115]
  ds_read_b128 a[80:83], v16 offset:3072
  v_exp_f32 v100, v100
  v_exp_f32 v101, v101
  v_mfma_f32_16x16x32_bf16 v[96:99], a[68:71], v[160:163], v[96:99]
  v_exp_f32 v102, v102
  v_exp_f32 v103, v103
  v_mfma_f32_16x16x32_bf16 v[96:99], a[72:75], v[192:195], v[96:99]
  v_cvt_pk_bf16_f32 v42, v100, v101
  v_cvt_pk_bf16_f32 v43, v102, v103
  v_mfma_f32_16x16x32_bf16 v[96:99], a[76:79], v[224:227], v[96:99]
  v_mfma_f32_16x16x32_bf16 v[100:103], a[64:67], v[132:135], v[116:119]
  ds_read_b128 a[84:87], v17 offset:3072
  v_exp_f32 v104, v104
  v_exp_f32 v105, v105
  v_mfma_f32_16x16x32_bf16 v[100:103], a[68:71], v[164:167], v[100:103]
  s_xor_b32 s67, s10, 16384
  s_add_u32 m0, s63, 32768
  s_nop 0
  buffer_load_dwordx4 v28, s[28:31], s67 offen offset:0 nt lds
  v_exp_f32 v106, v106
  v_exp_f32 v107, v107
  v_mfma_f32_16x16x32_bf16 v[100:103], a[72:75], v[196:199], v[100:103]
  v_cvt_pk_bf16_f32 v50, v104, v105
  v_cvt_pk_bf16_f32 v51, v106, v107
  v_mfma_f32_16x16x32_bf16 v[100:103], a[76:79], v[228:231], v[100:103]
  v_mfma_f32_16x16x32_bf16 v[104:107], a[64:67], v[136:139], v[120:123]
  ds_read_b128 a[88:91], v18 offset:3072
  v_exp_f32 v108, v108
  v_exp_f32 v109, v109
  v_mfma_f32_16x16x32_bf16 v[104:107], a[68:71], v[168:171], v[104:107]
  v_exp_f32 v110, v110
  v_exp_f32 v111, v111
  v_mfma_f32_16x16x32_bf16 v[104:107], a[72:75], v[200:203], v[104:107]
  v_cvt_pk_bf16_f32 v58, v108, v109
  v_cvt_pk_bf16_f32 v59, v110, v111
  v_mfma_f32_16x16x32_bf16 v[104:107], a[76:79], v[232:235], v[104:107]
  v_mfma_f32_16x16x32_bf16 v[108:111], a[64:67], v[140:143], v[124:127]
  ds_read_b128 a[92:95], v19 offset:3072
  v_exp_f32 v96, v96
  v_exp_f32 v97, v97
  v_mfma_f32_16x16x32_bf16 v[108:111], a[68:71], v[172:175], v[108:111]
  buffer_load_dwordx4 v28, s[28:31], s67 offen offset:1024 nt lds
  v_exp_f32 v98, v98
  v_exp_f32 v99, v99
  v_mfma_f32_16x16x32_bf16 v[108:111], a[72:75], v[204:207], v[108:111]
  v_cvt_pk_bf16_f32 v36, v96, v97
  v_cvt_pk_bf16_f32 v37, v98, v99
  v_mfma_f32_16x16x32_bf16 v[108:111], a[76:79], v[236:239], v[108:111]
  s_waitcnt vmcnt(6)
  s_barrier
  s_waitcnt lgkmcnt(0)
  v_mfma_f32_16x16x32_bf16 v[96:99], a[80:83], v[128:131], v[112:115]
  ds_read_b128 a[64:67], v16 offset:16384
  v_exp_f32 v100, v100
  v_exp_f32 v101, v101
  v_mfma_f32_16x16x32_bf16 v[96:99], a[84:87], v[160:163], v[96:99]
  ds_read_b64_tr_b16 a[96:97], v20 offset:0
  v_exp_f32 v102, v102
  v_exp_f32 v103, v103
  v_mfma_f32_16x16x32_bf16 v[96:99], a[88:91], v[192:195], v[96:99]
  ds_read_b64_tr_b16 a[98:99], v20 offset:1024
  v_cvt_pk_bf16_f32 v44, v100, v101
  v_cvt_pk_bf16_f32 v45, v102, v103
  v_mfma_f32_16x16x32_bf16 v[96:99], a[92:95], v[224:227], v[96:99]
  v_mfma_f32_16x16x32_bf16 v[100:103], a[80:83], v[132:135], v[116:119]
  ds_read_b128 a[68:71], v17 offset:16384
  v_exp_f32 v104, v104
  v_exp_f32 v105, v105
  v_mfma_f32_16x16x32_bf16 v[100:103], a[84:87], v[164:167], v[100:103]
  ds_read_b64_tr_b16 a[100:101], v20 offset:2048
  v_exp_f32 v106, v106
  v_exp_f32 v107, v107
  v_mfma_f32_16x16x32_bf16 v[100:103], a[88:91], v[196:199], v[100:103]
  ds_read_b64_tr_b16 a[102:103], v20 offset:3072
  v_cvt_pk_bf16_f32 v52, v104, v105
  v_cvt_pk_bf16_f32 v53, v106, v107
  v_mfma_f32_16x16x32_bf16 v[100:103], a[92:95], v[228:231], v[100:103]
  v_mfma_f32_16x16x32_bf16 v[104:107], a[80:83], v[136:139], v[120:123]
  ds_read_b128 a[72:75], v18 offset:16384
  v_exp_f32 v108, v108
  v_exp_f32 v109, v109
  v_mfma_f32_16x16x32_bf16 v[104:107], a[84:87], v[168:171], v[104:107]
  ds_read_b64_tr_b16 a[104:105], v21 offset:0
  v_exp_f32 v110, v110
  v_exp_f32 v111, v111
  v_mfma_f32_16x16x32_bf16 v[104:107], a[88:91], v[200:203], v[104:107]
  ds_read_b64_tr_b16 a[106:107], v21 offset:1024
  v_cvt_pk_bf16_f32 v60, v108, v109
  v_cvt_pk_bf16_f32 v61, v110, v111
  v_mfma_f32_16x16x32_bf16 v[104:107], a[92:95], v[232:235], v[104:107]
  v_mfma_f32_16x16x32_bf16 v[108:111], a[80:83], v[140:143], v[124:127]
  ds_read_b128 a[76:79], v19 offset:16384
  v_exp_f32 v96, v96
  v_exp_f32 v97, v97
  v_mfma_f32_16x16x32_bf16 v[108:111], a[84:87], v[172:175], v[108:111]
  ds_read_b64_tr_b16 a[108:109], v21 offset:2048
  v_exp_f32 v98, v98
  v_exp_f32 v99, v99
  v_mfma_f32_16x16x32_bf16 v[108:111], a[88:91], v[204:207], v[108:111]
  ds_read_b64_tr_b16 a[110:111], v21 offset:3072
  v_cvt_pk_bf16_f32 v38, v96, v97
  v_cvt_pk_bf16_f32 v39, v98, v99
  v_mfma_f32_16x16x32_bf16 v[108:111], a[92:95], v[236:239], v[108:111]
  v_exp_f32 v100, v100
  v_exp_f32 v101, v101
  v_exp_f32 v102, v102
  v_exp_f32 v103, v103
  v_cvt_pk_bf16_f32 v46, v100, v101
  v_cvt_pk_bf16_f32 v47, v102, v103
  v_exp_f32 v104, v104
  v_exp_f32 v105, v105
  v_exp_f32 v106, v106
  v_exp_f32 v107, v107
  v_cvt_pk_bf16_f32 v54, v104, v105
  v_cvt_pk_bf16_f32 v55, v106, v107
  v_mov_b32 v2, v66
  v_mov_b32 v3, v75
  v_mov_b32 v4, v67
  v_mov_b32 v5, v74
  s_waitcnt lgkmcnt(5)
  v_mfma_f32_16x16x32_bf16 v[96:99], a[64:67], v[128:131], v[112:115]
  v_exp_f32 v108, v108
  v_mfma_f32_16x16x32_bf16 v[96:99], a[68:71], v[160:163], v[96:99]
  ds_read_b128 a[80:83], v16 offset:17408
  v_mfma_f32_16x16x32_bf16 v[96:99], a[72:75], v[192:195], v[96:99]
  s_waitcnt lgkmcnt(3)
  v_exp_f32 v109, v109
  v_mfma_f32_16x16x32_bf16 v[96:99], a[76:79], v[224:227], v[96:99]
  ds_read_b64_tr_b16 a[112:113], v22 offset:0
  v_cvt_pk_bf16_f32 v62, v108, v109
  v_mfma_f32_16x16x32_bf16 v[144:147], v[32:35], a[96:99], 0
  v_exp_f32 v110, v110
  v_mfma_f32_16x16x32_bf16 v[144:147], v[36:39], a[100:103], v[144:147]
  ds_read_b64_tr_b16 a[114:115], v22 offset:1024
  v_mfma_f32_16x16x32_bf16 v[148:151], v[44:47], a[100:103], 0
  v_exp_f32 v111, v111
  v_mfma_f32_16x16x32_bf16 v[148:151], v[40:43], a[96:99], v[148:151]
  buffer_load_dwordx4 v28, s[28:31], s67 offen offset:2048 nt lds
  v_mfma_f32_16x16x32_bf16 v[100:103], a[64:67], v[132:135], v[116:119]
  v_exp_f32 v96, v96
  v_mfma_f32_16x16x32_bf16 v[100:103], a[68:71], v[164:167], v[100:103]
  ds_read_b128 a[84:87], v17 offset:17408
  v_cvt_pk_bf16_f32 v63, v110, v111
  v_mfma_f32_16x16x32_bf16 v[100:103], a[72:75], v[196:199], v[100:103]
  v_exp_f32 v97, v97
  v_mfma_f32_16x16x32_bf16 v[100:103], a[76:79], v[228:231], v[100:103]
  ds_read_b64_tr_b16 a[116:117], v22 offset:2048
  v_cvt_pk_bf16_f32 v64, v96, v97
  v_mfma_f32_16x16x32_bf16 a[0:3], v[48:51], a[96:99], 0
  v_exp_f32 v98, v98
  v_mfma_f32_16x16x32_bf16 a[0:3], v[52:55], a[100:103], a[0:3]
  ds_read_b64_tr_b16 a[118:119], v22 offset:3072
  v_mfma_f32_16x16x32_bf16 a[4:7], v[60:63], a[100:103], 0
  v_exp_f32 v99, v99
  v_mfma_f32_16x16x32_bf16 a[4:7], v[56:59], a[96:99], a[4:7]
  buffer_load_dwordx4 v28, s[28:31], s67 offen offset:3072 nt lds
  v_mfma_f32_16x16x32_bf16 v[104:107], a[64:67], v[136:139], v[120:123]
  v_exp_f32 v100, v100
  v_mfma_f32_16x16x32_bf16 v[104:107], a[68:71], v[168:171], v[104:107]
  ds_read_b128 a[88:91], v18 offset:17408
  v_cvt_pk_bf16_f32 v65, v98, v99
  v_mfma_f32_16x16x32_bf16 v[104:107], a[72:75], v[200:203], v[104:107]
  s_waitcnt lgkmcnt(7)
  v_exp_f32 v101, v101
  v_mfma_f32_16x16x32_bf16 v[104:107], a[76:79], v[232:235], v[104:107]
  ds_read_b64_tr_b16 a[120:121], v23 offset:0
  v_cvt_pk_bf16_f32 v72, v100, v101
  v_mfma_f32_16x16x32_bf16 v[152:155], v[32:35], a[104:107], 0
  v_exp_f32 v102, v102
  v_mfma_f32_16x16x32_bf16 v[152:155], v[36:39], a[108:111], v[152:155]
  ds_read_b64_tr_b16 a[122:123], v23 offset:1024
  v_mfma_f32_16x16x32_bf16 v[156:159], v[44:47], a[108:111], 0
  v_exp_f32 v103, v103
  v_mfma_f32_16x16x32_bf16 v[156:159], v[40:43], a[104:107], v[156:159]
  v_mfma_f32_16x16x32_bf16 v[108:111], a[64:67], v[140:143], v[124:127]
  v_exp_f32 v104, v104
  v_mfma_f32_16x16x32_bf16 v[108:111], a[68:71], v[172:175], v[108:111]
  ds_read_b128 a[92:95], v19 offset:17408
  v_cvt_pk_bf16_f32 v73, v102, v103
  v_mfma_f32_16x16x32_bf16 v[108:111], a[72:75], v[204:207], v[108:111]
  s_waitcnt lgkmcnt(3)
  v_exp_f32 v105, v105
  v_mfma_f32_16x16x32_bf16 v[108:111], a[76:79], v[236:239], v[108:111]
  ds_read_b64_tr_b16 a[124:125], v23 offset:2048
  v_cvt_pk_bf16_f32 v80, v104, v105
  v_mfma_f32_16x16x32_bf16 a[8:11], v[48:51], a[104:107], 0
  v_exp_f32 v106, v106
  v_mfma_f32_16x16x32_bf16 a[8:11], v[52:55], a[108:111], a[8:11]
  s_xor_b32 s68, s10, 16384
  ds_read_b64_tr_b16 a[126:127], v23 offset:3072
  v_mfma_f32_16x16x32_bf16 a[12:15], v[60:63], a[108:111], 0
  s_add_u32 m0, s63, 98304
  v_exp_f32 v107, v107
  v_mfma_f32_16x16x32_bf16 a[12:15], v[56:59], a[104:107], a[12:15]
  buffer_load_dwordx4 v29, s[32:35], s68 offen offset:0 nt lds
  v_mfma_f32_16x16x32_bf16 a[128:131], a[244:247], v[40:43], a[128:131]
  v_mfma_f32_16x16x32_bf16 a[128:131], a[244:247], v[44:47], a[128:131]
  v_mfma_f32_16x16x32_bf16 v[96:99], a[80:83], v[128:131], v[112:115]
  v_exp_f32 v108, v108
  v_mfma_f32_16x16x32_bf16 v[96:99], a[84:87], v[160:163], v[96:99]
  ds_read_b128 a[64:67], v16 offset:18432
  v_cvt_pk_bf16_f32 v81, v106, v107
  v_mfma_f32_16x16x32_bf16 v[96:99], a[88:91], v[192:195], v[96:99]
  s_waitcnt lgkmcnt(3)
  v_exp_f32 v109, v109
  v_mfma_f32_16x16x32_bf16 v[96:99], a[92:95], v[224:227], v[96:99]
  ds_read_b64_tr_b16 a[96:97], v24 offset:0
  v_cvt_pk_bf16_f32 v88, v108, v109
  v_mfma_f32_16x16x32_bf16 v[176:179], v[32:35], a[112:115], 0
  v_exp_f32 v110, v110
  v_mfma_f32_16x16x32_bf16 v[176:179], v[36:39], a[116:119], v[176:179]
  ds_read_b64_tr_b16 a[98:99], v24 offset:1024
  v_mfma_f32_16x16x32_bf16 v[180:183], v[44:47], a[116:119], 0
  v_exp_f32 v111, v111
  v_mfma_f32_16x16x32_bf16 v[180:183], v[40:43], a[112:115], v[180:183]
  buffer_load_dwordx4 v29, s[32:35], s68 offen offset:1024 nt lds
  v_mfma_f32_16x16x32_bf16 v[100:103], a[80:83], v[132:135], v[116:119]
  v_exp_f32 v96, v96
  v_mfma_f32_16x16x32_bf16 v[100:103], a[84:87], v[164:167], v[100:103]
  ds_read_b128 a[68:71], v17 offset:18432
  v_cvt_pk_bf16_f32 v89, v110, v111
  v_mfma_f32_16x16x32_bf16 v[100:103], a[88:91], v[196:199], v[100:103]
  v_exp_f32 v97, v97
  v_mfma_f32_16x16x32_bf16 v[100:103], a[92:95], v[228:231], v[100:103]
  ds_read_b64_tr_b16 a[100:101], v24 offset:2048
  v_cvt_pk_bf16_f32 v66, v96, v97
  v_mfma_f32_16x16x32_bf16 a[16:19], v[48:51], a[112:115], 0
  v_exp_f32 v98, v98
  v_mfma_f32_16x16x32_bf16 a[16:19], v[52:55], a[116:119], a[16:19]
  ds_read_b64_tr_b16 a[102:103], v24 offset:3072
  v_mfma_f32_16x16x32_bf16 a[20:23], v[60:63], a[116:119], 0
  v_exp_f32 v99, v99
  v_mfma_f32_16x16x32_bf16 a[20:23], v[56:59], a[112:115], a[20:23]
  v_mfma_f32_16x16x32_bf16 v[104:107], a[80:83], v[136:139], v[120:123]
  v_exp_f32 v100, v100
  v_mfma_f32_16x16x32_bf16 v[104:107], a[84:87], v[168:171], v[104:107]
  ds_read_b128 a[72:75], v18 offset:18432
  v_cvt_pk_bf16_f32 v67, v98, v99
  v_mfma_f32_16x16x32_bf16 v[104:107], a[88:91], v[200:203], v[104:107]
  s_waitcnt lgkmcnt(7)
  v_exp_f32 v101, v101
  v_mfma_f32_16x16x32_bf16 v[104:107], a[92:95], v[232:235], v[104:107]
  ds_read_b64_tr_b16 a[104:105], v25 offset:0
  v_cvt_pk_bf16_f32 v74, v100, v101
  v_mfma_f32_16x16x32_bf16 v[184:187], v[32:35], a[120:123], 0
  v_exp_f32 v102, v102
  v_mfma_f32_16x16x32_bf16 v[184:187], v[36:39], a[124:127], v[184:187]
  ds_read_b64_tr_b16 a[106:107], v25 offset:1024
  v_mfma_f32_16x16x32_bf16 v[188:191], v[44:47], a[124:127], 0
  v_exp_f32 v103, v103
  v_mfma_f32_16x16x32_bf16 v[188:191], v[40:43], a[120:123], v[188:191]
  buffer_load_dwordx4 v29, s[32:35], s68 offen offset:2048 nt lds
  v_mfma_f32_16x16x32_bf16 a[128:131], a[240:243], v[32:35], a[128:131]
  v_mfma_f32_16x16x32_bf16 a[128:131], a[240:243], v[36:39], a[128:131]
  v_mfma_f32_16x16x32_bf16 v[108:111], a[80:83], v[140:143], v[124:127]
  v_exp_f32 v104, v104
  v_mfma_f32_16x16x32_bf16 v[108:111], a[84:87], v[172:175], v[108:111]
  ds_read_b128 a[76:79], v19 offset:18432
  v_cvt_pk_bf16_f32 v75, v102, v103
  v_mfma_f32_16x16x32_bf16 v[108:111], a[88:91], v[204:207], v[108:111]
  s_waitcnt lgkmcnt(3)
  v_exp_f32 v105, v105
  v_mfma_f32_16x16x32_bf16 v[108:111], a[92:95], v[236:239], v[108:111]
  ds_read_b64_tr_b16 a[108:109], v25 offset:2048
  v_cvt_pk_bf16_f32 v82, v104, v105
  v_mfma_f32_16x16x32_bf16 a[24:27], v[48:51], a[120:123], 0
  v_exp_f32 v106, v106
  v_mfma_f32_16x16x32_bf16 a[24:27], v[52:55], a[124:127], a[24:27]
  ds_read_b64_tr_b16 a[110:111], v25 offset:3072
  v_mfma_f32_16x16x32_bf16 a[28:31], v[60:63], a[124:127], 0
  v_exp_f32 v107, v107
  v_mfma_f32_16x16x32_bf16 a[28:31], v[56:59], a[120:123], a[28:31]
  buffer_load_dwordx4 v29, s[32:35], s68 offen offset:3072 nt lds
  v_mfma_f32_16x16x32_bf16 v[96:99], a[64:67], v[128:131], v[112:115]
  v_exp_f32 v108, v108
  v_mfma_f32_16x16x32_bf16 v[96:99], a[68:71], v[160:163], v[96:99]
  ds_read_b128 a[80:83], v16 offset:19456
  v_cvt_pk_bf16_f32 v83, v106, v107
  v_mfma_f32_16x16x32_bf16 v[96:99], a[72:75], v[192:195], v[96:99]
  s_waitcnt lgkmcnt(3)
  v_exp_f32 v109, v109
  v_mfma_f32_16x16x32_bf16 v[96:99], a[76:79], v[224:227], v[96:99]
L_hop3:
  s_cbranch_execz L_hop7
  ds_read_b64_tr_b16 a[112:113], v26 offset:0
  v_cvt_pk_bf16_f32 v90, v108, v109
  v_mfma_f32_16x16x32_bf16 v[208:211], v[32:35], a[96:99], 0
  v_exp_f32 v110, v110
  v_mfma_f32_16x16x32_bf16 v[208:211], v[36:39], a[100:103], v[208:211]
  ds_read_b64_tr_b16 a[114:115], v26 offset:1024
  v_mfma_f32_16x16x32_bf16 v[212:215], v[44:47], a[100:103], 0
  v_exp_f32 v111, v111
  v_mfma_f32_16x16x32_bf16 v[212:215], v[40:43], a[96:99], v[212:215]
  v_mfma_f32_16x16x32_bf16 v[100:103], a[64:67], v[132:135], v[116:119]
  v_exp_f32 v96, v96
  v_mfma_f32_16x16x32_bf16 v[100:103], a[68:71], v[164:167], v[100:103]
  ds_read_b128 a[84:87], v17 offset:19456
  v_cvt_pk_bf16_f32 v91, v110, v111
  v_mfma_f32_16x16x32_bf16 v[100:103], a[72:75], v[196:199], v[100:103]
  v_exp_f32 v97, v97
  v_mfma_f32_16x16x32_bf16 v[100:103], a[76:79], v[228:231], v[100:103]
  ds_read_b64_tr_b16 a[116:117], v26 offset:2048
  v_cvt_pk_bf16_f32 v68, v96, v97
  v_mfma_f32_16x16x32_bf16 a[32:35], v[48:51], a[96:99], 0
  v_exp_f32 v98, v98
  v_mfma_f32_16x16x32_bf16 a[32:35], v[52:55], a[100:103], a[32:35]
  s_xor_b32 s67, s10, 20480
  ds_read_b64_tr_b16 a[118:119], v26 offset:3072
  v_mfma_f32_16x16x32_bf16 a[36:39], v[60:63], a[100:103], 0
  s_add_u32 m0, s63, 49152
  v_exp_f32 v99, v99
  v_mfma_f32_16x16x32_bf16 a[36:39], v[56:59], a[96:99], a[36:39]
  buffer_load_dwordx4 v28, s[28:31], s67 offen offset:0 nt lds
  v_mfma_f32_16x16x32_bf16 a[132:135], a[244:247], v[56:59], a[132:135]
  v_mfma_f32_16x16x32_bf16 a[132:135], a[244:247], v[60:63], a[132:135]
  v_mfma_f32_16x16x32_bf16 v[104:107], a[64:67], v[136:139], v[120:123]
  v_exp_f32 v100, v100
  v_mfma_f32_16x16x32_bf16 v[104:107], a[68:71], v[168:171], v[104:107]
  ds_read_b128 a[88:91], v18 offset:19456
  v_cvt_pk_bf16_f32 v69, v98, v99
  v_mfma_f32_16x16x32_bf16 v[104:107], a[72:75], v[200:203], v[104:107]
  s_waitcnt lgkmcnt(7)
  v_exp_f32 v101, v101
  v_mfma_f32_16x16x32_bf16 v[104:107], a[76:79], v[232:235], v[104:107]
  ds_read_b64_tr_b16 a[120:121], v27 offset:0
  v_cvt_pk_bf16_f32 v76, v100, v101
  v_mfma_f32_16x16x32_bf16 v[216:219], v[32:35], a[104:107], 0
  v_exp_f32 v102, v102
  v_mfma_f32_16x16x32_bf16 v[216:219], v[36:39], a[108:111], v[216:219]
  ds_read_b64_tr_b16 a[122:123], v27 offset:1024
  v_mfma_f32_16x16x32_bf16 v[220:223], v[44:47], a[108:111], 0
  v_exp_f32 v103, v103
  v_mfma_f32_16x16x32_bf16 v[220:223], v[40:43], a[104:107], v[220:223]
  buffer_load_dwordx4 v28, s[28:31], s67 offen offset:1024 nt lds
  v_mfma_f32_16x16x32_bf16 v[108:111], a[64:67], v[140:143], v[124:127]
  v_exp_f32 v104, v104
  v_mfma_f32_16x16x32_bf16 v[108:111], a[68:71], v[172:175], v[108:111]
  ds_read_b128 a[92:95], v19 offset:19456
  v_cvt_pk_bf16_f32 v77, v102, v103
  v_mfma_f32_16x16x32_bf16 v[108:111], a[72:75], v[204:207], v[108:111]
  s_waitcnt lgkmcnt(3)
  v_exp_f32 v105, v105
  v_mfma_f32_16x16x32_bf16 v[108:111], a[76:79], v[236:239], v[108:111]
  ds_read_b64_tr_b16 a[124:125], v27 offset:2048
  v_cvt_pk_bf16_f32 v84, v104, v105
  v_mfma_f32_16x16x32_bf16 a[40:43], v[48:51], a[104:107], 0
  v_exp_f32 v106, v106
  v_mfma_f32_16x16x32_bf16 a[40:43], v[52:55], a[108:111], a[40:43]
  ds_read_b64_tr_b16 a[126:127], v27 offset:3072
  v_mfma_f32_16x16x32_bf16 a[44:47], v[60:63], a[108:111], 0
  s_waitcnt vmcnt(6)
  v_exp_f32 v107, v107
  v_mfma_f32_16x16x32_bf16 a[44:47], v[56:59], a[104:107], a[44:47]
  v_mfma_f32_16x16x32_bf16 v[96:99], a[80:83], v[128:131], v[112:115]
  s_barrier
  v_exp_f32 v108, v108
  v_mfma_f32_16x16x32_bf16 v[96:99], a[84:87], v[160:163], v[96:99]
  ds_read_b128 a[64:67], v16 offset:32768
  v_cvt_pk_bf16_f32 v85, v106, v107
  v_mfma_f32_16x16x32_bf16 v[96:99], a[88:91], v[192:195], v[96:99]
  s_waitcnt lgkmcnt(3)
  v_exp_f32 v109, v109
  v_mfma_f32_16x16x32_bf16 v[96:99], a[92:95], v[224:227], v[96:99]
  ds_read_b64_tr_b16 a[96:97], v20 offset:16384
  v_cvt_pk_bf16_f32 v92, v108, v109
  v_mfma_f32_16x16x32_bf16 v[240:243], v[32:35], a[112:115], 0
  v_exp_f32 v110, v110
  v_mfma_f32_16x16x32_bf16 v[240:243], v[36:39], a[116:119], v[240:243]
  ds_read_b64_tr_b16 a[98:99], v20 offset:17408
  v_mfma_f32_16x16x32_bf16 v[244:247], v[44:47], a[116:119], 0
  v_exp_f32 v111, v111
  v_mfma_f32_16x16x32_bf16 v[244:247], v[40:43], a[112:115], v[244:247]
  buffer_store_dword v4, v5, s[56:59], s13 offen sc1
  v_mfma_f32_16x16x32_bf16 v[100:103], a[80:83], v[132:135], v[116:119]
  v_exp_f32 v96, v96
  v_mfma_f32_16x16x32_bf16 v[100:103], a[84:87], v[164:167], v[100:103]
  ds_read_b128 a[68:71], v17 offset:32768
  v_cvt_pk_bf16_f32 v93, v110, v111
  v_mfma_f32_16x16x32_bf16 v[100:103], a[88:91], v[196:199], v[100:103]
  v_exp_f32 v97, v97
  v_mfma_f32_16x16x32_bf16 v[100:103], a[92:95], v[228:231], v[100:103]
  ds_read_b64_tr_b16 a[100:101], v20 offset:18432
  v_cvt_pk_bf16_f32 v70, v96, v97
  v_mfma_f32_16x16x32_bf16 a[48:51], v[48:51], a[112:115], 0
  v_exp_f32 v98, v98
  v_mfma_f32_16x16x32_bf16 a[48:51], v[52:55], a[116:119], a[48:51]
  ds_read_b64_tr_b16 a[102:103], v20 offset:19456
  v_mfma_f32_16x16x32_bf16 a[52:55], v[60:63], a[116:119], 0
  v_exp_f32 v99, v99
  v_mfma_f32_16x16x32_bf16 a[52:55], v[56:59], a[112:115], a[52:55]
  buffer_load_dwordx4 v28, s[28:31], s67 offen offset:2048 nt lds
  v_mfma_f32_16x16x32_bf16 a[132:135], a[240:243], v[48:51], a[132:135]
  v_mfma_f32_16x16x32_bf16 a[132:135], a[240:243], v[52:55], a[132:135]
  v_mfma_f32_16x16x32_bf16 v[104:107], a[80:83], v[136:139], v[120:123]
  v_exp_f32 v100, v100
  v_mfma_f32_16x16x32_bf16 v[104:107], a[84:87], v[168:171], v[104:107]
  ds_read_b128 a[72:75], v18 offset:32768
  v_cvt_pk_bf16_f32 v71, v98, v99
  v_mfma_f32_16x16x32_bf16 v[104:107], a[88:91], v[200:203], v[104:107]
  s_waitcnt lgkmcnt(7)
  v_exp_f32 v101, v101
  v_mfma_f32_16x16x32_bf16 v[104:107], a[92:95], v[232:235], v[104:107]
  ds_read_b64_tr_b16 a[104:105], v21 offset:16384
  v_cvt_pk_bf16_f32 v78, v100, v101
  v_mfma_f32_16x16x32_bf16 v[248:251], v[32:35], a[120:123], 0
  v_exp_f32 v102, v102
  v_mfma_f32_16x16x32_bf16 v[248:251], v[36:39], a[124:127], v[248:251]
  ds_read_b64_tr_b16 a[106:107], v21 offset:17408
  v_mfma_f32_16x16x32_bf16 v[252:255], v[44:47], a[124:127], 0
  v_exp_f32 v103, v103
  v_mfma_f32_16x16x32_bf16 v[252:255], v[40:43], a[120:123], v[252:255]
  v_mfma_f32_16x16x32_bf16 v[108:111], a[80:83], v[140:143], v[124:127]
  v_exp_f32 v104, v104
  v_mfma_f32_16x16x32_bf16 v[108:111], a[84:87], v[172:175], v[108:111]
  ds_read_b128 a[76:79], v19 offset:32768
  v_cvt_pk_bf16_f32 v79, v102, v103
  v_mfma_f32_16x16x32_bf16 v[108:111], a[88:91], v[204:207], v[108:111]
  s_waitcnt lgkmcnt(3)
  v_exp_f32 v105, v105
  v_mfma_f32_16x16x32_bf16 v[108:111], a[92:95], v[236:239], v[108:111]
  ds_read_b64_tr_b16 a[108:109], v21 offset:18432
  v_cvt_pk_bf16_f32 v86, v104, v105
  v_mfma_f32_16x16x32_bf16 a[56:59], v[48:51], a[120:123], 0
  v_exp_f32 v106, v106
  v_mfma_f32_16x16x32_bf16 a[56:59], v[52:55], a[124:127], a[56:59]
  ds_read_b64_tr_b16 a[110:111], v21 offset:19456
  v_mfma_f32_16x16x32_bf16 a[60:63], v[60:63], a[124:127], 0
  v_exp_f32 v107, v107
  v_mfma_f32_16x16x32_bf16 a[60:63], v[56:59], a[120:123], a[60:63]
  v_cvt_pk_bf16_f32 v87, v106, v107
  v_mfma_f32_16x16x32_bf16 v[96:99], a[64:67], v[128:131], v[112:115]
  v_exp_f32 v108, v108
  v_mfma_f32_16x16x32_bf16 v[96:99], a[68:71], v[160:163], v[96:99]
  ds_read_b128 a[80:83], v16 offset:33792
  v_mfma_f32_16x16x32_bf16 v[96:99], a[72:75], v[192:195], v[96:99]
  s_waitcnt lgkmcnt(3)
  v_exp_f32 v109, v109
  v_mfma_f32_16x16x32_bf16 v[96:99], a[76:79], v[224:227], v[96:99]
  ds_read_b64_tr_b16 a[112:113], v22 offset:16384
  v_cvt_pk_bf16_f32 v94, v108, v109
  v_mfma_f32_16x16x32_bf16 v[144:147], v[64:67], a[96:99], v[144:147]
  v_exp_f32 v110, v110
  v_mfma_f32_16x16x32_bf16 v[144:147], v[68:71], a[100:103], v[144:147]
  ds_read_b64_tr_b16 a[114:115], v22 offset:17408
  v_mfma_f32_16x16x32_bf16 v[148:151], v[76:79], a[100:103], v[148:151]
  v_exp_f32 v111, v111
  v_mfma_f32_16x16x32_bf16 v[148:151], v[72:75], a[96:99], v[148:151]
  v_mfma_f32_16x16x32_bf16 v[100:103], a[64:67], v[132:135], v[116:119]
  v_exp_f32 v96, v96
  v_mfma_f32_16x16x32_bf16 v[100:103], a[68:71], v[164:167], v[100:103]
  ds_read_b128 a[84:87], v17 offset:33792
  v_cvt_pk_bf16_f32 v95, v110, v111
  v_mfma_f32_16x16x32_bf16 v[100:103], a[72:75], v[196:199], v[100:103]
  v_exp_f32 v97, v97
  v_mfma_f32_16x16x32_bf16 v[100:103], a[76:79], v[228:231], v[100:103]
  ds_read_b64_tr_b16 a[116:117], v22 offset:18432
  v_cvt_pk_bf16_f32 v32, v96, v97
  v_mfma_f32_16x16x32_bf16 a[0:3], v[80:83], a[96:99], a[0:3]
  v_exp_f32 v98, v98
  v_mfma_f32_16x16x32_bf16 a[0:3], v[84:87], a[100:103], a[0:3]
  ds_read_b64_tr_b16 a[118:119], v22 offset:19456
  v_mfma_f32_16x16x32_bf16 a[4:7], v[92:95], a[100:103], a[4:7]
  v_exp_f32 v99, v99
  v_mfma_f32_16x16x32_bf16 a[4:7], v[88:91], a[96:99], a[4:7]
  buffer_load_dwordx4 v28, s[28:31], s67 offen offset:3072 nt lds
  v_mfma_f32_16x16x32_bf16 v[104:107], a[64:67], v[136:139], v[120:123]
  v_exp_f32 v100, v100
  v_mfma_f32_16x16x32_bf16 v[104:107], a[68:71], v[168:171], v[104:107]
  ds_read_b128 a[88:91], v18 offset:33792
  v_cvt_pk_bf16_f32 v33, v98, v99
  v_mfma_f32_16x16x32_bf16 v[104:107], a[72:75], v[200:203], v[104:107]
  s_waitcnt lgkmcnt(7)
  v_exp_f32 v101, v101
  v_mfma_f32_16x16x32_bf16 v[104:107], a[76:79], v[232:235], v[104:107]
  ds_read_b64_tr_b16 a[120:121], v23 offset:16384
  v_cvt_pk_bf16_f32 v40, v100, v101
  v_mfma_f32_16x16x32_bf16 v[152:155], v[64:67], a[104:107], v[152:155]
  v_exp_f32 v102, v102
  v_mfma_f32_16x16x32_bf16 v[152:155], v[68:71], a[108:111], v[152:155]
  ds_read_b64_tr_b16 a[122:123], v23 offset:17408
  v_mfma_f32_16x16x32_bf16 v[156:159], v[76:79], a[108:111], v[156:159]
  v_exp_f32 v103, v103
  v_mfma_f32_16x16x32_bf16 v[156:159], v[72:75], a[104:107], v[156:159]
  v_mfma_f32_16x16x32_bf16 v[108:111], a[64:67], v[140:143], v[124:127]
  v_exp_f32 v104, v104
  v_mfma_f32_16x16x32_bf16 v[108:111], a[68:71], v[172:175], v[108:111]
  ds_read_b128 a[92:95], v19 offset:33792
  v_cvt_pk_bf16_f32 v41, v102, v103
  v_mfma_f32_16x16x32_bf16 v[108:111], a[72:75], v[204:207], v[108:111]
  s_waitcnt lgkmcnt(3)
  v_exp_f32 v105, v105
  v_mfma_f32_16x16x32_bf16 v[108:111], a[76:79], v[236:239], v[108:111]
  ds_read_b64_tr_b16 a[124:125], v23 offset:18432
  v_cvt_pk_bf16_f32 v48, v104, v105
  v_mfma_f32_16x16x32_bf16 a[8:11], v[80:83], a[104:107], a[8:11]
  v_exp_f32 v106, v106
  v_mfma_f32_16x16x32_bf16 a[8:11], v[84:87], a[108:111], a[8:11]
  s_xor_b32 s68, s10, 20480
  ds_read_b64_tr_b16 a[126:127], v23 offset:19456
  v_mfma_f32_16x16x32_bf16 a[12:15], v[92:95], a[108:111], a[12:15]
  s_add_u32 m0, s63, 114688
  v_exp_f32 v107, v107
  v_mfma_f32_16x16x32_bf16 a[12:15], v[88:91], a[104:107], a[12:15]
  buffer_load_dwordx4 v29, s[32:35], s68 offen offset:0 nt lds
  v_mfma_f32_16x16x32_bf16 a[128:131], a[244:247], v[72:75], a[128:131]
  v_mfma_f32_16x16x32_bf16 a[128:131], a[244:247], v[76:79], a[128:131]
  v_mfma_f32_16x16x32_bf16 v[96:99], a[80:83], v[128:131], v[112:115]
  v_exp_f32 v108, v108
  v_mfma_f32_16x16x32_bf16 v[96:99], a[84:87], v[160:163], v[96:99]
  ds_read_b128 a[64:67], v16 offset:34816
  v_cvt_pk_bf16_f32 v49, v106, v107
  v_mfma_f32_16x16x32_bf16 v[96:99], a[88:91], v[192:195], v[96:99]
  s_waitcnt lgkmcnt(3)
  v_exp_f32 v109, v109
  v_mfma_f32_16x16x32_bf16 v[96:99], a[92:95], v[224:227], v[96:99]
  ds_read_b64_tr_b16 a[96:97], v24 offset:16384
  v_cvt_pk_bf16_f32 v56, v108, v109
  v_mfma_f32_16x16x32_bf16 v[176:179], v[64:67], a[112:115], v[176:179]
  v_exp_f32 v110, v110
  v_mfma_f32_16x16x32_bf16 v[176:179], v[68:71], a[116:119], v[176:179]
  ds_read_b64_tr_b16 a[98:99], v24 offset:17408
  v_mfma_f32_16x16x32_bf16 v[180:183], v[76:79], a[116:119], v[180:183]
  v_exp_f32 v111, v111
  v_mfma_f32_16x16x32_bf16 v[180:183], v[72:75], a[112:115], v[180:183]
  buffer_load_dwordx4 v29, s[32:35], s68 offen offset:1024 nt lds
  v_mfma_f32_16x16x32_bf16 v[100:103], a[80:83], v[132:135], v[116:119]
  v_exp_f32 v96, v96
  v_mfma_f32_16x16x32_bf16 v[100:103], a[84:87], v[164:167], v[100:103]
  ds_read_b128 a[68:71], v17 offset:34816
  v_cvt_pk_bf16_f32 v57, v110, v111
  v_mfma_f32_16x16x32_bf16 v[100:103], a[88:91], v[196:199], v[100:103]
  v_exp_f32 v97, v97
  v_mfma_f32_16x16x32_bf16 v[100:103], a[92:95], v[228:231], v[100:103]
  ds_read_b64_tr_b16 a[100:101], v24 offset:18432
  v_cvt_pk_bf16_f32 v34, v96, v97
  v_mfma_f32_16x16x32_bf16 a[16:19], v[80:83], a[112:115], a[16:19]
  v_exp_f32 v98, v98
  v_mfma_f32_16x16x32_bf16 a[16:19], v[84:87], a[116:119], a[16:19]
  ds_read_b64_tr_b16 a[102:103], v24 offset:19456
  v_mfma_f32_16x16x32_bf16 a[20:23], v[92:95], a[116:119], a[20:23]
  v_exp_f32 v99, v99
  v_mfma_f32_16x16x32_bf16 a[20:23], v[88:91], a[112:115], a[20:23]
  v_mfma_f32_16x16x32_bf16 v[104:107], a[80:83], v[136:139], v[120:123]
  v_exp_f32 v100, v100
  v_mfma_f32_16x16x32_bf16 v[104:107], a[84:87], v[168:171], v[104:107]
  ds_read_b128 a[72:75], v18 offset:34816
  v_cvt_pk_bf16_f32 v35, v98, v99
  v_mfma_f32_16x16x32_bf16 v[104:107], a[88:91], v[200:203], v[104:107]
  s_waitcnt lgkmcnt(7)
  v_exp_f32 v101, v101
  v_mfma_f32_16x16x32_bf16 v[104:107], a[92:95], v[232:235], v[104:107]
  ds_read_b64_tr_b16 a[104:105], v25 offset:16384
  v_cvt_pk_bf16_f32 v42, v100, v101
  v_mfma_f32_16x16x32_bf16 v[184:187], v[64:67], a[120:123], v[184:187]
  v_exp_f32 v102, v102
  v_mfma_f32_16x16x32_bf16 v[184:187], v[68:71], a[124:127], v[184:187]
  ds_read_b64_tr_b16 a[106:107], v25 offset:17408
  v_mfma_f32_16x16x32_bf16 v[188:191], v[76:79], a[124:127], v[188:191]
  v_exp_f32 v103, v103
  v_mfma_f32_16x16x32_bf16 v[188:191], v[72:75], a[120:123], v[188:191]
  buffer_load_dwordx4 v29, s[32:35], s68 offen offset:2048 nt lds
  v_mfma_f32_16x16x32_bf16 a[128:131], a[240:243], v[64:67], a[128:131]
  v_mfma_f32_16x16x32_bf16 a[128:131], a[240:243], v[68:71], a[128:131]
  v_mfma_f32_16x16x32_bf16 v[108:111], a[80:83], v[140:143], v[124:127]
  v_exp_f32 v104, v104
  v_mfma_f32_16x16x32_bf16 v[108:111], a[84:87], v[172:175], v[108:111]
  ds_read_b128 a[76:79], v19 offset:34816
  v_cvt_pk_bf16_f32 v43, v102, v103
  v_mfma_f32_16x16x32_bf16 v[108:111], a[88:91], v[204:207], v[108:111]
  s_waitcnt lgkmcnt(3)
  v_exp_f32 v105, v105
  v_mfma_f32_16x16x32_bf16 v[108:111], a[92:95], v[236:239], v[108:111]
  ds_read_b64_tr_b16 a[108:109], v25 offset:18432
  v_cvt_pk_bf16_f32 v50, v104, v105
  v_mfma_f32_16x16x32_bf16 a[24:27], v[80:83], a[120:123], a[24:27]
  v_exp_f32 v106, v106
  v_mfma_f32_16x16x32_bf16 a[24:27], v[84:87], a[124:127], a[24:27]
  ds_read_b64_tr_b16 a[110:111], v25 offset:19456
  v_mfma_f32_16x16x32_bf16 a[28:31], v[92:95], a[124:127], a[28:31]
  v_exp_f32 v107, v107
  v_mfma_f32_16x16x32_bf16 a[28:31], v[88:91], a[120:123], a[28:31]
  buffer_load_dwordx4 v29, s[32:35], s68 offen offset:3072 nt lds
  v_mfma_f32_16x16x32_bf16 v[96:99], a[64:67], v[128:131], v[112:115]
  v_exp_f32 v108, v108
  v_mfma_f32_16x16x32_bf16 v[96:99], a[68:71], v[160:163], v[96:99]
  ds_read_b128 a[80:83], v16 offset:35840
  v_cvt_pk_bf16_f32 v51, v106, v107
  v_mfma_f32_16x16x32_bf16 v[96:99], a[72:75], v[192:195], v[96:99]
  s_waitcnt lgkmcnt(3)
  v_exp_f32 v109, v109
  v_mfma_f32_16x16x32_bf16 v[96:99], a[76:79], v[224:227], v[96:99]
  ds_read_b64_tr_b16 a[112:113], v26 offset:16384
  v_cvt_pk_bf16_f32 v58, v108, v109
  v_mfma_f32_16x16x32_bf16 v[208:211], v[64:67], a[96:99], v[208:211]
  v_exp_f32 v110, v110
  v_mfma_f32_16x16x32_bf16 v[208:211], v[68:71], a[100:103], v[208:211]
  ds_read_b64_tr_b16 a[114:115], v26 offset:17408
  v_mfma_f32_16x16x32_bf16 v[212:215], v[76:79], a[100:103], v[212:215]
  v_exp_f32 v111, v111
  v_mfma_f32_16x16x32_bf16 v[212:215], v[72:75], a[96:99], v[212:215]
  v_mfma_f32_16x16x32_bf16 v[100:103], a[64:67], v[132:135], v[116:119]
  v_exp_f32 v96, v96
  v_mfma_f32_16x16x32_bf16 v[100:103], a[68:71], v[164:167], v[100:103]
  ds_read_b128 a[84:87], v17 offset:35840
  v_cvt_pk_bf16_f32 v59, v110, v111
  v_mfma_f32_16x16x32_bf16 v[100:103], a[72:75], v[196:199], v[100:103]
  v_exp_f32 v97, v97
  v_mfma_f32_16x16x32_bf16 v[100:103], a[76:79], v[228:231], v[100:103]
  ds_read_b64_tr_b16 a[116:117], v26 offset:18432
  v_cvt_pk_bf16_f32 v36, v96, v97
  v_mfma_f32_16x16x32_bf16 a[32:35], v[80:83], a[96:99], a[32:35]
  v_exp_f32 v98, v98
  v_mfma_f32_16x16x32_bf16 a[32:35], v[84:87], a[100:103], a[32:35]
  s_xor_b32 s67, s10, 32768
  ds_read_b64_tr_b16 a[118:119], v26 offset:19456
  v_mfma_f32_16x16x32_bf16 a[36:39], v[92:95], a[100:103], a[36:39]
  s_add_u32 m0, s63, 0
  v_exp_f32 v99, v99
  v_mfma_f32_16x16x32_bf16 a[36:39], v[88:91], a[96:99], a[36:39]
  buffer_load_dwordx4 v28, s[28:31], s67 offen offset:0 nt lds
  v_mfma_f32_16x16x32_bf16 a[132:135], a[244:247], v[88:91], a[132:135]
  v_mfma_f32_16x16x32_bf16 a[132:135], a[244:247], v[92:95], a[132:135]
  v_mfma_f32_16x16x32_bf16 v[104:107], a[64:67], v[136:139], v[120:123]
  v_exp_f32 v100, v100
  v_mfma_f32_16x16x32_bf16 v[104:107], a[68:71], v[168:171], v[104:107]
  ds_read_b128 a[88:91], v18 offset:35840
  v_cvt_pk_bf16_f32 v37, v98, v99
  v_mfma_f32_16x16x32_bf16 v[104:107], a[72:75], v[200:203], v[104:107]
  s_waitcnt lgkmcnt(7)
  v_exp_f32 v101, v101
  v_mfma_f32_16x16x32_bf16 v[104:107], a[76:79], v[232:235], v[104:107]
  ds_read_b64_tr_b16 a[120:121], v27 offset:16384
  v_cvt_pk_bf16_f32 v44, v100, v101
  v_mfma_f32_16x16x32_bf16 v[216:219], v[64:67], a[104:107], v[216:219]
  v_exp_f32 v102, v102
  v_mfma_f32_16x16x32_bf16 v[216:219], v[68:71], a[108:111], v[216:219]
  ds_read_b64_tr_b16 a[122:123], v27 offset:17408
  v_mfma_f32_16x16x32_bf16 v[220:223], v[76:79], a[108:111], v[220:223]
  v_exp_f32 v103, v103
  v_mfma_f32_16x16x32_bf16 v[220:223], v[72:75], a[104:107], v[220:223]
  buffer_load_dwordx4 v28, s[28:31], s67 offen offset:1024 nt lds
  v_mfma_f32_16x16x32_bf16 v[108:111], a[64:67], v[140:143], v[124:127]
  v_exp_f32 v104, v104
  v_mfma_f32_16x16x32_bf16 v[108:111], a[68:71], v[172:175], v[108:111]
  ds_read_b128 a[92:95], v19 offset:35840
  v_cvt_pk_bf16_f32 v45, v102, v103
  v_mfma_f32_16x16x32_bf16 v[108:111], a[72:75], v[204:207], v[108:111]
  s_waitcnt lgkmcnt(3)
  v_exp_f32 v105, v105
  v_mfma_f32_16x16x32_bf16 v[108:111], a[76:79], v[236:239], v[108:111]
  ds_read_b64_tr_b16 a[124:125], v27 offset:18432
  v_cvt_pk_bf16_f32 v52, v104, v105
  v_mfma_f32_16x16x32_bf16 a[40:43], v[80:83], a[104:107], a[40:43]
  v_exp_f32 v106, v106
  v_mfma_f32_16x16x32_bf16 a[40:43], v[84:87], a[108:111], a[40:43]
  ds_read_b64_tr_b16 a[126:127], v27 offset:19456
  v_mfma_f32_16x16x32_bf16 a[44:47], v[92:95], a[108:111], a[44:47]
  s_waitcnt vmcnt(6)
  v_exp_f32 v107, v107
  v_mfma_f32_16x16x32_bf16 a[44:47], v[88:91], a[104:107], a[44:47]
  buffer_load_dwordx4 v28, s[28:31], s67 offen offset:2048 nt lds
  v_mfma_f32_16x16x32_bf16 v[96:99], a[80:83], v[128:131], v[112:115]
  s_barrier
  v_exp_f32 v108, v108
  s_mov_b64 exec, 0
  s_cmp_eq_u32 s62, 0
  s_cbranch_scc1 L_hopb0
  s_cmp_eq_u32 s62, 1
  s_cbranch_scc1 L_hopb1
  s_cmp_eq_u32 s62, 2
  s_cbranch_scc1 L_hopb2
  s_branch L_hopb3
L_hopback2:
  s_mov_b64 exec, -1
L_hop2skip:
  v_mfma_f32_16x16x32_bf16 v[96:99], a[84:87], v[160:163], v[96:99]
  ds_read_b128 a[64:67], v16 offset:49152
  v_cvt_pk_bf16_f32 v53, v106, v107
  v_mfma_f32_16x16x32_bf16 v[96:99], a[88:91], v[192:195], v[96:99]
  s_waitcnt lgkmcnt(3)
  v_exp_f32 v109, v109
  v_mfma_f32_16x16x32_bf16 v[96:99], a[92:95], v[224:227], v[96:99]
  ds_read_b64_tr_b16 a[96:97], v20 offset:32768
  v_cvt_pk_bf16_f32 v60, v108, v109
  v_mfma_f32_16x16x32_bf16 v[240:243], v[64:67], a[112:115], v[240:243]
  v_exp_f32 v110, v110
  v_mfma_f32_16x16x32_bf16 v[240:243], v[68:71], a[116:119], v[240:243]
  ds_read_b64_tr_b16 a[98:99], v20 offset:33792
  v_mfma_f32_16x16x32_bf16 v[244:247], v[76:79], a[116:119], v[244:247]
  v_exp_f32 v111, v111
  v_mfma_f32_16x16x32_bf16 v[244:247], v[72:75], a[112:115], v[244:247]
  v_mfma_f32_16x16x32_bf16 v[100:103], a[80:83], v[132:135], v[116:119]
  v_exp_f32 v96, v96
  v_mfma_f32_16x16x32_bf16 v[100:103], a[84:87], v[164:167], v[100:103]
  ds_read_b128 a[68:71], v17 offset:49152
  v_cvt_pk_bf16_f32 v61, v110, v111
  v_mfma_f32_16x16x32_bf16 v[100:103], a[88:91], v[196:199], v[100:103]
  v_exp_f32 v97, v97
  v_mfma_f32_16x16x32_bf16 v[100:103], a[92:95], v[228:231], v[100:103]
  ds_read_b64_tr_b16 a[100:101], v20 offset:34816
  v_cvt_pk_bf16_f32 v38, v96, v97
  v_mfma_f32_16x16x32_bf16 a[48:51], v[80:83], a[112:115], a[48:51]
  v_exp_f32 v98, v98
  v_mfma_f32_16x16x32_bf16 a[48:51], v[84:87], a[116:119], a[48:51]
  ds_read_b64_tr_b16 a[102:103], v20 offset:35840
  v_mfma_f32_16x16x32_bf16 a[52:55], v[92:95], a[116:119], a[52:55]
  v_exp_f32 v99, v99
  v_mfma_f32_16x16x32_bf16 a[52:55], v[88:91], a[112:115], a[52:55]
  buffer_load_dwordx4 v28, s[28:31], s67 offen offset:3072 nt lds
  v_mfma_f32_16x16x32_bf16 a[132:135], a[240:243], v[80:83], a[132:135]
  v_mfma_f32_16x16x32_bf16 a[132:135], a[240:243], v[84:87], a[132:135]
  v_mfma_f32_16x16x32_bf16 v[104:107], a[80:83], v[136:139], v[120:123]
  v_exp_f32 v100, v100
  v_mfma_f32_16x16x32_bf16 v[104:107], a[84:87], v[168:171], v[104:107]
  ds_read_b128 a[72:75], v18 offset:49152
  v_cvt_pk_bf16_f32 v39, v98, v99
  v_mfma_f32_16x16x32_bf16 v[104:107], a[88:91], v[200:203], v[104:107]
  s_waitcnt lgkmcnt(7)
  v_exp_f32 v101, v101
  v_mfma_f32_16x16x32_bf16 v[104:107], a[92:95], v[232:235], v[104:107]
  ds_read_b64_tr_b16 a[104:105], v21 offset:32768
  v_cvt_pk_bf16_f32 v46, v100, v101
  v_mfma_f32_16x16x32_bf16 v[248:251], v[64:67], a[120:123], v[248:251]
  v_exp_f32 v102, v102
  v_mfma_f32_16x16x32_bf16 v[248:251], v[68:71], a[124:127], v[248:251]
  ds_read_b64_tr_b16 a[106:107], v21 offset:33792
  v_mfma_f32_16x16x32_bf16 v[252:255], v[76:79], a[124:127], v[252:255]
  v_exp_f32 v103, v103
  v_mfma_f32_16x16x32_bf16 v[252:255], v[72:75], a[120:123], v[252:255]
  v_mfma_f32_16x16x32_bf16 v[108:111], a[80:83], v[140:143], v[124:127]
  v_exp_f32 v104, v104
  v_mfma_f32_16x16x32_bf16 v[108:111], a[84:87], v[172:175], v[108:111]
  ds_read_b128 a[76:79], v19 offset:49152
  v_cvt_pk_bf16_f32 v47, v102, v103
  v_mfma_f32_16x16x32_bf16 v[108:111], a[88:91], v[204:207], v[108:111]
  s_waitcnt lgkmcnt(3)
  v_exp_f32 v105, v105
  v_mfma_f32_16x16x32_bf16 v[108:111], a[92:95], v[236:239], v[108:111]
  ds_read_b64_tr_b16 a[108:109], v21 offset:34816
  v_cvt_pk_bf16_f32 v54, v104, v105
  v_mfma_f32_16x16x32_bf16 a[56:59], v[80:83], a[120:123], a[56:59]
  v_exp_f32 v106, v106
  v_mfma_f32_16x16x32_bf16 a[56:59], v[84:87], a[124:127], a[56:59]
  ds_read_b64_tr_b16 a[110:111], v21 offset:35840
  v_mfma_f32_16x16x32_bf16 a[60:63], v[92:95], a[124:127], a[60:63]
  v_exp_f32 v107, v107
  v_mfma_f32_16x16x32_bf16 a[60:63], v[88:91], a[120:123], a[60:63]
  v_cvt_pk_bf16_f32 v55, v106, v107
  v_mfma_f32_16x16x32_bf16 v[96:99], a[64:67], v[128:131], v[112:115]
  v_exp_f32 v108, v108
  v_mfma_f32_16x16x32_bf16 v[96:99], a[68:71], v[160:163], v[96:99]
  ds_read_b128 a[80:83], v16 offset:50176
  v_mfma_f32_16x16x32_bf16 v[96:99], a[72:75], v[192:195], v[96:99]
  s_waitcnt lgkmcnt(3)
  v_exp_f32 v109, v109
  v_mfma_f32_16x16x32_bf16 v[96:99], a[76:79], v[224:227], v[96:99]
  ds_read_b64_tr_b16 a[112:113], v22 offset:32768
  v_cvt_pk_bf16_f32 v62, v108, v109
  v_mfma_f32_16x16x32_bf16 v[144:147], v[32:35], a[96:99], v[144:147]
  v_exp_f32 v110, v110
  v_mfma_f32_16x16x32_bf16 v[144:147], v[36:39], a[100:103], v[144:147]
  ds_read_b64_tr_b16 a[114:115], v22 offset:33792
  v_mfma_f32_16x16x32_bf16 v[148:151], v[44:47], a[100:103], v[148:151]
  v_exp_f32 v111, v111
  v_mfma_f32_16x16x32_bf16 v[148:151], v[40:43], a[96:99], v[148:151]
  v_mfma_f32_16x16x32_bf16 v[100:103], a[64:67], v[132:135], v[116:119]
  v_exp_f32 v96, v96
  v_mfma_f32_16x16x32_bf16 v[100:103], a[68:71], v[164:167], v[100:103]
  ds_read_b128 a[84:87], v17 offset:50176
  v_cvt_pk_bf16_f32 v63, v110, v111
  v_mfma_f32_16x16x32_bf16 v[100:103], a[72:75], v[196:199], v[100:103]
  v_exp_f32 v97, v97
  v_mfma_f32_16x16x32_bf16 v[100:103], a[76:79], v[228:231], v[100:103]
  ds_read_b64_tr_b16 a[116:117], v22 offset:34816
  v_cvt_pk_bf16_f32 v64, v96, v97
  v_mfma_f32_16x16x32_bf16 a[0:3], v[48:51], a[96:99], a[0:3]
  v_exp_f32 v98, v98
  v_mfma_f32_16x16x32_bf16 a[0:3], v[52:55], a[100:103], a[0:3]
  s_xor_b32 s68, s10, 32768
  ds_read_b64_tr_b16 a[118:119], v22 offset:35840
  v_mfma_f32_16x16x32_bf16 a[4:7], v[60:63], a[100:103], a[4:7]
  s_add_u32 m0, s63, 65536
  v_exp_f32 v99, v99
  v_mfma_f32_16x16x32_bf16 a[4:7], v[56:59], a[96:99], a[4:7]
  buffer_load_dwordx4 v29, s[32:35], s68 offen offset:0 nt lds
  v_mfma_f32_16x16x32_bf16 v[104:107], a[64:67], v[136:139], v[120:123]
  v_exp_f32 v100, v100
  v_mfma_f32_16x16x32_bf16 v[104:107], a[68:71], v[168:171], v[104:107]
  ds_read_b128 a[88:91], v18 offset:50176
  v_cvt_pk_bf16_f32 v65, v98, v99
  v_mfma_f32_16x16x32_bf16 v[104:107], a[72:75], v[200:203], v[104:107]
  s_waitcnt lgkmcnt(7)
  v_exp_f32 v101, v101
  v_mfma_f32_16x16x32_bf16 v[104:107], a[76:79], v[232:235], v[104:107]
  ds_read_b64_tr_b16 a[120:121], v23 offset:32768
  v_cvt_pk_bf16_f32 v72, v100, v101
  v_mfma_f32_16x16x32_bf16 v[152:155], v[32:35], a[104:107], v[152:155]
  v_exp_f32 v102, v102
  v_mfma_f32_16x16x32_bf16 v[152:155], v[36:39], a[108:111], v[152:155]
  ds_read_b64_tr_b16 a[122:123], v23 offset:33792
  v_mfma_f32_16x16x32_bf16 v[156:159], v[44:47], a[108:111], v[156:159]
  v_exp_f32 v103, v103
  v_mfma_f32_16x16x32_bf16 v[156:159], v[40:43], a[104:107], v[156:159]
  v_mfma_f32_16x16x32_bf16 v[108:111], a[64:67], v[140:143], v[124:127]
  v_exp_f32 v104, v104
  v_mfma_f32_16x16x32_bf16 v[108:111], a[68:71], v[172:175], v[108:111]
  ds_read_b128 a[92:95], v19 offset:50176
  v_cvt_pk_bf16_f32 v73, v102, v103
  v_mfma_f32_16x16x32_bf16 v[108:111], a[72:75], v[204:207], v[108:111]
  s_waitcnt lgkmcnt(3)
  v_exp_f32 v105, v105
  v_mfma_f32_16x16x32_bf16 v[108:111], a[76:79], v[236:239], v[108:111]
  ds_read_b64_tr_b16 a[124:125], v23 offset:34816
  v_cvt_pk_bf16_f32 v80, v104, v105
  v_mfma_f32_16x16x32_bf16 a[8:11], v[48:51], a[104:107], a[8:11]
  v_exp_f32 v106, v106
  v_mfma_f32_16x16x32_bf16 a[8:11], v[52:55], a[108:111], a[8:11]
  ds_read_b64_tr_b16 a[126:127], v23 offset:35840
  v_mfma_f32_16x16x32_bf16 a[12:15], v[60:63], a[108:111], a[12:15]
  v_exp_f32 v107, v107
  v_mfma_f32_16x16x32_bf16 a[12:15], v[56:59], a[104:107], a[12:15]
  buffer_load_dwordx4 v29, s[32:35], s68 offen offset:1024 nt lds
  v_mfma_f32_16x16x32_bf16 a[128:131], a[244:247], v[40:43], a[128:131]
  v_mfma_f32_16x16x32_bf16 a[128:131], a[244:247], v[44:47], a[128:131]
  v_mfma_f32_16x16x32_bf16 v[96:99], a[80:83], v[128:131], v[112:115]
  v_exp_f32 v108, v108
  v_mfma_f32_16x16x32_bf16 v[96:99], a[84:87], v[160:163], v[96:99]
  ds_read_b128 a[64:67], v16 offset:51200
  v_cvt_pk_bf16_f32 v81, v106, v107
  v_mfma_f32_16x16x32_bf16 v[96:99], a[88:91], v[192:195], v[96:99]
  s_waitcnt lgkmcnt(3)
  v_exp_f32 v109, v109
  v_mfma_f32_16x16x32_bf16 v[96:99], a[92:95], v[224:227], v[96:99]
  ds_read_b64_tr_b16 a[96:97], v24 offset:32768
  v_cvt_pk_bf16_f32 v88, v108, v109
  v_mfma_f32_16x16x32_bf16 v[176:179], v[32:35], a[112:115], v[176:179]
  v_exp_f32 v110, v110
  v_mfma_f32_16x16x32_bf16 v[176:179], v[36:39], a[116:119], v[176:179]
  ds_read_b64_tr_b16 a[98:99], v24 offset:33792
  v_mfma_f32_16x16x32_bf16 v[180:183], v[44:47], a[116:119], v[180:183]
  v_exp_f32 v111, v111
  v_mfma_f32_16x16x32_bf16 v[180:183], v[40:43], a[112:115], v[180:183]
  buffer_load_dwordx4 v29, s[32:35], s68 offen offset:2048 nt lds
  v_mfma_f32_16x16x32_bf16 v[100:103], a[80:83], v[132:135], v[116:119]
  v_exp_f32 v96, v96
  v_mfma_f32_16x16x32_bf16 v[100:103], a[84:87], v[164:167], v[100:103]
  ds_read_b128 a[68:71], v17 offset:51200
  v_cvt_pk_bf16_f32 v89, v110, v111
  v_mfma_f32_16x16x32_bf16 v[100:103], a[88:91], v[196:199], v[100:103]
  v_exp_f32 v97, v97
  v_mfma_f32_16x16x32_bf16 v[100:103], a[92:95], v[228:231], v[100:103]
  ds_read_b64_tr_b16 a[100:101], v24 offset:34816
  v_cvt_pk_bf16_f32 v66, v96, v97
  v_mfma_f32_16x16x32_bf16 a[16:19], v[48:51], a[112:115], a[16:19]
  v_exp_f32 v98, v98
  v_mfma_f32_16x16x32_bf16 a[16:19], v[52:55], a[116:119], a[16:19]
  ds_read_b64_tr_b16 a[102:103], v24 offset:35840
  v_mfma_f32_16x16x32_bf16 a[20:23], v[60:63], a[116:119], a[20:23]
  v_exp_f32 v99, v99
  v_mfma_f32_16x16x32_bf16 a[20:23], v[56:59], a[112:115], a[20:23]
  v_mfma_f32_16x16x32_bf16 v[104:107], a[80:83], v[136:139], v[120:123]
  v_exp_f32 v100, v100
  v_mfma_f32_16x16x32_bf16 v[104:107], a[84:87], v[168:171], v[104:107]
  ds_read_b128 a[72:75], v18 offset:51200
  v_cvt_pk_bf16_f32 v67, v98, v99
  v_mfma_f32_16x16x32_bf16 v[104:107], a[88:91], v[200:203], v[104:107]
  s_waitcnt lgkmcnt(7)
  v_exp_f32 v101, v101
  v_mfma_f32_16x16x32_bf16 v[104:107], a[92:95], v[232:235], v[104:107]
  ds_read_b64_tr_b16 a[104:105], v25 offset:32768
  v_cvt_pk_bf16_f32 v74, v100, v101
  v_mfma_f32_16x16x32_bf16 v[184:187], v[32:35], a[120:123], v[184:187]
  v_exp_f32 v102, v102
  v_mfma_f32_16x16x32_bf16 v[184:187], v[36:39], a[124:127], v[184:187]
L_hop4:
  s_cbranch_execz L_hop8
  ds_read_b64_tr_b16 a[106:107], v25 offset:33792
  v_mfma_f32_16x16x32_bf16 v[188:191], v[44:47], a[124:127], v[188:191]
  v_exp_f32 v103, v103
  v_mfma_f32_16x16x32_bf16 v[188:191], v[40:43], a[120:123], v[188:191]
  buffer_load_dwordx4 v29, s[32:35], s68 offen offset:3072 nt lds
  v_mfma_f32_16x16x32_bf16 a[128:131], a[240:243], v[32:35], a[128:131]
  v_mfma_f32_16x16x32_bf16 a[128:131], a[240:243], v[36:39], a[128:131]
  v_mfma_f32_16x16x32_bf16 v[108:111], a[80:83], v[140:143], v[124:127]
  v_exp_f32 v104, v104
  v_mfma_f32_16x16x32_bf16 v[108:111], a[84:87], v[172:175], v[108:111]
  ds_read_b128 a[76:79], v19 offset:51200
  v_cvt_pk_bf16_f32 v75, v102, v103
  v_mfma_f32_16x16x32_bf16 v[108:111], a[88:91], v[204:207], v[108:111]
  s_waitcnt lgkmcnt(3)
  v_exp_f32 v105, v105
  v_mfma_f32_16x16x32_bf16 v[108:111], a[92:95], v[236:239], v[108:111]
  ds_read_b64_tr_b16 a[108:109], v25 offset:34816
  v_cvt_pk_bf16_f32 v82, v104, v105
  v_mfma_f32_16x16x32_bf16 a[24:27], v[48:51], a[120:123], a[24:27]
  v_exp_f32 v106, v106
  v_mfma_f32_16x16x32_bf16 a[24:27], v[52:55], a[124:127], a[24:27]
  s_xor_b32 s67, s10, 36864
  ds_read_b64_tr_b16 a[110:111], v25 offset:35840
  v_mfma_f32_16x16x32_bf16 a[28:31], v[60:63], a[124:127], a[28:31]
  s_add_u32 m0, s63, 16384
  v_exp_f32 v107, v107
  v_mfma_f32_16x16x32_bf16 a[28:31], v[56:59], a[120:123], a[28:31]
  buffer_load_dwordx4 v28, s[28:31], s67 offen offset:0 nt lds
  v_mfma_f32_16x16x32_bf16 v[96:99], a[64:67], v[128:131], v[112:115]
  v_exp_f32 v108, v108
  v_mfma_f32_16x16x32_bf16 v[96:99], a[68:71], v[160:163], v[96:99]
  ds_read_b128 a[80:83], v16 offset:52224
  v_cvt_pk_bf16_f32 v83, v106, v107
  v_mfma_f32_16x16x32_bf16 v[96:99], a[72:75], v[192:195], v[96:99]
  s_waitcnt lgkmcnt(3)
  v_exp_f32 v109, v109
  v_mfma_f32_16x16x32_bf16 v[96:99], a[76:79], v[224:227], v[96:99]
  ds_read_b64_tr_b16 a[112:113], v26 offset:32768
  v_cvt_pk_bf16_f32 v90, v108, v109
  v_mfma_f32_16x16x32_bf16 v[208:211], v[32:35], a[96:99], v[208:211]
  v_exp_f32 v110, v110
  v_mfma_f32_16x16x32_bf16 v[208:211], v[36:39], a[100:103], v[208:211]
  ds_read_b64_tr_b16 a[114:115], v26 offset:33792
  v_mfma_f32_16x16x32_bf16 v[212:215], v[44:47], a[100:103], v[212:215]
  v_exp_f32 v111, v111
  v_mfma_f32_16x16x32_bf16 v[212:215], v[40:43], a[96:99], v[212:215]
  v_mfma_f32_16x16x32_bf16 v[100:103], a[64:67], v[132:135], v[116:119]
  v_exp_f32 v96, v96
  v_mfma_f32_16x16x32_bf16 v[100:103], a[68:71], v[164:167], v[100:103]
  ds_read_b128 a[84:87], v17 offset:52224
  v_cvt_pk_bf16_f32 v91, v110, v111
  v_mfma_f32_16x16x32_bf16 v[100:103], a[72:75], v[196:199], v[100:103]
  v_exp_f32 v97, v97
  v_mfma_f32_16x16x32_bf16 v[100:103], a[76:79], v[228:231], v[100:103]
  ds_read_b64_tr_b16 a[116:117], v26 offset:34816
  v_cvt_pk_bf16_f32 v68, v96, v97
  v_mfma_f32_16x16x32_bf16 a[32:35], v[48:51], a[96:99], a[32:35]
  v_exp_f32 v98, v98
  v_mfma_f32_16x16x32_bf16 a[32:35], v[52:55], a[100:103], a[32:35]
  ds_read_b64_tr_b16 a[118:119], v26 offset:35840
  v_mfma_f32_16x16x32_bf16 a[36:39], v[60:63], a[100:103], a[36:39]
  v_exp_f32 v99, v99
  v_mfma_f32_16x16x32_bf16 a[36:39], v[56:59], a[96:99], a[36:39]
  buffer_load_dwordx4 v28, s[28:31], s67 offen offset:1024 nt lds
  v_mfma_f32_16x16x32_bf16 a[132:135], a[244:247], v[56:59], a[132:135]
  v_mfma_f32_16x16x32_bf16 a[132:135], a[244:247], v[60:63], a[132:135]
  v_mfma_f32_16x16x32_bf16 v[104:107], a[64:67], v[136:139], v[120:123]
  v_exp_f32 v100, v100
  v_mfma_f32_16x16x32_bf16 v[104:107], a[68:71], v[168:171], v[104:107]
  ds_read_b128 a[88:91], v18 offset:52224
  v_cvt_pk_bf16_f32 v69, v98, v99
  v_mfma_f32_16x16x32_bf16 v[104:107], a[72:75], v[200:203], v[104:107]
  s_waitcnt lgkmcnt(7)
  v_exp_f32 v101, v101
  v_mfma_f32_16x16x32_bf16 v[104:107], a[76:79], v[232:235], v[104:107]
  ds_read_b64_tr_b16 a[120:121], v27 offset:32768
  v_cvt_pk_bf16_f32 v76, v100, v101
  v_mfma_f32_16x16x32_bf16 v[216:219], v[32:35], a[104:107], v[216:219]
  v_exp_f32 v102, v102
  v_mfma_f32_16x16x32_bf16 v[216:219], v[36:39], a[108:111], v[216:219]
  ds_read_b64_tr_b16 a[122:123], v27 offset:33792
  v_mfma_f32_16x16x32_bf16 v[220:223], v[44:47], a[108:111], v[220:223]
  v_exp_f32 v103, v103
  v_mfma_f32_16x16x32_bf16 v[220:223], v[40:43], a[104:107], v[220:223]
  buffer_load_dwordx4 v28, s[28:31], s67 offen offset:2048 nt lds
  v_mfma_f32_16x16x32_bf16 v[108:111], a[64:67], v[140:143], v[124:127]
  v_exp_f32 v104, v104
  v_mfma_f32_16x16x32_bf16 v[108:111], a[68:71], v[172:175], v[108:111]
  ds_read_b128 a[92:95], v19 offset:52224
  v_cvt_pk_bf16_f32 v77, v102, v103
  v_mfma_f32_16x16x32_bf16 v[108:111], a[72:75], v[204:207], v[108:111]
  s_waitcnt lgkmcnt(3)
  v_exp_f32 v105, v105
  v_mfma_f32_16x16x32_bf16 v[108:111], a[76:79], v[236:239], v[108:111]
  ds_read_b64_tr_b16 a[124:125], v27 offset:34816
  v_cvt_pk_bf16_f32 v84, v104, v105
  v_mfma_f32_16x16x32_bf16 a[40:43], v[48:51], a[104:107], a[40:43]
  v_exp_f32 v106, v106
  v_mfma_f32_16x16x32_bf16 a[40:43], v[52:55], a[108:111], a[40:43]
  ds_read_b64_tr_b16 a[126:127], v27 offset:35840
  v_mfma_f32_16x16x32_bf16 a[44:47], v[60:63], a[108:111], a[44:47]
  s_waitcnt vmcnt(7)
  v_exp_f32 v107, v107
  v_mfma_f32_16x16x32_bf16 a[44:47], v[56:59], a[104:107], a[44:47]
  buffer_load_dwordx4 v28, s[28:31], s67 offen offset:3072 nt lds
  v_mfma_f32_16x16x32_bf16 v[96:99], a[80:83], v[128:131], v[112:115]
  s_barrier
  v_exp_f32 v108, v108
  v_mfma_f32_16x16x32_bf16 v[96:99], a[84:87], v[160:163], v[96:99]
  ds_read_b128 a[64:67], v16 offset:0
  v_cvt_pk_bf16_f32 v85, v106, v107
  v_mfma_f32_16x16x32_bf16 v[96:99], a[88:91], v[192:195], v[96:99]
  s_waitcnt lgkmcnt(3)
  v_exp_f32 v109, v109
  v_mfma_f32_16x16x32_bf16 v[96:99], a[92:95], v[224:227], v[96:99]
  ds_read_b64_tr_b16 a[96:97], v20 offset:49152
  v_cvt_pk_bf16_f32 v92, v108, v109
  v_mfma_f32_16x16x32_bf16 v[240:243], v[32:35], a[112:115], v[240:243]
  v_exp_f32 v110, v110
  v_mfma_f32_16x16x32_bf16 v[240:243], v[36:39], a[116:119], v[240:243]
  ds_read_b64_tr_b16 a[98:99], v20 offset:50176
  v_mfma_f32_16x16x32_bf16 v[244:247], v[44:47], a[116:119], v[244:247]
  v_exp_f32 v111, v111
  v_mfma_f32_16x16x32_bf16 v[244:247], v[40:43], a[112:115], v[244:247]
  v_mfma_f32_16x16x32_bf16 v[100:103], a[80:83], v[132:135], v[116:119]
  v_exp_f32 v96, v96
  v_mfma_f32_16x16x32_bf16 v[100:103], a[84:87], v[164:167], v[100:103]
  ds_read_b128 a[68:71], v17 offset:0
  v_cvt_pk_bf16_f32 v93, v110, v111
  v_mfma_f32_16x16x32_bf16 v[100:103], a[88:91], v[196:199], v[100:103]
  v_exp_f32 v97, v97
  v_mfma_f32_16x16x32_bf16 v[100:103], a[92:95], v[228:231], v[100:103]
  ds_read_b64_tr_b16 a[100:101], v20 offset:51200
  v_cvt_pk_bf16_f32 v70, v96, v97
  v_mfma_f32_16x16x32_bf16 a[48:51], v[48:51], a[112:115], a[48:51]
  v_exp_f32 v98, v98
  v_mfma_f32_16x16x32_bf16 a[48:51], v[52:55], a[116:119], a[48:51]
  s_xor_b32 s68, s10, 36864
  ds_read_b64_tr_b16 a[102:103], v20 offset:52224
  v_mfma_f32_16x16x32_bf16 a[52:55], v[60:63], a[116:119], a[52:55]
  s_add_u32 m0, s63, 81920
  v_exp_f32 v99, v99
  v_mfma_f32_16x16x32_bf16 a[52:55], v[56:59], a[112:115], a[52:55]
  buffer_load_dwordx4 v29, s[32:35], s68 offen offset:0 nt lds
  v_mfma_f32_16x16x32_bf16 a[132:135], a[240:243], v[48:51], a[132:135]
  v_mfma_f32_16x16x32_bf16 a[132:135], a[240:243], v[52:55], a[132:135]
  v_mfma_f32_16x16x32_bf16 v[104:107], a[80:83], v[136:139], v[120:123]
  v_exp_f32 v100, v100
  v_mfma_f32_16x16x32_bf16 v[104:107], a[84:87], v[168:171], v[104:107]
  ds_read_b128 a[72:75], v18 offset:0
  v_cvt_pk_bf16_f32 v71, v98, v99
  v_mfma_f32_16x16x32_bf16 v[104:107], a[88:91], v[200:203], v[104:107]
  s_waitcnt lgkmcnt(7)
  v_exp_f32 v101, v101
  v_mfma_f32_16x16x32_bf16 v[104:107], a[92:95], v[232:235], v[104:107]
  ds_read_b64_tr_b16 a[104:105], v21 offset:49152
  v_cvt_pk_bf16_f32 v78, v100, v101
  v_mfma_f32_16x16x32_bf16 v[248:251], v[32:35], a[120:123], v[248:251]
  v_exp_f32 v102, v102
  v_mfma_f32_16x16x32_bf16 v[248:251], v[36:39], a[124:127], v[248:251]
  ds_read_b64_tr_b16 a[106:107], v21 offset:50176
  v_mfma_f32_16x16x32_bf16 v[252:255], v[44:47], a[124:127], v[252:255]
  v_exp_f32 v103, v103
  v_mfma_f32_16x16x32_bf16 v[252:255], v[40:43], a[120:123], v[252:255]
  v_mfma_f32_16x16x32_bf16 v[108:111], a[80:83], v[140:143], v[124:127]
  v_exp_f32 v104, v104
  v_mfma_f32_16x16x32_bf16 v[108:111], a[84:87], v[172:175], v[108:111]
  ds_read_b128 a[76:79], v19 offset:0
  v_cvt_pk_bf16_f32 v79, v102, v103
  v_mfma_f32_16x16x32_bf16 v[108:111], a[88:91], v[204:207], v[108:111]
  s_waitcnt lgkmcnt(3)
  v_exp_f32 v105, v105
  v_mfma_f32_16x16x32_bf16 v[108:111], a[92:95], v[236:239], v[108:111]
  ds_read_b64_tr_b16 a[108:109], v21 offset:51200
  v_cvt_pk_bf16_f32 v86, v104, v105
  v_mfma_f32_16x16x32_bf16 a[56:59], v[48:51], a[120:123], a[56:59]
  v_exp_f32 v106, v106
  v_mfma_f32_16x16x32_bf16 a[56:59], v[52:55], a[124:127], a[56:59]
  ds_read_b64_tr_b16 a[110:111], v21 offset:52224
  v_mfma_f32_16x16x32_bf16 a[60:63], v[60:63], a[124:127], a[60:63]
  v_exp_f32 v107, v107
  v_mfma_f32_16x16x32_bf16 a[60:63], v[56:59], a[120:123], a[60:63]
  v_cvt_pk_bf16_f32 v87, v106, v107
  v_mfma_f32_16x16x32_bf16 v[96:99], a[64:67], v[128:131], v[112:115]
  v_exp_f32 v108, v108
  v_mfma_f32_16x16x32_bf16 v[96:99], a[68:71], v[160:163], v[96:99]
  ds_read_b128 a[80:83], v16 offset:1024
  v_mfma_f32_16x16x32_bf16 v[96:99], a[72:75], v[192:195], v[96:99]
  s_waitcnt lgkmcnt(3)
  v_exp_f32 v109, v109
  v_mfma_f32_16x16x32_bf16 v[96:99], a[76:79], v[224:227], v[96:99]
  ds_read_b64_tr_b16 a[112:113], v22 offset:49152
  v_cvt_pk_bf16_f32 v94, v108, v109
  v_mfma_f32_16x16x32_bf16 v[144:147], v[64:67], a[96:99], v[144:147]
  v_exp_f32 v110, v110
  v_mfma_f32_16x16x32_bf16 v[144:147], v[68:71], a[100:103], v[144:147]
  ds_read_b64_tr_b16 a[114:115], v22 offset:50176
  v_mfma_f32_16x16x32_bf16 v[148:151], v[76:79], a[100:103], v[148:151]
  v_exp_f32 v111, v111
  v_mfma_f32_16x16x32_bf16 v[148:151], v[72:75], a[96:99], v[148:151]
  v_mfma_f32_16x16x32_bf16 v[100:103], a[64:67], v[132:135], v[116:119]
  v_exp_f32 v96, v96
  v_mfma_f32_16x16x32_bf16 v[100:103], a[68:71], v[164:167], v[100:103]
  ds_read_b128 a[84:87], v17 offset:1024
  v_cvt_pk_bf16_f32 v95, v110, v111
  v_mfma_f32_16x16x32_bf16 v[100:103], a[72:75], v[196:199], v[100:103]
  v_exp_f32 v97, v97
  v_mfma_f32_16x16x32_bf16 v[100:103], a[76:79], v[228:231], v[100:103]
  ds_read_b64_tr_b16 a[116:117], v22 offset:51200
  v_cvt_pk_bf16_f32 v32, v96, v97
  v_mfma_f32_16x16x32_bf16 a[0:3], v[80:83], a[96:99], a[0:3]
  v_exp_f32 v98, v98
  v_mfma_f32_16x16x32_bf16 a[0:3], v[84:87], a[100:103], a[0:3]
  ds_read_b64_tr_b16 a[118:119], v22 offset:52224
  v_mfma_f32_16x16x32_bf16 a[4:7], v[92:95], a[100:103], a[4:7]
  v_exp_f32 v99, v99
  v_mfma_f32_16x16x32_bf16 a[4:7], v[88:91], a[96:99], a[4:7]
  buffer_load_dwordx4 v29, s[32:35], s68 offen offset:1024 nt lds
  v_mfma_f32_16x16x32_bf16 v[104:107], a[64:67], v[136:139], v[120:123]
  v_exp_f32 v100, v100
  v_mfma_f32_16x16x32_bf16 v[104:107], a[68:71], v[168:171], v[104:107]
  ds_read_b128 a[88:91], v18 offset:1024
  v_cvt_pk_bf16_f32 v33, v98, v99
  v_mfma_f32_16x16x32_bf16 v[104:107], a[72:75], v[200:203], v[104:107]
  s_waitcnt lgkmcnt(7)
  v_exp_f32 v101, v101
  v_mfma_f32_16x16x32_bf16 v[104:107], a[76:79], v[232:235], v[104:107]
  ds_read_b64_tr_b16 a[120:121], v23 offset:49152
  v_cvt_pk_bf16_f32 v40, v100, v101
  v_mfma_f32_16x16x32_bf16 v[152:155], v[64:67], a[104:107], v[152:155]
  v_exp_f32 v102, v102
  v_mfma_f32_16x16x32_bf16 v[152:155], v[68:71], a[108:111], v[152:155]
  ds_read_b64_tr_b16 a[122:123], v23 offset:50176
  v_mfma_f32_16x16x32_bf16 v[156:159], v[76:79], a[108:111], v[156:159]
  v_exp_f32 v103, v103
  v_mfma_f32_16x16x32_bf16 v[156:159], v[72:75], a[104:107], v[156:159]
  v_mfma_f32_16x16x32_bf16 v[108:111], a[64:67], v[140:143], v[124:127]
  v_exp_f32 v104, v104
  v_mfma_f32_16x16x32_bf16 v[108:111], a[68:71], v[172:175], v[108:111]
  ds_read_b128 a[92:95], v19 offset:1024
  v_cvt_pk_bf16_f32 v41, v102, v103
  v_mfma_f32_16x16x32_bf16 v[108:111], a[72:75], v[204:207], v[108:111]
  s_waitcnt lgkmcnt(3)
  v_exp_f32 v105, v105
  v_mfma_f32_16x16x32_bf16 v[108:111], a[76:79], v[236:239], v[108:111]
  ds_read_b64_tr_b16 a[124:125], v23 offset:51200
  v_cvt_pk_bf16_f32 v48, v104, v105
  v_mfma_f32_16x16x32_bf16 a[8:11], v[80:83], a[104:107], a[8:11]
  v_exp_f32 v106, v106
  v_mfma_f32_16x16x32_bf16 a[8:11], v[84:87], a[108:111], a[8:11]
  ds_read_b64_tr_b16 a[126:127], v23 offset:52224
  v_mfma_f32_16x16x32_bf16 a[12:15], v[92:95], a[108:111], a[12:15]
  v_exp_f32 v107, v107
  v_mfma_f32_16x16x32_bf16 a[12:15], v[88:91], a[104:107], a[12:15]
  buffer_load_dwordx4 v29, s[32:35], s68 offen offset:2048 nt lds
  v_mfma_f32_16x16x32_bf16 a[128:131], a[244:247], v[72:75], a[128:131]
  v_mfma_f32_16x16x32_bf16 a[128:131], a[244:247], v[76:79], a[128:131]
  v_mfma_f32_16x16x32_bf16 v[96:99], a[80:83], v[128:131], v[112:115]
  v_exp_f32 v108, v108
  v_mfma_f32_16x16x32_bf16 v[96:99], a[84:87], v[160:163], v[96:99]
  ds_read_b128 a[64:67], v16 offset:2048
  v_cvt_pk_bf16_f32 v49, v106, v107
  v_mfma_f32_16x16x32_bf16 v[96:99], a[88:91], v[192:195], v[96:99]
  s_waitcnt lgkmcnt(3)
  v_exp_f32 v109, v109
  v_mfma_f32_16x16x32_bf16 v[96:99], a[92:95], v[224:227], v[96:99]
  ds_read_b64_tr_b16 a[96:97], v24 offset:49152
  v_cvt_pk_bf16_f32 v56, v108, v109
  v_mfma_f32_16x16x32_bf16 v[176:179], v[64:67], a[112:115], v[176:179]
  v_exp_f32 v110, v110
  v_mfma_f32_16x16x32_bf16 v[176:179], v[68:71], a[116:119], v[176:179]
  ds_read_b64_tr_b16 a[98:99], v24 offset:50176
  v_mfma_f32_16x16x32_bf16 v[180:183], v[76:79], a[116:119], v[180:183]
  v_exp_f32 v111, v111
  v_mfma_f32_16x16x32_bf16 v[180:183], v[72:75], a[112:115], v[180:183]
  buffer_load_dwordx4 v29, s[32:35], s68 offen offset:3072 nt lds
  v_mfma_f32_16x16x32_bf16 v[100:103], a[80:83], v[132:135], v[116:119]
  v_exp_f32 v96, v96
  v_mfma_f32_16x16x32_bf16 v[100:103], a[84:87], v[164:167], v[100:103]
  ds_read_b128 a[68:71], v17 offset:2048
  v_cvt_pk_bf16_f32 v57, v110, v111
  v_mfma_f32_16x16x32_bf16 v[100:103], a[88:91], v[196:199], v[100:103]
  v_exp_f32 v97, v97
  v_mfma_f32_16x16x32_bf16 v[100:103], a[92:95], v[228:231], v[100:103]
  ds_read_b64_tr_b16 a[100:101], v24 offset:51200
  v_cvt_pk_bf16_f32 v34, v96, v97
  v_mfma_f32_16x16x32_bf16 a[16:19], v[80:83], a[112:115], a[16:19]
  v_exp_f32 v98, v98
  v_mfma_f32_16x16x32_bf16 a[16:19], v[84:87], a[116:119], a[16:19]
  ds_read_b64_tr_b16 a[102:103], v24 offset:52224
  v_mfma_f32_16x16x32_bf16 a[20:23], v[92:95], a[116:119], a[20:23]
  v_exp_f32 v99, v99
  v_mfma_f32_16x16x32_bf16 a[20:23], v[88:91], a[112:115], a[20:23]
  v_mfma_f32_16x16x32_bf16 v[104:107], a[80:83], v[136:139], v[120:123]
  v_exp_f32 v100, v100
  v_mfma_f32_16x16x32_bf16 v[104:107], a[84:87], v[168:171], v[104:107]
  ds_read_b128 a[72:75], v18 offset:2048
  v_cvt_pk_bf16_f32 v35, v98, v99
  v_mfma_f32_16x16x32_bf16 v[104:107], a[88:91], v[200:203], v[104:107]
  s_waitcnt lgkmcnt(7)
  v_exp_f32 v101, v101
  v_mfma_f32_16x16x32_bf16 v[104:107], a[92:95], v[232:235], v[104:107]
  ds_read_b64_tr_b16 a[104:105], v25 offset:49152
  v_cvt_pk_bf16_f32 v42, v100, v101
  v_mfma_f32_16x16x32_bf16 v[184:187], v[64:67], a[120:123], v[184:187]
  v_exp_f32 v102, v102
  v_mfma_f32_16x16x32_bf16 v[184:187], v[68:71], a[124:127], v[184:187]
  s_xor_b32 s67, s10, 49152
  ds_read_b64_tr_b16 a[106:107], v25 offset:50176
  v_mfma_f32_16x16x32_bf16 v[188:191], v[76:79], a[124:127], v[188:191]
  s_add_u32 m0, s63, 32768
  v_exp_f32 v103, v103
  v_mfma_f32_16x16x32_bf16 v[188:191], v[72:75], a[120:123], v[188:191]
  buffer_load_dwordx4 v28, s[28:31], s67 offen offset:0 nt lds
  v_mfma_f32_16x16x32_bf16 a[128:131], a[240:243], v[64:67], a[128:131]
  v_mfma_f32_16x16x32_bf16 a[128:131], a[240:243], v[68:71], a[128:131]
  v_mfma_f32_16x16x32_bf16 v[108:111], a[80:83], v[140:143], v[124:127]
  v_exp_f32 v104, v104
  v_mfma_f32_16x16x32_bf16 v[108:111], a[84:87], v[172:175], v[108:111]
  ds_read_b128 a[76:79], v19 offset:2048
  v_cvt_pk_bf16_f32 v43, v102, v103
  v_mfma_f32_16x16x32_bf16 v[108:111], a[88:91], v[204:207], v[108:111]
  s_waitcnt lgkmcnt(3)
  v_exp_f32 v105, v105
  v_mfma_f32_16x16x32_bf16 v[108:111], a[92:95], v[236:239], v[108:111]
  ds_read_b64_tr_b16 a[108:109], v25 offset:51200
  v_cvt_pk_bf16_f32 v50, v104, v105
  v_mfma_f32_16x16x32_bf16 a[24:27], v[80:83], a[120:123], a[24:27]
  v_exp_f32 v106, v106
  v_mfma_f32_16x16x32_bf16 a[24:27], v[84:87], a[124:127], a[24:27]
  ds_read_b64_tr_b16 a[110:111], v25 offset:52224
  v_mfma_f32_16x16x32_bf16 a[28:31], v[92:95], a[124:127], a[28:31]
  v_exp_f32 v107, v107
  v_mfma_f32_16x16x32_bf16 a[28:31], v[88:91], a[120:123], a[28:31]
  buffer_load_dwordx4 v28, s[28:31], s67 offen offset:1024 nt lds
  v_mfma_f32_16x16x32_bf16 v[96:99], a[64:67], v[128:131], v[112:115]
  v_exp_f32 v108, v108
  v_mfma_f32_16x16x32_bf16 v[96:99], a[68:71], v[160:163], v[96:99]
  ds_read_b128 a[80:83], v16 offset:3072
  v_cvt_pk_bf16_f32 v51, v106, v107
  v_mfma_f32_16x16x32_bf16 v[96:99], a[72:75], v[192:195], v[96:99]
  s_waitcnt lgkmcnt(3)
  v_exp_f32 v109, v109
  v_mfma_f32_16x16x32_bf16 v[96:99], a[76:79], v[224:227], v[96:99]
  ds_read_b64_tr_b16 a[112:113], v26 offset:49152
  v_cvt_pk_bf16_f32 v58, v108, v109
  v_mfma_f32_16x16x32_bf16 v[208:211], v[64:67], a[96:99], v[208:211]
  v_exp_f32 v110, v110
  v_mfma_f32_16x16x32_bf16 v[208:211], v[68:71], a[100:103], v[208:211]
  ds_read_b64_tr_b16 a[114:115], v26 offset:50176
  v_mfma_f32_16x16x32_bf16 v[212:215], v[76:79], a[100:103], v[212:215]
  v_exp_f32 v111, v111
  v_mfma_f32_16x16x32_bf16 v[212:215], v[72:75], a[96:99], v[212:215]
  v_mfma_f32_16x16x32_bf16 v[100:103], a[64:67], v[132:135], v[116:119]
  v_exp_f32 v96, v96
  v_mfma_f32_16x16x32_bf16 v[100:103], a[68:71], v[164:167], v[100:103]
  ds_read_b128 a[84:87], v17 offset:3072
  v_cvt_pk_bf16_f32 v59, v110, v111
  v_mfma_f32_16x16x32_bf16 v[100:103], a[72:75], v[196:199], v[100:103]
  v_exp_f32 v97, v97
  v_mfma_f32_16x16x32_bf16 v[100:103], a[76:79], v[228:231], v[100:103]
  ds_read_b64_tr_b16 a[116:117], v26 offset:51200
  v_cvt_pk_bf16_f32 v36, v96, v97
  v_mfma_f32_16x16x32_bf16 a[32:35], v[80:83], a[96:99], a[32:35]
  v_exp_f32 v98, v98
  v_mfma_f32_16x16x32_bf16 a[32:35], v[84:87], a[100:103], a[32:35]
  ds_read_b64_tr_b16 a[118:119], v26 offset:52224
  v_mfma_f32_16x16x32_bf16 a[36:39], v[92:95], a[100:103], a[36:39]
  v_exp_f32 v99, v99
  v_mfma_f32_16x16x32_bf16 a[36:39], v[88:91], a[96:99], a[36:39]
  buffer_load_dwordx4 v28, s[28:31], s67 offen offset:2048 nt lds
  v_mfma_f32_16x16x32_bf16 a[132:135], a[244:247], v[88:91], a[132:135]
  v_mfma_f32_16x16x32_bf16 a[132:135], a[244:247], v[92:95], a[132:135]
  v_mfma_f32_16x16x32_bf16 v[104:107], a[64:67], v[136:139], v[120:123]
  v_exp_f32 v100, v100
  v_mfma_f32_16x16x32_bf16 v[104:107], a[68:71], v[168:171], v[104:107]
  ds_read_b128 a[88:91], v18 offset:3072
  v_cvt_pk_bf16_f32 v37, v98, v99
  v_mfma_f32_16x16x32_bf16 v[104:107], a[72:75], v[200:203], v[104:107]
  s_waitcnt lgkmcnt(7)
  v_exp_f32 v101, v101
  v_mfma_f32_16x16x32_bf16 v[104:107], a[76:79], v[232:235], v[104:107]
  ds_read_b64_tr_b16 a[120:121], v27 offset:49152
  v_cvt_pk_bf16_f32 v44, v100, v101
  v_mfma_f32_16x16x32_bf16 v[216:219], v[64:67], a[104:107], v[216:219]
  v_exp_f32 v102, v102
  v_mfma_f32_16x16x32_bf16 v[216:219], v[68:71], a[108:111], v[216:219]
  ds_read_b64_tr_b16 a[122:123], v27 offset:50176
  v_mfma_f32_16x16x32_bf16 v[220:223], v[76:79], a[108:111], v[220:223]
  v_exp_f32 v103, v103
  v_mfma_f32_16x16x32_bf16 v[220:223], v[72:75], a[104:107], v[220:223]
  buffer_load_dwordx4 v28, s[28:31], s67 offen offset:3072 nt lds
  v_mfma_f32_16x16x32_bf16 v[108:111], a[64:67], v[140:143], v[124:127]
  v_exp_f32 v104, v104
  v_mfma_f32_16x16x32_bf16 v[108:111], a[68:71], v[172:175], v[108:111]
  ds_read_b128 a[92:95], v19 offset:3072
  v_cvt_pk_bf16_f32 v45, v102, v103
  v_mfma_f32_16x16x32_bf16 v[108:111], a[72:75], v[204:207], v[108:111]
  s_waitcnt lgkmcnt(3)
  v_exp_f32 v105, v105
  v_mfma_f32_16x16x32_bf16 v[108:111], a[76:79], v[236:239], v[108:111]
  ds_read_b64_tr_b16 a[124:125], v27 offset:51200
  v_cvt_pk_bf16_f32 v52, v104, v105
  v_mfma_f32_16x16x32_bf16 a[40:43], v[80:83], a[104:107], a[40:43]
  v_exp_f32 v106, v106
  v_mfma_f32_16x16x32_bf16 a[40:43], v[84:87], a[108:111], a[40:43]
  ds_read_b64_tr_b16 a[126:127], v27 offset:52224
  v_mfma_f32_16x16x32_bf16 a[44:47], v[92:95], a[108:111], a[44:47]
  s_waitcnt vmcnt(8)
  v_exp_f32 v107, v107
  v_mfma_f32_16x16x32_bf16 a[44:47], v[88:91], a[104:107], a[44:47]
  v_mfma_f32_16x16x32_bf16 v[96:99], a[80:83], v[128:131], v[112:115]
  s_barrier
  v_exp_f32 v108, v108
  v_mfma_f32_16x16x32_bf16 v[96:99], a[84:87], v[160:163], v[96:99]
  ds_read_b128 a[64:67], v16 offset:16384
  v_cvt_pk_bf16_f32 v53, v106, v107
  v_mfma_f32_16x16x32_bf16 v[96:99], a[88:91], v[192:195], v[96:99]
  s_waitcnt lgkmcnt(3)
  v_exp_f32 v109, v109
  v_mfma_f32_16x16x32_bf16 v[96:99], a[92:95], v[224:227], v[96:99]
  ds_read_b64_tr_b16 a[96:97], v20 offset:0
  v_cvt_pk_bf16_f32 v60, v108, v109
  v_mfma_f32_16x16x32_bf16 v[240:243], v[64:67], a[112:115], v[240:243]
  v_exp_f32 v110, v110
  v_mfma_f32_16x16x32_bf16 v[240:243], v[68:71], a[116:119], v[240:243]
  ds_read_b64_tr_b16 a[98:99], v20 offset:1024
  v_mfma_f32_16x16x32_bf16 v[244:247], v[76:79], a[116:119], v[244:247]
  v_exp_f32 v111, v111
  v_mfma_f32_16x16x32_bf16 v[244:247], v[72:75], a[112:115], v[244:247]
  v_mfma_f32_16x16x32_bf16 v[100:103], a[80:83], v[132:135], v[116:119]
  v_exp_f32 v96, v96
  v_mfma_f32_16x16x32_bf16 v[100:103], a[84:87], v[164:167], v[100:103]
  ds_read_b128 a[68:71], v17 offset:16384
  v_cvt_pk_bf16_f32 v61, v110, v111
  v_mfma_f32_16x16x32_bf16 v[100:103], a[88:91], v[196:199], v[100:103]
  v_exp_f32 v97, v97
  v_mfma_f32_16x16x32_bf16 v[100:103], a[92:95], v[228:231], v[100:103]
  ds_read_b64_tr_b16 a[100:101], v20 offset:2048
  v_cvt_pk_bf16_f32 v38, v96, v97
  v_mfma_f32_16x16x32_bf16 a[48:51], v[80:83], a[112:115], a[48:51]
  v_exp_f32 v98, v98
  v_mfma_f32_16x16x32_bf16 a[48:51], v[84:87], a[116:119], a[48:51]
  s_xor_b32 s68, s10, 49152
  ds_read_b64_tr_b16 a[102:103], v20 offset:3072
  v_mfma_f32_16x16x32_bf16 a[52:55], v[92:95], a[116:119], a[52:55]
  s_add_u32 m0, s63, 98304
  v_exp_f32 v99, v99
  v_mfma_f32_16x16x32_bf16 a[52:55], v[88:91], a[112:115], a[52:55]
  buffer_load_dwordx4 v29, s[32:35], s68 offen offset:0 nt lds
  v_mfma_f32_16x16x32_bf16 a[132:135], a[240:243], v[80:83], a[132:135]
  v_mfma_f32_16x16x32_bf16 a[132:135], a[240:243], v[84:87], a[132:135]
  v_mfma_f32_16x16x32_bf16 v[104:107], a[80:83], v[136:139], v[120:123]
  v_exp_f32 v100, v100
  v_mfma_f32_16x16x32_bf16 v[104:107], a[84:87], v[168:171], v[104:107]
  ds_read_b128 a[72:75], v18 offset:16384
  v_cvt_pk_bf16_f32 v39, v98, v99
  v_mfma_f32_16x16x32_bf16 v[104:107], a[88:91], v[200:203], v[104:107]
  s_waitcnt lgkmcnt(7)
  v_exp_f32 v101, v101
  v_mfma_f32_16x16x32_bf16 v[104:107], a[92:95], v[232:235], v[104:107]
  ds_read_b64_tr_b16 a[104:105], v21 offset:0
  v_cvt_pk_bf16_f32 v46, v100, v101
  v_mfma_f32_16x16x32_bf16 v[248:251], v[64:67], a[120:123], v[248:251]
  v_exp_f32 v102, v102
  v_mfma_f32_16x16x32_bf16 v[248:251], v[68:71], a[124:127], v[248:251]
  ds_read_b64_tr_b16 a[106:107], v21 offset:1024
  v_mfma_f32_16x16x32_bf16 v[252:255], v[76:79], a[124:127], v[252:255]
  v_exp_f32 v103, v103
  v_mfma_f32_16x16x32_bf16 v[252:255], v[72:75], a[120:123], v[252:255]
  v_mfma_f32_16x16x32_bf16 v[108:111], a[80:83], v[140:143], v[124:127]
  v_exp_f32 v104, v104
  v_mfma_f32_16x16x32_bf16 v[108:111], a[84:87], v[172:175], v[108:111]
  ds_read_b128 a[76:79], v19 offset:16384
  v_cvt_pk_bf16_f32 v47, v102, v103
  v_mfma_f32_16x16x32_bf16 v[108:111], a[88:91], v[204:207], v[108:111]
  s_waitcnt lgkmcnt(3)
  v_exp_f32 v105, v105
  v_mfma_f32_16x16x32_bf16 v[108:111], a[92:95], v[236:239], v[108:111]
  ds_read_b64_tr_b16 a[108:109], v21 offset:2048
  v_cvt_pk_bf16_f32 v54, v104, v105
  v_mfma_f32_16x16x32_bf16 a[56:59], v[80:83], a[120:123], a[56:59]
  v_exp_f32 v106, v106
  v_mfma_f32_16x16x32_bf16 a[56:59], v[84:87], a[124:127], a[56:59]
  ds_read_b64_tr_b16 a[110:111], v21 offset:3072
  v_mfma_f32_16x16x32_bf16 a[60:63], v[92:95], a[124:127], a[60:63]
  v_exp_f32 v107, v107
  v_mfma_f32_16x16x32_bf16 a[60:63], v[88:91], a[120:123], a[60:63]
  v_cvt_pk_bf16_f32 v55, v106, v107
  v_mfma_f32_16x16x32_bf16 v[96:99], a[64:67], v[128:131], v[112:115]
  v_exp_f32 v108, v108
  v_mfma_f32_16x16x32_bf16 v[96:99], a[68:71], v[160:163], v[96:99]
  ds_read_b128 a[80:83], v16 offset:17408
  v_mfma_f32_16x16x32_bf16 v[96:99], a[72:75], v[192:195], v[96:99]
  s_waitcnt lgkmcnt(3)
  v_exp_f32 v109, v109
  v_mfma_f32_16x16x32_bf16 v[96:99], a[76:79], v[224:227], v[96:99]
  ds_read_b64_tr_b16 a[112:113], v22 offset:0
  v_cvt_pk_bf16_f32 v62, v108, v109
  v_mfma_f32_16x16x32_bf16 v[144:147], v[32:35], a[96:99], v[144:147]
  v_exp_f32 v110, v110
  v_mfma_f32_16x16x32_bf16 v[144:147], v[36:39], a[100:103], v[144:147]
  ds_read_b64_tr_b16 a[114:115], v22 offset:1024
  v_mfma_f32_16x16x32_bf16 v[148:151], v[44:47], a[100:103], v[148:151]
  v_exp_f32 v111, v111
  v_mfma_f32_16x16x32_bf16 v[148:151], v[40:43], a[96:99], v[148:151]
  v_mfma_f32_16x16x32_bf16 v[100:103], a[64:67], v[132:135], v[116:119]
  v_exp_f32 v96, v96
  v_mfma_f32_16x16x32_bf16 v[100:103], a[68:71], v[164:167], v[100:103]
  ds_read_b128 a[84:87], v17 offset:17408
  v_cvt_pk_bf16_f32 v63, v110, v111
  v_mfma_f32_16x16x32_bf16 v[100:103], a[72:75], v[196:199], v[100:103]
  v_exp_f32 v97, v97
  v_mfma_f32_16x16x32_bf16 v[100:103], a[76:79], v[228:231], v[100:103]
  ds_read_b64_tr_b16 a[116:117], v22 offset:2048
  v_cvt_pk_bf16_f32 v64, v96, v97
  v_mfma_f32_16x16x32_bf16 a[0:3], v[48:51], a[96:99], a[0:3]
  v_exp_f32 v98, v98
  v_mfma_f32_16x16x32_bf16 a[0:3], v[52:55], a[100:103], a[0:3]
  ds_read_b64_tr_b16 a[118:119], v22 offset:3072
  v_mfma_f32_16x16x32_bf16 a[4:7], v[60:63], a[100:103], a[4:7]
  v_exp_f32 v99, v99
  v_mfma_f32_16x16x32_bf16 a[4:7], v[56:59], a[96:99], a[4:7]
  buffer_load_dwordx4 v29, s[32:35], s68 offen offset:1024 nt lds
  v_mfma_f32_16x16x32_bf16 v[104:107], a[64:67], v[136:139], v[120:123]
  v_exp_f32 v100, v100
  v_mfma_f32_16x16x32_bf16 v[104:107], a[68:71], v[168:171], v[104:107]
  ds_read_b128 a[88:91], v18 offset:17408
  v_cvt_pk_bf16_f32 v65, v98, v99
  v_mfma_f32_16x16x32_bf16 v[104:107], a[72:75], v[200:203], v[104:107]
  s_waitcnt lgkmcnt(7)
  v_exp_f32 v101, v101
  v_mfma_f32_16x16x32_bf16 v[104:107], a[76:79], v[232:235], v[104:107]
  ds_read_b64_tr_b16 a[120:121], v23 offset:0
  v_cvt_pk_bf16_f32 v72, v100, v101
  v_mfma_f32_16x16x32_bf16 v[152:155], v[32:35], a[104:107], v[152:155]
  v_exp_f32 v102, v102
  v_mfma_f32_16x16x32_bf16 v[152:155], v[36:39], a[108:111], v[152:155]
  ds_read_b64_tr_b16 a[122:123], v23 offset:1024
  v_mfma_f32_16x16x32_bf16 v[156:159], v[44:47], a[108:111], v[156:159]
  v_exp_f32 v103, v103
  v_mfma_f32_16x16x32_bf16 v[156:159], v[40:43], a[104:107], v[156:159]
  v_mfma_f32_16x16x32_bf16 v[108:111], a[64:67], v[140:143], v[124:127]
  v_exp_f32 v104, v104
  v_mfma_f32_16x16x32_bf16 v[108:111], a[68:71], v[172:175], v[108:111]
  ds_read_b128 a[92:95], v19 offset:17408
  v_cvt_pk_bf16_f32 v73, v102, v103
  v_mfma_f32_16x16x32_bf16 v[108:111], a[72:75], v[204:207], v[108:111]
  s_waitcnt lgkmcnt(3)
  v_exp_f32 v105, v105
  v_mfma_f32_16x16x32_bf16 v[108:111], a[76:79], v[236:239], v[108:111]
  ds_read_b64_tr_b16 a[124:125], v23 offset:2048
  v_cvt_pk_bf16_f32 v80, v104, v105
  v_mfma_f32_16x16x32_bf16 a[8:11], v[48:51], a[104:107], a[8:11]
  v_exp_f32 v106, v106
  v_mfma_f32_16x16x32_bf16 a[8:11], v[52:55], a[108:111], a[8:11]
  ds_read_b64_tr_b16 a[126:127], v23 offset:3072
  v_mfma_f32_16x16x32_bf16 a[12:15], v[60:63], a[108:111], a[12:15]
  v_exp_f32 v107, v107
  v_mfma_f32_16x16x32_bf16 a[12:15], v[56:59], a[104:107], a[12:15]
  buffer_load_dwordx4 v29, s[32:35], s68 offen offset:2048 nt lds
  v_smfmac_f32_16x16x64_bf16 a[128:131], a[136:139], v[40:47], v30
  v_mfma_f32_16x16x32_bf16 v[96:99], a[80:83], v[128:131], v[112:115]
  v_exp_f32 v108, v108
  v_mfma_f32_16x16x32_bf16 v[96:99], a[84:87], v[160:163], v[96:99]
  ds_read_b128 a[64:67], v16 offset:18432
  v_cvt_pk_bf16_f32 v81, v106, v107
  v_mfma_f32_16x16x32_bf16 v[96:99], a[88:91], v[192:195], v[96:99]
  s_waitcnt lgkmcnt(3)
  v_exp_f32 v109, v109
  v_mfma_f32_16x16x32_bf16 v[96:99], a[92:95], v[224:227], v[96:99]
  ds_read_b64_tr_b16 a[96:97], v24 offset:0
  v_cvt_pk_bf16_f32 v88, v108, v109
  v_mfma_f32_16x16x32_bf16 v[176:179], v[32:35], a[112:115], v[176:179]
  v_exp_f32 v110, v110
  v_mfma_f32_16x16x32_bf16 v[176:179], v[36:39], a[116:119], v[176:179]
  ds_read_b64_tr_b16 a[98:99], v24 offset:1024
  v_mfma_f32_16x16x32_bf16 v[180:183], v[44:47], a[116:119], v[180:183]
  v_exp_f32 v111, v111
  v_mfma_f32_16x16x32_bf16 v[180:183], v[40:43], a[112:115], v[180:183]
  buffer_load_dwordx4 v29, s[32:35], s68 offen offset:3072 nt lds
  v_mfma_f32_16x16x32_bf16 v[100:103], a[80:83], v[132:135], v[116:119]
  v_exp_f32 v96, v96
  v_mfma_f32_16x16x32_bf16 v[100:103], a[84:87], v[164:167], v[100:103]
  ds_read_b128 a[68:71], v17 offset:18432
  v_cvt_pk_bf16_f32 v89, v110, v111
  v_mfma_f32_16x16x32_bf16 v[100:103], a[88:91], v[196:199], v[100:103]
L_hop5:
  s_cbranch_execz L_hop9
  v_exp_f32 v97, v97
  v_mfma_f32_16x16x32_bf16 v[100:103], a[92:95], v[228:231], v[100:103]
  ds_read_b64_tr_b16 a[100:101], v24 offset:2048
  v_cvt_pk_bf16_f32 v66, v96, v97
  v_mfma_f32_16x16x32_bf16 a[16:19], v[48:51], a[112:115], a[16:19]
  v_exp_f32 v98, v98
  v_mfma_f32_16x16x32_bf16 a[16:19], v[52:55], a[116:119], a[16:19]
  ds_read_b64_tr_b16 a[102:103], v24 offset:3072
  v_mfma_f32_16x16x32_bf16 a[20:23], v[60:63], a[116:119], a[20:23]
  v_exp_f32 v99, v99
  v_mfma_f32_16x16x32_bf16 a[20:23], v[56:59], a[112:115], a[20:23]
  v_mfma_f32_16x16x32_bf16 v[104:107], a[80:83], v[136:139], v[120:123]
  v_exp_f32 v100, v100
  v_mfma_f32_16x16x32_bf16 v[104:107], a[84:87], v[168:171], v[104:107]
  ds_read_b128 a[72:75], v18 offset:18432
  v_cvt_pk_bf16_f32 v67, v98, v99
  v_mfma_f32_16x16x32_bf16 v[104:107], a[88:91], v[200:203], v[104:107]
  s_waitcnt lgkmcnt(7)
  v_exp_f32 v101, v101
  v_mfma_f32_16x16x32_bf16 v[104:107], a[92:95], v[232:235], v[104:107]
  ds_read_b64_tr_b16 a[104:105], v25 offset:0
  v_cvt_pk_bf16_f32 v74, v100, v101
  v_mfma_f32_16x16x32_bf16 v[184:187], v[32:35], a[120:123], v[184:187]
  v_exp_f32 v102, v102
  v_mfma_f32_16x16x32_bf16 v[184:187], v[36:39], a[124:127], v[184:187]
  s_xor_b32 s67, s10, 53248
  ds_read_b64_tr_b16 a[106:107], v25 offset:1024
  v_mfma_f32_16x16x32_bf16 v[188:191], v[44:47], a[124:127], v[188:191]
  s_add_u32 m0, s63, 49152
  v_exp_f32 v103, v103
  v_mfma_f32_16x16x32_bf16 v[188:191], v[40:43], a[120:123], v[188:191]
  buffer_load_dwordx4 v28, s[28:31], s67 offen offset:0 nt lds
  v_smfmac_f32_16x16x64_bf16 a[128:131], a[252:255], v[32:39], v30
  v_mfma_f32_16x16x32_bf16 v[108:111], a[80:83], v[140:143], v[124:127]
  v_exp_f32 v104, v104
  v_mfma_f32_16x16x32_bf16 v[108:111], a[84:87], v[172:175], v[108:111]
  ds_read_b128 a[76:79], v19 offset:18432
  v_cvt_pk_bf16_f32 v75, v102, v103
  v_mfma_f32_16x16x32_bf16 v[108:111], a[88:91], v[204:207], v[108:111]
  s_waitcnt lgkmcnt(3)
  v_exp_f32 v105, v105
  v_mfma_f32_16x16x32_bf16 v[108:111], a[92:95], v[236:239], v[108:111]
  ds_read_b64_tr_b16 a[108:109], v25 offset:2048
  v_cvt_pk_bf16_f32 v82, v104, v105
  v_mfma_f32_16x16x32_bf16 a[24:27], v[48:51], a[120:123], a[24:27]
  v_exp_f32 v106, v106
  v_mfma_f32_16x16x32_bf16 a[24:27], v[52:55], a[124:127], a[24:27]
  ds_read_b64_tr_b16 a[110:111], v25 offset:3072
  v_mfma_f32_16x16x32_bf16 a[28:31], v[60:63], a[124:127], a[28:31]
  v_exp_f32 v107, v107
  v_mfma_f32_16x16x32_bf16 a[28:31], v[56:59], a[120:123], a[28:31]
  buffer_load_dwordx4 v28, s[28:31], s67 offen offset:1024 nt lds
  v_mfma_f32_16x16x32_bf16 v[96:99], a[64:67], v[128:131], v[112:115]
  v_exp_f32 v108, v108
  v_mfma_f32_16x16x32_bf16 v[96:99], a[68:71], v[160:163], v[96:99]
  ds_read_b128 a[80:83], v16 offset:19456
  v_cvt_pk_bf16_f32 v83, v106, v107
  v_mfma_f32_16x16x32_bf16 v[96:99], a[72:75], v[192:195], v[96:99]
  s_waitcnt lgkmcnt(3)
  v_exp_f32 v109, v109
  v_mfma_f32_16x16x32_bf16 v[96:99], a[76:79], v[224:227], v[96:99]
  ds_read_b64_tr_b16 a[112:113], v26 offset:0
  v_cvt_pk_bf16_f32 v90, v108, v109
  v_mfma_f32_16x16x32_bf16 v[208:211], v[32:35], a[96:99], v[208:211]
  v_exp_f32 v110, v110
  v_mfma_f32_16x16x32_bf16 v[208:211], v[36:39], a[100:103], v[208:211]
  ds_read_b64_tr_b16 a[114:115], v26 offset:1024
  v_mfma_f32_16x16x32_bf16 v[212:215], v[44:47], a[100:103], v[212:215]
  v_exp_f32 v111, v111
  v_mfma_f32_16x16x32_bf16 v[212:215], v[40:43], a[96:99], v[212:215]
  v_mfma_f32_16x16x32_bf16 v[100:103], a[64:67], v[132:135], v[116:119]
  v_exp_f32 v96, v96
  v_mfma_f32_16x16x32_bf16 v[100:103], a[68:71], v[164:167], v[100:103]
  ds_read_b128 a[84:87], v17 offset:19456
  v_cvt_pk_bf16_f32 v91, v110, v111
  v_mfma_f32_16x16x32_bf16 v[100:103], a[72:75], v[196:199], v[100:103]
  v_exp_f32 v97, v97
  v_mfma_f32_16x16x32_bf16 v[100:103], a[76:79], v[228:231], v[100:103]
  ds_read_b64_tr_b16 a[116:117], v26 offset:2048
  v_cvt_pk_bf16_f32 v68, v96, v97
  v_mfma_f32_16x16x32_bf16 a[32:35], v[48:51], a[96:99], a[32:35]
  v_exp_f32 v98, v98
  v_mfma_f32_16x16x32_bf16 a[32:35], v[52:55], a[100:103], a[32:35]
  ds_read_b64_tr_b16 a[118:119], v26 offset:3072
  v_mfma_f32_16x16x32_bf16 a[36:39], v[60:63], a[100:103], a[36:39]
  v_exp_f32 v99, v99
  v_mfma_f32_16x16x32_bf16 a[36:39], v[56:59], a[96:99], a[36:39]
  buffer_load_dwordx4 v28, s[28:31], s67 offen offset:2048 nt lds
  v_smfmac_f32_16x16x64_bf16 a[132:135], a[136:139], v[56:63], v30
  v_mfma_f32_16x16x32_bf16 v[104:107], a[64:67], v[136:139], v[120:123]
  v_exp_f32 v100, v100
  v_mfma_f32_16x16x32_bf16 v[104:107], a[68:71], v[168:171], v[104:107]
  ds_read_b128 a[88:91], v18 offset:19456
  v_cvt_pk_bf16_f32 v69, v98, v99
  v_mfma_f32_16x16x32_bf16 v[104:107], a[72:75], v[200:203], v[104:107]
  s_waitcnt lgkmcnt(7)
  v_exp_f32 v101, v101
  v_mfma_f32_16x16x32_bf16 v[104:107], a[76:79], v[232:235], v[104:107]
  ds_read_b64_tr_b16 a[120:121], v27 offset:0
  v_cvt_pk_bf16_f32 v76, v100, v101
  v_mfma_f32_16x16x32_bf16 v[216:219], v[32:35], a[104:107], v[216:219]
  v_exp_f32 v102, v102
  v_mfma_f32_16x16x32_bf16 v[216:219], v[36:39], a[108:111], v[216:219]
  ds_read_b64_tr_b16 a[122:123], v27 offset:1024
  v_mfma_f32_16x16x32_bf16 v[220:223], v[44:47], a[108:111], v[220:223]
  v_exp_f32 v103, v103
  v_mfma_f32_16x16x32_bf16 v[220:223], v[40:43], a[104:107], v[220:223]
  buffer_load_dwordx4 v28, s[28:31], s67 offen offset:3072 nt lds
  v_mfma_f32_16x16x32_bf16 v[108:111], a[64:67], v[140:143], v[124:127]
  v_exp_f32 v104, v104
  v_mfma_f32_16x16x32_bf16 v[108:111], a[68:71], v[172:175], v[108:111]
  ds_read_b128 a[92:95], v19 offset:19456
  v_cvt_pk_bf16_f32 v77, v102, v103
  v_mfma_f32_16x16x32_bf16 v[108:111], a[72:75], v[204:207], v[108:111]
  s_waitcnt lgkmcnt(3)
  v_exp_f32 v105, v105
  v_mfma_f32_16x16x32_bf16 v[108:111], a[76:79], v[236:239], v[108:111]
  ds_read_b64_tr_b16 a[124:125], v27 offset:2048
  v_cvt_pk_bf16_f32 v84, v104, v105
  v_mfma_f32_16x16x32_bf16 a[40:43], v[48:51], a[104:107], a[40:43]
  v_exp_f32 v106, v106
  v_mfma_f32_16x16x32_bf16 a[40:43], v[52:55], a[108:111], a[40:43]
  ds_read_b64_tr_b16 a[126:127], v27 offset:3072
  v_mfma_f32_16x16x32_bf16 a[44:47], v[60:63], a[108:111], a[44:47]
  s_waitcnt vmcnt(8)
  v_exp_f32 v107, v107
  v_mfma_f32_16x16x32_bf16 a[44:47], v[56:59], a[104:107], a[44:47]
  v_mfma_f32_16x16x32_bf16 v[96:99], a[80:83], v[128:131], v[112:115]
  s_barrier
  v_exp_f32 v108, v108
  v_mfma_f32_16x16x32_bf16 v[96:99], a[84:87], v[160:163], v[96:99]
  ds_read_b128 a[64:67], v16 offset:32768
  v_cvt_pk_bf16_f32 v85, v106, v107
  v_mfma_f32_16x16x32_bf16 v[96:99], a[88:91], v[192:195], v[96:99]
  s_waitcnt lgkmcnt(3)
  v_exp_f32 v109, v109
  v_mfma_f32_16x16x32_bf16 v[96:99], a[92:95], v[224:227], v[96:99]
  ds_read_b64_tr_b16 a[96:97], v20 offset:16384
  v_cvt_pk_bf16_f32 v92, v108, v109
  v_mfma_f32_16x16x32_bf16 v[240:243], v[32:35], a[112:115], v[240:243]
  v_exp_f32 v110, v110
  v_mfma_f32_16x16x32_bf16 v[240:243], v[36:39], a[116:119], v[240:243]
  ds_read_b64_tr_b16 a[98:99], v20 offset:17408
  v_mfma_f32_16x16x32_bf16 v[244:247], v[44:47], a[116:119], v[244:247]
  v_exp_f32 v111, v111
  v_mfma_f32_16x16x32_bf16 v[244:247], v[40:43], a[112:115], v[244:247]
  v_mfma_f32_16x16x32_bf16 v[100:103], a[80:83], v[132:135], v[116:119]
  v_exp_f32 v96, v96
  v_mfma_f32_16x16x32_bf16 v[100:103], a[84:87], v[164:167], v[100:103]
  ds_read_b128 a[68:71], v17 offset:32768
  v_cvt_pk_bf16_f32 v93, v110, v111
  v_mfma_f32_16x16x32_bf16 v[100:103], a[88:91], v[196:199], v[100:103]
  v_exp_f32 v97, v97
  v_mfma_f32_16x16x32_bf16 v[100:103], a[92:95], v[228:231], v[100:103]
  ds_read_b64_tr_b16 a[100:101], v20 offset:18432
  v_cvt_pk_bf16_f32 v70, v96, v97
  v_mfma_f32_16x16x32_bf16 a[48:51], v[48:51], a[112:115], a[48:51]
  v_exp_f32 v98, v98
  v_mfma_f32_16x16x32_bf16 a[48:51], v[52:55], a[116:119], a[48:51]
  s_xor_b32 s68, s10, 53248
  ds_read_b64_tr_b16 a[102:103], v20 offset:19456
  v_mfma_f32_16x16x32_bf16 a[52:55], v[60:63], a[116:119], a[52:55]
  s_add_u32 m0, s63, 114688
  v_exp_f32 v99, v99
  v_mfma_f32_16x16x32_bf16 a[52:55], v[56:59], a[112:115], a[52:55]
  buffer_load_dwordx4 v29, s[32:35], s68 offen offset:0 nt lds
  v_smfmac_f32_16x16x64_bf16 a[132:135], a[252:255], v[48:55], v30
  v_mfma_f32_16x16x32_bf16 v[104:107], a[80:83], v[136:139], v[120:123]
  v_exp_f32 v100, v100
  v_mfma_f32_16x16x32_bf16 v[104:107], a[84:87], v[168:171], v[104:107]
  ds_read_b128 a[72:75], v18 offset:32768
  v_cvt_pk_bf16_f32 v71, v98, v99
  v_mfma_f32_16x16x32_bf16 v[104:107], a[88:91], v[200:203], v[104:107]
  s_waitcnt lgkmcnt(7)
  v_exp_f32 v101, v101
  v_mfma_f32_16x16x32_bf16 v[104:107], a[92:95], v[232:235], v[104:107]
  ds_read_b64_tr_b16 a[104:105], v21 offset:16384
  v_cvt_pk_bf16_f32 v78, v100, v101
  v_mfma_f32_16x16x32_bf16 v[248:251], v[32:35], a[120:123], v[248:251]
  v_exp_f32 v102, v102
  v_mfma_f32_16x16x32_bf16 v[248:251], v[36:39], a[124:127], v[248:251]
  ds_read_b64_tr_b16 a[106:107], v21 offset:17408
  v_mfma_f32_16x16x32_bf16 v[252:255], v[44:47], a[124:127], v[252:255]
  v_exp_f32 v103, v103
  v_mfma_f32_16x16x32_bf16 v[252:255], v[40:43], a[120:123], v[252:255]
  v_mfma_f32_16x16x32_bf16 v[108:111], a[80:83], v[140:143], v[124:127]
  v_exp_f32 v104, v104
  v_mfma_f32_16x16x32_bf16 v[108:111], a[84:87], v[172:175], v[108:111]
  ds_read_b128 a[76:79], v19 offset:32768
  v_cvt_pk_bf16_f32 v79, v102, v103
  v_mfma_f32_16x16x32_bf16 v[108:111], a[88:91], v[204:207], v[108:111]
  s_waitcnt lgkmcnt(3)
  v_exp_f32 v105, v105
  v_mfma_f32_16x16x32_bf16 v[108:111], a[92:95], v[236:239], v[108:111]
  ds_read_b64_tr_b16 a[108:109], v21 offset:18432
  v_cvt_pk_bf16_f32 v86, v104, v105
  v_mfma_f32_16x16x32_bf16 a[56:59], v[48:51], a[120:123], a[56:59]
  v_exp_f32 v106, v106
  v_mfma_f32_16x16x32_bf16 a[56:59], v[52:55], a[124:127], a[56:59]
  ds_read_b64_tr_b16 a[110:111], v21 offset:19456
  v_mfma_f32_16x16x32_bf16 a[60:63], v[60:63], a[124:127], a[60:63]
  v_exp_f32 v107, v107
  v_mfma_f32_16x16x32_bf16 a[60:63], v[56:59], a[120:123], a[60:63]
  v_cvt_pk_bf16_f32 v87, v106, v107
  v_mfma_f32_16x16x32_bf16 v[96:99], a[64:67], v[128:131], v[112:115]
  v_exp_f32 v108, v108
  v_mfma_f32_16x16x32_bf16 v[96:99], a[68:71], v[160:163], v[96:99]
  ds_read_b128 a[80:83], v16 offset:33792
  v_mfma_f32_16x16x32_bf16 v[96:99], a[72:75], v[192:195], v[96:99]
  s_waitcnt lgkmcnt(3)
  v_exp_f32 v109, v109
  v_mfma_f32_16x16x32_bf16 v[96:99], a[76:79], v[224:227], v[96:99]
  ds_read_b64_tr_b16 a[112:113], v22 offset:16384
  v_cvt_pk_bf16_f32 v94, v108, v109
  v_mfma_f32_16x16x32_bf16 v[144:147], v[64:67], a[96:99], v[144:147]
  v_exp_f32 v110, v110
  v_mfma_f32_16x16x32_bf16 v[144:147], v[68:71], a[100:103], v[144:147]
  ds_read_b64_tr_b16 a[114:115], v22 offset:17408
  v_mfma_f32_16x16x32_bf16 v[148:151], v[76:79], a[100:103], v[148:151]
  v_exp_f32 v111, v111
  v_mfma_f32_16x16x32_bf16 v[148:151], v[72:75], a[96:99], v[148:151]
  v_mfma_f32_16x16x32_bf16 v[100:103], a[64:67], v[132:135], v[116:119]
  v_exp_f32 v96, v96
  v_mfma_f32_16x16x32_bf16 v[100:103], a[68:71], v[164:167], v[100:103]
  ds_read_b128 a[84:87], v17 offset:33792
  v_cvt_pk_bf16_f32 v95, v110, v111
  v_mfma_f32_16x16x32_bf16 v[100:103], a[72:75], v[196:199], v[100:103]
  v_exp_f32 v97, v97
  v_mfma_f32_16x16x32_bf16 v[100:103], a[76:79], v[228:231], v[100:103]
  ds_read_b64_tr_b16 a[116:117], v22 offset:18432
  v_cvt_pk_bf16_f32 v32, v96, v97
  v_mfma_f32_16x16x32_bf16 a[0:3], v[80:83], a[96:99], a[0:3]
  v_exp_f32 v98, v98
  v_mfma_f32_16x16x32_bf16 a[0:3], v[84:87], a[100:103], a[0:3]
  ds_read_b64_tr_b16 a[118:119], v22 offset:19456
  v_mfma_f32_16x16x32_bf16 a[4:7], v[92:95], a[100:103], a[4:7]
  v_exp_f32 v99, v99
  v_mfma_f32_16x16x32_bf16 a[4:7], v[88:91], a[96:99], a[4:7]
  buffer_load_dwordx4 v29, s[32:35], s68 offen offset:1024 nt lds
  v_mfma_f32_16x16x32_bf16 v[104:107], a[64:67], v[136:139], v[120:123]
  v_exp_f32 v100, v100
  v_mfma_f32_16x16x32_bf16 v[104:107], a[68:71], v[168:171], v[104:107]
  ds_read_b128 a[88:91], v18 offset:33792
  v_cvt_pk_bf16_f32 v33, v98, v99
  v_mfma_f32_16x16x32_bf16 v[104:107], a[72:75], v[200:203], v[104:107]
  s_waitcnt lgkmcnt(7)
  v_exp_f32 v101, v101
  v_mfma_f32_16x16x32_bf16 v[104:107], a[76:79], v[232:235], v[104:107]
  ds_read_b64_tr_b16 a[120:121], v23 offset:16384
  v_cvt_pk_bf16_f32 v40, v100, v101
  v_mfma_f32_16x16x32_bf16 v[152:155], v[64:67], a[104:107], v[152:155]
  v_exp_f32 v102, v102
  v_mfma_f32_16x16x32_bf16 v[152:155], v[68:71], a[108:111], v[152:155]
  ds_read_b64_tr_b16 a[122:123], v23 offset:17408
  v_mfma_f32_16x16x32_bf16 v[156:159], v[76:79], a[108:111], v[156:159]
  v_exp_f32 v103, v103
  v_mfma_f32_16x16x32_bf16 v[156:159], v[72:75], a[104:107], v[156:159]
  v_mfma_f32_16x16x32_bf16 v[108:111], a[64:67], v[140:143], v[124:127]
  v_exp_f32 v104, v104
  v_mfma_f32_16x16x32_bf16 v[108:111], a[68:71], v[172:175], v[108:111]
  ds_read_b128 a[92:95], v19 offset:33792
  v_cvt_pk_bf16_f32 v41, v102, v103
  v_mfma_f32_16x16x32_bf16 v[108:111], a[72:75], v[204:207], v[108:111]
  s_waitcnt lgkmcnt(3)
  v_exp_f32 v105, v105
  v_mfma_f32_16x16x32_bf16 v[108:111], a[76:79], v[236:239], v[108:111]
  ds_read_b64_tr_b16 a[124:125], v23 offset:18432
  v_cvt_pk_bf16_f32 v48, v104, v105
  v_mfma_f32_16x16x32_bf16 a[8:11], v[80:83], a[104:107], a[8:11]
  v_exp_f32 v106, v106
  v_mfma_f32_16x16x32_bf16 a[8:11], v[84:87], a[108:111], a[8:11]
  ds_read_b64_tr_b16 a[126:127], v23 offset:19456
  v_mfma_f32_16x16x32_bf16 a[12:15], v[92:95], a[108:111], a[12:15]
  v_exp_f32 v107, v107
  v_mfma_f32_16x16x32_bf16 a[12:15], v[88:91], a[104:107], a[12:15]
  buffer_load_dwordx4 v29, s[32:35], s68 offen offset:2048 nt lds
  v_smfmac_f32_16x16x64_bf16 a[128:131], a[136:139], v[72:79], v30
  v_mfma_f32_16x16x32_bf16 v[96:99], a[80:83], v[128:131], v[112:115]
  v_exp_f32 v108, v108
  v_mfma_f32_16x16x32_bf16 v[96:99], a[84:87], v[160:163], v[96:99]
  ds_read_b128 a[64:67], v16 offset:34816
  v_cvt_pk_bf16_f32 v49, v106, v107
  v_mfma_f32_16x16x32_bf16 v[96:99], a[88:91], v[192:195], v[96:99]
  s_waitcnt lgkmcnt(3)
  v_exp_f32 v109, v109
  v_mfma_f32_16x16x32_bf16 v[96:99], a[92:95], v[224:227], v[96:99]
  ds_read_b64_tr_b16 a[96:97], v24 offset:16384
  v_cvt_pk_bf16_f32 v56, v108, v109
  v_mfma_f32_16x16x32_bf16 v[176:179], v[64:67], a[112:115], v[176:179]
  v_exp_f32 v110, v110
  v_mfma_f32_16x16x32_bf16 v[176:179], v[68:71], a[116:119], v[176:179]
  ds_read_b64_tr_b16 a[98:99], v24 offset:17408
  v_mfma_f32_16x16x32_bf16 v[180:183], v[76:79], a[116:119], v[180:183]
  v_exp_f32 v111, v111
  v_mfma_f32_16x16x32_bf16 v[180:183], v[72:75], a[112:115], v[180:183]
  buffer_load_dwordx4 v29, s[32:35], s68 offen offset:3072 nt lds
  v_mfma_f32_16x16x32_bf16 v[100:103], a[80:83], v[132:135], v[116:119]
  v_exp_f32 v96, v96
  v_mfma_f32_16x16x32_bf16 v[100:103], a[84:87], v[164:167], v[100:103]
  ds_read_b128 a[68:71], v17 offset:34816
  v_cvt_pk_bf16_f32 v57, v110, v111
  v_mfma_f32_16x16x32_bf16 v[100:103], a[88:91], v[196:199], v[100:103]
  v_exp_f32 v97, v97
  v_mfma_f32_16x16x32_bf16 v[100:103], a[92:95], v[228:231], v[100:103]
  ds_read_b64_tr_b16 a[100:101], v24 offset:18432
  v_cvt_pk_bf16_f32 v34, v96, v97
  v_mfma_f32_16x16x32_bf16 a[16:19], v[80:83], a[112:115], a[16:19]
  v_exp_f32 v98, v98
  v_mfma_f32_16x16x32_bf16 a[16:19], v[84:87], a[116:119], a[16:19]
  ds_read_b64_tr_b16 a[102:103], v24 offset:19456
  v_mfma_f32_16x16x32_bf16 a[20:23], v[92:95], a[116:119], a[20:23]
  v_exp_f32 v99, v99
  v_mfma_f32_16x16x32_bf16 a[20:23], v[88:91], a[112:115], a[20:23]
  v_mfma_f32_16x16x32_bf16 v[104:107], a[80:83], v[136:139], v[120:123]
  v_exp_f32 v100, v100
  v_mfma_f32_16x16x32_bf16 v[104:107], a[84:87], v[168:171], v[104:107]
  ds_read_b128 a[72:75], v18 offset:34816
  v_cvt_pk_bf16_f32 v35, v98, v99
  v_mfma_f32_16x16x32_bf16 v[104:107], a[88:91], v[200:203], v[104:107]
  s_waitcnt lgkmcnt(7)
  v_exp_f32 v101, v101
  v_mfma_f32_16x16x32_bf16 v[104:107], a[92:95], v[232:235], v[104:107]
  ds_read_b64_tr_b16 a[104:105], v25 offset:16384
  v_cvt_pk_bf16_f32 v42, v100, v101
  v_mfma_f32_16x16x32_bf16 v[184:187], v[64:67], a[120:123], v[184:187]
  v_exp_f32 v102, v102
  v_mfma_f32_16x16x32_bf16 v[184:187], v[68:71], a[124:127], v[184:187]
  s_xor_b32 s67, s10, 131072
  ds_read_b64_tr_b16 a[106:107], v25 offset:17408
  v_mfma_f32_16x16x32_bf16 v[188:191], v[76:79], a[124:127], v[188:191]
  s_add_u32 m0, s63, 0
  v_exp_f32 v103, v103
  v_mfma_f32_16x16x32_bf16 v[188:191], v[72:75], a[120:123], v[188:191]
  buffer_load_dwordx4 v28, s[28:31], s67 offen offset:0 nt lds
  v_smfmac_f32_16x16x64_bf16 a[128:131], a[252:255], v[64:71], v30
  v_mfma_f32_16x16x32_bf16 v[108:111], a[80:83], v[140:143], v[124:127]
  v_exp_f32 v104, v104
  v_mfma_f32_16x16x32_bf16 v[108:111], a[84:87], v[172:175], v[108:111]
  ds_read_b128 a[76:79], v19 offset:34816
  v_cvt_pk_bf16_f32 v43, v102, v103
  v_mfma_f32_16x16x32_bf16 v[108:111], a[88:91], v[204:207], v[108:111]
  s_waitcnt lgkmcnt(3)
  v_exp_f32 v105, v105
  v_mfma_f32_16x16x32_bf16 v[108:111], a[92:95], v[236:239], v[108:111]
  ds_read_b64_tr_b16 a[108:109], v25 offset:18432
  v_cvt_pk_bf16_f32 v50, v104, v105
  v_mfma_f32_16x16x32_bf16 a[24:27], v[80:83], a[120:123], a[24:27]
  v_exp_f32 v106, v106
  v_mfma_f32_16x16x32_bf16 a[24:27], v[84:87], a[124:127], a[24:27]
  ds_read_b64_tr_b16 a[110:111], v25 offset:19456
  v_mfma_f32_16x16x32_bf16 a[28:31], v[92:95], a[124:127], a[28:31]
  v_exp_f32 v107, v107
  v_mfma_f32_16x16x32_bf16 a[28:31], v[88:91], a[120:123], a[28:31]
  buffer_load_dwordx4 v28, s[28:31], s67 offen offset:1024 nt lds
  v_mfma_f32_16x16x32_bf16 v[96:99], a[64:67], v[128:131], v[112:115]
  v_exp_f32 v108, v108
  v_mfma_f32_16x16x32_bf16 v[96:99], a[68:71], v[160:163], v[96:99]
  ds_read_b128 a[80:83], v16 offset:35840
  v_cvt_pk_bf16_f32 v51, v106, v107
  v_mfma_f32_16x16x32_bf16 v[96:99], a[72:75], v[192:195], v[96:99]
  s_waitcnt lgkmcnt(3)
  v_exp_f32 v109, v109
  v_mfma_f32_16x16x32_bf16 v[96:99], a[76:79], v[224:227], v[96:99]
  ds_read_b64_tr_b16 a[112:113], v26 offset:16384
  v_cvt_pk_bf16_f32 v58, v108, v109
  v_mfma_f32_16x16x32_bf16 v[208:211], v[64:67], a[96:99], v[208:211]
  v_exp_f32 v110, v110
  v_mfma_f32_16x16x32_bf16 v[208:211], v[68:71], a[100:103], v[208:211]
  ds_read_b64_tr_b16 a[114:115], v26 offset:17408
  v_mfma_f32_16x16x32_bf16 v[212:215], v[76:79], a[100:103], v[212:215]
  v_exp_f32 v111, v111
  v_mfma_f32_16x16x32_bf16 v[212:215], v[72:75], a[96:99], v[212:215]
  v_mfma_f32_16x16x32_bf16 v[100:103], a[64:67], v[132:135], v[116:119]
  v_exp_f32 v96, v96
  v_mfma_f32_16x16x32_bf16 v[100:103], a[68:71], v[164:167], v[100:103]
  ds_read_b128 a[84:87], v17 offset:35840
  v_cvt_pk_bf16_f32 v59, v110, v111
  v_mfma_f32_16x16x32_bf16 v[100:103], a[72:75], v[196:199], v[100:103]
  v_exp_f32 v97, v97
  v_mfma_f32_16x16x32_bf16 v[100:103], a[76:79], v[228:231], v[100:103]
  ds_read_b64_tr_b16 a[116:117], v26 offset:18432
  v_cvt_pk_bf16_f32 v36, v96, v97
  v_mfma_f32_16x16x32_bf16 a[32:35], v[80:83], a[96:99], a[32:35]
  v_exp_f32 v98, v98
  v_mfma_f32_16x16x32_bf16 a[32:35], v[84:87], a[100:103], a[32:35]
  ds_read_b64_tr_b16 a[118:119], v26 offset:19456
  v_mfma_f32_16x16x32_bf16 a[36:39], v[92:95], a[100:103], a[36:39]
  v_exp_f32 v99, v99
  v_mfma_f32_16x16x32_bf16 a[36:39], v[88:91], a[96:99], a[36:39]
  buffer_load_dwordx4 v28, s[28:31], s67 offen offset:2048 nt lds
  v_smfmac_f32_16x16x64_bf16 a[132:135], a[136:139], v[88:95], v30
  v_mfma_f32_16x16x32_bf16 v[104:107], a[64:67], v[136:139], v[120:123]
  v_exp_f32 v100, v100
  v_mfma_f32_16x16x32_bf16 v[104:107], a[68:71], v[168:171], v[104:107]
  ds_read_b128 a[88:91], v18 offset:35840
  v_cvt_pk_bf16_f32 v37, v98, v99
  v_mfma_f32_16x16x32_bf16 v[104:107], a[72:75], v[200:203], v[104:107]
  s_waitcnt lgkmcnt(7)
  v_exp_f32 v101, v101
  v_mfma_f32_16x16x32_bf16 v[104:107], a[76:79], v[232:235], v[104:107]
  ds_read_b64_tr_b16 a[120:121], v27 offset:16384
  v_cvt_pk_bf16_f32 v44, v100, v101
  v_mfma_f32_16x16x32_bf16 v[216:219], v[64:67], a[104:107], v[216:219]
  v_exp_f32 v102, v102
  v_mfma_f32_16x16x32_bf16 v[216:219], v[68:71], a[108:111], v[216:219]
  ds_read_b64_tr_b16 a[122:123], v27 offset:17408
  v_mfma_f32_16x16x32_bf16 v[220:223], v[76:79], a[108:111], v[220:223]
  v_exp_f32 v103, v103
  v_mfma_f32_16x16x32_bf16 v[220:223], v[72:75], a[104:107], v[220:223]
  buffer_load_dwordx4 v28, s[28:31], s67 offen offset:3072 nt lds
  v_mfma_f32_16x16x32_bf16 v[108:111], a[64:67], v[140:143], v[124:127]
  v_exp_f32 v104, v104
  v_mfma_f32_16x16x32_bf16 v[108:111], a[68:71], v[172:175], v[108:111]
  ds_read_b128 a[92:95], v19 offset:35840
  v_cvt_pk_bf16_f32 v45, v102, v103
  v_mfma_f32_16x16x32_bf16 v[108:111], a[72:75], v[204:207], v[108:111]
  s_waitcnt lgkmcnt(3)
  v_exp_f32 v105, v105
  v_mfma_f32_16x16x32_bf16 v[108:111], a[76:79], v[236:239], v[108:111]
  ds_read_b64_tr_b16 a[124:125], v27 offset:18432
  v_cvt_pk_bf16_f32 v52, v104, v105
  v_mfma_f32_16x16x32_bf16 a[40:43], v[80:83], a[104:107], a[40:43]
  v_exp_f32 v106, v106
  v_mfma_f32_16x16x32_bf16 a[40:43], v[84:87], a[108:111], a[40:43]
  ds_read_b64_tr_b16 a[126:127], v27 offset:19456
  v_mfma_f32_16x16x32_bf16 a[44:47], v[92:95], a[108:111], a[44:47]
  s_waitcnt vmcnt(8)
  v_exp_f32 v107, v107
  v_mfma_f32_16x16x32_bf16 a[44:47], v[88:91], a[104:107], a[44:47]
  v_mfma_f32_16x16x32_bf16 v[96:99], a[80:83], v[128:131], v[112:115]
  s_barrier
  v_exp_f32 v108, v108
  v_mfma_f32_16x16x32_bf16 v[96:99], a[84:87], v[160:163], v[96:99]
  ds_read_b128 a[64:67], v16 offset:49152
  v_cvt_pk_bf16_f32 v53, v106, v107
  v_mfma_f32_16x16x32_bf16 v[96:99], a[88:91], v[192:195], v[96:99]
  s_waitcnt lgkmcnt(3)
  v_exp_f32 v109, v109
  v_mfma_f32_16x16x32_bf16 v[96:99], a[92:95], v[224:227], v[96:99]
  ds_read_b64_tr_b16 a[96:97], v20 offset:32768
  v_cvt_pk_bf16_f32 v60, v108, v109
  v_mfma_f32_16x16x32_bf16 v[240:243], v[64:67], a[112:115], v[240:243]
  v_exp_f32 v110, v110
  v_mfma_f32_16x16x32_bf16 v[240:243], v[68:71], a[116:119], v[240:243]
  ds_read_b64_tr_b16 a[98:99], v20 offset:33792
  v_mfma_f32_16x16x32_bf16 v[244:247], v[76:79], a[116:119], v[244:247]
  v_exp_f32 v111, v111
  v_mfma_f32_16x16x32_bf16 v[244:247], v[72:75], a[112:115], v[244:247]
  v_mfma_f32_16x16x32_bf16 v[100:103], a[80:83], v[132:135], v[116:119]
  v_exp_f32 v96, v96
  v_mfma_f32_16x16x32_bf16 v[100:103], a[84:87], v[164:167], v[100:103]
  ds_read_b128 a[68:71], v17 offset:49152
  v_cvt_pk_bf16_f32 v61, v110, v111
  v_mfma_f32_16x16x32_bf16 v[100:103], a[88:91], v[196:199], v[100:103]
  v_exp_f32 v97, v97
  v_mfma_f32_16x16x32_bf16 v[100:103], a[92:95], v[228:231], v[100:103]
  ds_read_b64_tr_b16 a[100:101], v20 offset:34816
  v_cvt_pk_bf16_f32 v38, v96, v97
  v_mfma_f32_16x16x32_bf16 a[48:51], v[80:83], a[112:115], a[48:51]
  v_exp_f32 v98, v98
  v_mfma_f32_16x16x32_bf16 a[48:51], v[84:87], a[116:119], a[48:51]
  s_xor_b32 s68, s10, 131072
  ds_read_b64_tr_b16 a[102:103], v20 offset:35840
  v_mfma_f32_16x16x32_bf16 a[52:55], v[92:95], a[116:119], a[52:55]
  s_add_u32 m0, s63, 65536
  v_exp_f32 v99, v99
  v_mfma_f32_16x16x32_bf16 a[52:55], v[88:91], a[112:115], a[52:55]
  buffer_load_dwordx4 v29, s[32:35], s68 offen offset:0 nt lds
  v_smfmac_f32_16x16x64_bf16 a[132:135], a[252:255], v[80:87], v30
  v_mfma_f32_16x16x32_bf16 v[104:107], a[80:83], v[136:139], v[120:123]
  v_exp_f32 v100, v100
  v_mfma_f32_16x16x32_bf16 v[104:107], a[84:87], v[168:171], v[104:107]
  ds_read_b128 a[72:75], v18 offset:49152
  v_cvt_pk_bf16_f32 v39, v98, v99
  v_mfma_f32_16x16x32_bf16 v[104:107], a[88:91], v[200:203], v[104:107]
  s_waitcnt lgkmcnt(7)
  v_exp_f32 v101, v101
  v_mfma_f32_16x16x32_bf16 v[104:107], a[92:95], v[232:235], v[104:107]
  ds_read_b64_tr_b16 a[104:105], v21 offset:32768
  v_cvt_pk_bf16_f32 v46, v100, v101
  v_mfma_f32_16x16x32_bf16 v[248:251], v[64:67], a[120:123], v[248:251]
  v_exp_f32 v102, v102
  v_mfma_f32_16x16x32_bf16 v[248:251], v[68:71], a[124:127], v[248:251]
  ds_read_b64_tr_b16 a[106:107], v21 offset:33792
  v_mfma_f32_16x16x32_bf16 v[252:255], v[76:79], a[124:127], v[252:255]
  v_exp_f32 v103, v103
  v_mfma_f32_16x16x32_bf16 v[252:255], v[72:75], a[120:123], v[252:255]
  v_mfma_f32_16x16x32_bf16 v[108:111], a[80:83], v[140:143], v[124:127]
  v_exp_f32 v104, v104
  v_mfma_f32_16x16x32_bf16 v[108:111], a[84:87], v[172:175], v[108:111]
  ds_read_b128 a[76:79], v19 offset:49152
  v_cvt_pk_bf16_f32 v47, v102, v103
  v_mfma_f32_16x16x32_bf16 v[108:111], a[88:91], v[204:207], v[108:111]
  s_waitcnt lgkmcnt(3)
  v_exp_f32 v105, v105
  v_mfma_f32_16x16x32_bf16 v[108:111], a[92:95], v[236:239], v[108:111]
  ds_read_b64_tr_b16 a[108:109], v21 offset:34816
  v_cvt_pk_bf16_f32 v54, v104, v105
  v_mfma_f32_16x16x32_bf16 a[56:59], v[80:83], a[120:123], a[56:59]
  v_exp_f32 v106, v106
  v_mfma_f32_16x16x32_bf16 a[56:59], v[84:87], a[124:127], a[56:59]
  ds_read_b64_tr_b16 a[110:111], v21 offset:35840
  v_mfma_f32_16x16x32_bf16 a[60:63], v[92:95], a[124:127], a[60:63]
  v_exp_f32 v107, v107
  v_mfma_f32_16x16x32_bf16 a[60:63], v[88:91], a[120:123], a[60:63]
  v_cvt_pk_bf16_f32 v55, v106, v107
  v_mfma_f32_16x16x32_bf16 v[96:99], a[64:67], v[128:131], v[112:115]
  v_exp_f32 v108, v108
  v_mfma_f32_16x16x32_bf16 v[96:99], a[68:71], v[160:163], v[96:99]
  ds_read_b128 a[80:83], v16 offset:50176
  v_mfma_f32_16x16x32_bf16 v[96:99], a[72:75], v[192:195], v[96:99]
  s_waitcnt lgkmcnt(3)
  v_exp_f32 v109, v109
  v_mfma_f32_16x16x32_bf16 v[96:99], a[76:79], v[224:227], v[96:99]
  ds_read_b64_tr_b16 a[112:113], v22 offset:32768
  v_cvt_pk_bf16_f32 v62, v108, v109
  v_mfma_f32_16x16x32_bf16 v[144:147], v[32:35], a[96:99], v[144:147]
  v_exp_f32 v110, v110
  v_mfma_f32_16x16x32_bf16 v[144:147], v[36:39], a[100:103], v[144:147]
  ds_read_b64_tr_b16 a[114:115], v22 offset:33792
  v_mfma_f32_16x16x32_bf16 v[148:151], v[44:47], a[100:103], v[148:151]
  v_exp_f32 v111, v111
  v_mfma_f32_16x16x32_bf16 v[148:151], v[40:43], a[96:99], v[148:151]
  v_mfma_f32_16x16x32_bf16 v[100:103], a[64:67], v[132:135], v[116:119]
  v_exp_f32 v96, v96
  v_mfma_f32_16x16x32_bf16 v[100:103], a[68:71], v[164:167], v[100:103]
  ds_read_b128 a[84:87], v17 offset:50176
  v_cvt_pk_bf16_f32 v63, v110, v111
  v_mfma_f32_16x16x32_bf16 v[100:103], a[72:75], v[196:199], v[100:103]
  v_exp_f32 v97, v97
  v_mfma_f32_16x16x32_bf16 v[100:103], a[76:79], v[228:231], v[100:103]
  ds_read_b64_tr_b16 a[116:117], v22 offset:34816
  v_cvt_pk_bf16_f32 v64, v96, v97
  v_mfma_f32_16x16x32_bf16 a[0:3], v[48:51], a[96:99], a[0:3]
  v_exp_f32 v98, v98
  v_mfma_f32_16x16x32_bf16 a[0:3], v[52:55], a[100:103], a[0:3]
  ds_read_b64_tr_b16 a[118:119], v22 offset:35840
  v_mfma_f32_16x16x32_bf16 a[4:7], v[60:63], a[100:103], a[4:7]
  v_exp_f32 v99, v99
  v_mfma_f32_16x16x32_bf16 a[4:7], v[56:59], a[96:99], a[4:7]
  buffer_load_dwordx4 v29, s[32:35], s68 offen offset:1024 nt lds
  v_mfma_f32_16x16x32_bf16 v[104:107], a[64:67], v[136:139], v[120:123]
  v_exp_f32 v100, v100
  v_mfma_f32_16x16x32_bf16 v[104:107], a[68:71], v[168:171], v[104:107]
  ds_read_b128 a[88:91], v18 offset:50176
  v_cvt_pk_bf16_f32 v65, v98, v99
  v_mfma_f32_16x16x32_bf16 v[104:107], a[72:75], v[200:203], v[104:107]
  s_waitcnt lgkmcnt(7)
  v_exp_f32 v101, v101
  v_mfma_f32_16x16x32_bf16 v[104:107], a[76:79], v[232:235], v[104:107]
  ds_read_b64_tr_b16 a[120:121], v23 offset:32768
  v_cvt_pk_bf16_f32 v72, v100, v101
  v_mfma_f32_16x16x32_bf16 v[152:155], v[32:35], a[104:107], v[152:155]
  v_exp_f32 v102, v102
  v_mfma_f32_16x16x32_bf16 v[152:155], v[36:39], a[108:111], v[152:155]
  ds_read_b64_tr_b16 a[122:123], v23 offset:33792
  v_mfma_f32_16x16x32_bf16 v[156:159], v[44:47], a[108:111], v[156:159]
  v_exp_f32 v103, v103
  v_mfma_f32_16x16x32_bf16 v[156:159], v[40:43], a[104:107], v[156:159]
  v_mfma_f32_16x16x32_bf16 v[108:111], a[64:67], v[140:143], v[124:127]
  v_exp_f32 v104, v104
  v_mfma_f32_16x16x32_bf16 v[108:111], a[68:71], v[172:175], v[108:111]
  ds_read_b128 a[92:95], v19 offset:50176
  v_cvt_pk_bf16_f32 v73, v102, v103
  v_mfma_f32_16x16x32_bf16 v[108:111], a[72:75], v[204:207], v[108:111]
  s_waitcnt lgkmcnt(3)
  v_exp_f32 v105, v105
  v_mfma_f32_16x16x32_bf16 v[108:111], a[76:79], v[236:239], v[108:111]
  ds_read_b64_tr_b16 a[124:125], v23 offset:34816
  v_cvt_pk_bf16_f32 v80, v104, v105
  v_mfma_f32_16x16x32_bf16 a[8:11], v[48:51], a[104:107], a[8:11]
  v_exp_f32 v106, v106
  v_mfma_f32_16x16x32_bf16 a[8:11], v[52:55], a[108:111], a[8:11]
  ds_read_b64_tr_b16 a[126:127], v23 offset:35840
  v_mfma_f32_16x16x32_bf16 a[12:15], v[60:63], a[108:111], a[12:15]
  v_exp_f32 v107, v107
  v_mfma_f32_16x16x32_bf16 a[12:15], v[56:59], a[104:107], a[12:15]
  buffer_load_dwordx4 v29, s[32:35], s68 offen offset:2048 nt lds
  v_smfmac_f32_16x16x64_bf16 a[128:131], a[136:139], v[40:47], v30
  v_mfma_f32_16x16x32_bf16 v[96:99], a[80:83], v[128:131], v[112:115]
  v_exp_f32 v108, v108
  v_mfma_f32_16x16x32_bf16 v[96:99], a[84:87], v[160:163], v[96:99]
  ds_read_b128 a[64:67], v16 offset:51200
  v_cvt_pk_bf16_f32 v81, v106, v107
  v_mfma_f32_16x16x32_bf16 v[96:99], a[88:91], v[192:195], v[96:99]
  s_waitcnt lgkmcnt(3)
  v_exp_f32 v109, v109
  v_mfma_f32_16x16x32_bf16 v[96:99], a[92:95], v[224:227], v[96:99]
L_hop6:
  s_cbranch_execz L_hop10
  ds_read_b64_tr_b16 a[96:97], v24 offset:32768
  v_cvt_pk_bf16_f32 v88, v108, v109
  v_mfma_f32_16x16x32_bf16 v[176:179], v[32:35], a[112:115], v[176:179]
  v_exp_f32 v110, v110
  v_mfma_f32_16x16x32_bf16 v[176:179], v[36:39], a[116:119], v[176:179]
  ds_read_b64_tr_b16 a[98:99], v24 offset:33792
  v_mfma_f32_16x16x32_bf16 v[180:183], v[44:47], a[116:119], v[180:183]
  v_exp_f32 v111, v111
  v_mfma_f32_16x16x32_bf16 v[180:183], v[40:43], a[112:115], v[180:183]
  buffer_load_dwordx4 v29, s[32:35], s68 offen offset:3072 nt lds
  v_mfma_f32_16x16x32_bf16 v[100:103], a[80:83], v[132:135], v[116:119]
  v_exp_f32 v96, v96
  v_mfma_f32_16x16x32_bf16 v[100:103], a[84:87], v[164:167], v[100:103]
  ds_read_b128 a[68:71], v17 offset:51200
  v_cvt_pk_bf16_f32 v89, v110, v111
  v_mfma_f32_16x16x32_bf16 v[100:103], a[88:91], v[196:199], v[100:103]
  v_exp_f32 v97, v97
  v_mfma_f32_16x16x32_bf16 v[100:103], a[92:95], v[228:231], v[100:103]
  ds_read_b64_tr_b16 a[100:101], v24 offset:34816
  v_cvt_pk_bf16_f32 v66, v96, v97
  v_mfma_f32_16x16x32_bf16 a[16:19], v[48:51], a[112:115], a[16:19]
  v_exp_f32 v98, v98
  v_mfma_f32_16x16x32_bf16 a[16:19], v[52:55], a[116:119], a[16:19]
  ds_read_b64_tr_b16 a[102:103], v24 offset:35840
  v_mfma_f32_16x16x32_bf16 a[20:23], v[60:63], a[116:119], a[20:23]
  v_exp_f32 v99, v99
  v_mfma_f32_16x16x32_bf16 a[20:23], v[56:59], a[112:115], a[20:23]
  v_mfma_f32_16x16x32_bf16 v[104:107], a[80:83], v[136:139], v[120:123]
  v_exp_f32 v100, v100
  v_mfma_f32_16x16x32_bf16 v[104:107], a[84:87], v[168:171], v[104:107]
  ds_read_b128 a[72:75], v18 offset:51200
  v_cvt_pk_bf16_f32 v67, v98, v99
  v_mfma_f32_16x16x32_bf16 v[104:107], a[88:91], v[200:203], v[104:107]
  s_waitcnt lgkmcnt(7)
  v_exp_f32 v101, v101
  v_mfma_f32_16x16x32_bf16 v[104:107], a[92:95], v[232:235], v[104:107]
  ds_read_b64_tr_b16 a[104:105], v25 offset:32768
  v_cvt_pk_bf16_f32 v74, v100, v101
  v_mfma_f32_16x16x32_bf16 v[184:187], v[32:35], a[120:123], v[184:187]
  v_exp_f32 v102, v102
  v_mfma_f32_16x16x32_bf16 v[184:187], v[36:39], a[124:127], v[184:187]
  s_xor_b32 s67, s10, 135168
  ds_read_b64_tr_b16 a[106:107], v25 offset:33792
  v_mfma_f32_16x16x32_bf16 v[188:191], v[44:47], a[124:127], v[188:191]
  s_add_u32 m0, s63, 16384
  v_exp_f32 v103, v103
  v_mfma_f32_16x16x32_bf16 v[188:191], v[40:43], a[120:123], v[188:191]
  buffer_load_dwordx4 v28, s[28:31], s67 offen offset:0 nt lds
  v_smfmac_f32_16x16x64_bf16 a[128:131], a[252:255], v[32:39], v30
  v_mfma_f32_16x16x32_bf16 v[108:111], a[80:83], v[140:143], v[124:127]
  v_exp_f32 v104, v104
  v_mfma_f32_16x16x32_bf16 v[108:111], a[84:87], v[172:175], v[108:111]
  ds_read_b128 a[76:79], v19 offset:51200
  v_cvt_pk_bf16_f32 v75, v102, v103
  v_mfma_f32_16x16x32_bf16 v[108:111], a[88:91], v[204:207], v[108:111]
  s_waitcnt lgkmcnt(3)
  v_exp_f32 v105, v105
  v_mfma_f32_16x16x32_bf16 v[108:111], a[92:95], v[236:239], v[108:111]
  ds_read_b64_tr_b16 a[108:109], v25 offset:34816
  v_cvt_pk_bf16_f32 v82, v104, v105
  v_mfma_f32_16x16x32_bf16 a[24:27], v[48:51], a[120:123], a[24:27]
  v_exp_f32 v106, v106
  v_mfma_f32_16x16x32_bf16 a[24:27], v[52:55], a[124:127], a[24:27]
  ds_read_b64_tr_b16 a[110:111], v25 offset:35840
  v_mfma_f32_16x16x32_bf16 a[28:31], v[60:63], a[124:127], a[28:31]
  v_exp_f32 v107, v107
  v_mfma_f32_16x16x32_bf16 a[28:31], v[56:59], a[120:123], a[28:31]
  buffer_load_dwordx4 v28, s[28:31], s67 offen offset:1024 nt lds
  v_mfma_f32_16x16x32_bf16 v[96:99], a[64:67], v[128:131], v[112:115]
  v_exp_f32 v108, v108
  v_mfma_f32_16x16x32_bf16 v[96:99], a[68:71], v[160:163], v[96:99]
  ds_read_b128 a[80:83], v16 offset:52224
  v_cvt_pk_bf16_f32 v83, v106, v107
  v_mfma_f32_16x16x32_bf16 v[96:99], a[72:75], v[192:195], v[96:99]
  s_waitcnt lgkmcnt(3)
  v_exp_f32 v109, v109
  v_mfma_f32_16x16x32_bf16 v[96:99], a[76:79], v[224:227], v[96:99]
  ds_read_b64_tr_b16 a[112:113], v26 offset:32768
  v_cvt_pk_bf16_f32 v90, v108, v109
  v_mfma_f32_16x16x32_bf16 v[208:211], v[32:35], a[96:99], v[208:211]
  v_exp_f32 v110, v110
  v_mfma_f32_16x16x32_bf16 v[208:211], v[36:39], a[100:103], v[208:211]
  ds_read_b64_tr_b16 a[114:115], v26 offset:33792
  v_mfma_f32_16x16x32_bf16 v[212:215], v[44:47], a[100:103], v[212:215]
  v_exp_f32 v111, v111
  v_mfma_f32_16x16x32_bf16 v[212:215], v[40:43], a[96:99], v[212:215]
  v_mfma_f32_16x16x32_bf16 v[100:103], a[64:67], v[132:135], v[116:119]
  v_exp_f32 v96, v96
  v_mfma_f32_16x16x32_bf16 v[100:103], a[68:71], v[164:167], v[100:103]
  ds_read_b128 a[84:87], v17 offset:52224
  v_cvt_pk_bf16_f32 v91, v110, v111
  v_mfma_f32_16x16x32_bf16 v[100:103], a[72:75], v[196:199], v[100:103]
  v_exp_f32 v97, v97
  v_mfma_f32_16x16x32_bf16 v[100:103], a[76:79], v[228:231], v[100:103]
  ds_read_b64_tr_b16 a[116:117], v26 offset:34816
  v_cvt_pk_bf16_f32 v68, v96, v97
  v_mfma_f32_16x16x32_bf16 a[32:35], v[48:51], a[96:99], a[32:35]
  v_exp_f32 v98, v98
  v_mfma_f32_16x16x32_bf16 a[32:35], v[52:55], a[100:103], a[32:35]
  ds_read_b64_tr_b16 a[118:119], v26 offset:35840
  v_mfma_f32_16x16x32_bf16 a[36:39], v[60:63], a[100:103], a[36:39]
  v_exp_f32 v99, v99
  v_mfma_f32_16x16x32_bf16 a[36:39], v[56:59], a[96:99], a[36:39]
  buffer_load_dwordx4 v28, s[28:31], s67 offen offset:2048 nt lds
  v_smfmac_f32_16x16x64_bf16 a[132:135], a[136:139], v[56:63], v30
  v_mfma_f32_16x16x32_bf16 v[104:107], a[64:67], v[136:139], v[120:123]
  v_exp_f32 v100, v100
  v_mfma_f32_16x16x32_bf16 v[104:107], a[68:71], v[168:171], v[104:107]
  ds_read_b128 a[88:91], v18 offset:52224
  v_cvt_pk_bf16_f32 v69, v98, v99
  v_mfma_f32_16x16x32_bf16 v[104:107], a[72:75], v[200:203], v[104:107]
  s_waitcnt lgkmcnt(7)
  v_exp_f32 v101, v101
  v_mfma_f32_16x16x32_bf16 v[104:107], a[76:79], v[232:235], v[104:107]
  ds_read_b64_tr_b16 a[120:121], v27 offset:32768
  v_cvt_pk_bf16_f32 v76, v100, v101
  v_mfma_f32_16x16x32_bf16 v[216:219], v[32:35], a[104:107], v[216:219]
  v_exp_f32 v102, v102
  v_mfma_f32_16x16x32_bf16 v[216:219], v[36:39], a[108:111], v[216:219]
  ds_read_b64_tr_b16 a[122:123], v27 offset:33792
  v_mfma_f32_16x16x32_bf16 v[220:223], v[44:47], a[108:111], v[220:223]
  v_exp_f32 v103, v103
  v_mfma_f32_16x16x32_bf16 v[220:223], v[40:43], a[104:107], v[220:223]
  buffer_load_dwordx4 v28, s[28:31], s67 offen offset:3072 nt lds
  v_mfma_f32_16x16x32_bf16 v[108:111], a[64:67], v[140:143], v[124:127]
  v_exp_f32 v104, v104
  v_mfma_f32_16x16x32_bf16 v[108:111], a[68:71], v[172:175], v[108:111]
  ds_read_b128 a[92:95], v19 offset:52224
  v_cvt_pk_bf16_f32 v77, v102, v103
  v_mfma_f32_16x16x32_bf16 v[108:111], a[72:75], v[204:207], v[108:111]
  s_waitcnt lgkmcnt(3)
  v_exp_f32 v105, v105
  v_mfma_f32_16x16x32_bf16 v[108:111], a[76:79], v[236:239], v[108:111]
  ds_read_b64_tr_b16 a[124:125], v27 offset:34816
  v_cvt_pk_bf16_f32 v84, v104, v105
  v_mfma_f32_16x16x32_bf16 a[40:43], v[48:51], a[104:107], a[40:43]
  v_exp_f32 v106, v106
  v_mfma_f32_16x16x32_bf16 a[40:43], v[52:55], a[108:111], a[40:43]
  ds_read_b64_tr_b16 a[126:127], v27 offset:35840
  v_mfma_f32_16x16x32_bf16 a[44:47], v[60:63], a[108:111], a[44:47]
  s_waitcnt vmcnt(8)
  v_exp_f32 v107, v107
  v_mfma_f32_16x16x32_bf16 a[44:47], v[56:59], a[104:107], a[44:47]
  v_mfma_f32_16x16x32_bf16 v[96:99], a[80:83], v[128:131], v[112:115]
  s_barrier
  v_exp_f32 v108, v108
  v_mfma_f32_16x16x32_bf16 v[96:99], a[84:87], v[160:163], v[96:99]
  ds_read_b128 a[64:67], v16 offset:0
  v_cvt_pk_bf16_f32 v85, v106, v107
  v_mfma_f32_16x16x32_bf16 v[96:99], a[88:91], v[192:195], v[96:99]
  s_waitcnt lgkmcnt(3)
  v_exp_f32 v109, v109
  v_mfma_f32_16x16x32_bf16 v[96:99], a[92:95], v[224:227], v[96:99]
  ds_read_b64_tr_b16 a[96:97], v20 offset:49152
  v_cvt_pk_bf16_f32 v92, v108, v109
  v_mfma_f32_16x16x32_bf16 v[240:243], v[32:35], a[112:115], v[240:243]
  v_exp_f32 v110, v110
  v_mfma_f32_16x16x32_bf16 v[240:243], v[36:39], a[116:119], v[240:243]
  ds_read_b64_tr_b16 a[98:99], v20 offset:50176
  v_mfma_f32_16x16x32_bf16 v[244:247], v[44:47], a[116:119], v[244:247]
  v_exp_f32 v111, v111
  v_mfma_f32_16x16x32_bf16 v[244:247], v[40:43], a[112:115], v[244:247]
  v_mfma_f32_16x16x32_bf16 v[100:103], a[80:83], v[132:135], v[116:119]
  v_exp_f32 v96, v96
  v_mfma_f32_16x16x32_bf16 v[100:103], a[84:87], v[164:167], v[100:103]
  ds_read_b128 a[68:71], v17 offset:0
  v_cvt_pk_bf16_f32 v93, v110, v111
  v_mfma_f32_16x16x32_bf16 v[100:103], a[88:91], v[196:199], v[100:103]
  v_exp_f32 v97, v97
  v_mfma_f32_16x16x32_bf16 v[100:103], a[92:95], v[228:231], v[100:103]
  ds_read_b64_tr_b16 a[100:101], v20 offset:51200
  v_cvt_pk_bf16_f32 v70, v96, v97
  v_mfma_f32_16x16x32_bf16 a[48:51], v[48:51], a[112:115], a[48:51]
  v_exp_f32 v98, v98
  v_mfma_f32_16x16x32_bf16 a[48:51], v[52:55], a[116:119], a[48:51]
  s_xor_b32 s68, s10, 135168
  ds_read_b64_tr_b16 a[102:103], v20 offset:52224
  v_mfma_f32_16x16x32_bf16 a[52:55], v[60:63], a[116:119], a[52:55]
  s_add_u32 m0, s63, 81920
  v_exp_f32 v99, v99
  v_mfma_f32_16x16x32_bf16 a[52:55], v[56:59], a[112:115], a[52:55]
  buffer_load_dwordx4 v29, s[32:35], s68 offen offset:0 nt lds
  v_smfmac_f32_16x16x64_bf16 a[132:135], a[252:255], v[48:55], v30
  v_mfma_f32_16x16x32_bf16 v[104:107], a[80:83], v[136:139], v[120:123]
  v_exp_f32 v100, v100
  v_mfma_f32_16x16x32_bf16 v[104:107], a[84:87], v[168:171], v[104:107]
  ds_read_b128 a[72:75], v18 offset:0
  v_cvt_pk_bf16_f32 v71, v98, v99
  v_mfma_f32_16x16x32_bf16 v[104:107], a[88:91], v[200:203], v[104:107]
  s_waitcnt lgkmcnt(7)
  v_exp_f32 v101, v101
  v_mfma_f32_16x16x32_bf16 v[104:107], a[92:95], v[232:235], v[104:107]
  ds_read_b64_tr_b16 a[104:105], v21 offset:49152
  v_cvt_pk_bf16_f32 v78, v100, v101
  v_mfma_f32_16x16x32_bf16 v[248:251], v[32:35], a[120:123], v[248:251]
  v_exp_f32 v102, v102
  v_mfma_f32_16x16x32_bf16 v[248:251], v[36:39], a[124:127], v[248:251]
  ds_read_b64_tr_b16 a[106:107], v21 offset:50176
  v_mfma_f32_16x16x32_bf16 v[252:255], v[44:47], a[124:127], v[252:255]
  v_exp_f32 v103, v103
  v_mfma_f32_16x16x32_bf16 v[252:255], v[40:43], a[120:123], v[252:255]
  v_mfma_f32_16x16x32_bf16 v[108:111], a[80:83], v[140:143], v[124:127]
  v_exp_f32 v104, v104
  v_mfma_f32_16x16x32_bf16 v[108:111], a[84:87], v[172:175], v[108:111]
  ds_read_b128 a[76:79], v19 offset:0
  v_cvt_pk_bf16_f32 v79, v102, v103
  v_mfma_f32_16x16x32_bf16 v[108:111], a[88:91], v[204:207], v[108:111]
  s_waitcnt lgkmcnt(3)
  v_exp_f32 v105, v105
  v_mfma_f32_16x16x32_bf16 v[108:111], a[92:95], v[236:239], v[108:111]
  ds_read_b64_tr_b16 a[108:109], v21 offset:51200
  v_cvt_pk_bf16_f32 v86, v104, v105
  v_mfma_f32_16x16x32_bf16 a[56:59], v[48:51], a[120:123], a[56:59]
  v_exp_f32 v106, v106
  v_mfma_f32_16x16x32_bf16 a[56:59], v[52:55], a[124:127], a[56:59]
  ds_read_b64_tr_b16 a[110:111], v21 offset:52224
  v_mfma_f32_16x16x32_bf16 a[60:63], v[60:63], a[124:127], a[60:63]
  v_exp_f32 v107, v107
  v_mfma_f32_16x16x32_bf16 a[60:63], v[56:59], a[120:123], a[60:63]
  v_cvt_pk_bf16_f32 v87, v106, v107
  v_mfma_f32_16x16x32_bf16 v[96:99], a[64:67], v[128:131], v[112:115]
  v_exp_f32 v108, v108
  v_mfma_f32_16x16x32_bf16 v[96:99], a[68:71], v[160:163], v[96:99]
  ds_read_b128 a[80:83], v16 offset:1024
  v_mfma_f32_16x16x32_bf16 v[96:99], a[72:75], v[192:195], v[96:99]
  s_waitcnt lgkmcnt(3)
  v_exp_f32 v109, v109
  v_mfma_f32_16x16x32_bf16 v[96:99], a[76:79], v[224:227], v[96:99]
  ds_read_b64_tr_b16 a[112:113], v22 offset:49152
  v_cvt_pk_bf16_f32 v94, v108, v109
  v_mfma_f32_16x16x32_bf16 v[144:147], v[64:67], a[96:99], v[144:147]
  v_exp_f32 v110, v110
  v_mfma_f32_16x16x32_bf16 v[144:147], v[68:71], a[100:103], v[144:147]
  ds_read_b64_tr_b16 a[114:115], v22 offset:50176
  v_mfma_f32_16x16x32_bf16 v[148:151], v[76:79], a[100:103], v[148:151]
  v_exp_f32 v111, v111
  v_mfma_f32_16x16x32_bf16 v[148:151], v[72:75], a[96:99], v[148:151]
  global_load_dword v7, v2, s[74:75]
  v_mfma_f32_16x16x32_bf16 v[100:103], a[64:67], v[132:135], v[116:119]
  v_exp_f32 v96, v96
  v_mfma_f32_16x16x32_bf16 v[100:103], a[68:71], v[164:167], v[100:103]
  ds_read_b128 a[84:87], v17 offset:1024
  v_cvt_pk_bf16_f32 v95, v110, v111
  v_mfma_f32_16x16x32_bf16 v[100:103], a[72:75], v[196:199], v[100:103]
  v_exp_f32 v97, v97
  v_mfma_f32_16x16x32_bf16 v[100:103], a[76:79], v[228:231], v[100:103]
  ds_read_b64_tr_b16 a[116:117], v22 offset:51200
  v_cvt_pk_bf16_f32 v32, v96, v97
  v_mfma_f32_16x16x32_bf16 a[0:3], v[80:83], a[96:99], a[0:3]
  v_exp_f32 v98, v98
  v_mfma_f32_16x16x32_bf16 a[0:3], v[84:87], a[100:103], a[0:3]
  ds_read_b64_tr_b16 a[118:119], v22 offset:52224
  v_mfma_f32_16x16x32_bf16 a[4:7], v[92:95], a[100:103], a[4:7]
  v_exp_f32 v99, v99
  v_mfma_f32_16x16x32_bf16 a[4:7], v[88:91], a[96:99], a[4:7]
  buffer_load_dwordx4 v29, s[32:35], s68 offen offset:1024 nt lds
  v_mfma_f32_16x16x32_bf16 v[104:107], a[64:67], v[136:139], v[120:123]
  v_exp_f32 v100, v100
  v_mfma_f32_16x16x32_bf16 v[104:107], a[68:71], v[168:171], v[104:107]
  ds_read_b128 a[88:91], v18 offset:1024
  v_cvt_pk_bf16_f32 v33, v98, v99
  v_mfma_f32_16x16x32_bf16 v[104:107], a[72:75], v[200:203], v[104:107]
  s_waitcnt lgkmcnt(7)
  v_exp_f32 v101, v101
  v_mfma_f32_16x16x32_bf16 v[104:107], a[76:79], v[232:235], v[104:107]
  ds_read_b64_tr_b16 a[120:121], v23 offset:49152
  v_cvt_pk_bf16_f32 v40, v100, v101
  v_mfma_f32_16x16x32_bf16 v[152:155], v[64:67], a[104:107], v[152:155]
  v_exp_f32 v102, v102
  v_mfma_f32_16x16x32_bf16 v[152:155], v[68:71], a[108:111], v[152:155]
  ds_read_b64_tr_b16 a[122:123], v23 offset:50176
  v_mfma_f32_16x16x32_bf16 v[156:159], v[76:79], a[108:111], v[156:159]
  v_exp_f32 v103, v103
  v_mfma_f32_16x16x32_bf16 v[156:159], v[72:75], a[104:107], v[156:159]
  v_mfma_f32_16x16x32_bf16 v[108:111], a[64:67], v[140:143], v[124:127]
  v_exp_f32 v104, v104
  v_mfma_f32_16x16x32_bf16 v[108:111], a[68:71], v[172:175], v[108:111]
  ds_read_b128 a[92:95], v19 offset:1024
  v_cvt_pk_bf16_f32 v41, v102, v103
  v_mfma_f32_16x16x32_bf16 v[108:111], a[72:75], v[204:207], v[108:111]
  s_waitcnt lgkmcnt(3)
  v_exp_f32 v105, v105
  v_mfma_f32_16x16x32_bf16 v[108:111], a[76:79], v[236:239], v[108:111]
  ds_read_b64_tr_b16 a[124:125], v23 offset:51200
  v_cvt_pk_bf16_f32 v48, v104, v105
  v_mfma_f32_16x16x32_bf16 a[8:11], v[80:83], a[104:107], a[8:11]
  v_exp_f32 v106, v106
  v_mfma_f32_16x16x32_bf16 a[8:11], v[84:87], a[108:111], a[8:11]
  ds_read_b64_tr_b16 a[126:127], v23 offset:52224
  v_mfma_f32_16x16x32_bf16 a[12:15], v[92:95], a[108:111], a[12:15]
  v_exp_f32 v107, v107
  v_mfma_f32_16x16x32_bf16 a[12:15], v[88:91], a[104:107], a[12:15]
  buffer_load_dwordx4 v29, s[32:35], s68 offen offset:2048 nt lds
  v_smfmac_f32_16x16x64_bf16 a[128:131], a[136:139], v[72:79], v30
  v_mfma_f32_16x16x32_bf16 v[96:99], a[80:83], v[128:131], v[112:115]
  v_exp_f32 v108, v108
  v_mfma_f32_16x16x32_bf16 v[96:99], a[84:87], v[160:163], v[96:99]
  ds_read_b128 a[64:67], v16 offset:2048
  v_cvt_pk_bf16_f32 v49, v106, v107
  v_mfma_f32_16x16x32_bf16 v[96:99], a[88:91], v[192:195], v[96:99]
  s_waitcnt lgkmcnt(3)
  v_exp_f32 v109, v109
  v_mfma_f32_16x16x32_bf16 v[96:99], a[92:95], v[224:227], v[96:99]
  ds_read_b64_tr_b16 a[96:97], v24 offset:49152
  v_cvt_pk_bf16_f32 v56, v108, v109
  v_mfma_f32_16x16x32_bf16 v[176:179], v[64:67], a[112:115], v[176:179]
  v_exp_f32 v110, v110
  v_mfma_f32_16x16x32_bf16 v[176:179], v[68:71], a[116:119], v[176:179]
  ds_read_b64_tr_b16 a[98:99], v24 offset:50176
  v_mfma_f32_16x16x32_bf16 v[180:183], v[76:79], a[116:119], v[180:183]
  v_exp_f32 v111, v111
  v_mfma_f32_16x16x32_bf16 v[180:183], v[72:75], a[112:115], v[180:183]
  buffer_load_dwordx4 v29, s[32:35], s68 offen offset:3072 nt lds
  v_mfma_f32_16x16x32_bf16 v[100:103], a[80:83], v[132:135], v[116:119]
  v_exp_f32 v96, v96
  v_mfma_f32_16x16x32_bf16 v[100:103], a[84:87], v[164:167], v[100:103]
  ds_read_b128 a[68:71], v17 offset:2048
  v_cvt_pk_bf16_f32 v57, v110, v111
  v_mfma_f32_16x16x32_bf16 v[100:103], a[88:91], v[196:199], v[100:103]
  v_exp_f32 v97, v97
  v_mfma_f32_16x16x32_bf16 v[100:103], a[92:95], v[228:231], v[100:103]
  ds_read_b64_tr_b16 a[100:101], v24 offset:51200
  v_cvt_pk_bf16_f32 v34, v96, v97
  v_mfma_f32_16x16x32_bf16 a[16:19], v[80:83], a[112:115], a[16:19]
  v_exp_f32 v98, v98
  v_mfma_f32_16x16x32_bf16 a[16:19], v[84:87], a[116:119], a[16:19]
  ds_read_b64_tr_b16 a[102:103], v24 offset:52224
  v_mfma_f32_16x16x32_bf16 a[20:23], v[92:95], a[116:119], a[20:23]
  v_exp_f32 v99, v99
  v_mfma_f32_16x16x32_bf16 a[20:23], v[88:91], a[112:115], a[20:23]
  v_mfma_f32_16x16x32_bf16 v[104:107], a[80:83], v[136:139], v[120:123]
  v_exp_f32 v100, v100
  v_mfma_f32_16x16x32_bf16 v[104:107], a[84:87], v[168:171], v[104:107]
  ds_read_b128 a[72:75], v18 offset:2048
  v_cvt_pk_bf16_f32 v35, v98, v99
  v_mfma_f32_16x16x32_bf16 v[104:107], a[88:91], v[200:203], v[104:107]
  s_waitcnt lgkmcnt(7)
  v_exp_f32 v101, v101
  v_mfma_f32_16x16x32_bf16 v[104:107], a[92:95], v[232:235], v[104:107]
  ds_read_b64_tr_b16 a[104:105], v25 offset:49152
  v_cvt_pk_bf16_f32 v42, v100, v101
  v_mfma_f32_16x16x32_bf16 v[184:187], v[64:67], a[120:123], v[184:187]
  v_exp_f32 v102, v102
  v_mfma_f32_16x16x32_bf16 v[184:187], v[68:71], a[124:127], v[184:187]
  s_xor_b32 s67, s10, 147456
  ds_read_b64_tr_b16 a[106:107], v25 offset:50176
  v_mfma_f32_16x16x32_bf16 v[188:191], v[76:79], a[124:127], v[188:191]
  s_add_u32 m0, s63, 32768
  v_exp_f32 v103, v103
  v_mfma_f32_16x16x32_bf16 v[188:191], v[72:75], a[120:123], v[188:191]
  buffer_load_dwordx4 v28, s[28:31], s67 offen offset:0 nt lds
  v_smfmac_f32_16x16x64_bf16 a[128:131], a[252:255], v[64:71], v30
  v_mfma_f32_16x16x32_bf16 v[108:111], a[80:83], v[140:143], v[124:127]
  v_exp_f32 v104, v104
  v_mfma_f32_16x16x32_bf16 v[108:111], a[84:87], v[172:175], v[108:111]
  ds_read_b128 a[76:79], v19 offset:2048
  v_cvt_pk_bf16_f32 v43, v102, v103
  v_mfma_f32_16x16x32_bf16 v[108:111], a[88:91], v[204:207], v[108:111]
  s_waitcnt lgkmcnt(3)
  v_exp_f32 v105, v105
  v_mfma_f32_16x16x32_bf16 v[108:111], a[92:95], v[236:239], v[108:111]
  ds_read_b64_tr_b16 a[108:109], v25 offset:51200
  v_cvt_pk_bf16_f32 v50, v104, v105
  v_mfma_f32_16x16x32_bf16 a[24:27], v[80:83], a[120:123], a[24:27]
  v_exp_f32 v106, v106
  v_mfma_f32_16x16x32_bf16 a[24:27], v[84:87], a[124:127], a[24:27]
  ds_read_b64_tr_b16 a[110:111], v25 offset:52224
  v_mfma_f32_16x16x32_bf16 a[28:31], v[92:95], a[124:127], a[28:31]
  v_exp_f32 v107, v107
  v_mfma_f32_16x16x32_bf16 a[28:31], v[88:91], a[120:123], a[28:31]
  buffer_load_dwordx4 v28, s[28:31], s67 offen offset:1024 nt lds
  v_mfma_f32_16x16x32_bf16 v[96:99], a[64:67], v[128:131], v[112:115]
  v_exp_f32 v108, v108
  v_mfma_f32_16x16x32_bf16 v[96:99], a[68:71], v[160:163], v[96:99]
  ds_read_b128 a[80:83], v16 offset:3072
  v_cvt_pk_bf16_f32 v51, v106, v107
  v_mfma_f32_16x16x32_bf16 v[96:99], a[72:75], v[192:195], v[96:99]
  s_waitcnt lgkmcnt(3)
  v_exp_f32 v109, v109
  v_mfma_f32_16x16x32_bf16 v[96:99], a[76:79], v[224:227], v[96:99]
  ds_read_b64_tr_b16 a[112:113], v26 offset:49152
  v_cvt_pk_bf16_f32 v58, v108, v109
  v_mfma_f32_16x16x32_bf16 v[208:211], v[64:67], a[96:99], v[208:211]
  v_exp_f32 v110, v110
  v_mfma_f32_16x16x32_bf16 v[208:211], v[68:71], a[100:103], v[208:211]
  ds_read_b64_tr_b16 a[114:115], v26 offset:50176
  v_mfma_f32_16x16x32_bf16 v[212:215], v[76:79], a[100:103], v[212:215]
  v_exp_f32 v111, v111
  v_mfma_f32_16x16x32_bf16 v[212:215], v[72:75], a[96:99], v[212:215]
  v_mfma_f32_16x16x32_bf16 v[100:103], a[64:67], v[132:135], v[116:119]
  v_exp_f32 v96, v96
  v_mfma_f32_16x16x32_bf16 v[100:103], a[68:71], v[164:167], v[100:103]
  ds_read_b128 a[84:87], v17 offset:3072
  v_cvt_pk_bf16_f32 v59, v110, v111
  v_mfma_f32_16x16x32_bf16 v[100:103], a[72:75], v[196:199], v[100:103]
  v_exp_f32 v97, v97
  v_mfma_f32_16x16x32_bf16 v[100:103], a[76:79], v[228:231], v[100:103]
  ds_read_b64_tr_b16 a[116:117], v26 offset:51200
  v_cvt_pk_bf16_f32 v36, v96, v97
  v_mfma_f32_16x16x32_bf16 a[32:35], v[80:83], a[96:99], a[32:35]
  v_exp_f32 v98, v98
  v_mfma_f32_16x16x32_bf16 a[32:35], v[84:87], a[100:103], a[32:35]
  ds_read_b64_tr_b16 a[118:119], v26 offset:52224
  v_mfma_f32_16x16x32_bf16 a[36:39], v[92:95], a[100:103], a[36:39]
  v_exp_f32 v99, v99
  v_mfma_f32_16x16x32_bf16 a[36:39], v[88:91], a[96:99], a[36:39]
  buffer_load_dwordx4 v28, s[28:31], s67 offen offset:2048 nt lds
  v_smfmac_f32_16x16x64_bf16 a[132:135], a[136:139], v[88:95], v30
  v_mfma_f32_16x16x32_bf16 v[104:107], a[64:67], v[136:139], v[120:123]
  v_exp_f32 v100, v100
  v_mfma_f32_16x16x32_bf16 v[104:107], a[68:71], v[168:171], v[104:107]
  ds_read_b128 a[88:91], v18 offset:3072
  v_cvt_pk_bf16_f32 v37, v98, v99
  v_mfma_f32_16x16x32_bf16 v[104:107], a[72:75], v[200:203], v[104:107]
  s_waitcnt lgkmcnt(7)
  v_exp_f32 v101, v101
  v_mfma_f32_16x16x32_bf16 v[104:107], a[76:79], v[232:235], v[104:107]
  ds_read_b64_tr_b16 a[120:121], v27 offset:49152
  v_cvt_pk_bf16_f32 v44, v100, v101
  v_mfma_f32_16x16x32_bf16 v[216:219], v[64:67], a[104:107], v[216:219]
  v_exp_f32 v102, v102
  v_mfma_f32_16x16x32_bf16 v[216:219], v[68:71], a[108:111], v[216:219]
  ds_read_b64_tr_b16 a[122:123], v27 offset:50176
  v_mfma_f32_16x16x32_bf16 v[220:223], v[76:79], a[108:111], v[220:223]
  v_exp_f32 v103, v103
  v_mfma_f32_16x16x32_bf16 v[220:223], v[72:75], a[104:107], v[220:223]
  buffer_load_dwordx4 v28, s[28:31], s67 offen offset:3072 nt lds
  v_mfma_f32_16x16x32_bf16 v[108:111], a[64:67], v[140:143], v[124:127]
  v_exp_f32 v104, v104
  v_mfma_f32_16x16x32_bf16 v[108:111], a[68:71], v[172:175], v[108:111]
  ds_read_b128 a[92:95], v19 offset:3072
  v_cvt_pk_bf16_f32 v45, v102, v103
  v_mfma_f32_16x16x32_bf16 v[108:111], a[72:75], v[204:207], v[108:111]
  s_waitcnt lgkmcnt(3)
  v_exp_f32 v105, v105
  v_mfma_f32_16x16x32_bf16 v[108:111], a[76:79], v[236:239], v[108:111]
  ds_read_b64_tr_b16 a[124:125], v27 offset:51200
  v_cvt_pk_bf16_f32 v52, v104, v105
  v_mfma_f32_16x16x32_bf16 a[40:43], v[80:83], a[104:107], a[40:43]
  v_exp_f32 v106, v106
  v_mfma_f32_16x16x32_bf16 a[40:43], v[84:87], a[108:111], a[40:43]
  ds_read_b64_tr_b16 a[126:127], v27 offset:52224
  v_mfma_f32_16x16x32_bf16 a[44:47], v[92:95], a[108:111], a[44:47]
  s_waitcnt vmcnt(9)
  v_exp_f32 v107, v107
  v_mfma_f32_16x16x32_bf16 a[44:47], v[88:91], a[104:107], a[44:47]
  v_mfma_f32_16x16x32_bf16 v[96:99], a[80:83], v[128:131], v[112:115]
  s_barrier
  v_exp_f32 v108, v108
  v_mfma_f32_16x16x32_bf16 v[96:99], a[84:87], v[160:163], v[96:99]
  ds_read_b128 a[64:67], v16 offset:16384
  v_cvt_pk_bf16_f32 v53, v106, v107
  v_mfma_f32_16x16x32_bf16 v[96:99], a[88:91], v[192:195], v[96:99]
  s_waitcnt lgkmcnt(3)
  v_exp_f32 v109, v109
  v_mfma_f32_16x16x32_bf16 v[96:99], a[92:95], v[224:227], v[96:99]
  ds_read_b64_tr_b16 a[96:97], v20 offset:0
  v_cvt_pk_bf16_f32 v60, v108, v109
  v_mfma_f32_16x16x32_bf16 v[240:243], v[64:67], a[112:115], v[240:243]
  v_exp_f32 v110, v110
  v_mfma_f32_16x16x32_bf16 v[240:243], v[68:71], a[116:119], v[240:243]
  ds_read_b64_tr_b16 a[98:99], v20 offset:1024
  v_mfma_f32_16x16x32_bf16 v[244:247], v[76:79], a[116:119], v[244:247]
  v_exp_f32 v111, v111
  v_mfma_f32_16x16x32_bf16 v[244:247], v[72:75], a[112:115], v[244:247]
  v_mfma_f32_16x16x32_bf16 v[100:103], a[80:83], v[132:135], v[116:119]
  v_exp_f32 v96, v96
  v_mfma_f32_16x16x32_bf16 v[100:103], a[84:87], v[164:167], v[100:103]
  ds_read_b128 a[68:71], v17 offset:16384
  v_cvt_pk_bf16_f32 v61, v110, v111
  v_mfma_f32_16x16x32_bf16 v[100:103], a[88:91], v[196:199], v[100:103]
  v_exp_f32 v97, v97
  v_mfma_f32_16x16x32_bf16 v[100:103], a[92:95], v[228:231], v[100:103]
  ds_read_b64_tr_b16 a[100:101], v20 offset:2048
  v_cvt_pk_bf16_f32 v38, v96, v97
  v_mfma_f32_16x16x32_bf16 a[48:51], v[80:83], a[112:115], a[48:51]
  v_exp_f32 v98, v98
  v_mfma_f32_16x16x32_bf16 a[48:51], v[84:87], a[116:119], a[48:51]
  s_xor_b32 s68, s10, 147456
  ds_read_b64_tr_b16 a[102:103], v20 offset:3072
  v_mfma_f32_16x16x32_bf16 a[52:55], v[92:95], a[116:119], a[52:55]
  s_add_u32 m0, s63, 98304
  v_exp_f32 v99, v99
  v_mfma_f32_16x16x32_bf16 a[52:55], v[88:91], a[112:115], a[52:55]
  buffer_load_dwordx4 v29, s[32:35], s68 offen offset:0 nt lds
  v_smfmac_f32_16x16x64_bf16 a[132:135], a[252:255], v[80:87], v30
  v_mfma_f32_16x16x32_bf16 v[104:107], a[80:83], v[136:139], v[120:123]
  v_exp_f32 v100, v100
  v_mfma_f32_16x16x32_bf16 v[104:107], a[84:87], v[168:171], v[104:107]
  ds_read_b128 a[72:75], v18 offset:16384
  v_cvt_pk_bf16_f32 v39, v98, v99
  v_mfma_f32_16x16x32_bf16 v[104:107], a[88:91], v[200:203], v[104:107]
  s_waitcnt lgkmcnt(7)
  v_exp_f32 v101, v101
  v_mfma_f32_16x16x32_bf16 v[104:107], a[92:95], v[232:235], v[104:107]
  ds_read_b64_tr_b16 a[104:105], v21 offset:0
  v_cvt_pk_bf16_f32 v46, v100, v101
  v_mfma_f32_16x16x32_bf16 v[248:251], v[64:67], a[120:123], v[248:251]
  v_exp_f32 v102, v102
  v_mfma_f32_16x16x32_bf16 v[248:251], v[68:71], a[124:127], v[248:251]
  ds_read_b64_tr_b16 a[106:107], v21 offset:1024
  v_mfma_f32_16x16x32_bf16 v[252:255], v[76:79], a[124:127], v[252:255]
  v_exp_f32 v103, v103
  v_mfma_f32_16x16x32_bf16 v[252:255], v[72:75], a[120:123], v[252:255]
  v_mfma_f32_16x16x32_bf16 v[108:111], a[80:83], v[140:143], v[124:127]
  v_exp_f32 v104, v104
  v_mfma_f32_16x16x32_bf16 v[108:111], a[84:87], v[172:175], v[108:111]
  ds_read_b128 a[76:79], v19 offset:16384
  v_cvt_pk_bf16_f32 v47, v102, v103
  v_mfma_f32_16x16x32_bf16 v[108:111], a[88:91], v[204:207], v[108:111]
  s_waitcnt lgkmcnt(3)
  v_exp_f32 v105, v105
  v_mfma_f32_16x16x32_bf16 v[108:111], a[92:95], v[236:239], v[108:111]
  ds_read_b64_tr_b16 a[108:109], v21 offset:2048
  v_cvt_pk_bf16_f32 v54, v104, v105
  v_mfma_f32_16x16x32_bf16 a[56:59], v[80:83], a[120:123], a[56:59]
  v_exp_f32 v106, v106
  v_mfma_f32_16x16x32_bf16 a[56:59], v[84:87], a[124:127], a[56:59]
  ds_read_b64_tr_b16 a[110:111], v21 offset:3072
  v_mfma_f32_16x16x32_bf16 a[60:63], v[92:95], a[124:127], a[60:63]
  v_exp_f32 v107, v107
  v_mfma_f32_16x16x32_bf16 a[60:63], v[88:91], a[120:123], a[60:63]
  v_cvt_pk_bf16_f32 v55, v106, v107
  v_mfma_f32_16x16x32_bf16 v[96:99], a[64:67], v[128:131], v[112:115]
  v_exp_f32 v108, v108
  v_mfma_f32_16x16x32_bf16 v[96:99], a[68:71], v[160:163], v[96:99]
  ds_read_b128 a[80:83], v16 offset:17408
  v_mfma_f32_16x16x32_bf16 v[96:99], a[72:75], v[192:195], v[96:99]
  s_waitcnt lgkmcnt(3)
  v_exp_f32 v109, v109
  v_mfma_f32_16x16x32_bf16 v[96:99], a[76:79], v[224:227], v[96:99]
  ds_read_b64_tr_b16 a[112:113], v22 offset:0
  v_cvt_pk_bf16_f32 v62, v108, v109
  v_mfma_f32_16x16x32_bf16 v[144:147], v[32:35], a[96:99], v[144:147]
  v_exp_f32 v110, v110
  v_mfma_f32_16x16x32_bf16 v[144:147], v[36:39], a[100:103], v[144:147]
  ds_read_b64_tr_b16 a[114:115], v22 offset:1024
  v_mfma_f32_16x16x32_bf16 v[148:151], v[44:47], a[100:103], v[148:151]
  v_exp_f32 v111, v111
  v_mfma_f32_16x16x32_bf16 v[148:151], v[40:43], a[96:99], v[148:151]
  v_mfma_f32_16x16x32_bf16 v[100:103], a[64:67], v[132:135], v[116:119]
  v_exp_f32 v96, v96
  v_mfma_f32_16x16x32_bf16 v[100:103], a[68:71], v[164:167], v[100:103]
  ds_read_b128 a[84:87], v17 offset:17408
  v_cvt_pk_bf16_f32 v63, v110, v111
  v_mfma_f32_16x16x32_bf16 v[100:103], a[72:75], v[196:199], v[100:103]
  v_exp_f32 v97, v97
  v_mfma_f32_16x16x32_bf16 v[100:103], a[76:79], v[228:231], v[100:103]
  ds_read_b64_tr_b16 a[116:117], v22 offset:2048
  v_cvt_pk_bf16_f32 v64, v96, v97
  v_mfma_f32_16x16x32_bf16 a[0:3], v[48:51], a[96:99], a[0:3]
  v_exp_f32 v98, v98
  v_mfma_f32_16x16x32_bf16 a[0:3], v[52:55], a[100:103], a[0:3]
  ds_read_b64_tr_b16 a[118:119], v22 offset:3072
  v_mfma_f32_16x16x32_bf16 a[4:7], v[60:63], a[100:103], a[4:7]
  v_exp_f32 v99, v99
  v_mfma_f32_16x16x32_bf16 a[4:7], v[56:59], a[96:99], a[4:7]
  buffer_load_dwordx4 v29, s[32:35], s68 offen offset:1024 nt lds
  v_mfma_f32_16x16x32_bf16 v[104:107], a[64:67], v[136:139], v[120:123]
  v_exp_f32 v100, v100
  v_mfma_f32_16x16x32_bf16 v[104:107], a[68:71], v[168:171], v[104:107]
  ds_read_b128 a[88:91], v18 offset:17408
  v_cvt_pk_bf16_f32 v65, v98, v99
  v_mfma_f32_16x16x32_bf16 v[104:107], a[72:75], v[200:203], v[104:107]
  s_waitcnt lgkmcnt(7)
  v_exp_f32 v101, v101
  v_mfma_f32_16x16x32_bf16 v[104:107], a[76:79], v[232:235], v[104:107]
  ds_read_b64_tr_b16 a[120:121], v23 offset:0
  v_cvt_pk_bf16_f32 v72, v100, v101
  v_mfma_f32_16x16x32_bf16 v[152:155], v[32:35], a[104:107], v[152:155]
  v_exp_f32 v102, v102
  v_mfma_f32_16x16x32_bf16 v[152:155], v[36:39], a[108:111], v[152:155]
  ds_read_b64_tr_b16 a[122:123], v23 offset:1024
  v_mfma_f32_16x16x32_bf16 v[156:159], v[44:47], a[108:111], v[156:159]
  v_exp_f32 v103, v103
  v_mfma_f32_16x16x32_bf16 v[156:159], v[40:43], a[104:107], v[156:159]
  v_mfma_f32_16x16x32_bf16 v[108:111], a[64:67], v[140:143], v[124:127]
  v_exp_f32 v104, v104
  v_mfma_f32_16x16x32_bf16 v[108:111], a[68:71], v[172:175], v[108:111]
  ds_read_b128 a[92:95], v19 offset:17408
  v_cvt_pk_bf16_f32 v73, v102, v103
  v_mfma_f32_16x16x32_bf16 v[108:111], a[72:75], v[204:207], v[108:111]
  s_waitcnt lgkmcnt(3)
  v_exp_f32 v105, v105
  v_mfma_f32_16x16x32_bf16 v[108:111], a[76:79], v[236:239], v[108:111]
  ds_read_b64_tr_b16 a[124:125], v23 offset:2048
  v_cvt_pk_bf16_f32 v80, v104, v105
  v_mfma_f32_16x16x32_bf16 a[8:11], v[48:51], a[104:107], a[8:11]
L_hop7:
  s_cbranch_execz L_hopback
  v_exp_f32 v106, v106
  v_mfma_f32_16x16x32_bf16 a[8:11], v[52:55], a[108:111], a[8:11]
  ds_read_b64_tr_b16 a[126:127], v23 offset:3072
  v_mfma_f32_16x16x32_bf16 a[12:15], v[60:63], a[108:111], a[12:15]
  v_exp_f32 v107, v107
  v_mfma_f32_16x16x32_bf16 a[12:15], v[56:59], a[104:107], a[12:15]
  buffer_load_dwordx4 v29, s[32:35], s68 offen offset:2048 nt lds
  v_mfma_f32_16x16x32_bf16 a[128:131], a[244:247], v[40:43], a[128:131]
  v_mfma_f32_16x16x32_bf16 a[128:131], a[244:247], v[44:47], a[128:131]
  v_mfma_f32_16x16x32_bf16 v[96:99], a[80:83], v[128:131], v[112:115]
  v_exp_f32 v108, v108
  v_mfma_f32_16x16x32_bf16 v[96:99], a[84:87], v[160:163], v[96:99]
  ds_read_b128 a[64:67], v16 offset:18432
  v_cvt_pk_bf16_f32 v81, v106, v107
  v_mfma_f32_16x16x32_bf16 v[96:99], a[88:91], v[192:195], v[96:99]
  s_waitcnt lgkmcnt(3)
  v_exp_f32 v109, v109
  v_mfma_f32_16x16x32_bf16 v[96:99], a[92:95], v[224:227], v[96:99]
  ds_read_b64_tr_b16 a[96:97], v24 offset:0
  v_cvt_pk_bf16_f32 v88, v108, v109
  v_mfma_f32_16x16x32_bf16 v[176:179], v[32:35], a[112:115], v[176:179]
  v_exp_f32 v110, v110
  v_mfma_f32_16x16x32_bf16 v[176:179], v[36:39], a[116:119], v[176:179]
  ds_read_b64_tr_b16 a[98:99], v24 offset:1024
  v_mfma_f32_16x16x32_bf16 v[180:183], v[44:47], a[116:119], v[180:183]
  v_exp_f32 v111, v111
  v_mfma_f32_16x16x32_bf16 v[180:183], v[40:43], a[112:115], v[180:183]
  buffer_load_dwordx4 v29, s[32:35], s68 offen offset:3072 nt lds
  v_mfma_f32_16x16x32_bf16 v[100:103], a[80:83], v[132:135], v[116:119]
  v_exp_f32 v96, v96
  v_mfma_f32_16x16x32_bf16 v[100:103], a[84:87], v[164:167], v[100:103]
  ds_read_b128 a[68:71], v17 offset:18432
  v_cvt_pk_bf16_f32 v89, v110, v111
  v_mfma_f32_16x16x32_bf16 v[100:103], a[88:91], v[196:199], v[100:103]
  v_exp_f32 v97, v97
  v_mfma_f32_16x16x32_bf16 v[100:103], a[92:95], v[228:231], v[100:103]
  ds_read_b64_tr_b16 a[100:101], v24 offset:2048
  v_cvt_pk_bf16_f32 v66, v96, v97
  v_mfma_f32_16x16x32_bf16 a[16:19], v[48:51], a[112:115], a[16:19]
  v_exp_f32 v98, v98
  v_mfma_f32_16x16x32_bf16 a[16:19], v[52:55], a[116:119], a[16:19]
  ds_read_b64_tr_b16 a[102:103], v24 offset:3072
  v_mfma_f32_16x16x32_bf16 a[20:23], v[60:63], a[116:119], a[20:23]
  v_exp_f32 v99, v99
  v_mfma_f32_16x16x32_bf16 a[20:23], v[56:59], a[112:115], a[20:23]
  v_mfma_f32_16x16x32_bf16 v[104:107], a[80:83], v[136:139], v[120:123]
  v_exp_f32 v100, v100
  v_mfma_f32_16x16x32_bf16 v[104:107], a[84:87], v[168:171], v[104:107]
  ds_read_b128 a[72:75], v18 offset:18432
  v_cvt_pk_bf16_f32 v67, v98, v99
  v_mfma_f32_16x16x32_bf16 v[104:107], a[88:91], v[200:203], v[104:107]
  s_waitcnt lgkmcnt(7)
  v_exp_f32 v101, v101
  v_mfma_f32_16x16x32_bf16 v[104:107], a[92:95], v[232:235], v[104:107]
  ds_read_b64_tr_b16 a[104:105], v25 offset:0
  v_cvt_pk_bf16_f32 v74, v100, v101
  v_mfma_f32_16x16x32_bf16 v[184:187], v[32:35], a[120:123], v[184:187]
  v_exp_f32 v102, v102
  v_mfma_f32_16x16x32_bf16 v[184:187], v[36:39], a[124:127], v[184:187]
  s_xor_b32 s67, s10, 151552
  ds_read_b64_tr_b16 a[106:107], v25 offset:1024
  v_mfma_f32_16x16x32_bf16 v[188:191], v[44:47], a[124:127], v[188:191]
  s_add_u32 m0, s63, 49152
  v_exp_f32 v103, v103
  v_mfma_f32_16x16x32_bf16 v[188:191], v[40:43], a[120:123], v[188:191]
  buffer_load_dwordx4 v28, s[28:31], s67 offen offset:0 nt lds
  v_mfma_f32_16x16x32_bf16 a[128:131], a[240:243], v[32:35], a[128:131]
  v_mfma_f32_16x16x32_bf16 a[128:131], a[240:243], v[36:39], a[128:131]
  v_mfma_f32_16x16x32_bf16 v[108:111], a[80:83], v[140:143], v[124:127]
  v_exp_f32 v104, v104
  v_mfma_f32_16x16x32_bf16 v[108:111], a[84:87], v[172:175], v[108:111]
  ds_read_b128 a[76:79], v19 offset:18432
  v_cvt_pk_bf16_f32 v75, v102, v103
  v_mfma_f32_16x16x32_bf16 v[108:111], a[88:91], v[204:207], v[108:111]
  s_waitcnt lgkmcnt(3)
  v_exp_f32 v105, v105
  v_mfma_f32_16x16x32_bf16 v[108:111], a[92:95], v[236:239], v[108:111]
  ds_read_b64_tr_b16 a[108:109], v25 offset:2048
  v_cvt_pk_bf16_f32 v82, v104, v105
  v_mfma_f32_16x16x32_bf16 a[24:27], v[48:51], a[120:123], a[24:27]
  v_exp_f32 v106, v106
  v_mfma_f32_16x16x32_bf16 a[24:27], v[52:55], a[124:127], a[24:27]
  ds_read_b64_tr_b16 a[110:111], v25 offset:3072
  v_mfma_f32_16x16x32_bf16 a[28:31], v[60:63], a[124:127], a[28:31]
  v_exp_f32 v107, v107
  v_mfma_f32_16x16x32_bf16 a[28:31], v[56:59], a[120:123], a[28:31]
  buffer_load_dwordx4 v28, s[28:31], s67 offen offset:1024 nt lds
  v_mfma_f32_16x16x32_bf16 v[96:99], a[64:67], v[128:131], v[112:115]
  s_lshl_b32 s66, s62, 2
  v_exp_f32 v108, v108
  v_mfma_f32_16x16x32_bf16 v[96:99], a[68:71], v[160:163], v[96:99]
  s_add_u32 s66, s66, 98304
  ds_read_b128 a[80:83], v16 offset:19456
  v_cvt_pk_bf16_f32 v83, v106, v107
  v_mfma_f32_16x16x32_bf16 v[96:99], a[72:75], v[192:195], v[96:99]
  s_waitcnt lgkmcnt(3)
  v_exp_f32 v109, v109
  v_mfma_f32_16x16x32_bf16 v[96:99], a[76:79], v[224:227], v[96:99]
  s_add_u32 s65, s63, 98304
  ds_read_b64_tr_b16 a[112:113], v26 offset:0
  v_cvt_pk_bf16_f32 v90, v108, v109
  v_mfma_f32_16x16x32_bf16 v[208:211], v[32:35], a[96:99], v[208:211]
  v_exp_f32 v110, v110
  v_mfma_f32_16x16x32_bf16 v[208:211], v[36:39], a[100:103], v[208:211]
  ds_read_b64_tr_b16 a[114:115], v26 offset:1024
  v_and_b32 v12, 3, v0
  v_mfma_f32_16x16x32_bf16 v[212:215], v[44:47], a[100:103], v[212:215]
  v_exp_f32 v111, v111
  v_mfma_f32_16x16x32_bf16 v[212:215], v[40:43], a[96:99], v[212:215]
  v_mfma_f32_16x16x32_bf16 v[100:103], a[64:67], v[132:135], v[116:119]
  v_exp_f32 v96, v96
  v_mfma_f32_16x16x32_bf16 v[100:103], a[68:71], v[164:167], v[100:103]
  ds_read_b128 a[84:87], v17 offset:19456
  v_cvt_pk_bf16_f32 v91, v110, v111
  v_mfma_f32_16x16x32_bf16 v[100:103], a[72:75], v[196:199], v[100:103]
  v_exp_f32 v97, v97
  v_mfma_f32_16x16x32_bf16 v[100:103], a[76:79], v[228:231], v[100:103]
  ds_read_b64_tr_b16 a[116:117], v26 offset:2048
  v_cvt_pk_bf16_f32 v68, v96, v97
  v_mfma_f32_16x16x32_bf16 a[32:35], v[48:51], a[96:99], a[32:35]
  v_exp_f32 v98, v98
  v_mfma_f32_16x16x32_bf16 a[32:35], v[52:55], a[100:103], a[32:35]
  ds_read_b64_tr_b16 a[118:119], v26 offset:3072
  v_lshl_add_u32 v12, v12, 12, s66
  v_mfma_f32_16x16x32_bf16 a[36:39], v[60:63], a[100:103], a[36:39]
  v_exp_f32 v99, v99
  v_mfma_f32_16x16x32_bf16 a[36:39], v[56:59], a[96:99], a[36:39]
  buffer_load_dwordx4 v28, s[28:31], s67 offen offset:2048 nt lds
  v_mfma_f32_16x16x32_bf16 a[132:135], a[244:247], v[56:59], a[132:135]
  v_mfma_f32_16x16x32_bf16 a[132:135], a[244:247], v[60:63], a[132:135]
  v_mfma_f32_16x16x32_bf16 v[104:107], a[64:67], v[136:139], v[120:123]
  v_exp_f32 v100, v100
  v_mfma_f32_16x16x32_bf16 v[104:107], a[68:71], v[168:171], v[104:107]
  ds_read_b128 a[88:91], v18 offset:19456
  v_cvt_pk_bf16_f32 v69, v98, v99
  v_mfma_f32_16x16x32_bf16 v[104:107], a[72:75], v[200:203], v[104:107]
  s_waitcnt lgkmcnt(7)
  v_exp_f32 v101, v101
  v_mfma_f32_16x16x32_bf16 v[104:107], a[76:79], v[232:235], v[104:107]
  ds_read_b64_tr_b16 a[120:121], v27 offset:0
  v_cvt_pk_bf16_f32 v76, v100, v101
  v_mfma_f32_16x16x32_bf16 v[216:219], v[32:35], a[104:107], v[216:219]
  v_exp_f32 v102, v102
  v_mfma_f32_16x16x32_bf16 v[216:219], v[36:39], a[108:111], v[216:219]
  ds_read_b64_tr_b16 a[122:123], v27 offset:1024
  v_mov_b32 v14, s65
  v_mfma_f32_16x16x32_bf16 v[220:223], v[44:47], a[108:111], v[220:223]
  v_exp_f32 v103, v103
  v_mfma_f32_16x16x32_bf16 v[220:223], v[40:43], a[104:107], v[220:223]
  buffer_load_dwordx4 v28, s[28:31], s67 offen offset:3072 nt lds
  v_mfma_f32_16x16x32_bf16 v[108:111], a[64:67], v[140:143], v[124:127]
  v_exp_f32 v104, v104
  v_mfma_f32_16x16x32_bf16 v[108:111], a[68:71], v[172:175], v[108:111]
  ds_read_b128 a[92:95], v19 offset:19456
  v_cvt_pk_bf16_f32 v77, v102, v103
  v_mfma_f32_16x16x32_bf16 v[108:111], a[72:75], v[204:207], v[108:111]
  s_waitcnt lgkmcnt(3)
  v_exp_f32 v105, v105
  v_mfma_f32_16x16x32_bf16 v[108:111], a[76:79], v[236:239], v[108:111]
  ds_read_b64_tr_b16 a[124:125], v27 offset:2048
  v_cvt_pk_bf16_f32 v84, v104, v105
  v_mfma_f32_16x16x32_bf16 a[40:43], v[48:51], a[104:107], a[40:43]
  v_exp_f32 v106, v106
  v_mfma_f32_16x16x32_bf16 a[40:43], v[52:55], a[108:111], a[40:43]
  ds_read_b64_tr_b16 a[126:127], v27 offset:3072
  v_mfma_f32_16x16x32_bf16 a[44:47], v[60:63], a[108:111], a[44:47]
  s_waitcnt vmcnt(8)
  v_exp_f32 v107, v107
  v_mfma_f32_16x16x32_bf16 a[44:47], v[56:59], a[104:107], a[44:47]
  v_mfma_f32_16x16x32_bf16 v[96:99], a[80:83], v[128:131], v[112:115]
  s_barrier
  v_exp_f32 v108, v108
  v_mfma_f32_16x16x32_bf16 v[96:99], a[84:87], v[160:163], v[96:99]
  ds_read_b128 a[64:67], v16 offset:32768
  v_cvt_pk_bf16_f32 v85, v106, v107
  v_mfma_f32_16x16x32_bf16 v[96:99], a[88:91], v[192:195], v[96:99]
  s_waitcnt lgkmcnt(3)
  v_exp_f32 v109, v109
  v_mfma_f32_16x16x32_bf16 v[96:99], a[92:95], v[224:227], v[96:99]
  ds_read_b64_tr_b16 a[96:97], v20 offset:16384
  v_cvt_pk_bf16_f32 v92, v108, v109
  v_mfma_f32_16x16x32_bf16 v[240:243], v[32:35], a[112:115], v[240:243]
  v_exp_f32 v110, v110
  v_mfma_f32_16x16x32_bf16 v[240:243], v[36:39], a[116:119], v[240:243]
  ds_read_b64_tr_b16 a[98:99], v20 offset:17408
  v_mfma_f32_16x16x32_bf16 v[244:247], v[44:47], a[116:119], v[244:247]
  v_exp_f32 v111, v111
  v_mfma_f32_16x16x32_bf16 v[244:247], v[40:43], a[112:115], v[244:247]
  v_mfma_f32_16x16x32_bf16 v[100:103], a[80:83], v[132:135], v[116:119]
  v_exp_f32 v96, v96
  v_mfma_f32_16x16x32_bf16 v[100:103], a[84:87], v[164:167], v[100:103]
  ds_read_b128 a[68:71], v17 offset:32768
  v_cvt_pk_bf16_f32 v93, v110, v111
  v_mfma_f32_16x16x32_bf16 v[100:103], a[88:91], v[196:199], v[100:103]
  v_exp_f32 v97, v97
  v_mfma_f32_16x16x32_bf16 v[100:103], a[92:95], v[228:231], v[100:103]
  ds_read_b64_tr_b16 a[100:101], v20 offset:18432
  v_cvt_pk_bf16_f32 v70, v96, v97
  v_mfma_f32_16x16x32_bf16 a[48:51], v[48:51], a[112:115], a[48:51]
  v_exp_f32 v98, v98
  v_mfma_f32_16x16x32_bf16 a[48:51], v[52:55], a[116:119], a[48:51]
  s_xor_b32 s68, s10, 151552
  ds_read_b64_tr_b16 a[102:103], v20 offset:19456
  v_mfma_f32_16x16x32_bf16 a[52:55], v[60:63], a[116:119], a[52:55]
  s_add_u32 m0, s63, 114688
  v_exp_f32 v99, v99
  v_mfma_f32_16x16x32_bf16 a[52:55], v[56:59], a[112:115], a[52:55]
  buffer_load_dwordx4 v29, s[32:35], s68 offen offset:0 nt lds
  v_mfma_f32_16x16x32_bf16 a[132:135], a[240:243], v[48:51], a[132:135]
  v_mfma_f32_16x16x32_bf16 a[132:135], a[240:243], v[52:55], a[132:135]
  v_mfma_f32_16x16x32_bf16 v[104:107], a[80:83], v[136:139], v[120:123]
  v_exp_f32 v100, v100
  v_mfma_f32_16x16x32_bf16 v[104:107], a[84:87], v[168:171], v[104:107]
  ds_read_b128 a[72:75], v18 offset:32768
  v_cvt_pk_bf16_f32 v71, v98, v99
  v_mfma_f32_16x16x32_bf16 v[104:107], a[88:91], v[200:203], v[104:107]
  s_waitcnt lgkmcnt(7)
  v_exp_f32 v101, v101
  v_mfma_f32_16x16x32_bf16 v[104:107], a[92:95], v[232:235], v[104:107]
  ds_read_b64_tr_b16 a[104:105], v21 offset:16384
  v_cvt_pk_bf16_f32 v78, v100, v101
  v_mfma_f32_16x16x32_bf16 v[248:251], v[32:35], a[120:123], v[248:251]
  v_exp_f32 v102, v102
  v_mfma_f32_16x16x32_bf16 v[248:251], v[36:39], a[124:127], v[248:251]
  ds_read_b64_tr_b16 a[106:107], v21 offset:17408
  v_mfma_f32_16x16x32_bf16 v[252:255], v[44:47], a[124:127], v[252:255]
  v_exp_f32 v103, v103
  v_mfma_f32_16x16x32_bf16 v[252:255], v[40:43], a[120:123], v[252:255]
  v_mfma_f32_16x16x32_bf16 v[108:111], a[80:83], v[140:143], v[124:127]
  v_exp_f32 v104, v104
  v_mfma_f32_16x16x32_bf16 v[108:111], a[84:87], v[172:175], v[108:111]
  ds_read_b128 a[76:79], v19 offset:32768
  v_cvt_pk_bf16_f32 v79, v102, v103
  v_mfma_f32_16x16x32_bf16 v[108:111], a[88:91], v[204:207], v[108:111]
  s_waitcnt lgkmcnt(3)
  v_exp_f32 v105, v105
  v_mfma_f32_16x16x32_bf16 v[108:111], a[92:95], v[236:239], v[108:111]
  ds_read_b64_tr_b16 a[108:109], v21 offset:18432
  v_cvt_pk_bf16_f32 v86, v104, v105
  v_mfma_f32_16x16x32_bf16 a[56:59], v[48:51], a[120:123], a[56:59]
  v_exp_f32 v106, v106
  v_mfma_f32_16x16x32_bf16 a[56:59], v[52:55], a[124:127], a[56:59]
  ds_read_b64_tr_b16 a[110:111], v21 offset:19456
  v_mfma_f32_16x16x32_bf16 a[60:63], v[60:63], a[124:127], a[60:63]
  v_exp_f32 v107, v107
  v_mfma_f32_16x16x32_bf16 a[60:63], v[56:59], a[120:123], a[60:63]
  v_cvt_pk_bf16_f32 v87, v106, v107
  v_mfma_f32_16x16x32_bf16 v[96:99], a[64:67], v[128:131], v[112:115]
  v_exp_f32 v108, v108
  v_mfma_f32_16x16x32_bf16 v[96:99], a[68:71], v[160:163], v[96:99]
  ds_read_b128 a[80:83], v16 offset:33792
  v_mfma_f32_16x16x32_bf16 v[96:99], a[72:75], v[192:195], v[96:99]
  s_waitcnt lgkmcnt(3)
  v_exp_f32 v109, v109
  v_mfma_f32_16x16x32_bf16 v[96:99], a[76:79], v[224:227], v[96:99]
  ds_read_b64_tr_b16 a[112:113], v22 offset:16384
  v_cvt_pk_bf16_f32 v94, v108, v109
  v_mfma_f32_16x16x32_bf16 v[144:147], v[64:67], a[96:99], v[144:147]
  v_exp_f32 v110, v110
  v_mfma_f32_16x16x32_bf16 v[144:147], v[68:71], a[100:103], v[144:147]
  ds_read_b64_tr_b16 a[114:115], v22 offset:17408
  v_mfma_f32_16x16x32_bf16 v[148:151], v[76:79], a[100:103], v[148:151]
  v_exp_f32 v111, v111
  v_mfma_f32_16x16x32_bf16 v[148:151], v[72:75], a[96:99], v[148:151]
  buffer_load_dword v8, v3, s[56:59], 0 offen sc1
  v_mfma_f32_16x16x32_bf16 v[100:103], a[64:67], v[132:135], v[116:119]
  v_exp_f32 v96, v96
  v_mfma_f32_16x16x32_bf16 v[100:103], a[68:71], v[164:167], v[100:103]
  ds_read_b128 a[84:87], v17 offset:33792
  v_cvt_pk_bf16_f32 v95, v110, v111
  v_mfma_f32_16x16x32_bf16 v[100:103], a[72:75], v[196:199], v[100:103]
  v_exp_f32 v97, v97
  v_mfma_f32_16x16x32_bf16 v[100:103], a[76:79], v[228:231], v[100:103]
  ds_read_b64_tr_b16 a[116:117], v22 offset:18432
  v_cvt_pk_bf16_f32 v32, v96, v97
  v_mfma_f32_16x16x32_bf16 a[0:3], v[80:83], a[96:99], a[0:3]
  v_exp_f32 v98, v98
  v_mfma_f32_16x16x32_bf16 a[0:3], v[84:87], a[100:103], a[0:3]
  ds_read_b64_tr_b16 a[118:119], v22 offset:19456
  v_mfma_f32_16x16x32_bf16 a[4:7], v[92:95], a[100:103], a[4:7]
  v_exp_f32 v99, v99
  v_mfma_f32_16x16x32_bf16 a[4:7], v[88:91], a[96:99], a[4:7]
  buffer_load_dwordx4 v29, s[32:35], s68 offen offset:1024 nt lds
  v_mfma_f32_16x16x32_bf16 v[104:107], a[64:67], v[136:139], v[120:123]
  v_exp_f32 v100, v100
  v_mfma_f32_16x16x32_bf16 v[104:107], a[68:71], v[168:171], v[104:107]
  ds_read_b128 a[88:91], v18 offset:33792
  v_cvt_pk_bf16_f32 v33, v98, v99
  v_mfma_f32_16x16x32_bf16 v[104:107], a[72:75], v[200:203], v[104:107]
  s_waitcnt lgkmcnt(7)
  v_exp_f32 v101, v101
  v_mfma_f32_16x16x32_bf16 v[104:107], a[76:79], v[232:235], v[104:107]
  ds_read_b64_tr_b16 a[120:121], v23 offset:16384
  v_cvt_pk_bf16_f32 v40, v100, v101
  v_mfma_f32_16x16x32_bf16 v[152:155], v[64:67], a[104:107], v[152:155]
  v_exp_f32 v102, v102
  v_mfma_f32_16x16x32_bf16 v[152:155], v[68:71], a[108:111], v[152:155]
  ds_read_b64_tr_b16 a[122:123], v23 offset:17408
  v_mfma_f32_16x16x32_bf16 v[156:159], v[76:79], a[108:111], v[156:159]
  v_exp_f32 v103, v103
  v_mfma_f32_16x16x32_bf16 v[156:159], v[72:75], a[104:107], v[156:159]
  v_mfma_f32_16x16x32_bf16 v[108:111], a[64:67], v[140:143], v[124:127]
  v_exp_f32 v104, v104
  v_mfma_f32_16x16x32_bf16 v[108:111], a[68:71], v[172:175], v[108:111]
  ds_read_b128 a[92:95], v19 offset:33792
  v_cvt_pk_bf16_f32 v41, v102, v103
  v_mfma_f32_16x16x32_bf16 v[108:111], a[72:75], v[204:207], v[108:111]
  s_waitcnt lgkmcnt(3)
  v_exp_f32 v105, v105
  v_mfma_f32_16x16x32_bf16 v[108:111], a[76:79], v[236:239], v[108:111]
  ds_read_b64_tr_b16 a[124:125], v23 offset:18432
  v_cvt_pk_bf16_f32 v48, v104, v105
  v_mfma_f32_16x16x32_bf16 a[8:11], v[80:83], a[104:107], a[8:11]
  v_exp_f32 v106, v106
  v_mfma_f32_16x16x32_bf16 a[8:11], v[84:87], a[108:111], a[8:11]
  ds_read_b64_tr_b16 a[126:127], v23 offset:19456
  v_mfma_f32_16x16x32_bf16 a[12:15], v[92:95], a[108:111], a[12:15]
  v_exp_f32 v107, v107
  v_mfma_f32_16x16x32_bf16 a[12:15], v[88:91], a[104:107], a[12:15]
  buffer_load_dwordx4 v29, s[32:35], s68 offen offset:2048 nt lds
  v_mfma_f32_16x16x32_bf16 a[128:131], a[244:247], v[72:75], a[128:131]
  v_mfma_f32_16x16x32_bf16 a[128:131], a[244:247], v[76:79], a[128:131]
  v_mfma_f32_16x16x32_bf16 v[96:99], a[80:83], v[128:131], v[112:115]
  v_exp_f32 v108, v108
  v_mfma_f32_16x16x32_bf16 v[96:99], a[84:87], v[160:163], v[96:99]
  ds_read_b128 a[64:67], v16 offset:34816
  v_cvt_pk_bf16_f32 v49, v106, v107
  v_mfma_f32_16x16x32_bf16 v[96:99], a[88:91], v[192:195], v[96:99]
  s_waitcnt lgkmcnt(3)
  v_exp_f32 v109, v109
  v_mfma_f32_16x16x32_bf16 v[96:99], a[92:95], v[224:227], v[96:99]
  ds_read_b64_tr_b16 a[96:97], v24 offset:16384
  v_cvt_pk_bf16_f32 v56, v108, v109
  v_mfma_f32_16x16x32_bf16 v[176:179], v[64:67], a[112:115], v[176:179]
  v_exp_f32 v110, v110
  v_mfma_f32_16x16x32_bf16 v[176:179], v[68:71], a[116:119], v[176:179]
  ds_read_b64_tr_b16 a[98:99], v24 offset:17408
  v_mfma_f32_16x16x32_bf16 v[180:183], v[76:79], a[116:119], v[180:183]
  v_exp_f32 v111, v111
  v_mfma_f32_16x16x32_bf16 v[180:183], v[72:75], a[112:115], v[180:183]
  buffer_load_dwordx4 v29, s[32:35], s68 offen offset:3072 nt lds
  v_mfma_f32_16x16x32_bf16 v[100:103], a[80:83], v[132:135], v[116:119]
  v_exp_f32 v96, v96
  v_mfma_f32_16x16x32_bf16 v[100:103], a[84:87], v[164:167], v[100:103]
  ds_read_b128 a[68:71], v17 offset:34816
  v_cvt_pk_bf16_f32 v57, v110, v111
  v_mfma_f32_16x16x32_bf16 v[100:103], a[88:91], v[196:199], v[100:103]
  v_exp_f32 v97, v97
  v_mfma_f32_16x16x32_bf16 v[100:103], a[92:95], v[228:231], v[100:103]
  ds_read_b64_tr_b16 a[100:101], v24 offset:18432
  v_cvt_pk_bf16_f32 v34, v96, v97
  v_mfma_f32_16x16x32_bf16 a[16:19], v[80:83], a[112:115], a[16:19]
  v_exp_f32 v98, v98
  v_mfma_f32_16x16x32_bf16 a[16:19], v[84:87], a[116:119], a[16:19]
  ds_read_b64_tr_b16 a[102:103], v24 offset:19456
  v_mfma_f32_16x16x32_bf16 a[20:23], v[92:95], a[116:119], a[20:23]
  v_exp_f32 v99, v99
  v_mfma_f32_16x16x32_bf16 a[20:23], v[88:91], a[112:115], a[20:23]
  v_mfma_f32_16x16x32_bf16 v[104:107], a[80:83], v[136:139], v[120:123]
  v_exp_f32 v100, v100
  v_mfma_f32_16x16x32_bf16 v[104:107], a[84:87], v[168:171], v[104:107]
  ds_read_b128 a[72:75], v18 offset:34816
  v_cvt_pk_bf16_f32 v35, v98, v99
  v_mfma_f32_16x16x32_bf16 v[104:107], a[88:91], v[200:203], v[104:107]
  s_waitcnt lgkmcnt(7)
  v_exp_f32 v101, v101
  v_mfma_f32_16x16x32_bf16 v[104:107], a[92:95], v[232:235], v[104:107]
  ds_read_b64_tr_b16 a[104:105], v25 offset:16384
  v_cvt_pk_bf16_f32 v42, v100, v101
  v_mfma_f32_16x16x32_bf16 v[184:187], v[64:67], a[120:123], v[184:187]
  v_exp_f32 v102, v102
  v_mfma_f32_16x16x32_bf16 v[184:187], v[68:71], a[124:127], v[184:187]
  s_xor_b32 s67, s10, 163840
  ds_read_b64_tr_b16 a[106:107], v25 offset:17408
  v_mfma_f32_16x16x32_bf16 v[188:191], v[76:79], a[124:127], v[188:191]
  s_add_u32 m0, s63, 0
  v_exp_f32 v103, v103
  v_mfma_f32_16x16x32_bf16 v[188:191], v[72:75], a[120:123], v[188:191]
  buffer_load_dwordx4 v28, s[28:31], s67 offen offset:0 nt lds
  v_mfma_f32_16x16x32_bf16 a[128:131], a[240:243], v[64:67], a[128:131]
  v_mfma_f32_16x16x32_bf16 a[128:131], a[240:243], v[68:71], a[128:131]
  v_mfma_f32_16x16x32_bf16 v[108:111], a[80:83], v[140:143], v[124:127]
  v_exp_f32 v104, v104
  v_mfma_f32_16x16x32_bf16 v[108:111], a[84:87], v[172:175], v[108:111]
  ds_read_b128 a[76:79], v19 offset:34816
  v_cvt_pk_bf16_f32 v43, v102, v103
  v_mfma_f32_16x16x32_bf16 v[108:111], a[88:91], v[204:207], v[108:111]
  s_waitcnt lgkmcnt(3)
  v_exp_f32 v105, v105
  v_mfma_f32_16x16x32_bf16 v[108:111], a[92:95], v[236:239], v[108:111]
  ds_read_b64_tr_b16 a[108:109], v25 offset:18432
  v_cvt_pk_bf16_f32 v50, v104, v105
  v_mfma_f32_16x16x32_bf16 a[24:27], v[80:83], a[120:123], a[24:27]
  v_exp_f32 v106, v106
  v_mfma_f32_16x16x32_bf16 a[24:27], v[84:87], a[124:127], a[24:27]
  ds_read_b64_tr_b16 a[110:111], v25 offset:19456
  v_mfma_f32_16x16x32_bf16 a[28:31], v[92:95], a[124:127], a[28:31]
  v_exp_f32 v107, v107
  v_mfma_f32_16x16x32_bf16 a[28:31], v[88:91], a[120:123], a[28:31]
  buffer_load_dwordx4 v28, s[28:31], s67 offen offset:1024 nt lds
  v_mfma_f32_16x16x32_bf16 v[96:99], a[64:67], v[128:131], v[112:115]
  v_exp_f32 v108, v108
  v_mfma_f32_16x16x32_bf16 v[96:99], a[68:71], v[160:163], v[96:99]
  ds_read_b128 a[80:83], v16 offset:35840
  v_cvt_pk_bf16_f32 v51, v106, v107
  v_mfma_f32_16x16x32_bf16 v[96:99], a[72:75], v[192:195], v[96:99]
  s_waitcnt lgkmcnt(3)
  v_exp_f32 v109, v109
  v_mfma_f32_16x16x32_bf16 v[96:99], a[76:79], v[224:227], v[96:99]
  ds_read_b64_tr_b16 a[112:113], v26 offset:16384
  v_cvt_pk_bf16_f32 v58, v108, v109
  v_mfma_f32_16x16x32_bf16 v[208:211], v[64:67], a[96:99], v[208:211]
  v_exp_f32 v110, v110
  v_mfma_f32_16x16x32_bf16 v[208:211], v[68:71], a[100:103], v[208:211]
  ds_read_b64_tr_b16 a[114:115], v26 offset:17408
  v_mfma_f32_16x16x32_bf16 v[212:215], v[76:79], a[100:103], v[212:215]
  v_exp_f32 v111, v111
  v_mfma_f32_16x16x32_bf16 v[212:215], v[72:75], a[96:99], v[212:215]
  v_mfma_f32_16x16x32_bf16 v[100:103], a[64:67], v[132:135], v[116:119]
  v_exp_f32 v96, v96
  v_mfma_f32_16x16x32_bf16 v[100:103], a[68:71], v[164:167], v[100:103]
  ds_read_b128 a[84:87], v17 offset:35840
  v_cvt_pk_bf16_f32 v59, v110, v111
  v_mfma_f32_16x16x32_bf16 v[100:103], a[72:75], v[196:199], v[100:103]
  v_exp_f32 v97, v97
  v_mfma_f32_16x16x32_bf16 v[100:103], a[76:79], v[228:231], v[100:103]
  ds_read_b64_tr_b16 a[116:117], v26 offset:18432
  v_cvt_pk_bf16_f32 v36, v96, v97
  v_mfma_f32_16x16x32_bf16 a[32:35], v[80:83], a[96:99], a[32:35]
  v_exp_f32 v98, v98
  v_mfma_f32_16x16x32_bf16 a[32:35], v[84:87], a[100:103], a[32:35]
  ds_read_b64_tr_b16 a[118:119], v26 offset:19456
  v_mfma_f32_16x16x32_bf16 a[36:39], v[92:95], a[100:103], a[36:39]
  v_exp_f32 v99, v99
  v_mfma_f32_16x16x32_bf16 a[36:39], v[88:91], a[96:99], a[36:39]
  buffer_load_dwordx4 v28, s[28:31], s67 offen offset:2048 nt lds
  v_mfma_f32_16x16x32_bf16 a[132:135], a[244:247], v[88:91], a[132:135]
  v_mfma_f32_16x16x32_bf16 a[132:135], a[244:247], v[92:95], a[132:135]
  v_mfma_f32_16x16x32_bf16 v[104:107], a[64:67], v[136:139], v[120:123]
  v_exp_f32 v100, v100
  v_mfma_f32_16x16x32_bf16 v[104:107], a[68:71], v[168:171], v[104:107]
  ds_read_b128 a[88:91], v18 offset:35840
  v_cvt_pk_bf16_f32 v37, v98, v99
  v_mfma_f32_16x16x32_bf16 v[104:107], a[72:75], v[200:203], v[104:107]
  s_waitcnt lgkmcnt(7)
  v_exp_f32 v101, v101
  v_mfma_f32_16x16x32_bf16 v[104:107], a[76:79], v[232:235], v[104:107]
  ds_read_b64_tr_b16 a[120:121], v27 offset:16384
  v_cvt_pk_bf16_f32 v44, v100, v101
  v_mfma_f32_16x16x32_bf16 v[216:219], v[64:67], a[104:107], v[216:219]
  v_exp_f32 v102, v102
  v_mfma_f32_16x16x32_bf16 v[216:219], v[68:71], a[108:111], v[216:219]
  ds_read_b64_tr_b16 a[122:123], v27 offset:17408
  v_mfma_f32_16x16x32_bf16 v[220:223], v[76:79], a[108:111], v[220:223]
  v_exp_f32 v103, v103
  v_mfma_f32_16x16x32_bf16 v[220:223], v[72:75], a[104:107], v[220:223]
  buffer_load_dwordx4 v28, s[28:31], s67 offen offset:3072 nt lds
  v_mfma_f32_16x16x32_bf16 v[108:111], a[64:67], v[140:143], v[124:127]
  v_exp_f32 v104, v104
  v_mfma_f32_16x16x32_bf16 v[108:111], a[68:71], v[172:175], v[108:111]
  ds_read_b128 a[92:95], v19 offset:35840
  v_cvt_pk_bf16_f32 v45, v102, v103
  v_mfma_f32_16x16x32_bf16 v[108:111], a[72:75], v[204:207], v[108:111]
  s_waitcnt lgkmcnt(3)
  v_exp_f32 v105, v105
  v_mfma_f32_16x16x32_bf16 v[108:111], a[76:79], v[236:239], v[108:111]
  ds_read_b64_tr_b16 a[124:125], v27 offset:18432
  v_cvt_pk_bf16_f32 v52, v104, v105
  v_mfma_f32_16x16x32_bf16 a[40:43], v[80:83], a[104:107], a[40:43]
  v_exp_f32 v106, v106
  v_mfma_f32_16x16x32_bf16 a[40:43], v[84:87], a[108:111], a[40:43]
  ds_read_b64_tr_b16 a[126:127], v27 offset:19456
  v_mfma_f32_16x16x32_bf16 a[44:47], v[92:95], a[108:111], a[44:47]
  s_waitcnt vmcnt(9)
  v_exp_f32 v107, v107
  v_mfma_f32_16x16x32_bf16 a[44:47], v[88:91], a[104:107], a[44:47]
  v_mfma_f32_16x16x32_bf16 v[96:99], a[80:83], v[128:131], v[112:115]
  s_barrier
  v_exp_f32 v108, v108
  v_mfma_f32_16x16x32_bf16 v[96:99], a[84:87], v[160:163], v[96:99]
  ds_read_b128 a[64:67], v16 offset:49152
  v_cvt_pk_bf16_f32 v53, v106, v107
  v_mfma_f32_16x16x32_bf16 v[96:99], a[88:91], v[192:195], v[96:99]
  s_waitcnt lgkmcnt(3)
  v_exp_f32 v109, v109
  v_mfma_f32_16x16x32_bf16 v[96:99], a[92:95], v[224:227], v[96:99]
  ds_read_b64_tr_b16 a[96:97], v20 offset:32768
  v_cvt_pk_bf16_f32 v60, v108, v109
  v_mfma_f32_16x16x32_bf16 v[240:243], v[64:67], a[112:115], v[240:243]
  v_exp_f32 v110, v110
  v_mfma_f32_16x16x32_bf16 v[240:243], v[68:71], a[116:119], v[240:243]
  ds_read_b64_tr_b16 a[98:99], v20 offset:33792
  v_mfma_f32_16x16x32_bf16 v[244:247], v[76:79], a[116:119], v[244:247]
  v_exp_f32 v111, v111
  v_mfma_f32_16x16x32_bf16 v[244:247], v[72:75], a[112:115], v[244:247]
  v_mfma_f32_16x16x32_bf16 v[100:103], a[80:83], v[132:135], v[116:119]
  v_exp_f32 v96, v96
  v_mfma_f32_16x16x32_bf16 v[100:103], a[84:87], v[164:167], v[100:103]
  ds_read_b128 a[68:71], v17 offset:49152
  v_cvt_pk_bf16_f32 v61, v110, v111
  v_mfma_f32_16x16x32_bf16 v[100:103], a[88:91], v[196:199], v[100:103]
  v_exp_f32 v97, v97
  v_mfma_f32_16x16x32_bf16 v[100:103], a[92:95], v[228:231], v[100:103]
  ds_read_b64_tr_b16 a[100:101], v20 offset:34816
  v_cvt_pk_bf16_f32 v38, v96, v97
  v_mfma_f32_16x16x32_bf16 a[48:51], v[80:83], a[112:115], a[48:51]
  v_exp_f32 v98, v98
  v_mfma_f32_16x16x32_bf16 a[48:51], v[84:87], a[116:119], a[48:51]
  s_xor_b32 s68, s10, 163840
  ds_read_b64_tr_b16 a[102:103], v20 offset:35840
  v_mfma_f32_16x16x32_bf16 a[52:55], v[92:95], a[116:119], a[52:55]
  s_add_u32 m0, s63, 65536
  v_exp_f32 v99, v99
  v_mfma_f32_16x16x32_bf16 a[52:55], v[88:91], a[112:115], a[52:55]
  buffer_load_dwordx4 v29, s[32:35], s68 offen offset:0 nt lds
  v_mfma_f32_16x16x32_bf16 a[132:135], a[240:243], v[80:83], a[132:135]
  v_mfma_f32_16x16x32_bf16 a[132:135], a[240:243], v[84:87], a[132:135]
  v_mfma_f32_16x16x32_bf16 v[104:107], a[80:83], v[136:139], v[120:123]
  v_exp_f32 v100, v100
  v_mfma_f32_16x16x32_bf16 v[104:107], a[84:87], v[168:171], v[104:107]
  ds_read_b128 a[72:75], v18 offset:49152
  v_cvt_pk_bf16_f32 v39, v98, v99
  v_mfma_f32_16x16x32_bf16 v[104:107], a[88:91], v[200:203], v[104:107]
  s_waitcnt lgkmcnt(7)
  v_exp_f32 v101, v101
  v_mfma_f32_16x16x32_bf16 v[104:107], a[92:95], v[232:235], v[104:107]
  ds_read_b64_tr_b16 a[104:105], v21 offset:32768
  v_cvt_pk_bf16_f32 v46, v100, v101
  v_mfma_f32_16x16x32_bf16 v[248:251], v[64:67], a[120:123], v[248:251]
  v_exp_f32 v102, v102
  v_mfma_f32_16x16x32_bf16 v[248:251], v[68:71], a[124:127], v[248:251]
  ds_read_b64_tr_b16 a[106:107], v21 offset:33792
  v_mfma_f32_16x16x32_bf16 v[252:255], v[76:79], a[124:127], v[252:255]
  v_exp_f32 v103, v103
  v_mfma_f32_16x16x32_bf16 v[252:255], v[72:75], a[120:123], v[252:255]
  v_mfma_f32_16x16x32_bf16 v[108:111], a[80:83], v[140:143], v[124:127]
  v_exp_f32 v104, v104
  v_mfma_f32_16x16x32_bf16 v[108:111], a[84:87], v[172:175], v[108:111]
  ds_read_b128 a[76:79], v19 offset:49152
  v_cvt_pk_bf16_f32 v47, v102, v103
  v_mfma_f32_16x16x32_bf16 v[108:111], a[88:91], v[204:207], v[108:111]
  s_waitcnt lgkmcnt(3)
  v_exp_f32 v105, v105
  v_mfma_f32_16x16x32_bf16 v[108:111], a[92:95], v[236:239], v[108:111]
  ds_read_b64_tr_b16 a[108:109], v21 offset:34816
  v_cvt_pk_bf16_f32 v54, v104, v105
  v_mfma_f32_16x16x32_bf16 a[56:59], v[80:83], a[120:123], a[56:59]
  v_exp_f32 v106, v106
  v_mfma_f32_16x16x32_bf16 a[56:59], v[84:87], a[124:127], a[56:59]
  ds_read_b64_tr_b16 a[110:111], v21 offset:35840
  v_mfma_f32_16x16x32_bf16 a[60:63], v[92:95], a[124:127], a[60:63]
  v_exp_f32 v107, v107
  v_mfma_f32_16x16x32_bf16 a[60:63], v[88:91], a[120:123], a[60:63]
  v_cvt_pk_bf16_f32 v55, v106, v107
  v_mfma_f32_16x16x32_bf16 v[96:99], a[64:67], v[128:131], v[112:115]
  s_waitcnt vmcnt(8)
  v_exp_f32 v108, v108
  v_mfma_f32_16x16x32_bf16 v[96:99], a[68:71], v[160:163], v[96:99]
  ds_read_b128 a[80:83], v16 offset:50176
  v_mfma_f32_16x16x32_bf16 v[96:99], a[72:75], v[192:195], v[96:99]
  s_waitcnt lgkmcnt(3)
  v_exp_f32 v109, v109
  v_mfma_f32_16x16x32_bf16 v[96:99], a[76:79], v[224:227], v[96:99]
  ds_read_b64_tr_b16 a[112:113], v22 offset:32768
  v_cvt_pk_bf16_f32 v62, v108, v109
  v_mfma_f32_16x16x32_bf16 v[144:147], v[32:35], a[96:99], v[144:147]
  v_exp_f32 v110, v110
  v_mfma_f32_16x16x32_bf16 v[144:147], v[36:39], a[100:103], v[144:147]
  ds_read_b64_tr_b16 a[114:115], v22 offset:33792
  v_cmp_ne_u32 vcc, 1, v8
  v_mfma_f32_16x16x32_bf16 v[148:151], v[44:47], a[100:103], v[148:151]
  v_exp_f32 v111, v111
  v_mfma_f32_16x16x32_bf16 v[148:151], v[40:43], a[96:99], v[148:151]
  v_mfma_f32_16x16x32_bf16 v[100:103], a[64:67], v[132:135], v[116:119]
  v_exp_f32 v96, v96
  v_mfma_f32_16x16x32_bf16 v[100:103], a[68:71], v[164:167], v[100:103]
  ds_read_b128 a[84:87], v17 offset:50176
  v_cvt_pk_bf16_f32 v63, v110, v111
  v_mfma_f32_16x16x32_bf16 v[100:103], a[72:75], v[196:199], v[100:103]
  v_exp_f32 v97, v97
  v_mfma_f32_16x16x32_bf16 v[100:103], a[76:79], v[228:231], v[100:103]
  s_cmp_eq_u64 vcc, 0
  ds_read_b64_tr_b16 a[116:117], v22 offset:34816
  v_cvt_pk_bf16_f32 v64, v96, v97
  v_mfma_f32_16x16x32_bf16 a[0:3], v[48:51], a[96:99], a[0:3]
  s_cbranch_scc0 L_spin_cnt
L_back_cnt:
  v_exp_f32 v98, v98
  v_mfma_f32_16x16x32_bf16 a[0:3], v[52:55], a[100:103], a[0:3]
L_hop8:
  s_cbranch_execz L_hopback
  ds_read_b64_tr_b16 a[118:119], v22 offset:35840
  v_mfma_f32_16x16x32_bf16 a[4:7], v[60:63], a[100:103], a[4:7]
  v_exp_f32 v99, v99
  v_mfma_f32_16x16x32_bf16 a[4:7], v[56:59], a[96:99], a[4:7]
  buffer_load_dwordx4 v29, s[32:35], s68 offen offset:1024 nt lds
  v_mfma_f32_16x16x32_bf16 v[104:107], a[64:67], v[136:139], v[120:123]
  s_add_u32 s80, s18, 0
  v_exp_f32 v100, v100
  v_mfma_f32_16x16x32_bf16 v[104:107], a[68:71], v[168:171], v[104:107]
  ds_read_b128 a[88:91], v18 offset:50176
  v_cvt_pk_bf16_f32 v65, v98, v99
  v_mfma_f32_16x16x32_bf16 v[104:107], a[72:75], v[200:203], v[104:107]
  s_waitcnt lgkmcnt(7)
  v_exp_f32 v101, v101
  v_mfma_f32_16x16x32_bf16 v[104:107], a[76:79], v[232:235], v[104:107]
  ds_read_b64_tr_b16 a[120:121], v23 offset:32768
  v_cvt_pk_bf16_f32 v72, v100, v101
  v_mfma_f32_16x16x32_bf16 v[152:155], v[32:35], a[104:107], v[152:155]
  v_exp_f32 v102, v102
  v_mfma_f32_16x16x32_bf16 v[152:155], v[36:39], a[108:111], v[152:155]
  ds_read_b64_tr_b16 a[122:123], v23 offset:33792
  v_mfma_f32_16x16x32_bf16 v[156:159], v[44:47], a[108:111], v[156:159]
  v_exp_f32 v103, v103
  v_mfma_f32_16x16x32_bf16 v[156:159], v[40:43], a[104:107], v[156:159]
  buffer_load_dwordx4 a[140:143], v1, s[44:47], s80 offen offset:0 sc1
  v_mfma_f32_16x16x32_bf16 v[108:111], a[64:67], v[140:143], v[124:127]
  v_exp_f32 v104, v104
  v_mfma_f32_16x16x32_bf16 v[108:111], a[68:71], v[172:175], v[108:111]
  ds_read_b128 a[92:95], v19 offset:50176
  v_cvt_pk_bf16_f32 v73, v102, v103
  v_mfma_f32_16x16x32_bf16 v[108:111], a[72:75], v[204:207], v[108:111]
  s_waitcnt lgkmcnt(3)
  v_exp_f32 v105, v105
  v_mfma_f32_16x16x32_bf16 v[108:111], a[76:79], v[236:239], v[108:111]
  ds_read_b64_tr_b16 a[124:125], v23 offset:34816
  v_cvt_pk_bf16_f32 v80, v104, v105
  v_mfma_f32_16x16x32_bf16 a[8:11], v[48:51], a[104:107], a[8:11]
  v_exp_f32 v106, v106
  v_mfma_f32_16x16x32_bf16 a[8:11], v[52:55], a[108:111], a[8:11]
  ds_read_b64_tr_b16 a[126:127], v23 offset:35840
  v_mfma_f32_16x16x32_bf16 a[12:15], v[60:63], a[108:111], a[12:15]
  v_exp_f32 v107, v107
  v_mfma_f32_16x16x32_bf16 a[12:15], v[56:59], a[104:107], a[12:15]
  buffer_load_dwordx4 v29, s[32:35], s68 offen offset:2048 nt lds
  v_mfma_f32_16x16x32_bf16 a[128:131], a[244:247], v[40:43], a[128:131]
  buffer_load_dwordx4 a[144:147], v1, s[44:47], s80 offen offset:1024 sc1
  v_mfma_f32_16x16x32_bf16 a[128:131], a[244:247], v[44:47], a[128:131]
  buffer_load_dwordx4 a[148:151], v1, s[44:47], s80 offen offset:2048 sc1
  v_mfma_f32_16x16x32_bf16 v[96:99], a[80:83], v[128:131], v[112:115]
  v_exp_f32 v108, v108
  v_mfma_f32_16x16x32_bf16 v[96:99], a[84:87], v[160:163], v[96:99]
  ds_read_b128 a[64:67], v16 offset:51200
  v_cvt_pk_bf16_f32 v81, v106, v107
  v_mfma_f32_16x16x32_bf16 v[96:99], a[88:91], v[192:195], v[96:99]
  s_waitcnt lgkmcnt(3)
  v_exp_f32 v109, v109
  v_mfma_f32_16x16x32_bf16 v[96:99], a[92:95], v[224:227], v[96:99]
  ds_read_b64_tr_b16 a[96:97], v24 offset:32768
  v_cvt_pk_bf16_f32 v88, v108, v109
  v_mfma_f32_16x16x32_bf16 v[176:179], v[32:35], a[112:115], v[176:179]
  v_exp_f32 v110, v110
  v_mfma_f32_16x16x32_bf16 v[176:179], v[36:39], a[116:119], v[176:179]
  ds_read_b64_tr_b16 a[98:99], v24 offset:33792
  v_mfma_f32_16x16x32_bf16 v[180:183], v[44:47], a[116:119], v[180:183]
  v_exp_f32 v111, v111
  v_mfma_f32_16x16x32_bf16 v[180:183], v[40:43], a[112:115], v[180:183]
  buffer_load_dwordx4 a[152:155], v1, s[44:47], s80 offen offset:3072 sc1
  v_mfma_f32_16x16x32_bf16 v[100:103], a[80:83], v[132:135], v[116:119]
  v_exp_f32 v96, v96
  v_mfma_f32_16x16x32_bf16 v[100:103], a[84:87], v[164:167], v[100:103]
  ds_read_b128 a[68:71], v17 offset:51200
  v_cvt_pk_bf16_f32 v89, v110, v111
  v_mfma_f32_16x16x32_bf16 v[100:103], a[88:91], v[196:199], v[100:103]
  v_exp_f32 v97, v97
  v_mfma_f32_16x16x32_bf16 v[100:103], a[92:95], v[228:231], v[100:103]
  ds_read_b64_tr_b16 a[100:101], v24 offset:34816
  v_cvt_pk_bf16_f32 v66, v96, v97
  v_mfma_f32_16x16x32_bf16 a[16:19], v[48:51], a[112:115], a[16:19]
  v_exp_f32 v98, v98
  v_mfma_f32_16x16x32_bf16 a[16:19], v[52:55], a[116:119], a[16:19]
  ds_read_b64_tr_b16 a[102:103], v24 offset:35840
  v_mfma_f32_16x16x32_bf16 a[20:23], v[60:63], a[116:119], a[20:23]
  v_exp_f32 v99, v99
  v_mfma_f32_16x16x32_bf16 a[20:23], v[56:59], a[112:115], a[20:23]
  buffer_load_dwordx4 v29, s[32:35], s68 offen offset:3072 nt lds
  v_mfma_f32_16x16x32_bf16 v[104:107], a[80:83], v[136:139], v[120:123]
  v_exp_f32 v100, v100
  v_mfma_f32_16x16x32_bf16 v[104:107], a[84:87], v[168:171], v[104:107]
  ds_read_b128 a[72:75], v18 offset:51200
  v_cvt_pk_bf16_f32 v67, v98, v99
  v_mfma_f32_16x16x32_bf16 v[104:107], a[88:91], v[200:203], v[104:107]
  s_waitcnt lgkmcnt(7)
  v_exp_f32 v101, v101
  v_mfma_f32_16x16x32_bf16 v[104:107], a[92:95], v[232:235], v[104:107]
  ds_read_b64_tr_b16 a[104:105], v25 offset:32768
  v_cvt_pk_bf16_f32 v74, v100, v101
  v_mfma_f32_16x16x32_bf16 v[184:187], v[32:35], a[120:123], v[184:187]
  v_exp_f32 v102, v102
  v_mfma_f32_16x16x32_bf16 v[184:187], v[36:39], a[124:127], v[184:187]
  ds_read_b64_tr_b16 a[106:107], v25 offset:33792
  v_mfma_f32_16x16x32_bf16 v[188:191], v[44:47], a[124:127], v[188:191]
  v_exp_f32 v103, v103
  v_mfma_f32_16x16x32_bf16 v[188:191], v[40:43], a[120:123], v[188:191]
  v_mfma_f32_16x16x32_bf16 a[128:131], a[240:243], v[32:35], a[128:131]
  v_mfma_f32_16x16x32_bf16 a[128:131], a[240:243], v[36:39], a[128:131]
  v_mfma_f32_16x16x32_bf16 v[108:111], a[80:83], v[140:143], v[124:127]
  v_exp_f32 v104, v104
  v_mfma_f32_16x16x32_bf16 v[108:111], a[84:87], v[172:175], v[108:111]
  ds_read_b128 a[76:79], v19 offset:51200
  v_cvt_pk_bf16_f32 v75, v102, v103
  v_mfma_f32_16x16x32_bf16 v[108:111], a[88:91], v[204:207], v[108:111]
  s_waitcnt lgkmcnt(3)
  v_exp_f32 v105, v105
  v_mfma_f32_16x16x32_bf16 v[108:111], a[92:95], v[236:239], v[108:111]
  ds_read_b64_tr_b16 a[108:109], v25 offset:34816
  v_cvt_pk_bf16_f32 v82, v104, v105
  v_mfma_f32_16x16x32_bf16 a[24:27], v[48:51], a[120:123], a[24:27]
  v_exp_f32 v106, v106
  v_mfma_f32_16x16x32_bf16 a[24:27], v[52:55], a[124:127], a[24:27]
  s_xor_b32 s67, s10, 167936
  ds_read_b64_tr_b16 a[110:111], v25 offset:35840
  v_mfma_f32_16x16x32_bf16 a[28:31], v[60:63], a[124:127], a[28:31]
  s_add_u32 m0, s63, 16384
  v_exp_f32 v107, v107
  v_mfma_f32_16x16x32_bf16 a[28:31], v[56:59], a[120:123], a[28:31]
  buffer_load_dwordx4 v28, s[28:31], s67 offen offset:0 nt lds
  v_mfma_f32_16x16x32_bf16 v[96:99], a[64:67], v[128:131], v[112:115]
  v_exp_f32 v108, v108
  v_mfma_f32_16x16x32_bf16 v[96:99], a[68:71], v[160:163], v[96:99]
  ds_read_b128 a[80:83], v16 offset:52224
  v_cvt_pk_bf16_f32 v83, v106, v107
  v_mfma_f32_16x16x32_bf16 v[96:99], a[72:75], v[192:195], v[96:99]
  s_waitcnt lgkmcnt(3)
  v_exp_f32 v109, v109
  v_mfma_f32_16x16x32_bf16 v[96:99], a[76:79], v[224:227], v[96:99]
  ds_read_b64_tr_b16 a[112:113], v26 offset:32768
  v_cvt_pk_bf16_f32 v90, v108, v109
  v_mfma_f32_16x16x32_bf16 v[208:211], v[32:35], a[96:99], v[208:211]
  v_exp_f32 v110, v110
  v_mfma_f32_16x16x32_bf16 v[208:211], v[36:39], a[100:103], v[208:211]
  ds_read_b64_tr_b16 a[114:115], v26 offset:33792
  v_mfma_f32_16x16x32_bf16 v[212:215], v[44:47], a[100:103], v[212:215]
  v_exp_f32 v111, v111
  v_mfma_f32_16x16x32_bf16 v[212:215], v[40:43], a[96:99], v[212:215]
  v_mfma_f32_16x16x32_bf16 v[100:103], a[64:67], v[132:135], v[116:119]
  v_exp_f32 v96, v96
  v_mfma_f32_16x16x32_bf16 v[100:103], a[68:71], v[164:167], v[100:103]
  ds_read_b128 a[84:87], v17 offset:52224
  v_cvt_pk_bf16_f32 v91, v110, v111
  v_mfma_f32_16x16x32_bf16 v[100:103], a[72:75], v[196:199], v[100:103]
  v_exp_f32 v97, v97
  v_mfma_f32_16x16x32_bf16 v[100:103], a[76:79], v[228:231], v[100:103]
  ds_read_b64_tr_b16 a[116:117], v26 offset:34816
  v_cvt_pk_bf16_f32 v68, v96, v97
  v_mfma_f32_16x16x32_bf16 a[32:35], v[48:51], a[96:99], a[32:35]
  v_exp_f32 v98, v98
  v_mfma_f32_16x16x32_bf16 a[32:35], v[52:55], a[100:103], a[32:35]
  ds_read_b64_tr_b16 a[118:119], v26 offset:35840
  v_mfma_f32_16x16x32_bf16 a[36:39], v[60:63], a[100:103], a[36:39]
  v_exp_f32 v99, v99
  v_mfma_f32_16x16x32_bf16 a[36:39], v[56:59], a[96:99], a[36:39]
  buffer_load_dwordx4 v28, s[28:31], s67 offen offset:1024 nt lds
  v_mfma_f32_16x16x32_bf16 a[132:135], a[244:247], v[56:59], a[132:135]
  v_mfma_f32_16x16x32_bf16 a[132:135], a[244:247], v[60:63], a[132:135]
  v_mfma_f32_16x16x32_bf16 v[104:107], a[64:67], v[136:139], v[120:123]
  v_exp_f32 v100, v100
  v_mfma_f32_16x16x32_bf16 v[104:107], a[68:71], v[168:171], v[104:107]
  ds_read_b128 a[88:91], v18 offset:52224
  v_cvt_pk_bf16_f32 v69, v98, v99
  v_mfma_f32_16x16x32_bf16 v[104:107], a[72:75], v[200:203], v[104:107]
  s_waitcnt lgkmcnt(7)
  v_exp_f32 v101, v101
  v_mfma_f32_16x16x32_bf16 v[104:107], a[76:79], v[232:235], v[104:107]
  ds_read_b64_tr_b16 a[120:121], v27 offset:32768
  v_cvt_pk_bf16_f32 v76, v100, v101
  v_mfma_f32_16x16x32_bf16 v[216:219], v[32:35], a[104:107], v[216:219]
  v_exp_f32 v102, v102
  v_mfma_f32_16x16x32_bf16 v[216:219], v[36:39], a[108:111], v[216:219]
  ds_read_b64_tr_b16 a[122:123], v27 offset:33792
  v_mfma_f32_16x16x32_bf16 v[220:223], v[44:47], a[108:111], v[220:223]
  v_exp_f32 v103, v103
  v_mfma_f32_16x16x32_bf16 v[220:223], v[40:43], a[104:107], v[220:223]
  buffer_load_dwordx4 v28, s[28:31], s67 offen offset:2048 nt lds
  v_mfma_f32_16x16x32_bf16 v[108:111], a[64:67], v[140:143], v[124:127]
  v_exp_f32 v104, v104
  v_mfma_f32_16x16x32_bf16 v[108:111], a[68:71], v[172:175], v[108:111]
  ds_read_b128 a[92:95], v19 offset:52224
  v_cvt_pk_bf16_f32 v77, v102, v103
  v_mfma_f32_16x16x32_bf16 v[108:111], a[72:75], v[204:207], v[108:111]
  s_waitcnt lgkmcnt(3)
  v_exp_f32 v105, v105
  v_mfma_f32_16x16x32_bf16 v[108:111], a[76:79], v[236:239], v[108:111]
  ds_read_b64_tr_b16 a[124:125], v27 offset:34816
  v_cvt_pk_bf16_f32 v84, v104, v105
  v_mfma_f32_16x16x32_bf16 a[40:43], v[48:51], a[104:107], a[40:43]
  v_exp_f32 v106, v106
  v_mfma_f32_16x16x32_bf16 a[40:43], v[52:55], a[108:111], a[40:43]
  ds_read_b64_tr_b16 a[126:127], v27 offset:35840
  v_mfma_f32_16x16x32_bf16 a[44:47], v[60:63], a[108:111], a[44:47]
  s_waitcnt vmcnt(11)
  v_exp_f32 v107, v107
  v_mfma_f32_16x16x32_bf16 a[44:47], v[56:59], a[104:107], a[44:47]
  v_mfma_f32_16x16x32_bf16 v[96:99], a[80:83], v[128:131], v[112:115]
  s_barrier
  v_exp_f32 v108, v108
  v_mfma_f32_16x16x32_bf16 v[96:99], a[84:87], v[160:163], v[96:99]
  ds_read_b128 a[64:67], v16 offset:0
  v_cvt_pk_bf16_f32 v85, v106, v107
  v_mfma_f32_16x16x32_bf16 v[96:99], a[88:91], v[192:195], v[96:99]
  s_waitcnt lgkmcnt(3)
  v_exp_f32 v109, v109
  v_mfma_f32_16x16x32_bf16 v[96:99], a[92:95], v[224:227], v[96:99]
  ds_read_b64_tr_b16 a[96:97], v20 offset:49152
  v_cvt_pk_bf16_f32 v92, v108, v109
  v_mfma_f32_16x16x32_bf16 v[240:243], v[32:35], a[112:115], v[240:243]
  v_exp_f32 v110, v110
  v_mfma_f32_16x16x32_bf16 v[240:243], v[36:39], a[116:119], v[240:243]
  ds_read_b64_tr_b16 a[98:99], v20 offset:50176
  v_mfma_f32_16x16x32_bf16 v[244:247], v[44:47], a[116:119], v[244:247]
  v_exp_f32 v111, v111
  v_mfma_f32_16x16x32_bf16 v[244:247], v[40:43], a[112:115], v[244:247]
  v_mfma_f32_16x16x32_bf16 v[100:103], a[80:83], v[132:135], v[116:119]
  v_exp_f32 v96, v96
  v_mfma_f32_16x16x32_bf16 v[100:103], a[84:87], v[164:167], v[100:103]
  ds_read_b128 a[68:71], v17 offset:0
  v_cvt_pk_bf16_f32 v93, v110, v111
  v_mfma_f32_16x16x32_bf16 v[100:103], a[88:91], v[196:199], v[100:103]
  v_exp_f32 v97, v97
  v_mfma_f32_16x16x32_bf16 v[100:103], a[92:95], v[228:231], v[100:103]
  ds_read_b64_tr_b16 a[100:101], v20 offset:51200
  v_cvt_pk_bf16_f32 v70, v96, v97
  v_mfma_f32_16x16x32_bf16 a[48:51], v[48:51], a[112:115], a[48:51]
  v_exp_f32 v98, v98
  v_mfma_f32_16x16x32_bf16 a[48:51], v[52:55], a[116:119], a[48:51]
  ds_read_b64_tr_b16 a[102:103], v20 offset:52224
  v_mfma_f32_16x16x32_bf16 a[52:55], v[60:63], a[116:119], a[52:55]
  v_exp_f32 v99, v99
  v_mfma_f32_16x16x32_bf16 a[52:55], v[56:59], a[112:115], a[52:55]
  buffer_load_dwordx4 v28, s[28:31], s67 offen offset:3072 nt lds
  v_mfma_f32_16x16x32_bf16 a[132:135], a[240:243], v[48:51], a[132:135]
  v_mfma_f32_16x16x32_bf16 a[132:135], a[240:243], v[52:55], a[132:135]
  v_mfma_f32_16x16x32_bf16 v[104:107], a[80:83], v[136:139], v[120:123]
  v_exp_f32 v100, v100
  v_mfma_f32_16x16x32_bf16 v[104:107], a[84:87], v[168:171], v[104:107]
  ds_read_b128 a[72:75], v18 offset:0
  v_cvt_pk_bf16_f32 v71, v98, v99
  v_mfma_f32_16x16x32_bf16 v[104:107], a[88:91], v[200:203], v[104:107]
  s_waitcnt lgkmcnt(7)
  v_exp_f32 v101, v101
  v_mfma_f32_16x16x32_bf16 v[104:107], a[92:95], v[232:235], v[104:107]
  ds_read_b64_tr_b16 a[104:105], v21 offset:49152
  v_cvt_pk_bf16_f32 v78, v100, v101
  v_mfma_f32_16x16x32_bf16 v[248:251], v[32:35], a[120:123], v[248:251]
  v_exp_f32 v102, v102
  v_mfma_f32_16x16x32_bf16 v[248:251], v[36:39], a[124:127], v[248:251]
  ds_read_b64_tr_b16 a[106:107], v21 offset:50176
  v_mfma_f32_16x16x32_bf16 v[252:255], v[44:47], a[124:127], v[252:255]
  v_exp_f32 v103, v103
  v_mfma_f32_16x16x32_bf16 v[252:255], v[40:43], a[120:123], v[252:255]
  v_mfma_f32_16x16x32_bf16 v[108:111], a[80:83], v[140:143], v[124:127]
  v_exp_f32 v104, v104
  v_mfma_f32_16x16x32_bf16 v[108:111], a[84:87], v[172:175], v[108:111]
  ds_read_b128 a[76:79], v19 offset:0
  v_cvt_pk_bf16_f32 v79, v102, v103
  v_mfma_f32_16x16x32_bf16 v[108:111], a[88:91], v[204:207], v[108:111]
  s_waitcnt lgkmcnt(3)
  v_exp_f32 v105, v105
  v_mfma_f32_16x16x32_bf16 v[108:111], a[92:95], v[236:239], v[108:111]
  ds_read_b64_tr_b16 a[108:109], v21 offset:51200
  v_cvt_pk_bf16_f32 v86, v104, v105
  v_mfma_f32_16x16x32_bf16 a[56:59], v[48:51], a[120:123], a[56:59]
  v_exp_f32 v106, v106
  v_mfma_f32_16x16x32_bf16 a[56:59], v[52:55], a[124:127], a[56:59]
  ds_read_b64_tr_b16 a[110:111], v21 offset:52224
  v_mfma_f32_16x16x32_bf16 a[60:63], v[60:63], a[124:127], a[60:63]
  v_exp_f32 v107, v107
  v_mfma_f32_16x16x32_bf16 a[60:63], v[56:59], a[120:123], a[60:63]
  v_cvt_pk_bf16_f32 v87, v106, v107
L_tail:
  v_mfma_f32_16x16x32_bf16 v[96:99], a[64:67], v[128:131], v[112:115]
  v_exp_f32 v108, v108
  v_mfma_f32_16x16x32_bf16 v[96:99], a[68:71], v[160:163], v[96:99]
  ds_read_b128 a[80:83], v16 offset:1024
  v_mfma_f32_16x16x32_bf16 v[96:99], a[72:75], v[192:195], v[96:99]
  s_waitcnt lgkmcnt(3)
  v_exp_f32 v109, v109
  v_mfma_f32_16x16x32_bf16 v[96:99], a[76:79], v[224:227], v[96:99]
  ds_read_b64_tr_b16 a[112:113], v22 offset:49152
  v_cvt_pk_bf16_f32 v94, v108, v109
  v_mfma_f32_16x16x32_bf16 v[144:147], v[64:67], a[96:99], v[144:147]
  v_exp_f32 v110, v110
  v_mfma_f32_16x16x32_bf16 v[144:147], v[68:71], a[100:103], v[144:147]
  ds_read_b64_tr_b16 a[114:115], v22 offset:50176
  v_mfma_f32_16x16x32_bf16 v[148:151], v[76:79], a[100:103], v[148:151]
  v_exp_f32 v111, v111
  v_mfma_f32_16x16x32_bf16 v[148:151], v[72:75], a[96:99], v[148:151]
  v_mfma_f32_16x16x32_bf16 v[100:103], a[64:67], v[132:135], v[116:119]
  v_exp_f32 v96, v96
  v_mfma_f32_16x16x32_bf16 v[100:103], a[68:71], v[164:167], v[100:103]
  ds_read_b128 a[84:87], v17 offset:1024
  v_cvt_pk_bf16_f32 v95, v110, v111
  v_mfma_f32_16x16x32_bf16 v[100:103], a[72:75], v[196:199], v[100:103]
  v_exp_f32 v97, v97
  v_mfma_f32_16x16x32_bf16 v[100:103], a[76:79], v[228:231], v[100:103]
  ds_read_b64_tr_b16 a[116:117], v22 offset:51200
  v_cvt_pk_bf16_f32 v32, v96, v97
  v_mfma_f32_16x16x32_bf16 a[0:3], v[80:83], a[96:99], a[0:3]
  v_exp_f32 v98, v98
  v_mfma_f32_16x16x32_bf16 a[0:3], v[84:87], a[100:103], a[0:3]
  s_xor_b32 s68, s10, 167936
  ds_read_b64_tr_b16 a[118:119], v22 offset:52224
  v_mfma_f32_16x16x32_bf16 a[4:7], v[92:95], a[100:103], a[4:7]
  s_add_u32 m0, s63, 81920
  v_exp_f32 v99, v99
  v_mfma_f32_16x16x32_bf16 a[4:7], v[88:91], a[96:99], a[4:7]
  buffer_load_dwordx4 v29, s[32:35], s68 offen offset:0 nt lds
  v_mfma_f32_16x16x32_bf16 v[104:107], a[64:67], v[136:139], v[120:123]
  s_add_u32 s81, s18, 4096
  v_exp_f32 v100, v100
  v_mfma_f32_16x16x32_bf16 v[104:107], a[68:71], v[168:171], v[104:107]
  ds_read_b128 a[88:91], v18 offset:1024
  v_cvt_pk_bf16_f32 v33, v98, v99
  v_mfma_f32_16x16x32_bf16 v[104:107], a[72:75], v[200:203], v[104:107]
  s_waitcnt lgkmcnt(7)
  v_exp_f32 v101, v101
  v_mfma_f32_16x16x32_bf16 v[104:107], a[76:79], v[232:235], v[104:107]
  ds_read_b64_tr_b16 a[120:121], v23 offset:49152
  v_cvt_pk_bf16_f32 v40, v100, v101
  v_mfma_f32_16x16x32_bf16 v[152:155], v[64:67], a[104:107], v[152:155]
  v_exp_f32 v102, v102
  v_mfma_f32_16x16x32_bf16 v[152:155], v[68:71], a[108:111], v[152:155]
  ds_read_b64_tr_b16 a[122:123], v23 offset:50176
  v_mfma_f32_16x16x32_bf16 v[156:159], v[76:79], a[108:111], v[156:159]
  v_exp_f32 v103, v103
  v_mfma_f32_16x16x32_bf16 v[156:159], v[72:75], a[104:107], v[156:159]
  buffer_load_dwordx4 a[156:159], v1, s[44:47], s81 offen offset:0 sc1
  v_mfma_f32_16x16x32_bf16 v[108:111], a[64:67], v[140:143], v[124:127]
  v_exp_f32 v104, v104
  v_mfma_f32_16x16x32_bf16 v[108:111], a[68:71], v[172:175], v[108:111]
  ds_read_b128 a[92:95], v19 offset:1024
  v_cvt_pk_bf16_f32 v41, v102, v103
  v_mfma_f32_16x16x32_bf16 v[108:111], a[72:75], v[204:207], v[108:111]
  s_waitcnt lgkmcnt(3)
  v_exp_f32 v105, v105
  v_mfma_f32_16x16x32_bf16 v[108:111], a[76:79], v[236:239], v[108:111]
  ds_read_b64_tr_b16 a[124:125], v23 offset:51200
  v_cvt_pk_bf16_f32 v48, v104, v105
  v_mfma_f32_16x16x32_bf16 a[8:11], v[80:83], a[104:107], a[8:11]
  v_exp_f32 v106, v106
  v_mfma_f32_16x16x32_bf16 a[8:11], v[84:87], a[108:111], a[8:11]
  ds_read_b64_tr_b16 a[126:127], v23 offset:52224
  v_mfma_f32_16x16x32_bf16 a[12:15], v[92:95], a[108:111], a[12:15]
  v_exp_f32 v107, v107
  v_mfma_f32_16x16x32_bf16 a[12:15], v[88:91], a[104:107], a[12:15]
  buffer_load_dwordx4 v29, s[32:35], s68 offen offset:1024 nt lds
  v_mfma_f32_16x16x32_bf16 a[128:131], a[244:247], v[72:75], a[128:131]
  buffer_load_dwordx4 a[160:163], v1, s[44:47], s81 offen offset:1024 sc1
  v_mfma_f32_16x16x32_bf16 a[128:131], a[244:247], v[76:79], a[128:131]
  buffer_load_dwordx4 a[164:167], v1, s[44:47], s81 offen offset:2048 sc1
  v_mfma_f32_16x16x32_bf16 v[96:99], a[80:83], v[128:131], v[112:115]
  v_exp_f32 v108, v108
  v_mfma_f32_16x16x32_bf16 v[96:99], a[84:87], v[160:163], v[96:99]
  ds_read_b128 a[64:67], v16 offset:2048
  v_cvt_pk_bf16_f32 v49, v106, v107
  v_mfma_f32_16x16x32_bf16 v[96:99], a[88:91], v[192:195], v[96:99]
  s_waitcnt lgkmcnt(3)
  v_exp_f32 v109, v109
  v_mfma_f32_16x16x32_bf16 v[96:99], a[92:95], v[224:227], v[96:99]
  ds_read_b64_tr_b16 a[96:97], v24 offset:49152
  v_cvt_pk_bf16_f32 v56, v108, v109
  v_mfma_f32_16x16x32_bf16 v[176:179], v[64:67], a[112:115], v[176:179]
  v_exp_f32 v110, v110
  v_mfma_f32_16x16x32_bf16 v[176:179], v[68:71], a[116:119], v[176:179]
  ds_read_b64_tr_b16 a[98:99], v24 offset:50176
  v_mfma_f32_16x16x32_bf16 v[180:183], v[76:79], a[116:119], v[180:183]
  v_exp_f32 v111, v111
  v_mfma_f32_16x16x32_bf16 v[180:183], v[72:75], a[112:115], v[180:183]
  buffer_load_dwordx4 v29, s[32:35], s68 offen offset:2048 nt lds
  v_mfma_f32_16x16x32_bf16 v[100:103], a[80:83], v[132:135], v[116:119]
  v_exp_f32 v96, v96
  v_mfma_f32_16x16x32_bf16 v[100:103], a[84:87], v[164:167], v[100:103]
  ds_read_b128 a[68:71], v17 offset:2048
  v_cvt_pk_bf16_f32 v57, v110, v111
  v_mfma_f32_16x16x32_bf16 v[100:103], a[88:91], v[196:199], v[100:103]
  v_exp_f32 v97, v97
  v_mfma_f32_16x16x32_bf16 v[100:103], a[92:95], v[228:231], v[100:103]
  ds_read_b64_tr_b16 a[100:101], v24 offset:51200
  v_cvt_pk_bf16_f32 v34, v96, v97
  v_mfma_f32_16x16x32_bf16 a[16:19], v[80:83], a[112:115], a[16:19]
  v_exp_f32 v98, v98
  v_mfma_f32_16x16x32_bf16 a[16:19], v[84:87], a[116:119], a[16:19]
  ds_read_b64_tr_b16 a[102:103], v24 offset:52224
  v_mfma_f32_16x16x32_bf16 a[20:23], v[92:95], a[116:119], a[20:23]
  v_exp_f32 v99, v99
  v_mfma_f32_16x16x32_bf16 a[20:23], v[88:91], a[112:115], a[20:23]
  buffer_load_dwordx4 a[168:171], v1, s[44:47], s81 offen offset:3072 sc1
  v_mfma_f32_16x16x32_bf16 v[104:107], a[80:83], v[136:139], v[120:123]
  v_exp_f32 v100, v100
  v_mfma_f32_16x16x32_bf16 v[104:107], a[84:87], v[168:171], v[104:107]
  ds_read_b128 a[72:75], v18 offset:2048
  v_cvt_pk_bf16_f32 v35, v98, v99
  v_mfma_f32_16x16x32_bf16 v[104:107], a[88:91], v[200:203], v[104:107]
  s_waitcnt lgkmcnt(7)
  v_exp_f32 v101, v101
  v_mfma_f32_16x16x32_bf16 v[104:107], a[92:95], v[232:235], v[104:107]
  ds_read_b64_tr_b16 a[104:105], v25 offset:49152
  v_cvt_pk_bf16_f32 v42, v100, v101
  v_mfma_f32_16x16x32_bf16 v[184:187], v[64:67], a[120:123], v[184:187]
  v_exp_f32 v102, v102
  v_mfma_f32_16x16x32_bf16 v[184:187], v[68:71], a[124:127], v[184:187]
  ds_read_b64_tr_b16 a[106:107], v25 offset:50176
  v_mfma_f32_16x16x32_bf16 v[188:191], v[76:79], a[124:127], v[188:191]
  v_exp_f32 v103, v103
  v_mfma_f32_16x16x32_bf16 v[188:191], v[72:75], a[120:123], v[188:191]
  buffer_load_dwordx4 v29, s[32:35], s68 offen offset:3072 nt lds
  v_mfma_f32_16x16x32_bf16 a[128:131], a[240:243], v[64:67], a[128:131]
  v_mfma_f32_16x16x32_bf16 a[128:131], a[240:243], v[68:71], a[128:131]
  v_mfma_f32_16x16x32_bf16 v[108:111], a[80:83], v[140:143], v[124:127]
  v_exp_f32 v104, v104
  v_mfma_f32_16x16x32_bf16 v[108:111], a[84:87], v[172:175], v[108:111]
  ds_read_b128 a[76:79], v19 offset:2048
  v_cvt_pk_bf16_f32 v43, v102, v103
  v_mfma_f32_16x16x32_bf16 v[108:111], a[88:91], v[204:207], v[108:111]
  s_waitcnt lgkmcnt(3)
  v_exp_f32 v105, v105
  v_mfma_f32_16x16x32_bf16 v[108:111], a[92:95], v[236:239], v[108:111]
  ds_read_b64_tr_b16 a[108:109], v25 offset:51200
  v_cvt_pk_bf16_f32 v50, v104, v105
  v_mfma_f32_16x16x32_bf16 a[24:27], v[80:83], a[120:123], a[24:27]
  v_exp_f32 v106, v106
  v_mfma_f32_16x16x32_bf16 a[24:27], v[84:87], a[124:127], a[24:27]
  s_xor_b32 s67, s10, 180224
  ds_read_b64_tr_b16 a[110:111], v25 offset:52224
  v_mfma_f32_16x16x32_bf16 a[28:31], v[92:95], a[124:127], a[28:31]
  s_add_u32 m0, s63, 32768
  v_exp_f32 v107, v107
  v_mfma_f32_16x16x32_bf16 a[28:31], v[88:91], a[120:123], a[28:31]
  buffer_load_dwordx4 v28, s[28:31], s67 offen offset:0 nt lds
  v_mfma_f32_16x16x32_bf16 v[96:99], a[64:67], v[128:131], v[112:115]
  v_exp_f32 v108, v108
  v_mfma_f32_16x16x32_bf16 v[96:99], a[68:71], v[160:163], v[96:99]
  ds_read_b128 a[80:83], v16 offset:3072
  v_cvt_pk_bf16_f32 v51, v106, v107
  v_mfma_f32_16x16x32_bf16 v[96:99], a[72:75], v[192:195], v[96:99]
  s_waitcnt lgkmcnt(3)
  v_exp_f32 v109, v109
  v_mfma_f32_16x16x32_bf16 v[96:99], a[76:79], v[224:227], v[96:99]
  ds_read_b64_tr_b16 a[112:113], v26 offset:49152
  v_cvt_pk_bf16_f32 v58, v108, v109
  v_mfma_f32_16x16x32_bf16 v[208:211], v[64:67], a[96:99], v[208:211]
  v_exp_f32 v110, v110
  v_mfma_f32_16x16x32_bf16 v[208:211], v[68:71], a[100:103], v[208:211]
  ds_read_b64_tr_b16 a[114:115], v26 offset:50176
  v_mfma_f32_16x16x32_bf16 v[212:215], v[76:79], a[100:103], v[212:215]
  v_exp_f32 v111, v111
  v_mfma_f32_16x16x32_bf16 v[212:215], v[72:75], a[96:99], v[212:215]
  v_mfma_f32_16x16x32_bf16 v[100:103], a[64:67], v[132:135], v[116:119]
  v_exp_f32 v96, v96
  v_mfma_f32_16x16x32_bf16 v[100:103], a[68:71], v[164:167], v[100:103]
  ds_read_b128 a[84:87], v17 offset:3072
  v_cvt_pk_bf16_f32 v59, v110, v111
  v_mfma_f32_16x16x32_bf16 v[100:103], a[72:75], v[196:199], v[100:103]
  v_exp_f32 v97, v97
  v_mfma_f32_16x16x32_bf16 v[100:103], a[76:79], v[228:231], v[100:103]
  ds_read_b64_tr_b16 a[116:117], v26 offset:51200
  v_cvt_pk_bf16_f32 v36, v96, v97
  v_mfma_f32_16x16x32_bf16 a[32:35], v[80:83], a[96:99], a[32:35]
  v_exp_f32 v98, v98
  v_mfma_f32_16x16x32_bf16 a[32:35], v[84:87], a[100:103], a[32:35]
  ds_read_b64_tr_b16 a[118:119], v26 offset:52224
  v_mfma_f32_16x16x32_bf16 a[36:39], v[92:95], a[100:103], a[36:39]
  v_exp_f32 v99, v99
  v_mfma_f32_16x16x32_bf16 a[36:39], v[88:91], a[96:99], a[36:39]
  buffer_load_dwordx4 v28, s[28:31], s67 offen offset:1024 nt lds
  v_mfma_f32_16x16x32_bf16 a[132:135], a[244:247], v[88:91], a[132:135]
  v_mfma_f32_16x16x32_bf16 a[132:135], a[244:247], v[92:95], a[132:135]
  v_mfma_f32_16x16x32_bf16 v[104:107], a[64:67], v[136:139], v[120:123]
  v_exp_f32 v100, v100
  v_mfma_f32_16x16x32_bf16 v[104:107], a[68:71], v[168:171], v[104:107]
  ds_read_b128 a[88:91], v18 offset:3072
  v_cvt_pk_bf16_f32 v37, v98, v99
  v_mfma_f32_16x16x32_bf16 v[104:107], a[72:75], v[200:203], v[104:107]
  s_waitcnt lgkmcnt(7)
  v_exp_f32 v101, v101
  v_mfma_f32_16x16x32_bf16 v[104:107], a[76:79], v[232:235], v[104:107]
  ds_read_b64_tr_b16 a[120:121], v27 offset:49152
  v_cvt_pk_bf16_f32 v44, v100, v101
  v_mfma_f32_16x16x32_bf16 v[216:219], v[64:67], a[104:107], v[216:219]
  v_exp_f32 v102, v102
  v_mfma_f32_16x16x32_bf16 v[216:219], v[68:71], a[108:111], v[216:219]
  ds_read_b64_tr_b16 a[122:123], v27 offset:50176
  v_mfma_f32_16x16x32_bf16 v[220:223], v[76:79], a[108:111], v[220:223]
  v_exp_f32 v103, v103
  v_mfma_f32_16x16x32_bf16 v[220:223], v[72:75], a[104:107], v[220:223]
  buffer_load_dwordx4 v28, s[28:31], s67 offen offset:2048 nt lds
  v_mfma_f32_16x16x32_bf16 v[108:111], a[64:67], v[140:143], v[124:127]
  v_exp_f32 v104, v104
  v_mfma_f32_16x16x32_bf16 v[108:111], a[68:71], v[172:175], v[108:111]
  ds_read_b128 a[92:95], v19 offset:3072
  v_cvt_pk_bf16_f32 v45, v102, v103
  v_mfma_f32_16x16x32_bf16 v[108:111], a[72:75], v[204:207], v[108:111]
  s_waitcnt lgkmcnt(3)
  v_exp_f32 v105, v105
  v_mfma_f32_16x16x32_bf16 v[108:111], a[76:79], v[236:239], v[108:111]
  ds_read_b64_tr_b16 a[124:125], v27 offset:51200
  v_cvt_pk_bf16_f32 v52, v104, v105
  v_mfma_f32_16x16x32_bf16 a[40:43], v[80:83], a[104:107], a[40:43]
  v_exp_f32 v106, v106
  v_mfma_f32_16x16x32_bf16 a[40:43], v[84:87], a[108:111], a[40:43]
  ds_read_b64_tr_b16 a[126:127], v27 offset:52224
  v_mfma_f32_16x16x32_bf16 a[44:47], v[92:95], a[108:111], a[44:47]
  s_waitcnt vmcnt(11)
  v_exp_f32 v107, v107
  v_mfma_f32_16x16x32_bf16 a[44:47], v[88:91], a[104:107], a[44:47]
  v_mfma_f32_16x16x32_bf16 v[96:99], a[80:83], v[128:131], v[112:115]
  s_barrier
  v_exp_f32 v108, v108
  v_mfma_f32_16x16x32_bf16 v[96:99], a[84:87], v[160:163], v[96:99]
  ds_read_b128 a[64:67], v16 offset:16384
  v_cvt_pk_bf16_f32 v53, v106, v107
  v_mfma_f32_16x16x32_bf16 v[96:99], a[88:91], v[192:195], v[96:99]
  s_waitcnt lgkmcnt(3)
  v_exp_f32 v109, v109
  v_mfma_f32_16x16x32_bf16 v[96:99], a[92:95], v[224:227], v[96:99]
  ds_read_b64_tr_b16 a[96:97], v20 offset:0
  v_cvt_pk_bf16_f32 v60, v108, v109
  v_mfma_f32_16x16x32_bf16 v[240:243], v[64:67], a[112:115], v[240:243]
  v_exp_f32 v110, v110
  v_mfma_f32_16x16x32_bf16 v[240:243], v[68:71], a[116:119], v[240:243]
  ds_read_b64_tr_b16 a[98:99], v20 offset:1024
  v_mfma_f32_16x16x32_bf16 v[244:247], v[76:79], a[116:119], v[244:247]
  v_exp_f32 v111, v111
  v_mfma_f32_16x16x32_bf16 v[244:247], v[72:75], a[112:115], v[244:247]
  v_mfma_f32_16x16x32_bf16 v[100:103], a[80:83], v[132:135], v[116:119]
  v_exp_f32 v96, v96
  v_mfma_f32_16x16x32_bf16 v[100:103], a[84:87], v[164:167], v[100:103]
  ds_read_b128 a[68:71], v17 offset:16384
  v_cvt_pk_bf16_f32 v61, v110, v111
  v_mfma_f32_16x16x32_bf16 v[100:103], a[88:91], v[196:199], v[100:103]
  v_exp_f32 v97, v97
  v_mfma_f32_16x16x32_bf16 v[100:103], a[92:95], v[228:231], v[100:103]
  ds_read_b64_tr_b16 a[100:101], v20 offset:2048
  v_cvt_pk_bf16_f32 v38, v96, v97
  v_mfma_f32_16x16x32_bf16 a[48:51], v[80:83], a[112:115], a[48:51]
  v_exp_f32 v98, v98
  v_mfma_f32_16x16x32_bf16 a[48:51], v[84:87], a[116:119], a[48:51]
  ds_read_b64_tr_b16 a[102:103], v20 offset:3072
  v_mfma_f32_16x16x32_bf16 a[52:55], v[92:95], a[116:119], a[52:55]
  v_exp_f32 v99, v99
  v_mfma_f32_16x16x32_bf16 a[52:55], v[88:91], a[112:115], a[52:55]
  buffer_load_dwordx4 v28, s[28:31], s67 offen offset:3072 nt lds
  v_mfma_f32_16x16x32_bf16 a[132:135], a[240:243], v[80:83], a[132:135]
  v_mfma_f32_16x16x32_bf16 a[132:135], a[240:243], v[84:87], a[132:135]
  v_mfma_f32_16x16x32_bf16 v[104:107], a[80:83], v[136:139], v[120:123]
  v_exp_f32 v100, v100
  v_mfma_f32_16x16x32_bf16 v[104:107], a[84:87], v[168:171], v[104:107]
  ds_read_b128 a[72:75], v18 offset:16384
  v_cvt_pk_bf16_f32 v39, v98, v99
  v_mfma_f32_16x16x32_bf16 v[104:107], a[88:91], v[200:203], v[104:107]
  s_waitcnt lgkmcnt(7)
  v_exp_f32 v101, v101
  v_mfma_f32_16x16x32_bf16 v[104:107], a[92:95], v[232:235], v[104:107]
  ds_read_b64_tr_b16 a[104:105], v21 offset:0
  v_cvt_pk_bf16_f32 v46, v100, v101
  v_mfma_f32_16x16x32_bf16 v[248:251], v[64:67], a[120:123], v[248:251]
  v_exp_f32 v102, v102
  v_mfma_f32_16x16x32_bf16 v[248:251], v[68:71], a[124:127], v[248:251]
  ds_read_b64_tr_b16 a[106:107], v21 offset:1024
  v_mfma_f32_16x16x32_bf16 v[252:255], v[76:79], a[124:127], v[252:255]
  v_exp_f32 v103, v103
  v_mfma_f32_16x16x32_bf16 v[252:255], v[72:75], a[120:123], v[252:255]
  v_mfma_f32_16x16x32_bf16 v[108:111], a[80:83], v[140:143], v[124:127]
  v_exp_f32 v104, v104
  v_mfma_f32_16x16x32_bf16 v[108:111], a[84:87], v[172:175], v[108:111]
  ds_read_b128 a[76:79], v19 offset:16384
  v_cvt_pk_bf16_f32 v47, v102, v103
  v_mfma_f32_16x16x32_bf16 v[108:111], a[88:91], v[204:207], v[108:111]
  s_waitcnt lgkmcnt(3)
  v_exp_f32 v105, v105
  v_mfma_f32_16x16x32_bf16 v[108:111], a[92:95], v[236:239], v[108:111]
  ds_read_b64_tr_b16 a[108:109], v21 offset:2048
  v_cvt_pk_bf16_f32 v54, v104, v105
  v_mfma_f32_16x16x32_bf16 a[56:59], v[80:83], a[120:123], a[56:59]
  v_exp_f32 v106, v106
  v_mfma_f32_16x16x32_bf16 a[56:59], v[84:87], a[124:127], a[56:59]
  ds_read_b64_tr_b16 a[110:111], v21 offset:3072
  v_mfma_f32_16x16x32_bf16 a[60:63], v[92:95], a[124:127], a[60:63]
L_hop9:
  s_cbranch_execz L_hopback
  v_exp_f32 v107, v107
  v_mfma_f32_16x16x32_bf16 a[60:63], v[88:91], a[120:123], a[60:63]
  v_cvt_pk_bf16_f32 v55, v106, v107
  v_mfma_f32_16x16x32_bf16 v[96:99], a[64:67], v[128:131], v[112:115]
  v_exp_f32 v108, v108
  v_mfma_f32_16x16x32_bf16 v[96:99], a[68:71], v[160:163], v[96:99]
  ds_read_b128 a[80:83], v16 offset:17408
  v_mfma_f32_16x16x32_bf16 v[96:99], a[72:75], v[192:195], v[96:99]
  s_waitcnt lgkmcnt(3)
  v_exp_f32 v109, v109
  v_mfma_f32_16x16x32_bf16 v[96:99], a[76:79], v[224:227], v[96:99]
  ds_read_b64_tr_b16 a[112:113], v22 offset:0
  v_cvt_pk_bf16_f32 v62, v108, v109
  v_mfma_f32_16x16x32_bf16 v[144:147], v[32:35], a[96:99], v[144:147]
  v_exp_f32 v110, v110
  v_mfma_f32_16x16x32_bf16 v[144:147], v[36:39], a[100:103], v[144:147]
  ds_read_b64_tr_b16 a[114:115], v22 offset:1024
  v_mfma_f32_16x16x32_bf16 v[148:151], v[44:47], a[100:103], v[148:151]
  v_exp_f32 v111, v111
  v_mfma_f32_16x16x32_bf16 v[148:151], v[40:43], a[96:99], v[148:151]
  v_mfma_f32_16x16x32_bf16 v[100:103], a[64:67], v[132:135], v[116:119]
  v_exp_f32 v96, v96
  v_mfma_f32_16x16x32_bf16 v[100:103], a[68:71], v[164:167], v[100:103]
  ds_read_b128 a[84:87], v17 offset:17408
  v_cvt_pk_bf16_f32 v63, v110, v111
  v_mfma_f32_16x16x32_bf16 v[100:103], a[72:75], v[196:199], v[100:103]
  v_exp_f32 v97, v97
  v_mfma_f32_16x16x32_bf16 v[100:103], a[76:79], v[228:231], v[100:103]
  ds_read_b64_tr_b16 a[116:117], v22 offset:2048
  v_cvt_pk_bf16_f32 v64, v96, v97
  v_mfma_f32_16x16x32_bf16 a[0:3], v[48:51], a[96:99], a[0:3]
  v_exp_f32 v98, v98
  v_mfma_f32_16x16x32_bf16 a[0:3], v[52:55], a[100:103], a[0:3]
  s_xor_b32 s68, s10, 180224
  ds_read_b64_tr_b16 a[118:119], v22 offset:3072
  v_mfma_f32_16x16x32_bf16 a[4:7], v[60:63], a[100:103], a[4:7]
  s_add_u32 m0, s63, 98304
  v_exp_f32 v99, v99
  v_mfma_f32_16x16x32_bf16 a[4:7], v[56:59], a[96:99], a[4:7]
  buffer_load_dwordx4 v29, s[32:35], s68 offen offset:0 nt lds
  v_mfma_f32_16x16x32_bf16 v[104:107], a[64:67], v[136:139], v[120:123]
  s_add_u32 s82, s18, 8192
  v_exp_f32 v100, v100
  v_mfma_f32_16x16x32_bf16 v[104:107], a[68:71], v[168:171], v[104:107]
  ds_read_b128 a[88:91], v18 offset:17408
  v_cvt_pk_bf16_f32 v65, v98, v99
  v_mfma_f32_16x16x32_bf16 v[104:107], a[72:75], v[200:203], v[104:107]
  s_waitcnt lgkmcnt(7)
  v_exp_f32 v101, v101
  v_mfma_f32_16x16x32_bf16 v[104:107], a[76:79], v[232:235], v[104:107]
  ds_read_b64_tr_b16 a[120:121], v23 offset:0
  v_cvt_pk_bf16_f32 v72, v100, v101
  v_mfma_f32_16x16x32_bf16 v[152:155], v[32:35], a[104:107], v[152:155]
  v_exp_f32 v102, v102
  v_mfma_f32_16x16x32_bf16 v[152:155], v[36:39], a[108:111], v[152:155]
  ds_read_b64_tr_b16 a[122:123], v23 offset:1024
  v_mfma_f32_16x16x32_bf16 v[156:159], v[44:47], a[108:111], v[156:159]
  v_exp_f32 v103, v103
  v_mfma_f32_16x16x32_bf16 v[156:159], v[40:43], a[104:107], v[156:159]
  buffer_load_dwordx4 a[172:175], v1, s[44:47], s82 offen offset:0 sc1
  v_mfma_f32_16x16x32_bf16 v[108:111], a[64:67], v[140:143], v[124:127]
  v_exp_f32 v104, v104
  v_mfma_f32_16x16x32_bf16 v[108:111], a[68:71], v[172:175], v[108:111]
  ds_read_b128 a[92:95], v19 offset:17408
  v_cvt_pk_bf16_f32 v73, v102, v103
  v_mfma_f32_16x16x32_bf16 v[108:111], a[72:75], v[204:207], v[108:111]
  s_waitcnt lgkmcnt(3)
  v_exp_f32 v105, v105
  v_mfma_f32_16x16x32_bf16 v[108:111], a[76:79], v[236:239], v[108:111]
  ds_read_b64_tr_b16 a[124:125], v23 offset:2048
  v_cvt_pk_bf16_f32 v80, v104, v105
  v_mfma_f32_16x16x32_bf16 a[8:11], v[48:51], a[104:107], a[8:11]
  v_exp_f32 v106, v106
  v_mfma_f32_16x16x32_bf16 a[8:11], v[52:55], a[108:111], a[8:11]
  ds_read_b64_tr_b16 a[126:127], v23 offset:3072
  v_mfma_f32_16x16x32_bf16 a[12:15], v[60:63], a[108:111], a[12:15]
  v_exp_f32 v107, v107
  v_mfma_f32_16x16x32_bf16 a[12:15], v[56:59], a[104:107], a[12:15]
  buffer_load_dwordx4 v29, s[32:35], s68 offen offset:1024 nt lds
  v_mfma_f32_16x16x32_bf16 a[128:131], a[244:247], v[40:43], a[128:131]
  buffer_load_dwordx4 a[176:179], v1, s[44:47], s82 offen offset:1024 sc1
  v_mfma_f32_16x16x32_bf16 a[128:131], a[244:247], v[44:47], a[128:131]
  buffer_load_dwordx4 a[180:183], v1, s[44:47], s82 offen offset:2048 sc1
  v_mfma_f32_16x16x32_bf16 v[96:99], a[80:83], v[128:131], v[112:115]
  v_exp_f32 v108, v108
  v_mfma_f32_16x16x32_bf16 v[96:99], a[84:87], v[160:163], v[96:99]
  ds_read_b128 a[64:67], v16 offset:18432
  v_cvt_pk_bf16_f32 v81, v106, v107
  v_mfma_f32_16x16x32_bf16 v[96:99], a[88:91], v[192:195], v[96:99]
  s_waitcnt lgkmcnt(3)
  v_exp_f32 v109, v109
  v_mfma_f32_16x16x32_bf16 v[96:99], a[92:95], v[224:227], v[96:99]
  ds_read_b64_tr_b16 a[96:97], v24 offset:0
  v_cvt_pk_bf16_f32 v88, v108, v109
  v_mfma_f32_16x16x32_bf16 v[176:179], v[32:35], a[112:115], v[176:179]
  v_exp_f32 v110, v110
  v_mfma_f32_16x16x32_bf16 v[176:179], v[36:39], a[116:119], v[176:179]
  ds_read_b64_tr_b16 a[98:99], v24 offset:1024
  v_mfma_f32_16x16x32_bf16 v[180:183], v[44:47], a[116:119], v[180:183]
  v_exp_f32 v111, v111
  v_mfma_f32_16x16x32_bf16 v[180:183], v[40:43], a[112:115], v[180:183]
  buffer_load_dwordx4 a[184:187], v1, s[44:47], s82 offen offset:3072 sc1
  v_mfma_f32_16x16x32_bf16 v[100:103], a[80:83], v[132:135], v[116:119]
  v_exp_f32 v96, v96
  v_mfma_f32_16x16x32_bf16 v[100:103], a[84:87], v[164:167], v[100:103]
  ds_read_b128 a[68:71], v17 offset:18432
  v_cvt_pk_bf16_f32 v89, v110, v111
  v_mfma_f32_16x16x32_bf16 v[100:103], a[88:91], v[196:199], v[100:103]
  v_exp_f32 v97, v97
  v_mfma_f32_16x16x32_bf16 v[100:103], a[92:95], v[228:231], v[100:103]
  ds_read_b64_tr_b16 a[100:101], v24 offset:2048
  v_cvt_pk_bf16_f32 v66, v96, v97
  v_mfma_f32_16x16x32_bf16 a[16:19], v[48:51], a[112:115], a[16:19]
  v_exp_f32 v98, v98
  v_mfma_f32_16x16x32_bf16 a[16:19], v[52:55], a[116:119], a[16:19]
  ds_read_b64_tr_b16 a[102:103], v24 offset:3072
  v_mfma_f32_16x16x32_bf16 a[20:23], v[60:63], a[116:119], a[20:23]
  v_exp_f32 v99, v99
  v_mfma_f32_16x16x32_bf16 a[20:23], v[56:59], a[112:115], a[20:23]
  buffer_load_dwordx4 v29, s[32:35], s68 offen offset:2048 nt lds
  v_mfma_f32_16x16x32_bf16 v[104:107], a[80:83], v[136:139], v[120:123]
  v_exp_f32 v100, v100
  v_mfma_f32_16x16x32_bf16 v[104:107], a[84:87], v[168:171], v[104:107]
  ds_read_b128 a[72:75], v18 offset:18432
  v_cvt_pk_bf16_f32 v67, v98, v99
  v_mfma_f32_16x16x32_bf16 v[104:107], a[88:91], v[200:203], v[104:107]
  s_waitcnt lgkmcnt(7)
  v_exp_f32 v101, v101
  v_mfma_f32_16x16x32_bf16 v[104:107], a[92:95], v[232:235], v[104:107]
  ds_read_b64_tr_b16 a[104:105], v25 offset:0
  v_cvt_pk_bf16_f32 v74, v100, v101
  v_mfma_f32_16x16x32_bf16 v[184:187], v[32:35], a[120:123], v[184:187]
  v_exp_f32 v102, v102
  v_mfma_f32_16x16x32_bf16 v[184:187], v[36:39], a[124:127], v[184:187]
  ds_read_b64_tr_b16 a[106:107], v25 offset:1024
  v_mfma_f32_16x16x32_bf16 v[188:191], v[44:47], a[124:127], v[188:191]
  v_exp_f32 v103, v103
  v_mfma_f32_16x16x32_bf16 v[188:191], v[40:43], a[120:123], v[188:191]
  v_mfma_f32_16x16x32_bf16 a[128:131], a[240:243], v[32:35], a[128:131]
  v_mfma_f32_16x16x32_bf16 a[128:131], a[240:243], v[36:39], a[128:131]
  v_mfma_f32_16x16x32_bf16 v[108:111], a[80:83], v[140:143], v[124:127]
  v_exp_f32 v104, v104
  v_mfma_f32_16x16x32_bf16 v[108:111], a[84:87], v[172:175], v[108:111]
  ds_read_b128 a[76:79], v19 offset:18432
  v_cvt_pk_bf16_f32 v75, v102, v103
  v_mfma_f32_16x16x32_bf16 v[108:111], a[88:91], v[204:207], v[108:111]
  s_waitcnt lgkmcnt(3)
  v_exp_f32 v105, v105
  v_mfma_f32_16x16x32_bf16 v[108:111], a[92:95], v[236:239], v[108:111]
  ds_read_b64_tr_b16 a[108:109], v25 offset:2048
  v_cvt_pk_bf16_f32 v82, v104, v105
  v_mfma_f32_16x16x32_bf16 a[24:27], v[48:51], a[120:123], a[24:27]
  v_exp_f32 v106, v106
  v_mfma_f32_16x16x32_bf16 a[24:27], v[52:55], a[124:127], a[24:27]
  ds_read_b64_tr_b16 a[110:111], v25 offset:3072
  v_mfma_f32_16x16x32_bf16 a[28:31], v[60:63], a[124:127], a[28:31]
  v_exp_f32 v107, v107
  v_mfma_f32_16x16x32_bf16 a[28:31], v[56:59], a[120:123], a[28:31]
  buffer_load_dwordx4 v29, s[32:35], s68 offen offset:3072 nt lds
  v_mfma_f32_16x16x32_bf16 v[96:99], a[64:67], v[128:131], v[112:115]
  v_exp_f32 v108, v108
  v_mfma_f32_16x16x32_bf16 v[96:99], a[68:71], v[160:163], v[96:99]
  ds_read_b128 a[80:83], v16 offset:19456
  v_cvt_pk_bf16_f32 v83, v106, v107
  v_mfma_f32_16x16x32_bf16 v[96:99], a[72:75], v[192:195], v[96:99]
  s_waitcnt lgkmcnt(3)
  v_exp_f32 v109, v109
  v_mfma_f32_16x16x32_bf16 v[96:99], a[76:79], v[224:227], v[96:99]
  ds_read_b64_tr_b16 a[112:113], v26 offset:0
  v_cvt_pk_bf16_f32 v90, v108, v109
  v_mfma_f32_16x16x32_bf16 v[208:211], v[32:35], a[96:99], v[208:211]
  v_exp_f32 v110, v110
  v_mfma_f32_16x16x32_bf16 v[208:211], v[36:39], a[100:103], v[208:211]
  ds_read_b64_tr_b16 a[114:115], v26 offset:1024
  ds_read_b128 a[84:87], v17 offset:19456
  v_mfma_f32_16x16x32_bf16 v[212:215], v[44:47], a[100:103], v[212:215]
  v_exp_f32 v111, v111
  v_mfma_f32_16x16x32_bf16 v[212:215], v[40:43], a[96:99], v[212:215]
  v_mfma_f32_16x16x32_bf16 v[100:103], a[64:67], v[132:135], v[116:119]
  v_exp_f32 v96, v96
  v_mfma_f32_16x16x32_bf16 v[100:103], a[68:71], v[164:167], v[100:103]
  ds_read_b64_tr_b16 a[116:117], v26 offset:2048
  v_cvt_pk_bf16_f32 v91, v110, v111
  v_mfma_f32_16x16x32_bf16 v[100:103], a[72:75], v[196:199], v[100:103]
  v_exp_f32 v97, v97
  v_mfma_f32_16x16x32_bf16 v[100:103], a[76:79], v[228:231], v[100:103]
  ds_read_b64_tr_b16 a[118:119], v26 offset:3072
  v_cvt_pk_bf16_f32 v68, v96, v97
  v_mfma_f32_16x16x32_bf16 a[32:35], v[48:51], a[96:99], a[32:35]
  v_exp_f32 v98, v98
  v_mfma_f32_16x16x32_bf16 a[32:35], v[52:55], a[100:103], a[32:35]
  s_xor_b32 s67, s10, 184320
  ds_read_b128 a[88:91], v18 offset:19456
  v_mfma_f32_16x16x32_bf16 a[36:39], v[60:63], a[100:103], a[36:39]
  s_add_u32 m0, s63, 49152
  v_exp_f32 v99, v99
  v_mfma_f32_16x16x32_bf16 a[36:39], v[56:59], a[96:99], a[36:39]
  ds_read_b64_tr_b16 a[120:121], v27 offset:0
  buffer_load_dwordx4 v28, s[28:31], s67 offen offset:0 nt lds
  v_mfma_f32_16x16x32_bf16 a[132:135], a[244:247], v[56:59], a[132:135]
  v_mfma_f32_16x16x32_bf16 a[132:135], a[244:247], v[60:63], a[132:135]
  v_mfma_f32_16x16x32_bf16 v[104:107], a[64:67], v[136:139], v[120:123]
  v_exp_f32 v100, v100
  v_mfma_f32_16x16x32_bf16 v[104:107], a[68:71], v[168:171], v[104:107]
  ds_read_b64_tr_b16 a[122:123], v27 offset:1024
  v_cvt_pk_bf16_f32 v69, v98, v99
  v_mfma_f32_16x16x32_bf16 v[104:107], a[72:75], v[200:203], v[104:107]
  s_waitcnt lgkmcnt(9)
  v_exp_f32 v101, v101
  v_mfma_f32_16x16x32_bf16 v[104:107], a[76:79], v[232:235], v[104:107]
  ds_read_b128 a[92:95], v19 offset:19456
  v_cvt_pk_bf16_f32 v76, v100, v101
  v_mfma_f32_16x16x32_bf16 v[216:219], v[32:35], a[104:107], v[216:219]
  v_exp_f32 v102, v102
  v_mfma_f32_16x16x32_bf16 v[216:219], v[36:39], a[108:111], v[216:219]
  ds_read_b64_tr_b16 a[124:125], v27 offset:2048
  v_mfma_f32_16x16x32_bf16 v[220:223], v[44:47], a[108:111], v[220:223]
  v_exp_f32 v103, v103
  v_mfma_f32_16x16x32_bf16 v[220:223], v[40:43], a[104:107], v[220:223]
  buffer_load_dwordx4 v28, s[28:31], s67 offen offset:1024 nt lds
  v_mfma_f32_16x16x32_bf16 v[108:111], a[64:67], v[140:143], v[124:127]
  v_exp_f32 v104, v104
  v_mfma_f32_16x16x32_bf16 v[108:111], a[68:71], v[172:175], v[108:111]
  ds_read_b64_tr_b16 a[126:127], v27 offset:3072
  v_cvt_pk_bf16_f32 v77, v102, v103
  v_mfma_f32_16x16x32_bf16 v[108:111], a[72:75], v[204:207], v[108:111]
  s_waitcnt lgkmcnt(5)
  v_exp_f32 v105, v105
  v_mfma_f32_16x16x32_bf16 v[108:111], a[76:79], v[236:239], v[108:111]
  v_cvt_pk_bf16_f32 v84, v104, v105
  v_mfma_f32_16x16x32_bf16 a[40:43], v[48:51], a[104:107], a[40:43]
  v_exp_f32 v106, v106
  v_mfma_f32_16x16x32_bf16 a[40:43], v[52:55], a[108:111], a[40:43]
  v_mfma_f32_16x16x32_bf16 a[44:47], v[60:63], a[108:111], a[44:47]
  s_waitcnt vmcnt(10)
  v_exp_f32 v107, v107
  v_mfma_f32_16x16x32_bf16 a[44:47], v[56:59], a[104:107], a[44:47]
  s_waitcnt lgkmcnt(0)
  v_mfma_f32_16x16x32_bf16 v[96:99], a[80:83], v[128:131], v[112:115]
  s_barrier
  v_exp_f32 v108, v108
  v_mfma_f32_16x16x32_bf16 v[96:99], a[84:87], v[160:163], v[96:99]
  ds_read_b128 a[64:67], v16 offset:32768
  v_cvt_pk_bf16_f32 v85, v106, v107
  v_mfma_f32_16x16x32_bf16 v[96:99], a[88:91], v[192:195], v[96:99]
  s_waitcnt lgkmcnt(3)
  v_exp_f32 v109, v109
  v_mfma_f32_16x16x32_bf16 v[96:99], a[92:95], v[224:227], v[96:99]
  ds_read_b64_tr_b16 a[96:97], v20 offset:16384
  v_cvt_pk_bf16_f32 v92, v108, v109
  v_mfma_f32_16x16x32_bf16 v[240:243], v[32:35], a[112:115], v[240:243]
  v_exp_f32 v110, v110
  v_mfma_f32_16x16x32_bf16 v[240:243], v[36:39], a[116:119], v[240:243]
  ds_read_b64_tr_b16 a[98:99], v20 offset:17408
  v_mfma_f32_16x16x32_bf16 v[244:247], v[44:47], a[116:119], v[244:247]
  v_exp_f32 v111, v111
  v_mfma_f32_16x16x32_bf16 v[244:247], v[40:43], a[112:115], v[244:247]
  v_mfma_f32_16x16x32_bf16 v[100:103], a[80:83], v[132:135], v[116:119]
  v_exp_f32 v96, v96
  v_mfma_f32_16x16x32_bf16 v[100:103], a[84:87], v[164:167], v[100:103]
  ds_read_b128 a[68:71], v17 offset:32768
  v_cvt_pk_bf16_f32 v93, v110, v111
  v_mfma_f32_16x16x32_bf16 v[100:103], a[88:91], v[196:199], v[100:103]
  v_exp_f32 v97, v97
  v_mfma_f32_16x16x32_bf16 v[100:103], a[92:95], v[228:231], v[100:103]
  ds_read_b64_tr_b16 a[100:101], v20 offset:18432
  v_cvt_pk_bf16_f32 v70, v96, v97
  v_mfma_f32_16x16x32_bf16 a[48:51], v[48:51], a[112:115], a[48:51]
  v_exp_f32 v98, v98
  v_mfma_f32_16x16x32_bf16 a[48:51], v[52:55], a[116:119], a[48:51]
  ds_read_b64_tr_b16 a[102:103], v20 offset:19456
  v_mfma_f32_16x16x32_bf16 a[52:55], v[60:63], a[116:119], a[52:55]
  v_exp_f32 v99, v99
  v_mfma_f32_16x16x32_bf16 a[52:55], v[56:59], a[112:115], a[52:55]
  buffer_load_dwordx4 v28, s[28:31], s67 offen offset:2048 nt lds
  v_mfma_f32_16x16x32_bf16 a[132:135], a[240:243], v[48:51], a[132:135]
  v_mfma_f32_16x16x32_bf16 a[132:135], a[240:243], v[52:55], a[132:135]
  v_mfma_f32_16x16x32_bf16 v[104:107], a[80:83], v[136:139], v[120:123]
  v_exp_f32 v100, v100
  v_mfma_f32_16x16x32_bf16 v[104:107], a[84:87], v[168:171], v[104:107]
  ds_read_b128 a[72:75], v18 offset:32768
  v_cvt_pk_bf16_f32 v71, v98, v99
  v_mfma_f32_16x16x32_bf16 v[104:107], a[88:91], v[200:203], v[104:107]
  s_waitcnt lgkmcnt(7)
  v_exp_f32 v101, v101
  v_mfma_f32_16x16x32_bf16 v[104:107], a[92:95], v[232:235], v[104:107]
  ds_read_b64_tr_b16 a[104:105], v21 offset:16384
  v_cvt_pk_bf16_f32 v78, v100, v101
  v_mfma_f32_16x16x32_bf16 v[248:251], v[32:35], a[120:123], v[248:251]
  v_exp_f32 v102, v102
  v_mfma_f32_16x16x32_bf16 v[248:251], v[36:39], a[124:127], v[248:251]
  ds_read_b64_tr_b16 a[106:107], v21 offset:17408
  v_mfma_f32_16x16x32_bf16 v[252:255], v[44:47], a[124:127], v[252:255]
  v_exp_f32 v103, v103
  v_mfma_f32_16x16x32_bf16 v[252:255], v[40:43], a[120:123], v[252:255]
  v_mfma_f32_16x16x32_bf16 v[108:111], a[80:83], v[140:143], v[124:127]
  v_exp_f32 v104, v104
  v_mfma_f32_16x16x32_bf16 v[108:111], a[84:87], v[172:175], v[108:111]
  ds_read_b128 a[76:79], v19 offset:32768
  v_cvt_pk_bf16_f32 v79, v102, v103
  v_mfma_f32_16x16x32_bf16 v[108:111], a[88:91], v[204:207], v[108:111]
  s_waitcnt lgkmcnt(3)
  v_exp_f32 v105, v105
  v_mfma_f32_16x16x32_bf16 v[108:111], a[92:95], v[236:239], v[108:111]
  ds_read_b64_tr_b16 a[108:109], v21 offset:18432
  v_cvt_pk_bf16_f32 v86, v104, v105
  v_mfma_f32_16x16x32_bf16 a[56:59], v[48:51], a[120:123], a[56:59]
  v_exp_f32 v106, v106
  v_mfma_f32_16x16x32_bf16 a[56:59], v[52:55], a[124:127], a[56:59]
  ds_read_b64_tr_b16 a[110:111], v21 offset:19456
  v_mfma_f32_16x16x32_bf16 a[60:63], v[60:63], a[124:127], a[60:63]
  v_exp_f32 v107, v107
  v_mfma_f32_16x16x32_bf16 a[60:63], v[56:59], a[120:123], a[60:63]
  v_cvt_pk_bf16_f32 v87, v106, v107
  v_mfma_f32_16x16x32_bf16 v[96:99], a[64:67], v[128:131], v[112:115]
  v_exp_f32 v108, v108
  v_mfma_f32_16x16x32_bf16 v[96:99], a[68:71], v[160:163], v[96:99]
  ds_read_b128 a[80:83], v16 offset:33792
  v_mfma_f32_16x16x32_bf16 v[96:99], a[72:75], v[192:195], v[96:99]
  s_waitcnt lgkmcnt(3)
  v_exp_f32 v109, v109
  v_mfma_f32_16x16x32_bf16 v[96:99], a[76:79], v[224:227], v[96:99]
  ds_read_b64_tr_b16 a[112:113], v22 offset:16384
  v_cvt_pk_bf16_f32 v94, v108, v109
  v_mfma_f32_16x16x32_bf16 v[144:147], v[64:67], a[96:99], v[144:147]
  v_exp_f32 v110, v110
  v_mfma_f32_16x16x32_bf16 v[144:147], v[68:71], a[100:103], v[144:147]
  ds_read_b64_tr_b16 a[114:115], v22 offset:17408
  v_mfma_f32_16x16x32_bf16 v[148:151], v[76:79], a[100:103], v[148:151]
  v_exp_f32 v111, v111
  v_mfma_f32_16x16x32_bf16 v[148:151], v[72:75], a[96:99], v[148:151]
  v_mfma_f32_16x16x32_bf16 v[100:103], a[64:67], v[132:135], v[116:119]
  v_exp_f32 v96, v96
  v_mfma_f32_16x16x32_bf16 v[100:103], a[68:71], v[164:167], v[100:103]
  ds_read_b128 a[84:87], v17 offset:33792
  v_cvt_pk_bf16_f32 v95, v110, v111
  v_mfma_f32_16x16x32_bf16 v[100:103], a[72:75], v[196:199], v[100:103]
  v_exp_f32 v97, v97
  v_mfma_f32_16x16x32_bf16 v[100:103], a[76:79], v[228:231], v[100:103]
  ds_read_b64_tr_b16 a[116:117], v22 offset:18432
  v_cvt_pk_bf16_f32 v32, v96, v97
  v_mfma_f32_16x16x32_bf16 a[0:3], v[80:83], a[96:99], a[0:3]
  v_exp_f32 v98, v98
  v_mfma_f32_16x16x32_bf16 a[0:3], v[84:87], a[100:103], a[0:3]
  ds_read_b64_tr_b16 a[118:119], v22 offset:19456
  v_mfma_f32_16x16x32_bf16 a[4:7], v[92:95], a[100:103], a[4:7]
  v_exp_f32 v99, v99
  v_mfma_f32_16x16x32_bf16 a[4:7], v[88:91], a[96:99], a[4:7]
  buffer_load_dwordx4 v28, s[28:31], s67 offen offset:3072 nt lds
  v_mfma_f32_16x16x32_bf16 v[104:107], a[64:67], v[136:139], v[120:123]
  s_add_u32 s83, s18, 12288
  v_exp_f32 v100, v100
  v_mfma_f32_16x16x32_bf16 v[104:107], a[68:71], v[168:171], v[104:107]
  ds_read_b128 a[88:91], v18 offset:33792
  v_cvt_pk_bf16_f32 v33, v98, v99
  v_mfma_f32_16x16x32_bf16 v[104:107], a[72:75], v[200:203], v[104:107]
  s_waitcnt lgkmcnt(7)
  v_exp_f32 v101, v101
  v_mfma_f32_16x16x32_bf16 v[104:107], a[76:79], v[232:235], v[104:107]
  ds_read_b64_tr_b16 a[120:121], v23 offset:16384
  v_cvt_pk_bf16_f32 v40, v100, v101
  v_mfma_f32_16x16x32_bf16 v[152:155], v[64:67], a[104:107], v[152:155]
  v_exp_f32 v102, v102
  v_mfma_f32_16x16x32_bf16 v[152:155], v[68:71], a[108:111], v[152:155]
  ds_read_b64_tr_b16 a[122:123], v23 offset:17408
  buffer_load_dwordx4 a[188:191], v1, s[44:47], s83 offen offset:0 sc1
  v_mfma_f32_16x16x32_bf16 v[156:159], v[76:79], a[108:111], v[156:159]
  v_exp_f32 v103, v103
  v_mfma_f32_16x16x32_bf16 v[156:159], v[72:75], a[104:107], v[156:159]
  buffer_load_dwordx4 a[192:195], v1, s[44:47], s83 offen offset:1024 sc1
  v_mfma_f32_16x16x32_bf16 v[108:111], a[64:67], v[140:143], v[124:127]
  v_exp_f32 v104, v104
  v_mfma_f32_16x16x32_bf16 v[108:111], a[68:71], v[172:175], v[108:111]
  ds_read_b128 a[92:95], v19 offset:33792
  v_cvt_pk_bf16_f32 v41, v102, v103
  v_mfma_f32_16x16x32_bf16 v[108:111], a[72:75], v[204:207], v[108:111]
  s_waitcnt lgkmcnt(3)
  v_exp_f32 v105, v105
  v_mfma_f32_16x16x32_bf16 v[108:111], a[76:79], v[236:239], v[108:111]
  ds_read_b64_tr_b16 a[124:125], v23 offset:18432
  v_cvt_pk_bf16_f32 v48, v104, v105
  v_mfma_f32_16x16x32_bf16 a[8:11], v[80:83], a[104:107], a[8:11]
  v_exp_f32 v106, v106
  v_mfma_f32_16x16x32_bf16 a[8:11], v[84:87], a[108:111], a[8:11]
  s_xor_b32 s68, s10, 184320
  ds_read_b64_tr_b16 a[126:127], v23 offset:19456
  buffer_load_dwordx4 a[196:199], v1, s[44:47], s83 offen offset:2048 sc1
  v_mfma_f32_16x16x32_bf16 a[12:15], v[92:95], a[108:111], a[12:15]
  s_add_u32 m0, s63, 114688
  v_exp_f32 v107, v107
  v_mfma_f32_16x16x32_bf16 a[12:15], v[88:91], a[104:107], a[12:15]
  buffer_load_dwordx4 v29, s[32:35], s68 offen offset:0 nt lds
  v_smfmac_f32_16x16x64_bf16 a[128:131], a[136:139], v[72:79], v30
  v_mfma_f32_16x16x32_bf16 v[96:99], a[80:83], v[128:131], v[112:115]
  v_exp_f32 v108, v108
  v_mfma_f32_16x16x32_bf16 v[96:99], a[84:87], v[160:163], v[96:99]
  ds_read_b128 a[64:67], v16 offset:34816
  v_cvt_pk_bf16_f32 v49, v106, v107
  v_mfma_f32_16x16x32_bf16 v[96:99], a[88:91], v[192:195], v[96:99]
  s_waitcnt lgkmcnt(3)
  v_exp_f32 v109, v109
  v_mfma_f32_16x16x32_bf16 v[96:99], a[92:95], v[224:227], v[96:99]
  ds_read_b64_tr_b16 a[96:97], v24 offset:16384
  v_cvt_pk_bf16_f32 v56, v108, v109
  v_mfma_f32_16x16x32_bf16 v[176:179], v[64:67], a[112:115], v[176:179]
  v_exp_f32 v110, v110
  v_mfma_f32_16x16x32_bf16 v[176:179], v[68:71], a[116:119], v[176:179]
  ds_read_b64_tr_b16 a[98:99], v24 offset:17408
  v_mfma_f32_16x16x32_bf16 v[180:183], v[76:79], a[116:119], v[180:183]
  v_exp_f32 v111, v111
  v_mfma_f32_16x16x32_bf16 v[180:183], v[72:75], a[112:115], v[180:183]
  buffer_load_dwordx4 v29, s[32:35], s68 offen offset:1024 nt lds
  v_mfma_f32_16x16x32_bf16 v[100:103], a[80:83], v[132:135], v[116:119]
  v_exp_f32 v96, v96
  v_mfma_f32_16x16x32_bf16 v[100:103], a[84:87], v[164:167], v[100:103]
  ds_read_b128 a[68:71], v17 offset:34816
  v_cvt_pk_bf16_f32 v57, v110, v111
  v_mfma_f32_16x16x32_bf16 v[100:103], a[88:91], v[196:199], v[100:103]
  v_exp_f32 v97, v97
  v_mfma_f32_16x16x32_bf16 v[100:103], a[92:95], v[228:231], v[100:103]
  ds_read_b64_tr_b16 a[100:101], v24 offset:18432
  v_cvt_pk_bf16_f32 v34, v96, v97
  v_mfma_f32_16x16x32_bf16 a[16:19], v[80:83], a[112:115], a[16:19]
  v_exp_f32 v98, v98
  v_mfma_f32_16x16x32_bf16 a[16:19], v[84:87], a[116:119], a[16:19]
  ds_read_b64_tr_b16 a[102:103], v24 offset:19456
  v_mfma_f32_16x16x32_bf16 a[20:23], v[92:95], a[116:119], a[20:23]
  v_exp_f32 v99, v99
  v_mfma_f32_16x16x32_bf16 a[20:23], v[88:91], a[112:115], a[20:23]
  buffer_load_dwordx4 a[200:203], v1, s[44:47], s83 offen offset:3072 sc1
  v_mfma_f32_16x16x32_bf16 v[104:107], a[80:83], v[136:139], v[120:123]
  v_exp_f32 v100, v100
  v_mfma_f32_16x16x32_bf16 v[104:107], a[84:87], v[168:171], v[104:107]
  ds_read_b128 a[72:75], v18 offset:34816
  v_cvt_pk_bf16_f32 v35, v98, v99
  v_mfma_f32_16x16x32_bf16 v[104:107], a[88:91], v[200:203], v[104:107]
  s_waitcnt lgkmcnt(7)
  v_exp_f32 v101, v101
  v_mfma_f32_16x16x32_bf16 v[104:107], a[92:95], v[232:235], v[104:107]
  ds_read_b64_tr_b16 a[104:105], v25 offset:16384
  v_cvt_pk_bf16_f32 v42, v100, v101
  v_mfma_f32_16x16x32_bf16 v[184:187], v[64:67], a[120:123], v[184:187]
  v_exp_f32 v102, v102
  v_mfma_f32_16x16x32_bf16 v[184:187], v[68:71], a[124:127], v[184:187]
  ds_read_b64_tr_b16 a[106:107], v25 offset:17408
  v_mfma_f32_16x16x32_bf16 v[188:191], v[76:79], a[124:127], v[188:191]
  v_exp_f32 v103, v103
  v_mfma_f32_16x16x32_bf16 v[188:191], v[72:75], a[120:123], v[188:191]
  buffer_load_dwordx4 v29, s[32:35], s68 offen offset:2048 nt lds
  v_smfmac_f32_16x16x64_bf16 a[128:131], a[252:255], v[64:71], v30
  v_mfma_f32_16x16x32_bf16 v[108:111], a[80:83], v[140:143], v[124:127]
  v_exp_f32 v104, v104
  v_mfma_f32_16x16x32_bf16 v[108:111], a[84:87], v[172:175], v[108:111]
  ds_read_b128 a[76:79], v19 offset:34816
  v_cvt_pk_bf16_f32 v43, v102, v103
  v_mfma_f32_16x16x32_bf16 v[108:111], a[88:91], v[204:207], v[108:111]
  s_waitcnt lgkmcnt(3)
  v_exp_f32 v105, v105
  v_mfma_f32_16x16x32_bf16 v[108:111], a[92:95], v[236:239], v[108:111]
  ds_read_b64_tr_b16 a[108:109], v25 offset:18432
  v_cvt_pk_bf16_f32 v50, v104, v105
  v_mfma_f32_16x16x32_bf16 a[24:27], v[80:83], a[120:123], a[24:27]
  v_exp_f32 v106, v106
  v_mfma_f32_16x16x32_bf16 a[24:27], v[84:87], a[124:127], a[24:27]
  ds_read_b64_tr_b16 a[110:111], v25 offset:19456
  v_mfma_f32_16x16x32_bf16 a[28:31], v[92:95], a[124:127], a[28:31]
  v_exp_f32 v107, v107
  v_mfma_f32_16x16x32_bf16 a[28:31], v[88:91], a[120:123], a[28:31]
  buffer_load_dwordx4 v29, s[32:35], s68 offen offset:3072 nt lds
  v_mfma_f32_16x16x32_bf16 v[96:99], a[64:67], v[128:131], v[112:115]
  s_add_u32 s87, s18, 28672
  v_exp_f32 v108, v108
  v_mfma_f32_16x16x32_bf16 v[96:99], a[68:71], v[160:163], v[96:99]
  s_add_u32 m0, s63, 131072
  ds_read_b128 a[80:83], v16 offset:35840
  v_cvt_pk_bf16_f32 v51, v106, v107
  v_mfma_f32_16x16x32_bf16 v[96:99], a[72:75], v[192:195], v[96:99]
  s_waitcnt lgkmcnt(3)
  v_exp_f32 v109, v109
  v_mfma_f32_16x16x32_bf16 v[96:99], a[76:79], v[224:227], v[96:99]
  ds_read_b64_tr_b16 a[112:113], v26 offset:16384
  v_cvt_pk_bf16_f32 v58, v108, v109
  v_mfma_f32_16x16x32_bf16 v[208:211], v[64:67], a[96:99], v[208:211]
  v_exp_f32 v110, v110
  v_mfma_f32_16x16x32_bf16 v[208:211], v[68:71], a[100:103], v[208:211]
  ds_read_b64_tr_b16 a[114:115], v26 offset:17408
  ds_read_b128 a[84:87], v17 offset:35840
  v_mfma_f32_16x16x32_bf16 v[212:215], v[76:79], a[100:103], v[212:215]
  v_exp_f32 v111, v111
  v_mfma_f32_16x16x32_bf16 v[212:215], v[72:75], a[96:99], v[212:215]
  buffer_load_dwordx4 v1, s[44:47], s87 offen offset:0 sc1 lds
  v_mfma_f32_16x16x32_bf16 v[100:103], a[64:67], v[132:135], v[116:119]
  v_exp_f32 v96, v96
  v_mfma_f32_16x16x32_bf16 v[100:103], a[68:71], v[164:167], v[100:103]
  ds_read_b64_tr_b16 a[116:117], v26 offset:18432
  v_cvt_pk_bf16_f32 v59, v110, v111
  v_mfma_f32_16x16x32_bf16 v[100:103], a[72:75], v[196:199], v[100:103]
  v_exp_f32 v97, v97
  v_mfma_f32_16x16x32_bf16 v[100:103], a[76:79], v[228:231], v[100:103]
  ds_read_b64_tr_b16 a[118:119], v26 offset:19456
  v_cvt_pk_bf16_f32 v36, v96, v97
  v_mfma_f32_16x16x32_bf16 a[32:35], v[80:83], a[96:99], a[32:35]
  v_exp_f32 v98, v98
  v_mfma_f32_16x16x32_bf16 a[32:35], v[84:87], a[100:103], a[32:35]
  ds_read_b128 a[88:91], v18 offset:35840
  buffer_load_dwordx4 v1, s[44:47], s87 offen offset:1024 sc1 lds
  v_mfma_f32_16x16x32_bf16 a[36:39], v[92:95], a[100:103], a[36:39]
  v_exp_f32 v99, v99
  v_mfma_f32_16x16x32_bf16 a[36:39], v[88:91], a[96:99], a[36:39]
  ds_read_b64_tr_b16 a[120:121], v27 offset:16384
  buffer_load_dwordx4 v1, s[44:47], s87 offen offset:2048 sc1 lds
  v_smfmac_f32_16x16x64_bf16 a[132:135], a[136:139], v[88:95], v30
  buffer_load_dwordx4 v1, s[44:47], s87 offen offset:3072 sc1 lds
  v_mfma_f32_16x16x32_bf16 v[104:107], a[64:67], v[136:139], v[120:123]
  s_add_u32 s88, s18, 32768
  v_exp_f32 v100, v100
  v_mfma_f32_16x16x32_bf16 v[104:107], a[68:71], v[168:171], v[104:107]
  s_add_u32 m0, s63, 147456
  ds_read_b64_tr_b16 a[122:123], v27 offset:17408
  v_cvt_pk_bf16_f32 v37, v98, v99
  v_mfma_f32_16x16x32_bf16 v[104:107], a[72:75], v[200:203], v[104:107]
  s_waitcnt lgkmcnt(9)
  v_exp_f32 v101, v101
  v_mfma_f32_16x16x32_bf16 v[104:107], a[76:79], v[232:235], v[104:107]
  ds_read_b128 a[92:95], v19 offset:35840
  v_cvt_pk_bf16_f32 v44, v100, v101
  v_mfma_f32_16x16x32_bf16 v[216:219], v[64:67], a[104:107], v[216:219]
  v_exp_f32 v102, v102
  v_mfma_f32_16x16x32_bf16 v[216:219], v[68:71], a[108:111], v[216:219]
  ds_read_b64_tr_b16 a[124:125], v27 offset:18432
  buffer_load_dwordx4 v1, s[44:47], s88 offen offset:0 sc1 lds
  v_mfma_f32_16x16x32_bf16 v[220:223], v[76:79], a[108:111], v[220:223]
  v_exp_f32 v103, v103
  v_mfma_f32_16x16x32_bf16 v[220:223], v[72:75], a[104:107], v[220:223]
  buffer_load_dwordx4 v1, s[44:47], s88 offen offset:1024 sc1 lds
  v_mfma_f32_16x16x32_bf16 v[108:111], a[64:67], v[140:143], v[124:127]
  v_exp_f32 v104, v104
  v_mfma_f32_16x16x32_bf16 v[108:111], a[68:71], v[172:175], v[108:111]
  ds_read_b64_tr_b16 a[126:127], v27 offset:19456
  v_cvt_pk_bf16_f32 v45, v102, v103
  v_mfma_f32_16x16x32_bf16 v[108:111], a[72:75], v[204:207], v[108:111]
  s_waitcnt lgkmcnt(5)
  v_exp_f32 v105, v105
  v_mfma_f32_16x16x32_bf16 v[108:111], a[76:79], v[236:239], v[108:111]
  v_cvt_pk_bf16_f32 v52, v104, v105
  v_mfma_f32_16x16x32_bf16 a[40:43], v[80:83], a[104:107], a[40:43]
  v_exp_f32 v106, v106
  v_mfma_f32_16x16x32_bf16 a[40:43], v[84:87], a[108:111], a[40:43]
  buffer_load_dwordx4 v1, s[44:47], s88 offen offset:2048 sc1 lds
  v_mfma_f32_16x16x32_bf16 a[44:47], v[92:95], a[108:111], a[44:47]
  s_waitcnt vmcnt(15)
  v_exp_f32 v107, v107
  v_mfma_f32_16x16x32_bf16 a[44:47], v[88:91], a[104:107], a[44:47]
  s_waitcnt lgkmcnt(0)
  buffer_load_dwordx4 v1, s[44:47], s88 offen offset:3072 sc1 lds
  v_mfma_f32_16x16x32_bf16 v[96:99], a[80:83], v[128:131], v[112:115]
  s_barrier
  v_exp_f32 v108, v108
  v_mfma_f32_16x16x32_bf16 v[96:99], a[84:87], v[160:163], v[96:99]
  s_add_u32 s89, s18, 36864
  ds_read_b128 a[64:67], v16 offset:49152
  v_cvt_pk_bf16_f32 v53, v106, v107
  v_mfma_f32_16x16x32_bf16 v[96:99], a[88:91], v[192:195], v[96:99]
  s_waitcnt lgkmcnt(3)
  v_exp_f32 v109, v109
  v_mfma_f32_16x16x32_bf16 v[96:99], a[92:95], v[224:227], v[96:99]
  s_add_u32 m0, s63, 0
  ds_read_b64_tr_b16 a[96:97], v20 offset:32768
  v_cvt_pk_bf16_f32 v60, v108, v109
  v_mfma_f32_16x16x32_bf16 v[240:243], v[64:67], a[112:115], v[240:243]
  v_exp_f32 v110, v110
  v_mfma_f32_16x16x32_bf16 v[240:243], v[68:71], a[116:119], v[240:243]
  ds_read_b64_tr_b16 a[98:99], v20 offset:33792
  buffer_load_dwordx4 v1, s[44:47], s89 offen offset:0 sc1 lds
  v_mfma_f32_16x16x32_bf16 v[244:247], v[76:79], a[116:119], v[244:247]
  v_exp_f32 v111, v111
  v_mfma_f32_16x16x32_bf16 v[244:247], v[72:75], a[112:115], v[244:247]
  buffer_load_dwordx4 v1, s[44:47], s89 offen offset:1024 sc1 lds
  v_mfma_f32_16x16x32_bf16 v[100:103], a[80:83], v[132:135], v[116:119]
  v_exp_f32 v96, v96
  v_mfma_f32_16x16x32_bf16 v[100:103], a[84:87], v[164:167], v[100:103]
  ds_read_b128 a[68:71], v17 offset:49152
  v_cvt_pk_bf16_f32 v61, v110, v111
  v_mfma_f32_16x16x32_bf16 v[100:103], a[88:91], v[196:199], v[100:103]
L_hop10:
  s_cbranch_execz L_hopback
  v_exp_f32 v97, v97
  v_mfma_f32_16x16x32_bf16 v[100:103], a[92:95], v[228:231], v[100:103]
  ds_read_b64_tr_b16 a[100:101], v20 offset:34816
  v_cvt_pk_bf16_f32 v38, v96, v97
  v_mfma_f32_16x16x32_bf16 a[48:51], v[80:83], a[112:115], a[48:51]
  v_exp_f32 v98, v98
  v_mfma_f32_16x16x32_bf16 a[48:51], v[84:87], a[116:119], a[48:51]
  ds_read_b64_tr_b16 a[102:103], v20 offset:35840
  buffer_load_dwordx4 v1, s[44:47], s89 offen offset:2048 sc1 lds
  v_mfma_f32_16x16x32_bf16 a[52:55], v[92:95], a[116:119], a[52:55]
  v_exp_f32 v99, v99
  v_mfma_f32_16x16x32_bf16 a[52:55], v[88:91], a[112:115], a[52:55]
  buffer_load_dwordx4 v1, s[44:47], s89 offen offset:3072 sc1 lds
  v_smfmac_f32_16x16x64_bf16 a[132:135], a[252:255], v[80:87], v30
  v_mfma_f32_16x16x32_bf16 v[104:107], a[80:83], v[136:139], v[120:123]
  s_add_u32 s80, s18, 40960
  v_exp_f32 v100, v100
  v_mfma_f32_16x16x32_bf16 v[104:107], a[84:87], v[168:171], v[104:107]
  s_add_u32 m0, s63, 16384
  ds_read_b128 a[72:75], v18 offset:49152
  v_cvt_pk_bf16_f32 v39, v98, v99
  v_mfma_f32_16x16x32_bf16 v[104:107], a[88:91], v[200:203], v[104:107]
  s_waitcnt lgkmcnt(7)
  v_exp_f32 v101, v101
  v_mfma_f32_16x16x32_bf16 v[104:107], a[92:95], v[232:235], v[104:107]
  ds_read_b64_tr_b16 a[104:105], v21 offset:32768
  v_cvt_pk_bf16_f32 v46, v100, v101
  v_mfma_f32_16x16x32_bf16 v[248:251], v[64:67], a[120:123], v[248:251]
  v_exp_f32 v102, v102
  v_mfma_f32_16x16x32_bf16 v[248:251], v[68:71], a[124:127], v[248:251]
  ds_read_b64_tr_b16 a[106:107], v21 offset:33792
  buffer_load_dwordx4 v1, s[44:47], s80 offen offset:0 sc1 lds
  v_mfma_f32_16x16x32_bf16 v[252:255], v[76:79], a[124:127], v[252:255]
  v_exp_f32 v103, v103
  v_mfma_f32_16x16x32_bf16 v[252:255], v[72:75], a[120:123], v[252:255]
  buffer_load_dwordx4 v1, s[44:47], s80 offen offset:1024 sc1 lds
  v_mfma_f32_16x16x32_bf16 v[108:111], a[80:83], v[140:143], v[124:127]
  v_exp_f32 v104, v104
  v_mfma_f32_16x16x32_bf16 v[108:111], a[84:87], v[172:175], v[108:111]
  ds_read_b128 a[76:79], v19 offset:49152
  v_cvt_pk_bf16_f32 v47, v102, v103
  v_mfma_f32_16x16x32_bf16 v[108:111], a[88:91], v[204:207], v[108:111]
  s_waitcnt lgkmcnt(3)
  v_exp_f32 v105, v105
  v_mfma_f32_16x16x32_bf16 v[108:111], a[92:95], v[236:239], v[108:111]
  ds_read_b64_tr_b16 a[108:109], v21 offset:34816
  v_cvt_pk_bf16_f32 v54, v104, v105
  v_mfma_f32_16x16x32_bf16 a[56:59], v[80:83], a[120:123], a[56:59]
  v_exp_f32 v106, v106
  v_mfma_f32_16x16x32_bf16 a[56:59], v[84:87], a[124:127], a[56:59]
  ds_read_b64_tr_b16 a[110:111], v21 offset:35840
  buffer_load_dwordx4 v1, s[44:47], s80 offen offset:2048 sc1 lds
  v_mfma_f32_16x16x32_bf16 a[60:63], v[92:95], a[124:127], a[60:63]
  v_exp_f32 v107, v107
  v_mfma_f32_16x16x32_bf16 a[60:63], v[88:91], a[120:123], a[60:63]
  buffer_load_dwordx4 v1, s[44:47], s80 offen offset:3072 sc1 lds
  v_cvt_pk_bf16_f32 v55, v106, v107
  v_mfma_f32_16x16x32_bf16 v[96:99], a[64:67], v[128:131], v[112:115]
  s_add_u32 s81, s18, 45056
  v_exp_f32 v108, v108
  v_mfma_f32_16x16x32_bf16 v[96:99], a[68:71], v[160:163], v[96:99]
  s_add_u32 m0, s63, 65536
  ds_read_b128 a[80:83], v16 offset:50176
  v_mfma_f32_16x16x32_bf16 v[96:99], a[72:75], v[192:195], v[96:99]
  s_waitcnt lgkmcnt(3)
  v_exp_f32 v109, v109
  v_mfma_f32_16x16x32_bf16 v[96:99], a[76:79], v[224:227], v[96:99]
  ds_read_b64_tr_b16 a[112:113], v22 offset:32768
  buffer_load_dwordx4 v1, s[44:47], s81 offen offset:0 sc1 lds
  v_cvt_pk_bf16_f32 v62, v108, v109
  v_mfma_f32_16x16x32_bf16 v[144:147], v[32:35], a[96:99], v[144:147]
  v_exp_f32 v110, v110
  v_mfma_f32_16x16x32_bf16 v[144:147], v[36:39], a[100:103], v[144:147]
  ds_read_b64_tr_b16 a[114:115], v22 offset:33792
  buffer_load_dwordx4 v1, s[44:47], s81 offen offset:1024 sc1 lds
  v_mfma_f32_16x16x32_bf16 v[148:151], v[44:47], a[100:103], v[148:151]
  v_exp_f32 v111, v111
  v_mfma_f32_16x16x32_bf16 v[148:151], v[40:43], a[96:99], v[148:151]
  buffer_load_dwordx4 v1, s[44:47], s81 offen offset:2048 sc1 lds
  v_mfma_f32_16x16x32_bf16 v[100:103], a[64:67], v[132:135], v[116:119]
  v_exp_f32 v96, v96
  v_mfma_f32_16x16x32_bf16 v[100:103], a[68:71], v[164:167], v[100:103]
  ds_read_b128 a[84:87], v17 offset:50176
  v_cvt_pk_bf16_f32 v63, v110, v111
  v_mfma_f32_16x16x32_bf16 v[100:103], a[72:75], v[196:199], v[100:103]
  v_exp_f32 v97, v97
  v_mfma_f32_16x16x32_bf16 v[100:103], a[76:79], v[228:231], v[100:103]
  ds_read_b64_tr_b16 a[116:117], v22 offset:34816
  v_cvt_pk_bf16_f32 v64, v96, v97
  v_mfma_f32_16x16x32_bf16 a[0:3], v[48:51], a[96:99], a[0:3]
  v_exp_f32 v98, v98
  v_mfma_f32_16x16x32_bf16 a[0:3], v[52:55], a[100:103], a[0:3]
  ds_read_b64_tr_b16 a[118:119], v22 offset:35840
  v_and_b32 v9, 1, v0
  v_mfma_f32_16x16x32_bf16 a[4:7], v[60:63], a[100:103], a[4:7]
  v_exp_f32 v99, v99
  v_mfma_f32_16x16x32_bf16 a[4:7], v[56:59], a[96:99], a[4:7]
  buffer_load_dwordx4 v1, s[44:47], s81 offen offset:3072 sc1 lds
  v_mfma_f32_16x16x32_bf16 v[104:107], a[64:67], v[136:139], v[120:123]
  s_add_u32 s82, s18, 49152
  v_exp_f32 v100, v100
  v_mfma_f32_16x16x32_bf16 v[104:107], a[68:71], v[168:171], v[104:107]
  s_add_u32 m0, s63, 32768
  ds_read_b128 a[88:91], v18 offset:50176
  v_cvt_pk_bf16_f32 v65, v98, v99
  v_mfma_f32_16x16x32_bf16 v[104:107], a[72:75], v[200:203], v[104:107]
  s_waitcnt lgkmcnt(7)
  v_exp_f32 v101, v101
  v_mfma_f32_16x16x32_bf16 v[104:107], a[76:79], v[232:235], v[104:107]
  ds_read_b64_tr_b16 a[120:121], v23 offset:32768
  buffer_load_dwordx4 v1, s[44:47], s82 offen offset:0 sc1 lds
  v_cvt_pk_bf16_f32 v72, v100, v101
  v_mfma_f32_16x16x32_bf16 v[152:155], v[32:35], a[104:107], v[152:155]
  v_exp_f32 v102, v102
  v_mfma_f32_16x16x32_bf16 v[152:155], v[36:39], a[108:111], v[152:155]
  ds_read_b64_tr_b16 a[122:123], v23 offset:33792
  v_lshlrev_b32 v9, 6, v9
  v_mfma_f32_16x16x32_bf16 v[156:159], v[44:47], a[108:111], v[156:159]
  v_exp_f32 v103, v103
  v_mfma_f32_16x16x32_bf16 v[156:159], v[40:43], a[104:107], v[156:159]
  buffer_load_dwordx4 v1, s[44:47], s82 offen offset:1024 sc1 lds
  v_mfma_f32_16x16x32_bf16 v[108:111], a[64:67], v[140:143], v[124:127]
  v_exp_f32 v104, v104
  v_mfma_f32_16x16x32_bf16 v[108:111], a[68:71], v[172:175], v[108:111]
  ds_read_b128 a[92:95], v19 offset:50176
  v_cvt_pk_bf16_f32 v73, v102, v103
  v_mfma_f32_16x16x32_bf16 v[108:111], a[72:75], v[204:207], v[108:111]
  s_waitcnt lgkmcnt(3)
  v_exp_f32 v105, v105
  v_mfma_f32_16x16x32_bf16 v[108:111], a[76:79], v[236:239], v[108:111]
  ds_read_b64_tr_b16 a[124:125], v23 offset:34816
  v_cvt_pk_bf16_f32 v80, v104, v105
  v_mfma_f32_16x16x32_bf16 a[8:11], v[48:51], a[104:107], a[8:11]
  v_exp_f32 v106, v106
  v_mfma_f32_16x16x32_bf16 a[8:11], v[52:55], a[108:111], a[8:11]
  ds_read_b64_tr_b16 a[126:127], v23 offset:35840
  v_and_b32 v10, 48, v0
  v_mfma_f32_16x16x32_bf16 a[12:15], v[60:63], a[108:111], a[12:15]
  v_exp_f32 v107, v107
  v_mfma_f32_16x16x32_bf16 a[12:15], v[56:59], a[104:107], a[12:15]
  buffer_load_dwordx4 v1, s[44:47], s82 offen offset:2048 sc1 lds
  v_smfmac_f32_16x16x64_bf16 a[128:131], a[136:139], v[40:47], v30
  buffer_load_dwordx4 v1, s[44:47], s82 offen offset:3072 sc1 lds
  v_mfma_f32_16x16x32_bf16 v[96:99], a[80:83], v[128:131], v[112:115]
  s_add_u32 s83, s18, 53248
  v_exp_f32 v108, v108
  v_mfma_f32_16x16x32_bf16 v[96:99], a[84:87], v[160:163], v[96:99]
  s_add_u32 m0, s63, 81920
  ds_read_b128 a[64:67], v16 offset:51200
  v_cvt_pk_bf16_f32 v81, v106, v107
  v_mfma_f32_16x16x32_bf16 v[96:99], a[88:91], v[192:195], v[96:99]
  s_waitcnt lgkmcnt(3)
  v_exp_f32 v109, v109
  v_mfma_f32_16x16x32_bf16 v[96:99], a[92:95], v[224:227], v[96:99]
  ds_read_b64_tr_b16 a[96:97], v24 offset:32768
  buffer_load_dwordx4 v1, s[44:47], s83 offen offset:0 sc1 lds
  v_cvt_pk_bf16_f32 v88, v108, v109
  v_mfma_f32_16x16x32_bf16 v[176:179], v[32:35], a[112:115], v[176:179]
  v_exp_f32 v110, v110
  v_mfma_f32_16x16x32_bf16 v[176:179], v[36:39], a[116:119], v[176:179]
  ds_read_b64_tr_b16 a[98:99], v24 offset:33792
  v_sub_u32 v10, v10, v9
  v_mfma_f32_16x16x32_bf16 v[180:183], v[44:47], a[116:119], v[180:183]
  v_exp_f32 v111, v111
  v_mfma_f32_16x16x32_bf16 v[180:183], v[40:43], a[112:115], v[180:183]
  buffer_load_dwordx4 v1, s[44:47], s83 offen offset:1024 sc1 lds
  v_mfma_f32_16x16x32_bf16 v[100:103], a[80:83], v[132:135], v[116:119]
  v_exp_f32 v96, v96
  v_mfma_f32_16x16x32_bf16 v[100:103], a[84:87], v[164:167], v[100:103]
  ds_read_b128 a[68:71], v17 offset:51200
  v_cvt_pk_bf16_f32 v89, v110, v111
  v_mfma_f32_16x16x32_bf16 v[100:103], a[88:91], v[196:199], v[100:103]
  v_exp_f32 v97, v97
  v_mfma_f32_16x16x32_bf16 v[100:103], a[92:95], v[228:231], v[100:103]
  ds_read_b64_tr_b16 a[100:101], v24 offset:34816
  buffer_load_dwordx4 v1, s[44:47], s83 offen offset:2048 sc1 lds
  v_cvt_pk_bf16_f32 v66, v96, v97
  v_mfma_f32_16x16x32_bf16 a[16:19], v[48:51], a[112:115], a[16:19]
  v_exp_f32 v98, v98
  v_mfma_f32_16x16x32_bf16 a[16:19], v[52:55], a[116:119], a[16:19]
  ds_read_b64_tr_b16 a[102:103], v24 offset:35840
  v_add_u32 v10, 64, v10
  v_mfma_f32_16x16x32_bf16 a[20:23], v[60:63], a[116:119], a[20:23]
  v_exp_f32 v99, v99
  v_mfma_f32_16x16x32_bf16 a[20:23], v[56:59], a[112:115], a[20:23]
  buffer_load_dwordx4 v1, s[44:47], s83 offen offset:3072 sc1 lds
  v_mfma_f32_16x16x32_bf16 v[104:107], a[80:83], v[136:139], v[120:123]
  s_add_u32 s84, s18, 16384
  v_exp_f32 v100, v100
  v_mfma_f32_16x16x32_bf16 v[104:107], a[84:87], v[168:171], v[104:107]
  ds_read_b128 a[72:75], v18 offset:51200
  v_cvt_pk_bf16_f32 v67, v98, v99
  v_mfma_f32_16x16x32_bf16 v[104:107], a[88:91], v[200:203], v[104:107]
  s_waitcnt lgkmcnt(7)
  v_exp_f32 v101, v101
  v_mfma_f32_16x16x32_bf16 v[104:107], a[92:95], v[232:235], v[104:107]
  ds_read_b64_tr_b16 a[104:105], v25 offset:32768
  v_cvt_pk_bf16_f32 v74, v100, v101
  v_mfma_f32_16x16x32_bf16 v[184:187], v[32:35], a[120:123], v[184:187]
  v_exp_f32 v102, v102
  v_mfma_f32_16x16x32_bf16 v[184:187], v[36:39], a[124:127], v[184:187]
  ds_read_b64_tr_b16 a[106:107], v25 offset:33792
  buffer_load_dwordx4 a[204:207], v1, s[44:47], s84 offen offset:0 sc1
  v_mfma_f32_16x16x32_bf16 v[188:191], v[44:47], a[124:127], v[188:191]
  v_exp_f32 v103, v103
  v_mfma_f32_16x16x32_bf16 v[188:191], v[40:43], a[120:123], v[188:191]
  buffer_load_dwordx4 a[208:211], v1, s[44:47], s84 offen offset:1024 sc1
  v_smfmac_f32_16x16x64_bf16 a[128:131], a[252:255], v[32:39], v30
  buffer_load_dwordx4 a[212:215], v1, s[44:47], s84 offen offset:2048 sc1
  v_mfma_f32_16x16x32_bf16 v[108:111], a[80:83], v[140:143], v[124:127]
  v_exp_f32 v104, v104
  v_mfma_f32_16x16x32_bf16 v[108:111], a[84:87], v[172:175], v[108:111]
  ds_read_b128 a[76:79], v19 offset:51200
  v_cvt_pk_bf16_f32 v75, v102, v103
  v_mfma_f32_16x16x32_bf16 v[108:111], a[88:91], v[204:207], v[108:111]
  s_waitcnt lgkmcnt(3)
  v_exp_f32 v105, v105
  v_mfma_f32_16x16x32_bf16 v[108:111], a[92:95], v[236:239], v[108:111]
  ds_read_b64_tr_b16 a[108:109], v25 offset:34816
  v_cvt_pk_bf16_f32 v82, v104, v105
  v_mfma_f32_16x16x32_bf16 a[24:27], v[48:51], a[120:123], a[24:27]
  v_exp_f32 v106, v106
  v_mfma_f32_16x16x32_bf16 a[24:27], v[52:55], a[124:127], a[24:27]
  ds_read_b64_tr_b16 a[110:111], v25 offset:35840
  v_lshrrev_b32 v9, 4, v0
  v_mfma_f32_16x16x32_bf16 a[28:31], v[60:63], a[124:127], a[28:31]
  v_exp_f32 v107, v107
  v_mfma_f32_16x16x32_bf16 a[28:31], v[56:59], a[120:123], a[28:31]
  buffer_load_dwordx4 a[216:219], v1, s[44:47], s84 offen offset:3072 sc1
  v_mfma_f32_16x16x32_bf16 v[96:99], a[64:67], v[128:131], v[112:115]
  s_add_u32 s85, s18, 20480
  v_exp_f32 v108, v108
  v_mfma_f32_16x16x32_bf16 v[96:99], a[68:71], v[160:163], v[96:99]
  ds_read_b128 a[80:83], v16 offset:52224
  v_cvt_pk_bf16_f32 v83, v106, v107
  v_mfma_f32_16x16x32_bf16 v[96:99], a[72:75], v[192:195], v[96:99]
  s_waitcnt lgkmcnt(3)
  v_exp_f32 v109, v109
  v_mfma_f32_16x16x32_bf16 v[96:99], a[76:79], v[224:227], v[96:99]
  ds_read_b64_tr_b16 a[112:113], v26 offset:32768
  buffer_load_dwordx4 a[220:223], v1, s[44:47], s85 offen offset:0 sc1
  v_cvt_pk_bf16_f32 v90, v108, v109
  v_mfma_f32_16x16x32_bf16 v[208:211], v[32:35], a[96:99], v[208:211]
  v_exp_f32 v110, v110
  v_mfma_f32_16x16x32_bf16 v[208:211], v[36:39], a[100:103], v[208:211]
  ds_read_b64_tr_b16 a[114:115], v26 offset:33792
  ds_read_b128 a[84:87], v17 offset:52224
  v_lshlrev_b32 v9, 6, v9
  v_mfma_f32_16x16x32_bf16 v[212:215], v[44:47], a[100:103], v[212:215]
  v_exp_f32 v111, v111
  v_mfma_f32_16x16x32_bf16 v[212:215], v[40:43], a[96:99], v[212:215]
  buffer_load_dwordx4 a[224:227], v1, s[44:47], s85 offen offset:1024 sc1
  v_mfma_f32_16x16x32_bf16 v[100:103], a[64:67], v[132:135], v[116:119]
  v_exp_f32 v96, v96
  v_mfma_f32_16x16x32_bf16 v[100:103], a[68:71], v[164:167], v[100:103]
  ds_read_b64_tr_b16 a[116:117], v26 offset:34816
  v_cvt_pk_bf16_f32 v91, v110, v111
  v_mfma_f32_16x16x32_bf16 v[100:103], a[72:75], v[196:199], v[100:103]
  v_exp_f32 v97, v97
  v_mfma_f32_16x16x32_bf16 v[100:103], a[76:79], v[228:231], v[100:103]
  ds_read_b64_tr_b16 a[118:119], v26 offset:35840
  v_cvt_pk_bf16_f32 v68, v96, v97
  v_mfma_f32_16x16x32_bf16 a[32:35], v[48:51], a[96:99], a[32:35]
  v_exp_f32 v98, v98
  v_mfma_f32_16x16x32_bf16 a[32:35], v[52:55], a[100:103], a[32:35]
  ds_read_b128 a[88:91], v18 offset:52224
  v_xor_b32 v11, v9, v1
  v_mfma_f32_16x16x32_bf16 a[36:39], v[60:63], a[100:103], a[36:39]
  v_exp_f32 v99, v99
  v_mfma_f32_16x16x32_bf16 a[36:39], v[56:59], a[96:99], a[36:39]
  ds_read_b64_tr_b16 a[120:121], v27 offset:32768
  buffer_load_dwordx4 a[228:231], v1, s[44:47], s85 offen offset:2048 sc1
  v_smfmac_f32_16x16x64_bf16 a[132:135], a[136:139], v[56:63], v30
  buffer_load_dwordx4 a[232:235], v1, s[44:47], s85 offen offset:3072 sc1
  v_mfma_f32_16x16x32_bf16 v[104:107], a[64:67], v[136:139], v[120:123]
  s_add_u32 s86, s18, 24576
  v_exp_f32 v100, v100
  v_mfma_f32_16x16x32_bf16 v[104:107], a[68:71], v[168:171], v[104:107]
  ds_read_b64_tr_b16 a[122:123], v27 offset:33792
  v_cvt_pk_bf16_f32 v69, v98, v99
  v_mfma_f32_16x16x32_bf16 v[104:107], a[72:75], v[200:203], v[104:107]
  s_waitcnt lgkmcnt(9)
  v_exp_f32 v101, v101
  v_mfma_f32_16x16x32_bf16 v[104:107], a[76:79], v[232:235], v[104:107]
  ds_read_b128 a[92:95], v19 offset:52224
  v_cvt_pk_bf16_f32 v76, v100, v101
  v_mfma_f32_16x16x32_bf16 v[216:219], v[32:35], a[104:107], v[216:219]
  v_exp_f32 v102, v102
  v_mfma_f32_16x16x32_bf16 v[216:219], v[36:39], a[108:111], v[216:219]
  ds_read_b64_tr_b16 a[124:125], v27 offset:34816
  buffer_load_dwordx4 a[236:239], v1, s[44:47], s86 offen offset:0 sc1
  v_mfma_f32_16x16x32_bf16 v[220:223], v[44:47], a[108:111], v[220:223]
  v_exp_f32 v103, v103
  v_mfma_f32_16x16x32_bf16 v[220:223], v[40:43], a[104:107], v[220:223]
  buffer_load_dwordx4 a[240:243], v1, s[44:47], s86 offen offset:1024 sc1
  v_mfma_f32_16x16x32_bf16 v[108:111], a[64:67], v[140:143], v[124:127]
  v_exp_f32 v104, v104
  v_mfma_f32_16x16x32_bf16 v[108:111], a[68:71], v[172:175], v[108:111]
  ds_read_b64_tr_b16 a[126:127], v27 offset:35840
  v_cvt_pk_bf16_f32 v77, v102, v103
  v_mfma_f32_16x16x32_bf16 v[108:111], a[72:75], v[204:207], v[108:111]
  s_waitcnt lgkmcnt(5)
  v_exp_f32 v105, v105
  v_mfma_f32_16x16x32_bf16 v[108:111], a[76:79], v[236:239], v[108:111]
  v_cvt_pk_bf16_f32 v84, v104, v105
  v_mfma_f32_16x16x32_bf16 a[40:43], v[48:51], a[104:107], a[40:43]
  v_exp_f32 v106, v106
  v_mfma_f32_16x16x32_bf16 a[40:43], v[52:55], a[108:111], a[40:43]
  buffer_load_dwordx4 a[244:247], v1, s[44:47], s86 offen offset:2048 sc1
  v_mfma_f32_16x16x32_bf16 a[44:47], v[60:63], a[108:111], a[44:47]
  s_waitcnt vmcnt(27)
  v_exp_f32 v107, v107
  v_mfma_f32_16x16x32_bf16 a[44:47], v[56:59], a[104:107], a[44:47]
  s_waitcnt lgkmcnt(0)
  buffer_load_dwordx4 a[248:251], v1, s[44:47], s86 offen offset:3072 sc1
  v_mfma_f32_16x16x32_bf16 v[96:99], a[80:83], v[128:131], v[112:115]
  s_barrier
  v_exp_f32 v108, v108
  v_mfma_f32_16x16x32_bf16 v[96:99], a[84:87], v[160:163], v[96:99]
  s_add_u32 s84, s18, 57344
  ds_read_b64_tr_b16 a[64:65], v22 offset:49152
  ds_read_b64_tr_b16 a[66:67], v22 offset:50176
  v_cvt_pk_bf16_f32 v85, v106, v107
  v_mfma_f32_16x16x32_bf16 v[96:99], a[88:91], v[192:195], v[96:99]
  s_waitcnt lgkmcnt(4)
  v_exp_f32 v109, v109
  v_mfma_f32_16x16x32_bf16 v[96:99], a[92:95], v[224:227], v[96:99]
  s_add_u32 m0, s63, 49152
  ds_read_b64_tr_b16 a[96:97], v20 offset:49152
  v_cvt_pk_bf16_f32 v92, v108, v109
  v_mfma_f32_16x16x32_bf16 v[240:243], v[32:35], a[112:115], v[240:243]
  v_exp_f32 v110, v110
  v_mfma_f32_16x16x32_bf16 v[240:243], v[36:39], a[116:119], v[240:243]
  ds_read_b64_tr_b16 a[98:99], v20 offset:50176
  buffer_load_dwordx4 v1, s[44:47], s84 offen offset:0 sc1 lds
  v_mfma_f32_16x16x32_bf16 v[244:247], v[44:47], a[116:119], v[244:247]
  v_exp_f32 v111, v111
  v_mfma_f32_16x16x32_bf16 v[244:247], v[40:43], a[112:115], v[244:247]
  ds_read_b64_tr_b16 a[68:69], v22 offset:51200
  ds_read_b64_tr_b16 a[70:71], v22 offset:52224
  v_mfma_f32_16x16x32_bf16 v[100:103], a[80:83], v[132:135], v[116:119]
  v_exp_f32 v96, v96
  v_mfma_f32_16x16x32_bf16 v[100:103], a[84:87], v[164:167], v[100:103]
  ds_read_b64_tr_b16 a[72:73], v23 offset:49152
  ds_read_b64_tr_b16 a[74:75], v23 offset:50176
  v_cvt_pk_bf16_f32 v93, v110, v111
  v_mfma_f32_16x16x32_bf16 v[100:103], a[88:91], v[196:199], v[100:103]
  v_exp_f32 v97, v97
  v_mfma_f32_16x16x32_bf16 v[100:103], a[92:95], v[228:231], v[100:103]
  ds_read_b64_tr_b16 a[100:101], v20 offset:51200
  v_cvt_pk_bf16_f32 v70, v96, v97
  v_mfma_f32_16x16x32_bf16 a[48:51], v[48:51], a[112:115], a[48:51]
  v_exp_f32 v98, v98
  v_mfma_f32_16x16x32_bf16 a[48:51], v[52:55], a[116:119], a[48:51]
  ds_read_b64_tr_b16 a[102:103], v20 offset:52224
  buffer_load_dwordx4 v1, s[44:47], s84 offen offset:1024 sc1 lds
  v_mfma_f32_16x16x32_bf16 a[52:55], v[60:63], a[116:119], a[52:55]
  v_exp_f32 v99, v99
  v_mfma_f32_16x16x32_bf16 a[52:55], v[56:59], a[112:115], a[52:55]
  ds_read_b64_tr_b16 a[76:77], v23 offset:51200
  ds_read_b64_tr_b16 a[78:79], v23 offset:52224
  v_smfmac_f32_16x16x64_bf16 a[132:135], a[252:255], v[48:55], v30
  buffer_load_dwordx4 v1, s[44:47], s84 offen offset:2048 sc1 lds
  v_mfma_f32_16x16x32_bf16 v[104:107], a[80:83], v[136:139], v[120:123]
  v_exp_f32 v100, v100
  v_mfma_f32_16x16x32_bf16 v[104:107], a[84:87], v[168:171], v[104:107]
  ds_read_b64_tr_b16 a[112:113], v24 offset:49152
  ds_read_b64_tr_b16 a[114:115], v24 offset:50176
  v_cvt_pk_bf16_f32 v71, v98, v99
  v_mfma_f32_16x16x32_bf16 v[104:107], a[88:91], v[200:203], v[104:107]
  s_waitcnt lgkmcnt(14)
  v_exp_f32 v101, v101
  v_mfma_f32_16x16x32_bf16 v[104:107], a[92:95], v[232:235], v[104:107]
  ds_read_b64_tr_b16 a[104:105], v21 offset:49152
  v_cvt_pk_bf16_f32 v78, v100, v101
  v_mfma_f32_16x16x32_bf16 v[248:251], v[32:35], a[120:123], v[248:251]
  v_exp_f32 v102, v102
  v_mfma_f32_16x16x32_bf16 v[248:251], v[36:39], a[124:127], v[248:251]
  ds_read_b64_tr_b16 a[106:107], v21 offset:50176
  v_mfma_f32_16x16x32_bf16 v[252:255], v[44:47], a[124:127], v[252:255]
  v_exp_f32 v103, v103
  v_mfma_f32_16x16x32_bf16 v[252:255], v[40:43], a[120:123], v[252:255]
  buffer_load_dwordx4 v1, s[44:47], s84 offen offset:3072 sc1 lds
  v_mfma_f32_16x16x32_bf16 v[108:111], a[80:83], v[140:143], v[124:127]
  v_exp_f32 v104, v104
  v_mfma_f32_16x16x32_bf16 v[108:111], a[84:87], v[172:175], v[108:111]
  ds_read_b64_tr_b16 a[116:117], v24 offset:51200
  ds_read_b64_tr_b16 a[118:119], v24 offset:52224
  v_cvt_pk_bf16_f32 v79, v102, v103
  v_mfma_f32_16x16x32_bf16 v[108:111], a[88:91], v[204:207], v[108:111]
  v_exp_f32 v105, v105
  v_mfma_f32_16x16x32_bf16 v[108:111], a[92:95], v[236:239], v[108:111]
  ds_read_b64_tr_b16 a[108:109], v21 offset:51200
  v_cvt_pk_bf16_f32 v86, v104, v105
  v_mfma_f32_16x16x32_bf16 a[56:59], v[48:51], a[120:123], a[56:59]
  v_exp_f32 v106, v106
  v_mfma_f32_16x16x32_bf16 a[56:59], v[52:55], a[124:127], a[56:59]
  ds_read_b64_tr_b16 a[110:111], v21 offset:52224
  v_mfma_f32_16x16x32_bf16 a[60:63], v[60:63], a[124:127], a[60:63]
  v_exp_f32 v107, v107
  v_mfma_f32_16x16x32_bf16 a[60:63], v[56:59], a[120:123], a[60:63]
  v_cvt_pk_bf16_f32 v87, v106, v107
  v_smfmac_f32_16x16x64_bf16 a[128:131], a[252:255], v[64:71], v30
  s_add_u32 s88, s18, 73728
  s_add_u32 s70, s90, 0
  ds_read_b64_tr_b16 a[80:81], v25 offset:49152
  ds_read_b64_tr_b16 a[82:83], v25 offset:50176
  v_smfmac_f32_16x16x64_bf16 a[128:131], a[136:139], v[72:79], v30
  s_add_u32 s71, s90, 4096
  ds_read_b64_tr_b16 a[84:85], v25 offset:51200
  ds_read_b64_tr_b16 a[86:87], v25 offset:52224
  buffer_load_dwordx4 v[32:35], v1, s[44:47], s88 offen offset:0 sc1
  v_smfmac_f32_16x16x64_bf16 a[132:135], a[252:255], v[80:87], v30
  s_waitcnt lgkmcnt(14)
  ds_read_b64_tr_b16 a[88:89], v26 offset:49152
  ds_read_b64_tr_b16 a[90:91], v26 offset:50176
  buffer_load_dwordx4 v[36:39], v1, s[44:47], s88 offen offset:1024 sc1
  v_mfma_f32_16x16x32_bf16 v[144:147], v[64:67], a[96:99], v[144:147]
  s_add_u32 s72, s90, 8192
  ds_read_b64_tr_b16 a[92:93], v26 offset:51200
  ds_read_b64_tr_b16 a[94:95], v26 offset:52224
  v_exp_f32 v108, v108
  v_mfma_f32_16x16x32_bf16 v[144:147], v[68:71], a[100:103], v[144:147]
  s_waitcnt lgkmcnt(8)
  ds_read_b64_tr_b16 a[120:121], v27 offset:49152
  ds_read_b64_tr_b16 a[122:123], v27 offset:50176
  buffer_load_dwordx4 v[40:43], v1, s[44:47], s88 offen offset:2048 sc1
  v_exp_f32 v109, v109
  v_mfma_f32_16x16x32_bf16 v[152:155], v[68:71], a[108:111], v[152:155]
  s_add_u32 s73, s90, 12288
  ds_read_b64_tr_b16 a[124:125], v27 offset:51200
  ds_read_b64_tr_b16 a[126:127], v27 offset:52224
  v_accvgpr_read_b32 v6, a128
  v_accvgpr_read_b32 v7, a129
  v_add_f32 v6, v6, v7
  v_mfma_f32_16x16x32_bf16 v[152:155], v[64:67], a[104:107], v[152:155]
  s_waitcnt lgkmcnt(15)
  buffer_load_dwordx4 v[44:47], v1, s[44:47], s88 offen offset:3072 sc1
  v_rcp_f32 v7, v6
  v_mfma_f32_16x16x32_bf16 v[176:179], v[64:67], a[64:67], v[176:179]
  s_lshl_b32 s65, s92, 5
  ds_bpermute_b32 v2, v10, v7 offset:0
  ds_bpermute_b32 v3, v10, v7 offset:4
  v_exp_f32 v110, v110
  s_add_u32 s89, s18, 77824
  v_mfma_f32_16x16x32_bf16 v[176:179], v[68:71], a[68:71], v[176:179]
  s_waitcnt lgkmcnt(15)
  ds_bpermute_b32 v4, v10, v7 offset:8
  ds_bpermute_b32 v5, v10, v7 offset:12
  buffer_load_dwordx4 v[48:51], v1, s[44:47], s89 offen offset:0 sc1
  v_exp_f32 v111, v111
  v_mfma_f32_16x16x32_bf16 v[184:187], v[68:71], a[76:79], v[184:187]
  s_add_u32 s65, s65, s19
  v_cvt_pk_bf16_f32 v94, v108, v109
  v_cvt_pk_bf16_f32 v95, v110, v111
  v_mfma_f32_16x16x32_bf16 v[184:187], v[64:67], a[72:75], v[184:187]
  s_waitcnt lgkmcnt(15)
  buffer_load_dwordx4 v[52:55], v1, s[44:47], s89 offen offset:1024 sc1
  v_mfma_f32_16x16x32_bf16 v[208:211], v[64:67], a[112:115], v[208:211]
  s_waitcnt lgkmcnt(0)
  v_mfma_f32_16x16x32_bf16 v[208:211], v[68:71], a[116:119], v[208:211]
  s_lshl_b32 s65, s65, 10
  buffer_load_dwordx4 v[56:59], v1, s[44:47], s89 offen offset:2048 sc1
  v_mul_f32_dpp v144, v2, v144 quad_perm:[1,1,1,1] row_mask:0xf bank_mask:0xf
  v_mul_f32_dpp v152, v2, v152 quad_perm:[1,1,1,1] row_mask:0xf bank_mask:0xf
  v_mul_f32_dpp v145, v3, v145 quad_perm:[1,1,1,1] row_mask:0xf bank_mask:0xf
  v_smfmac_f32_16x16x64_bf16 a[132:135], a[136:139], v[88:95], v30
  s_waitcnt lgkmcnt(12)
  v_mul_f32_dpp v153, v3, v153 quad_perm:[1,1,1,1] row_mask:0xf bank_mask:0xf
  v_mul_f32_dpp v146, v4, v146 quad_perm:[1,1,1,1] row_mask:0xf bank_mask:0xf
  v_mul_f32_dpp v154, v4, v154 quad_perm:[1,1,1,1] row_mask:0xf bank_mask:0xf
  v_mfma_f32_16x16x32_bf16 v[216:219], v[68:71], a[84:87], v[216:219]
  s_add_u32 s65, s65, 2097152
  buffer_load_dwordx4 v[60:63], v1, s[44:47], s89 offen offset:3072 sc1
  v_mul_f32_dpp v147, v5, v147 quad_perm:[1,1,1,1] row_mask:0xf bank_mask:0xf
  v_mul_f32_dpp v155, v5, v155 quad_perm:[1,1,1,1] row_mask:0xf bank_mask:0xf
  v_cvt_pk_bf16_f32 v144, v144, v145
  v_mfma_f32_16x16x32_bf16 v[216:219], v[64:67], a[80:83], v[216:219]
  s_waitcnt lgkmcnt(8)
  v_cvt_pk_bf16_f32 v145, v146, v147
  v_cvt_pk_bf16_f32 v146, v152, v153
  v_cvt_pk_bf16_f32 v147, v154, v155
  v_mfma_f32_16x16x32_bf16 v[240:243], v[64:67], a[88:91], v[240:243]
  buffer_store_dwordx4 v[144:147], v11, s[40:43], s70 offen offset:0 sc1
  v_mul_f32_dpp v176, v2, v176 quad_perm:[1,1,1,1] row_mask:0xf bank_mask:0xf
  v_mul_f32_dpp v184, v2, v184 quad_perm:[1,1,1,1] row_mask:0xf bank_mask:0xf
  v_mul_f32_dpp v177, v3, v177 quad_perm:[1,1,1,1] row_mask:0xf bank_mask:0xf
  v_mfma_f32_16x16x32_bf16 v[240:243], v[68:71], a[92:95], v[240:243]
  s_waitcnt lgkmcnt(4)
  v_mul_f32_dpp v185, v3, v185 quad_perm:[1,1,1,1] row_mask:0xf bank_mask:0xf
  v_mul_f32_dpp v178, v4, v178 quad_perm:[1,1,1,1] row_mask:0xf bank_mask:0xf
  v_mul_f32_dpp v186, v4, v186 quad_perm:[1,1,1,1] row_mask:0xf bank_mask:0xf
  v_mfma_f32_16x16x32_bf16 v[248:251], v[68:71], a[124:127], v[248:251]
  v_mul_f32_dpp v179, v5, v179 quad_perm:[1,1,1,1] row_mask:0xf bank_mask:0xf
  v_mul_f32_dpp v187, v5, v187 quad_perm:[1,1,1,1] row_mask:0xf bank_mask:0xf
  v_cvt_pk_bf16_f32 v176, v176, v177
  v_mfma_f32_16x16x32_bf16 v[248:251], v[64:67], a[120:123], v[248:251]
  v_cvt_pk_bf16_f32 v177, v178, v179
  v_cvt_pk_bf16_f32 v178, v184, v185
  v_cvt_pk_bf16_f32 v179, v186, v187
  v_mfma_f32_16x16x32_bf16 v[148:151], v[72:75], a[96:99], v[148:151]
  buffer_store_dwordx4 v[176:179], v11, s[40:43], s70 offen offset:1024 sc1
  v_mul_f32_dpp v208, v2, v208 quad_perm:[1,1,1,1] row_mask:0xf bank_mask:0xf
  v_mul_f32_dpp v216, v2, v216 quad_perm:[1,1,1,1] row_mask:0xf bank_mask:0xf
  v_mul_f32_dpp v209, v3, v209 quad_perm:[1,1,1,1] row_mask:0xf bank_mask:0xf
  v_mfma_f32_16x16x32_bf16 v[148:151], v[76:79], a[100:103], v[148:151]
  v_min_u32 v30, 3, v0
  v_mul_f32_dpp v217, v3, v217 quad_perm:[1,1,1,1] row_mask:0xf bank_mask:0xf
  v_mul_f32_dpp v210, v4, v210 quad_perm:[1,1,1,1] row_mask:0xf bank_mask:0xf
  v_mul_f32_dpp v218, v4, v218 quad_perm:[1,1,1,1] row_mask:0xf bank_mask:0xf
  v_mfma_f32_16x16x32_bf16 v[156:159], v[76:79], a[108:111], v[156:159]
  v_lshl_add_u32 v30, v30, 9, s65
  v_mul_f32_dpp v211, v5, v211 quad_perm:[1,1,1,1] row_mask:0xf bank_mask:0xf
  v_mul_f32_dpp v219, v5, v219 quad_perm:[1,1,1,1] row_mask:0xf bank_mask:0xf
  v_cvt_pk_bf16_f32 v208, v208, v209
  v_mfma_f32_16x16x32_bf16 v[156:159], v[72:75], a[104:107], v[156:159]
  v_cvt_pk_bf16_f32 v209, v210, v211
  v_cvt_pk_bf16_f32 v210, v216, v217
  v_cvt_pk_bf16_f32 v211, v218, v219
  v_mfma_f32_16x16x32_bf16 v[180:183], v[72:75], a[64:67], v[180:183]
  buffer_store_dwordx4 v[208:211], v11, s[40:43], s70 offen offset:2048 sc1
  v_accvgpr_read_b32 v8, a132
  v_mul_f32_dpp v240, v2, v240 quad_perm:[1,1,1,1] row_mask:0xf bank_mask:0xf
  v_mul_f32_dpp v248, v2, v248 quad_perm:[1,1,1,1] row_mask:0xf bank_mask:0xf
  v_mul_f32_dpp v241, v3, v241 quad_perm:[1,1,1,1] row_mask:0xf bank_mask:0xf
  v_mfma_f32_16x16x32_bf16 v[180:183], v[76:79], a[68:71], v[180:183]
  v_accvgpr_read_b32 v9, a133
  v_mul_f32_dpp v249, v3, v249 quad_perm:[1,1,1,1] row_mask:0xf bank_mask:0xf
  v_mul_f32_dpp v242, v4, v242 quad_perm:[1,1,1,1] row_mask:0xf bank_mask:0xf
  v_mul_f32_dpp v250, v4, v250 quad_perm:[1,1,1,1] row_mask:0xf bank_mask:0xf
  v_mfma_f32_16x16x32_bf16 v[188:191], v[76:79], a[76:79], v[188:191]
  v_add_f32 v8, v8, v9
  v_mul_f32_dpp v243, v5, v243 quad_perm:[1,1,1,1] row_mask:0xf bank_mask:0xf
  v_mul_f32_dpp v251, v5, v251 quad_perm:[1,1,1,1] row_mask:0xf bank_mask:0xf
  v_cvt_pk_bf16_f32 v240, v240, v241
  v_mfma_f32_16x16x32_bf16 v[188:191], v[72:75], a[72:75], v[188:191]
  v_rcp_f32 v9, v8
  v_cvt_pk_bf16_f32 v241, v242, v243
  v_cvt_pk_bf16_f32 v242, v248, v249
  v_cvt_pk_bf16_f32 v243, v250, v251
  v_mfma_f32_16x16x32_bf16 v[212:215], v[72:75], a[112:115], v[212:215]
  buffer_store_dwordx4 v[240:243], v11, s[40:43], s70 offen offset:3072 sc1
  v_add_f32 v6, v6, v8
  v_mul_f32_dpp v148, v2, v148 quad_perm:[0,0,0,0] row_mask:0xf bank_mask:0xf
  v_mul_f32_dpp v156, v2, v156 quad_perm:[0,0,0,0] row_mask:0xf bank_mask:0xf
  v_mul_f32_dpp v149, v3, v149 quad_perm:[0,0,0,0] row_mask:0xf bank_mask:0xf
  v_mfma_f32_16x16x32_bf16 v[212:215], v[76:79], a[116:119], v[212:215]
  buffer_load_dword v31, v30, s[56:59], 0 offen offset:0 sc1
  v_cmp_nge_f32 vcc, s94, v6
  v_mul_f32_dpp v157, v3, v157 quad_perm:[0,0,0,0] row_mask:0xf bank_mask:0xf
  v_mul_f32_dpp v150, v4, v150 quad_perm:[0,0,0,0] row_mask:0xf bank_mask:0xf
  v_mul_f32_dpp v158, v4, v158 quad_perm:[0,0,0,0] row_mask:0xf bank_mask:0xf
  v_mfma_f32_16x16x32_bf16 v[220:223], v[76:79], a[84:87], v[220:223]
  ds_bpermute_b32 v104, v10, v9 offset:0
  v_mul_f32_dpp v151, v5, v151 quad_perm:[0,0,0,0] row_mask:0xf bank_mask:0xf
  v_mul_f32_dpp v159, v5, v159 quad_perm:[0,0,0,0] row_mask:0xf bank_mask:0xf
  v_cvt_pk_bf16_f32 v148, v148, v149
  v_mfma_f32_16x16x32_bf16 v[220:223], v[72:75], a[80:83], v[220:223]
  s_cmp_lg_u64 vcc, 0
  ds_bpermute_b32 v105, v10, v9 offset:4
  v_cvt_pk_bf16_f32 v149, v150, v151
  v_cvt_pk_bf16_f32 v150, v156, v157
  v_cvt_pk_bf16_f32 v151, v158, v159
  v_mfma_f32_16x16x32_bf16 v[244:247], v[72:75], a[88:91], v[244:247]
  s_cselect_b32 s66, 1, 0
  ds_bpermute_b32 v106, v10, v9 offset:8
  buffer_store_dwordx4 v[148:151], v11, s[40:43], s71 offen offset:0 sc1
  v_mov_b32 v13, s66
  v_mul_f32_dpp v180, v2, v180 quad_perm:[0,0,0,0] row_mask:0xf bank_mask:0xf
  v_mul_f32_dpp v188, v2, v188 quad_perm:[0,0,0,0] row_mask:0xf bank_mask:0xf
  v_mul_f32_dpp v181, v3, v181 quad_perm:[0,0,0,0] row_mask:0xf bank_mask:0xf
  v_mfma_f32_16x16x32_bf16 v[244:247], v[76:79], a[92:95], v[244:247]
  ds_bpermute_b32 v107, v10, v9 offset:12
  v_mul_f32_dpp v189, v3, v189 quad_perm:[0,0,0,0] row_mask:0xf bank_mask:0xf
  v_mul_f32_dpp v182, v4, v182 quad_perm:[0,0,0,0] row_mask:0xf bank_mask:0xf
  v_mul_f32_dpp v190, v4, v190 quad_perm:[0,0,0,0] row_mask:0xf bank_mask:0xf
  v_mfma_f32_16x16x32_bf16 v[252:255], v[76:79], a[124:127], v[252:255]
L_hopb0:
  s_cbranch_execz L_hopback2
  ds_write_b32 v12, v13 offset:0
  v_mul_f32_dpp v183, v5, v183 quad_perm:[0,0,0,0] row_mask:0xf bank_mask:0xf
  v_mul_f32_dpp v191, v5, v191 quad_perm:[0,0,0,0] row_mask:0xf bank_mask:0xf
  v_cvt_pk_bf16_f32 v180, v180, v181
  v_mfma_f32_16x16x32_bf16 v[252:255], v[72:75], a[120:123], v[252:255]
  v_cvt_pk_bf16_f32 v181, v182, v183
  v_cvt_pk_bf16_f32 v182, v188, v189
  v_cvt_pk_bf16_f32 v183, v190, v191
  v_mfma_f32_16x16x32_bf16 a[0:3], v[80:83], a[96:99], a[0:3]
  buffer_store_dwordx4 v[180:183], v11, s[40:43], s71 offen offset:1024 sc1
  v_mul_f32_dpp v212, v2, v212 quad_perm:[0,0,0,0] row_mask:0xf bank_mask:0xf
  v_mul_f32_dpp v220, v2, v220 quad_perm:[0,0,0,0] row_mask:0xf bank_mask:0xf
  v_mul_f32_dpp v213, v3, v213 quad_perm:[0,0,0,0] row_mask:0xf bank_mask:0xf
  v_mfma_f32_16x16x32_bf16 a[0:3], v[84:87], a[100:103], a[0:3]
  s_waitcnt lgkmcnt(0)
  v_mul_f32_dpp v221, v3, v221 quad_perm:[0,0,0,0] row_mask:0xf bank_mask:0xf
  v_mul_f32_dpp v214, v4, v214 quad_perm:[0,0,0,0] row_mask:0xf bank_mask:0xf
  v_mul_f32_dpp v222, v4, v222 quad_perm:[0,0,0,0] row_mask:0xf bank_mask:0xf
  v_mfma_f32_16x16x32_bf16 a[4:7], v[92:95], a[100:103], a[4:7]
  s_barrier
  ds_read_b128 v[96:99], v14 offset:0
  v_cmp_eq_u32 vcc, 0, v0
  v_mul_f32_dpp v215, v5, v215 quad_perm:[0,0,0,0] row_mask:0xf bank_mask:0xf
  v_mul_f32_dpp v223, v5, v223 quad_perm:[0,0,0,0] row_mask:0xf bank_mask:0xf
  v_cvt_pk_bf16_f32 v212, v212, v213
  v_mfma_f32_16x16x32_bf16 a[4:7], v[88:91], a[96:99], a[4:7]
  v_mov_b32 v12, 2147483392
  v_cvt_pk_bf16_f32 v213, v214, v215
  v_cvt_pk_bf16_f32 v214, v220, v221
  v_cvt_pk_bf16_f32 v215, v222, v223
  v_mfma_f32_16x16x32_bf16 a[8:11], v[80:83], a[104:107], a[8:11]
  buffer_store_dwordx4 v[212:215], v11, s[40:43], s71 offen offset:2048 sc1
  v_mov_b32 v13, 1
  v_mul_f32_dpp v244, v2, v244 quad_perm:[0,0,0,0] row_mask:0xf bank_mask:0xf
  v_mul_f32_dpp v252, v2, v252 quad_perm:[0,0,0,0] row_mask:0xf bank_mask:0xf
  v_mul_f32_dpp v245, v3, v245 quad_perm:[0,0,0,0] row_mask:0xf bank_mask:0xf
  v_mfma_f32_16x16x32_bf16 a[8:11], v[84:87], a[108:111], a[8:11]
  v_cndmask_b32 v12, v12, 0, vcc
  v_mul_f32_dpp v253, v3, v253 quad_perm:[0,0,0,0] row_mask:0xf bank_mask:0xf
  v_mul_f32_dpp v246, v4, v246 quad_perm:[0,0,0,0] row_mask:0xf bank_mask:0xf
  v_mul_f32_dpp v254, v4, v254 quad_perm:[0,0,0,0] row_mask:0xf bank_mask:0xf
  v_mfma_f32_16x16x32_bf16 a[12:15], v[92:95], a[108:111], a[12:15]
  v_mov_b32 v7, v30
  v_mul_f32_dpp v247, v5, v247 quad_perm:[0,0,0,0] row_mask:0xf bank_mask:0xf
  v_mul_f32_dpp v255, v5, v255 quad_perm:[0,0,0,0] row_mask:0xf bank_mask:0xf
  v_cvt_pk_bf16_f32 v244, v244, v245
  v_mfma_f32_16x16x32_bf16 a[12:15], v[88:91], a[104:107], a[12:15]
  s_waitcnt lgkmcnt(0)
  v_or3_b32 v8, v96, v97, v98
  v_cvt_pk_bf16_f32 v245, v246, v247
  v_cvt_pk_bf16_f32 v246, v252, v253
  v_cvt_pk_bf16_f32 v247, v254, v255
  v_mfma_f32_16x16x32_bf16 a[16:19], v[80:83], a[64:67], a[16:19]
  buffer_store_dwordx4 v[244:247], v11, s[40:43], s71 offen offset:3072 sc1
  v_or_b32 v8, v8, v99
  v_mfma_f32_16x16x32_bf16 a[16:19], v[84:87], a[68:71], a[16:19]
  v_readfirstlane_b32 s66, v8
  v_mfma_f32_16x16x32_bf16 a[20:23], v[92:95], a[68:71], a[20:23]
  v_mfma_f32_16x16x32_bf16 a[20:23], v[88:91], a[64:67], a[20:23]
  s_cmp_lg_u32 s66, 0
  v_mfma_f32_16x16x32_bf16 a[24:27], v[80:83], a[72:75], a[24:27]
  s_cbranch_scc1 L_slow
  v_mfma_f32_16x16x32_bf16 a[24:27], v[84:87], a[76:79], a[24:27]
  v_accvgpr_read_b32 v192, a0
  v_accvgpr_read_b32 v193, a1
  v_accvgpr_read_b32 v194, a2
  v_accvgpr_read_b32 v195, a3
  v_mfma_f32_16x16x32_bf16 a[28:31], v[92:95], a[76:79], a[28:31]
  v_accvgpr_read_b32 v196, a8
  v_accvgpr_read_b32 v197, a9
  v_accvgpr_read_b32 v198, a10
  v_accvgpr_read_b32 v199, a11
  v_mfma_f32_16x16x32_bf16 a[28:31], v[88:91], a[72:75], a[28:31]
  v_mul_f32_dpp v192, v104, v192 quad_perm:[1,1,1,1] row_mask:0xf bank_mask:0xf
  v_mul_f32_dpp v196, v104, v196 quad_perm:[1,1,1,1] row_mask:0xf bank_mask:0xf
  v_mul_f32_dpp v193, v105, v193 quad_perm:[1,1,1,1] row_mask:0xf bank_mask:0xf
  v_mul_f32_dpp v197, v105, v197 quad_perm:[1,1,1,1] row_mask:0xf bank_mask:0xf
  v_mfma_f32_16x16x32_bf16 a[32:35], v[80:83], a[112:115], a[32:35]
  v_mul_f32_dpp v194, v106, v194 quad_perm:[1,1,1,1] row_mask:0xf bank_mask:0xf
  v_mul_f32_dpp v198, v106, v198 quad_perm:[1,1,1,1] row_mask:0xf bank_mask:0xf
  v_mul_f32_dpp v195, v107, v195 quad_perm:[1,1,1,1] row_mask:0xf bank_mask:0xf
  v_mul_f32_dpp v199, v107, v199 quad_perm:[1,1,1,1] row_mask:0xf bank_mask:0xf
  v_mfma_f32_16x16x32_bf16 a[32:35], v[84:87], a[116:119], a[32:35]
  v_cvt_pk_bf16_f32 v16, v192, v193
  v_cvt_pk_bf16_f32 v17, v194, v195
  v_cvt_pk_bf16_f32 v18, v196, v197
  v_cvt_pk_bf16_f32 v19, v198, v199
  v_mfma_f32_16x16x32_bf16 a[36:39], v[92:95], a[116:119], a[36:39]
  v_accvgpr_read_b32 v200, a4
  v_accvgpr_read_b32 v201, a5
  v_accvgpr_read_b32 v202, a6
  v_accvgpr_read_b32 v203, a7
  v_mfma_f32_16x16x32_bf16 a[36:39], v[88:91], a[112:115], a[36:39]
  v_accvgpr_read_b32 v204, a12
  v_accvgpr_read_b32 v205, a13
  v_accvgpr_read_b32 v206, a14
  v_accvgpr_read_b32 v207, a15
  v_mfma_f32_16x16x32_bf16 a[40:43], v[80:83], a[80:83], a[40:43]
  v_mul_f32_dpp v200, v104, v200 quad_perm:[0,0,0,0] row_mask:0xf bank_mask:0xf
  v_mul_f32_dpp v204, v104, v204 quad_perm:[0,0,0,0] row_mask:0xf bank_mask:0xf
  v_mul_f32_dpp v201, v105, v201 quad_perm:[0,0,0,0] row_mask:0xf bank_mask:0xf
  v_mul_f32_dpp v205, v105, v205 quad_perm:[0,0,0,0] row_mask:0xf bank_mask:0xf
  v_mfma_f32_16x16x32_bf16 a[40:43], v[84:87], a[84:87], a[40:43]
  v_mul_f32_dpp v202, v106, v202 quad_perm:[0,0,0,0] row_mask:0xf bank_mask:0xf
  v_mul_f32_dpp v206, v106, v206 quad_perm:[0,0,0,0] row_mask:0xf bank_mask:0xf
  v_mul_f32_dpp v203, v107, v203 quad_perm:[0,0,0,0] row_mask:0xf bank_mask:0xf
  v_mul_f32_dpp v207, v107, v207 quad_perm:[0,0,0,0] row_mask:0xf bank_mask:0xf
  v_mfma_f32_16x16x32_bf16 a[44:47], v[92:95], a[84:87], a[44:47]
  v_cvt_pk_bf16_f32 v112, v200, v201
  v_cvt_pk_bf16_f32 v113, v202, v203
  v_cvt_pk_bf16_f32 v114, v204, v205
  v_cvt_pk_bf16_f32 v115, v206, v207
  v_mfma_f32_16x16x32_bf16 a[44:47], v[88:91], a[80:83], a[44:47]
  v_accvgpr_read_b32 v224, a16
  v_accvgpr_read_b32 v225, a17
  v_accvgpr_read_b32 v226, a18
  v_accvgpr_read_b32 v227, a19
  v_mfma_f32_16x16x32_bf16 a[48:51], v[80:83], a[88:91], a[48:51]
  v_accvgpr_read_b32 v228, a24
  v_accvgpr_read_b32 v229, a25
  v_accvgpr_read_b32 v230, a26
  v_accvgpr_read_b32 v231, a27
  v_mfma_f32_16x16x32_bf16 a[48:51], v[84:87], a[92:95], a[48:51]
  v_mul_f32_dpp v224, v104, v224 quad_perm:[1,1,1,1] row_mask:0xf bank_mask:0xf
  v_mul_f32_dpp v228, v104, v228 quad_perm:[1,1,1,1] row_mask:0xf bank_mask:0xf
  v_mul_f32_dpp v225, v105, v225 quad_perm:[1,1,1,1] row_mask:0xf bank_mask:0xf
  v_mul_f32_dpp v229, v105, v229 quad_perm:[1,1,1,1] row_mask:0xf bank_mask:0xf
  v_mfma_f32_16x16x32_bf16 a[52:55], v[92:95], a[92:95], a[52:55]
  v_mul_f32_dpp v226, v106, v226 quad_perm:[1,1,1,1] row_mask:0xf bank_mask:0xf
  v_mul_f32_dpp v230, v106, v230 quad_perm:[1,1,1,1] row_mask:0xf bank_mask:0xf
  v_mul_f32_dpp v227, v107, v227 quad_perm:[1,1,1,1] row_mask:0xf bank_mask:0xf
  v_mul_f32_dpp v231, v107, v231 quad_perm:[1,1,1,1] row_mask:0xf bank_mask:0xf
  v_mfma_f32_16x16x32_bf16 a[52:55], v[88:91], a[88:91], a[52:55]
  v_cvt_pk_bf16_f32 v20, v224, v225
  v_cvt_pk_bf16_f32 v21, v226, v227
  v_cvt_pk_bf16_f32 v22, v228, v229
  v_cvt_pk_bf16_f32 v23, v230, v231
  v_mfma_f32_16x16x32_bf16 a[56:59], v[80:83], a[120:123], a[56:59]
  v_mfma_f32_16x16x32_bf16 a[56:59], v[84:87], a[124:127], a[56:59]
  v_mfma_f32_16x16x32_bf16 a[60:63], v[92:95], a[124:127], a[60:63]
  v_mfma_f32_16x16x32_bf16 a[60:63], v[88:91], a[120:123], a[60:63]
  v_accvgpr_read_b32 v232, a20
  v_accvgpr_read_b32 v233, a21
  v_accvgpr_read_b32 v234, a22
  v_accvgpr_read_b32 v235, a23
  v_accvgpr_read_b32 v236, a28
  v_accvgpr_read_b32 v237, a29
  v_accvgpr_read_b32 v238, a30
  v_accvgpr_read_b32 v239, a31
  v_mul_f32_dpp v232, v104, v232 quad_perm:[0,0,0,0] row_mask:0xf bank_mask:0xf
  v_mul_f32_dpp v236, v104, v236 quad_perm:[0,0,0,0] row_mask:0xf bank_mask:0xf
  v_mul_f32_dpp v233, v105, v233 quad_perm:[0,0,0,0] row_mask:0xf bank_mask:0xf
  v_mul_f32_dpp v237, v105, v237 quad_perm:[0,0,0,0] row_mask:0xf bank_mask:0xf
  v_mul_f32_dpp v234, v106, v234 quad_perm:[0,0,0,0] row_mask:0xf bank_mask:0xf
  v_mul_f32_dpp v238, v106, v238 quad_perm:[0,0,0,0] row_mask:0xf bank_mask:0xf
  v_mul_f32_dpp v235, v107, v235 quad_perm:[0,0,0,0] row_mask:0xf bank_mask:0xf
  v_mul_f32_dpp v239, v107, v239 quad_perm:[0,0,0,0] row_mask:0xf bank_mask:0xf
  v_cvt_pk_bf16_f32 v116, v232, v233
  v_cvt_pk_bf16_f32 v117, v234, v235
  v_cvt_pk_bf16_f32 v118, v236, v237
  v_cvt_pk_bf16_f32 v119, v238, v239
  s_waitcnt vmcnt(4)
  buffer_store_dword v13, v12, s[56:59], s95 offen sc1
  v_cmp_ne_u32 vcc, 1, v31
  s_nop 1
  s_cmp_eq_u64 vcc, 0
  s_cselect_b32 s60, 1, 0
  s_cbranch_scc0 L_skip_o
  s_add_u32 s9, s8, 0
  s_add_u32 m0, s63, 98304
  s_nop 0
  buffer_load_dwordx4 v1, s[40:43], s9 offen offset:0 sc1 lds
  buffer_load_dwordx4 v1, s[40:43], s9 offen offset:1024 sc1 lds
  buffer_load_dwordx4 v1, s[40:43], s9 offen offset:2048 sc1 lds
  buffer_load_dwordx4 v1, s[40:43], s9 offen offset:3072 sc1 lds
  s_add_u32 s10, s8, 524288
  s_add_u32 m0, s63, 114688
  s_nop 0
  buffer_load_dwordx4 v1, s[40:43], s10 offen offset:0 sc1 lds
  buffer_load_dwordx4 v1, s[40:43], s10 offen offset:1024 sc1 lds
  buffer_load_dwordx4 v1, s[40:43], s10 offen offset:2048 sc1 lds
  buffer_load_dwordx4 v1, s[40:43], s10 offen offset:3072 sc1 lds
L_skip_o:
  v_accvgpr_read_b32 v192, a32
  v_accvgpr_read_b32 v193, a33
  v_accvgpr_read_b32 v194, a34
  v_accvgpr_read_b32 v195, a35
  v_accvgpr_read_b32 v196, a40
  v_accvgpr_read_b32 v197, a41
  v_accvgpr_read_b32 v198, a42
  v_accvgpr_read_b32 v199, a43
  v_mul_f32_dpp v192, v104, v192 quad_perm:[1,1,1,1] row_mask:0xf bank_mask:0xf
  v_mul_f32_dpp v196, v104, v196 quad_perm:[1,1,1,1] row_mask:0xf bank_mask:0xf
  v_mul_f32_dpp v193, v105, v193 quad_perm:[1,1,1,1] row_mask:0xf bank_mask:0xf
  v_mul_f32_dpp v197, v105, v197 quad_perm:[1,1,1,1] row_mask:0xf bank_mask:0xf
  v_mul_f32_dpp v194, v106, v194 quad_perm:[1,1,1,1] row_mask:0xf bank_mask:0xf
  v_mul_f32_dpp v198, v106, v198 quad_perm:[1,1,1,1] row_mask:0xf bank_mask:0xf
  v_mul_f32_dpp v195, v107, v195 quad_perm:[1,1,1,1] row_mask:0xf bank_mask:0xf
  v_mul_f32_dpp v199, v107, v199 quad_perm:[1,1,1,1] row_mask:0xf bank_mask:0xf
  v_cvt_pk_bf16_f32 v24, v192, v193
  v_cvt_pk_bf16_f32 v25, v194, v195
  v_cvt_pk_bf16_f32 v26, v196, v197
  v_cvt_pk_bf16_f32 v27, v198, v199
  v_accvgpr_read_b32 v200, a36
  v_accvgpr_read_b32 v201, a37
  v_accvgpr_read_b32 v202, a38
  v_accvgpr_read_b32 v203, a39
  v_accvgpr_read_b32 v204, a44
  v_accvgpr_read_b32 v205, a45
  v_accvgpr_read_b32 v206, a46
  v_accvgpr_read_b32 v207, a47
  v_mul_f32_dpp v200, v104, v200 quad_perm:[0,0,0,0] row_mask:0xf bank_mask:0xf
  v_mul_f32_dpp v204, v104, v204 quad_perm:[0,0,0,0] row_mask:0xf bank_mask:0xf
  v_mul_f32_dpp v201, v105, v201 quad_perm:[0,0,0,0] row_mask:0xf bank_mask:0xf
  v_mul_f32_dpp v205, v105, v205 quad_perm:[0,0,0,0] row_mask:0xf bank_mask:0xf
  v_mul_f32_dpp v202, v106, v202 quad_perm:[0,0,0,0] row_mask:0xf bank_mask:0xf
  v_mul_f32_dpp v206, v106, v206 quad_perm:[0,0,0,0] row_mask:0xf bank_mask:0xf
  v_mul_f32_dpp v203, v107, v203 quad_perm:[0,0,0,0] row_mask:0xf bank_mask:0xf
  v_mul_f32_dpp v207, v107, v207 quad_perm:[0,0,0,0] row_mask:0xf bank_mask:0xf
  v_cvt_pk_bf16_f32 v120, v200, v201
  v_cvt_pk_bf16_f32 v121, v202, v203
  v_cvt_pk_bf16_f32 v122, v204, v205
  v_cvt_pk_bf16_f32 v123, v206, v207
  v_accvgpr_read_b32 v224, a48
  v_accvgpr_read_b32 v225, a49
  v_accvgpr_read_b32 v226, a50
  v_accvgpr_read_b32 v227, a51
  v_accvgpr_read_b32 v228, a56
  v_accvgpr_read_b32 v229, a57
  v_accvgpr_read_b32 v230, a58
  v_accvgpr_read_b32 v231, a59
  v_mul_f32_dpp v224, v104, v224 quad_perm:[1,1,1,1] row_mask:0xf bank_mask:0xf
  v_mul_f32_dpp v228, v104, v228 quad_perm:[1,1,1,1] row_mask:0xf bank_mask:0xf
  v_mul_f32_dpp v225, v105, v225 quad_perm:[1,1,1,1] row_mask:0xf bank_mask:0xf
  v_mul_f32_dpp v229, v105, v229 quad_perm:[1,1,1,1] row_mask:0xf bank_mask:0xf
  v_mul_f32_dpp v226, v106, v226 quad_perm:[1,1,1,1] row_mask:0xf bank_mask:0xf
  v_mul_f32_dpp v230, v106, v230 quad_perm:[1,1,1,1] row_mask:0xf bank_mask:0xf
  v_mul_f32_dpp v227, v107, v227 quad_perm:[1,1,1,1] row_mask:0xf bank_mask:0xf
  v_mul_f32_dpp v231, v107, v231 quad_perm:[1,1,1,1] row_mask:0xf bank_mask:0xf
  v_cvt_pk_bf16_f32 v28, v224, v225
  v_cvt_pk_bf16_f32 v29, v226, v227
  v_cvt_pk_bf16_f32 v30, v228, v229
  v_cvt_pk_bf16_f32 v31, v230, v231
  v_accvgpr_read_b32 v232, a52
  v_accvgpr_read_b32 v233, a53
  v_accvgpr_read_b32 v234, a54
  v_accvgpr_read_b32 v235, a55
  v_accvgpr_read_b32 v236, a60
  v_accvgpr_read_b32 v237, a61
  v_accvgpr_read_b32 v238, a62
  v_accvgpr_read_b32 v239, a63
  v_mul_f32_dpp v232, v104, v232 quad_perm:[0,0,0,0] row_mask:0xf bank_mask:0xf
  v_mul_f32_dpp v236, v104, v236 quad_perm:[0,0,0,0] row_mask:0xf bank_mask:0xf
  v_mul_f32_dpp v233, v105, v233 quad_perm:[0,0,0,0] row_mask:0xf bank_mask:0xf
  v_mul_f32_dpp v237, v105, v237 quad_perm:[0,0,0,0] row_mask:0xf bank_mask:0xf
  v_mul_f32_dpp v234, v106, v234 quad_perm:[0,0,0,0] row_mask:0xf bank_mask:0xf
  v_mul_f32_dpp v238, v106, v238 quad_perm:[0,0,0,0] row_mask:0xf bank_mask:0xf
  v_mul_f32_dpp v235, v107, v235 quad_perm:[0,0,0,0] row_mask:0xf bank_mask:0xf
  v_mul_f32_dpp v239, v107, v239 quad_perm:[0,0,0,0] row_mask:0xf bank_mask:0xf
  v_cvt_pk_bf16_f32 v124, v232, v233
  v_cvt_pk_bf16_f32 v125, v234, v235
  v_cvt_pk_bf16_f32 v126, v236, v237
  v_cvt_pk_bf16_f32 v127, v238, v239
L_join:
  v_mov_b32 v10, v11
  v_add_u32 v80, s63, v1
  v_add_u32 v81, 0x10000, v80
  v_add_u32 v82, 0x20000, v80
  ds_read_b128 a[32:35], v80 offset:0
  ds_read_b128 a[36:39], v80 offset:1024
  ds_read_b128 a[40:43], v80 offset:2048
  ds_read_b128 a[44:47], v80 offset:3072
  ds_read_b128 a[48:51], v80 offset:16384
  ds_read_b128 a[52:55], v80 offset:17408
  ds_read_b128 a[56:59], v80 offset:18432
  ds_read_b128 a[60:63], v80 offset:19456
  ds_read_b128 a[0:3], v82 offset:0
  ds_read_b128 a[4:7], v82 offset:1024
  ds_read_b128 a[8:11], v82 offset:2048
  ds_read_b128 a[12:15], v82 offset:3072
  ds_read_b128 a[16:19], v82 offset:16384
  ds_read_b128 a[20:23], v82 offset:17408
  ds_read_b128 a[24:27], v82 offset:18432
  ds_read_b128 a[28:31], v82 offset:19456
  ds_read_b128 a[64:67], v81 offset:0
  ds_read_b128 a[68:71], v81 offset:1024
  ds_read_b128 a[72:75], v81 offset:2048
  ds_read_b128 a[76:79], v81 offset:3072
  ds_read_b128 a[80:83], v80 offset:32768
  ds_read_b128 a[84:87], v80 offset:33792
  ds_read_b128 a[88:91], v80 offset:34816
  ds_read_b128 a[92:95], v80 offset:35840
  ds_read_b128 a[96:99], v81 offset:16384
  ds_read_b128 a[100:103], v81 offset:17408
  ds_read_b128 a[104:107], v81 offset:18432
  ds_read_b128 a[108:111], v81 offset:19456
  ds_read_b128 a[112:115], v80 offset:49152
  ds_read_b128 a[116:119], v80 offset:50176
  ds_read_b128 a[120:123], v80 offset:51200
  ds_read_b128 a[124:127], v80 offset:52224
  s_add_u32 s85, s18, 61440
  s_nop 0
  buffer_load_dwordx4 a[128:131], v1, s[44:47], s85 offen offset:0 sc1
  buffer_load_dwordx4 a[132:135], v1, s[44:47], s85 offen offset:1024 sc1
  buffer_load_dwordx4 a[136:139], v1, s[44:47], s85 offen offset:2048 sc1
  buffer_load_dwordx4 a[252:255], v1, s[44:47], s85 offen offset:3072 sc1
  s_waitcnt vmcnt(4)
  buffer_store_dword v13, v12, s[56:59], s95 offen offset:384 sc1
  s_and_b32 s65, s62, 1
  s_mul_i32 s65, s65, 18432
  v_and_b32 v83, 3, v0
  v_lshlrev_b32 v84, 2, v83
  v_lshrrev_b32 v85, 2, v0
  v_xor_b32 v84, v84, v85
  v_lshlrev_b32 v84, 4, v84
  v_lshl_add_u32 v83, v83, 8, v84
  v_bfe_u32 v84, v0, 4, 1
  v_lshl_add_u32 v83, v84, 3, v83
  s_xor_b32 s66, s65, 0
  v_add_u32 v240, s66, v83
  v_xor_b32 v241, 8, v240
  v_add_u32 v248, 0x10000, v240
  v_add_u32 v249, 0x10000, v241
  s_xor_b32 s66, s65, 2048
  v_add_u32 v242, s66, v83
  v_xor_b32 v243, 8, v242
  v_add_u32 v250, 0x10000, v242
  v_add_u32 v251, 0x10000, v243
  s_xor_b32 s66, s65, 16384
  v_add_u32 v244, s66, v83
  v_xor_b32 v245, 8, v244
  v_add_u32 v252, 0x10000, v244
  v_add_u32 v253, 0x10000, v245
  s_xor_b32 s66, s65, 18432
  v_add_u32 v246, s66, v83
  v_xor_b32 v247, 8, v246
  v_add_u32 v254, 0x10000, v246
  v_add_u32 v255, 0x10000, v247
  s_waitcnt lgkmcnt(15)
  s_cmp_eq_u32 s60, 0
  s_cbranch_scc1 L_late_o
  s_add_u32 s9, s8, 16384
  s_add_u32 m0, s63, 0
  s_nop 0
  buffer_load_dwordx4 v1, s[40:43], s9 offen offset:0 sc1 lds
  buffer_load_dwordx4 v1, s[40:43], s9 offen offset:1024 sc1 lds
  buffer_load_dwordx4 v1, s[40:43], s9 offen offset:2048 sc1 lds
  buffer_load_dwordx4 v1, s[40:43], s9 offen offset:3072 sc1 lds
  buffer_store_dwordx4 v[16:19], v10, s[40:43], s72 offen offset:0 sc1
  buffer_store_dwordx4 v[20:23], v10, s[40:43], s72 offen offset:1024 sc1
  buffer_store_dwordx4 v[24:27], v10, s[40:43], s72 offen offset:2048 sc1
  buffer_store_dwordx4 v[28:31], v10, s[40:43], s72 offen offset:3072 sc1
  s_waitcnt vmcnt(13)
L_late_o_back:
  s_waitcnt lgkmcnt(0)
  s_barrier
  ds_read_b64_tr_b16 v[144:145], v248 offset:32768
  ds_read_b64_tr_b16 v[146:147], v249 offset:32768
  ds_read_b64_tr_b16 v[148:149], v248 offset:33792
  ds_read_b64_tr_b16 v[150:151], v249 offset:33792
  ds_read_b64_tr_b16 v[152:153], v250 offset:32768
  ds_read_b64_tr_b16 v[154:155], v251 offset:32768
  ds_read_b64_tr_b16 v[156:157], v250 offset:33792
  ds_read_b64_tr_b16 v[158:159], v251 offset:33792
  ds_read_b64_tr_b16 v[176:177], v252 offset:32768
  ds_read_b64_tr_b16 v[178:179], v253 offset:32768
  ds_read_b64_tr_b16 v[180:181], v252 offset:33792
  ds_read_b64_tr_b16 v[182:183], v253 offset:33792
  ds_read_b64_tr_b16 v[184:185], v254 offset:32768
  ds_read_b64_tr_b16 v[186:187], v255 offset:32768
  ds_read_b64_tr_b16 v[188:189], v254 offset:33792
  ds_read_b64_tr_b16 v[190:191], v255 offset:33792
  s_waitcnt lgkmcnt(8)
  v_mfma_f32_16x16x32_bf16 v[192:195], a[140:143], v[144:147], 0
  s_add_u32 s10, s8, 540672
  v_mfma_f32_16x16x32_bf16 v[192:195], a[148:151], v[148:151], v[192:195]
  s_add_u32 m0, s63, 16384
  ds_read_b64_tr_b16 v[208:209], v248 offset:36864
  ds_read_b64_tr_b16 v[210:211], v249 offset:36864
  v_mfma_f32_16x16x32_bf16 v[192:195], a[156:159], v[152:155], v[192:195]
  s_lshl_b32 s65, s12, 2
  buffer_load_dwordx4 v1, s[40:43], s10 offen offset:0 sc1 lds
  v_mfma_f32_16x16x32_bf16 v[192:195], a[164:167], v[156:159], v[192:195]
  s_add_u32 s65, s65, s62
  ds_read_b64_tr_b16 v[212:213], v248 offset:37888
  ds_read_b64_tr_b16 v[214:215], v249 offset:37888
  v_mfma_f32_16x16x32_bf16 v[196:199], a[168:171], v[156:159], 0
  s_lshl_b32 s65, s65, 9
  buffer_load_dword v6, v7, s[56:59], 0 offen offset:384 sc1
  v_mfma_f32_16x16x32_bf16 v[196:199], a[160:163], v[152:155], v[196:199]
  s_add_u32 s65, s65, 3145728
  ds_read_b64_tr_b16 v[216:217], v250 offset:36864
  ds_read_b64_tr_b16 v[218:219], v251 offset:36864
  v_mfma_f32_16x16x32_bf16 v[196:199], a[152:155], v[148:151], v[196:199]
  s_mul_i32 s68, s12, 12
  buffer_load_dwordx4 v1, s[40:43], s10 offen offset:1024 sc1 lds
  v_mfma_f32_16x16x32_bf16 v[196:199], a[144:147], v[144:147], v[196:199]
  s_add_u32 s68, s68, s62
  ds_read_b64_tr_b16 v[220:221], v250 offset:37888
  ds_read_b64_tr_b16 v[222:223], v251 offset:37888
  v_mfma_f32_16x16x32_bf16 v[200:203], a[172:175], v[144:147], 0
  s_mul_i32 s68, s68, 3072
  v_mfma_f32_16x16x32_bf16 v[200:203], a[176:179], v[148:151], v[200:203]
  s_waitcnt lgkmcnt(8)
  buffer_load_dwordx4 v1, s[40:43], s10 offen offset:2048 sc1 lds
  v_mfma_f32_16x16x32_bf16 v[204:207], a[140:143], v[176:179], 0
  s_lshl_b32 s66, s62, 10
  v_mfma_f32_16x16x32_bf16 v[204:207], a[148:151], v[180:183], v[204:207]
  s_add_u32 s66, s66, 131072
  ds_read_b64_tr_b16 v[144:145], v252 offset:36864
  ds_read_b64_tr_b16 v[146:147], v253 offset:36864
  v_mfma_f32_16x16x32_bf16 v[204:207], a[156:159], v[184:187], v[204:207]
  s_mul_i32 s67, s62, 2688
  buffer_load_dwordx4 v1, s[40:43], s10 offen offset:3072 sc1 lds
  v_mfma_f32_16x16x32_bf16 v[204:207], a[164:167], v[188:191], v[204:207]
  s_add_u32 s67, s67, 135168
  ds_read_b64_tr_b16 v[148:149], v252 offset:37888
  ds_read_b64_tr_b16 v[150:151], v253 offset:37888
  v_mfma_f32_16x16x32_bf16 v[224:227], a[168:171], v[188:191], 0
  s_lshr_b32 s74, s62, 1
  v_mfma_f32_16x16x32_bf16 v[224:227], a[160:163], v[184:187], v[224:227]
  s_add_u32 s86, s18, 65536
  ds_read_b64_tr_b16 v[152:153], v254 offset:36864
  ds_read_b64_tr_b16 v[154:155], v255 offset:36864
  v_mfma_f32_16x16x32_bf16 v[224:227], a[152:155], v[180:183], v[224:227]
  s_mul_i32 s74, s74, 160
  buffer_load_dwordx4 v[128:131], v1, s[44:47], s86 offen offset:0 sc1
  v_mfma_f32_16x16x32_bf16 v[224:227], a[144:147], v[176:179], v[224:227]
  s_add_u32 s74, s74, 135168
  ds_read_b64_tr_b16 v[156:157], v254 offset:37888
  ds_read_b64_tr_b16 v[158:159], v255 offset:37888
  v_mfma_f32_16x16x32_bf16 v[228:231], a[172:175], v[176:179], 0
  s_and_b32 s75, s62, 1
  v_mfma_f32_16x16x32_bf16 v[228:231], a[176:179], v[180:183], v[228:231]
  s_waitcnt lgkmcnt(8)
  buffer_load_dwordx4 v[132:135], v1, s[44:47], s86 offen offset:1024 sc1
  v_mfma_f32_16x16x32_bf16 v[192:195], a[180:183], v[208:211], v[192:195]
  v_mfma_f32_16x16x32_bf16 v[192:195], a[188:191], v[212:215], v[192:195]
  ds_read_b64_tr_b16 v[176:177], v248 offset:40960
  ds_read_b64_tr_b16 v[178:179], v249 offset:40960
  v_mfma_f32_16x16x32_bf16 v[192:195], a[196:199], v[216:219], v[192:195]
  buffer_load_dwordx4 v[136:139], v1, s[44:47], s86 offen offset:2048 sc1
  v_mfma_f32_16x16x32_bf16 v[192:195], a[204:207], v[220:223], v[192:195]
  ds_read_b64_tr_b16 v[180:181], v248 offset:41984
  ds_read_b64_tr_b16 v[182:183], v249 offset:41984
  v_mfma_f32_16x16x32_bf16 v[196:199], a[208:211], v[220:223], v[196:199]
  v_mfma_f32_16x16x32_bf16 v[196:199], a[200:203], v[216:219], v[196:199]
  ds_read_b64_tr_b16 v[184:185], v250 offset:40960
  ds_read_b64_tr_b16 v[186:187], v251 offset:40960
  v_mfma_f32_16x16x32_bf16 v[196:199], a[192:195], v[212:215], v[196:199]
  buffer_load_dwordx4 v[140:143], v1, s[44:47], s86 offen offset:3072 sc1
  v_mfma_f32_16x16x32_bf16 v[196:199], a[184:187], v[208:211], v[196:199]
  ds_read_b64_tr_b16 v[188:189], v250 offset:41984
  ds_read_b64_tr_b16 v[190:191], v251 offset:41984
  v_mfma_f32_16x16x32_bf16 v[200:203], a[212:215], v[208:211], v[200:203]
  v_mfma_f32_16x16x32_bf16 v[200:203], a[216:219], v[212:215], v[200:203]
  s_waitcnt lgkmcnt(8)
  v_mfma_f32_16x16x32_bf16 v[204:207], a[180:183], v[144:147], v[204:207]
  s_add_u32 s87, s18, 69632
  v_mfma_f32_16x16x32_bf16 v[204:207], a[188:191], v[148:151], v[204:207]
  ds_read_b64_tr_b16 v[208:209], v252 offset:40960
  ds_read_b64_tr_b16 v[210:211], v253 offset:40960
  v_mfma_f32_16x16x32_bf16 v[204:207], a[196:199], v[152:155], v[204:207]
  buffer_load_dwordx4 v[160:163], v1, s[44:47], s87 offen offset:0 sc1
  v_mfma_f32_16x16x32_bf16 v[204:207], a[204:207], v[156:159], v[204:207]
  ds_read_b64_tr_b16 v[212:213], v252 offset:41984
  ds_read_b64_tr_b16 v[214:215], v253 offset:41984
  v_mfma_f32_16x16x32_bf16 v[224:227], a[208:211], v[156:159], v[224:227]
  s_waitcnt vmcnt(8)
  v_cmp_ne_u32 vcc, 1, v6
  v_mfma_f32_16x16x32_bf16 v[224:227], a[200:203], v[152:155], v[224:227]
  ds_read_b64_tr_b16 v[216:217], v254 offset:40960
  ds_read_b64_tr_b16 v[218:219], v255 offset:40960
  v_mfma_f32_16x16x32_bf16 v[224:227], a[192:195], v[148:151], v[224:227]
  s_cmp_eq_u64 vcc, 0
  buffer_load_dwordx4 v[164:167], v1, s[44:47], s87 offen offset:1024 sc1
  v_mfma_f32_16x16x32_bf16 v[224:227], a[184:187], v[144:147], v[224:227]
  s_cbranch_scc0 L_spin_oa
L_back_oa:
  ds_read_b64_tr_b16 v[220:221], v254 offset:41984
  ds_read_b64_tr_b16 v[222:223], v255 offset:41984
  v_mfma_f32_16x16x32_bf16 v[228:231], a[212:215], v[144:147], v[228:231]
  v_mfma_f32_16x16x32_bf16 v[228:231], a[216:219], v[148:151], v[228:231]
  s_waitcnt lgkmcnt(8)
  buffer_load_dwordx4 v[168:171], v1, s[44:47], s87 offen offset:2048 sc1
  v_mfma_f32_16x16x32_bf16 v[192:195], a[220:223], v[176:179], v[192:195]
  v_mfma_f32_16x16x32_bf16 v[192:195], a[228:231], v[180:183], v[192:195]
  ds_read_b64_tr_b16 v[144:145], v248 offset:45056
  ds_read_b64_tr_b16 v[146:147], v249 offset:45056
  v_mfma_f32_16x16x32_bf16 v[192:195], a[236:239], v[184:187], v[192:195]
  buffer_load_dwordx4 v[172:175], v1, s[44:47], s87 offen offset:3072 sc1
  v_mfma_f32_16x16x32_bf16 v[192:195], a[244:247], v[188:191], v[192:195]
  s_add_u32 s9, s8, 4096
  ds_read_b64_tr_b16 v[148:149], v248 offset:46080
  ds_read_b64_tr_b16 v[150:151], v249 offset:46080
  v_mfma_f32_16x16x32_bf16 v[196:199], a[248:251], v[188:191], v[196:199]
  s_add_u32 m0, s63, 32768
  v_cmp_gt_u32 vcc, 32, v0
  v_lshlrev_b32 v9, 3, v0
  v_mfma_f32_16x16x32_bf16 v[196:199], a[240:243], v[184:187], v[196:199]
  ds_read_b64_tr_b16 v[152:153], v250 offset:45056
  ds_read_b64_tr_b16 v[154:155], v251 offset:45056
  v_mfma_f32_16x16x32_bf16 v[196:199], a[232:235], v[180:183], v[196:199]
  buffer_load_dwordx4 v1, s[40:43], s9 offen offset:0 sc1 lds
  v_mfma_f32_16x16x32_bf16 v[196:199], a[224:227], v[176:179], v[196:199]
  ds_read_b64_tr_b16 v[156:157], v250 offset:46080
  ds_read_b64_tr_b16 v[158:159], v251 offset:46080
  v_mfma_f32_16x16x32_bf16 v[200:203], a[0:3], v[176:179], v[200:203]
  s_waitcnt vmcnt(14)
  v_min_u32 v2, 1, v0
  v_lshl_add_u32 v2, v2, 7, s65
  v_mfma_f32_16x16x32_bf16 v[200:203], a[4:7], v[180:183], v[200:203]
  s_waitcnt lgkmcnt(8)
  buffer_store_dword v13, v12, s[56:59], s95 offen offset:128 sc1
  v_mfma_f32_16x16x32_bf16 v[204:207], a[220:223], v[208:211], v[204:207]
  buffer_load_dwordx4 v1, s[40:43], s9 offen offset:1024 sc1 lds
  v_mfma_f32_16x16x32_bf16 v[204:207], a[228:231], v[212:215], v[204:207]
  ds_read_b64_tr_b16 v[176:177], v252 offset:45056
  ds_read_b64_tr_b16 v[178:179], v253 offset:45056
  v_mfma_f32_16x16x32_bf16 v[204:207], a[236:239], v[216:219], v[204:207]
  v_add_u32 v104, s66, v1
  v_xor_b32 v105, 1024, v104
  v_mfma_f32_16x16x32_bf16 v[204:207], a[244:247], v[220:223], v[204:207]
  ds_read_b64_tr_b16 v[180:181], v252 offset:46080
  ds_read_b64_tr_b16 v[182:183], v253 offset:46080
  v_mfma_f32_16x16x32_bf16 v[224:227], a[248:251], v[220:223], v[224:227]
  buffer_load_dwordx4 v1, s[40:43], s9 offen offset:2048 sc1 lds
  v_mfma_f32_16x16x32_bf16 v[224:227], a[240:243], v[216:219], v[224:227]
  ds_read_b64_tr_b16 v[184:185], v254 offset:45056
  ds_read_b64_tr_b16 v[186:187], v255 offset:45056
  v_mfma_f32_16x16x32_bf16 v[224:227], a[232:235], v[212:215], v[224:227]
  v_and_b32 v3, 15, v0
  v_mul_u32_u24 v3, 336, v3
  v_mfma_f32_16x16x32_bf16 v[224:227], a[224:227], v[208:211], v[224:227]
  ds_read_b64_tr_b16 v[188:189], v254 offset:46080
  ds_read_b64_tr_b16 v[190:191], v255 offset:46080
  v_mfma_f32_16x16x32_bf16 v[228:231], a[0:3], v[208:211], v[228:231]
  s_waitcnt vmcnt(12)
  buffer_load_dwordx4 v1, s[40:43], s9 offen offset:3072 sc1 lds
  v_mfma_f32_16x16x32_bf16 v[228:231], a[4:7], v[212:215], v[228:231]
  s_waitcnt lgkmcnt(8)
  v_lshrrev_b32 v4, 4, v0
  v_lshl_add_u32 v3, v4, 3, v3
  v_mfma_f32_16x16x32_bf16 v[192:195], a[8:11], v[144:147], v[192:195]
  s_barrier
  v_add_u32 v3, s74, v3
  v_mov_b32 v4, s75
  v_mfma_f32_16x16x32_bf16 v[192:195], a[16:19], v[148:151], v[192:195]
  s_add_u32 s10, s8, 528384
  ds_read_b64_tr_b16 v[208:209], v240 offset:0
  ds_read_b64_tr_b16 v[210:211], v241 offset:0
  v_mfma_f32_16x16x32_bf16 v[192:195], a[24:27], v[152:155], v[192:195]
  s_add_u32 m0, s63, 49152
  v_mul_u32_u24 v5, 5376, v4
  v_mul_u32_u24 v4, 96, v4
  v_mfma_f32_16x16x32_bf16 v[192:195], a[32:35], v[156:159], v[192:195]
L_hopb1:
  s_cbranch_execz L_hopback2
  ds_read_b64_tr_b16 v[212:213], v240 offset:1024
  ds_read_b64_tr_b16 v[214:215], v241 offset:1024
  v_mfma_f32_16x16x32_bf16 v[196:199], a[36:39], v[156:159], v[196:199]
  buffer_load_dwordx4 v1, s[40:43], s10 offen offset:0 sc1 lds
  v_mfma_f32_16x16x32_bf16 v[196:199], a[28:31], v[152:155], v[196:199]
  ds_read_b64_tr_b16 v[216:217], v242 offset:0
  ds_read_b64_tr_b16 v[218:219], v243 offset:0
  v_mfma_f32_16x16x32_bf16 v[196:199], a[20:23], v[148:151], v[196:199]
  v_add3_u32 v108, v3, v5, 64
  v_add3_u32 v106, v3, v5, v4
  v_mfma_f32_16x16x32_bf16 v[196:199], a[12:15], v[144:147], v[196:199]
  ds_read_b64_tr_b16 v[220:221], v242 offset:1024
  ds_read_b64_tr_b16 v[222:223], v243 offset:1024
  v_mfma_f32_16x16x32_bf16 v[200:203], a[40:43], v[144:147], v[200:203]
  buffer_load_dwordx4 v1, s[40:43], s10 offen offset:1024 sc1 lds
  v_mfma_f32_16x16x32_bf16 v[200:203], a[44:47], v[148:151], v[200:203]
  s_waitcnt lgkmcnt(8)
  v_sub_u32 v5, 5376, v5
  v_add3_u32 v107, v3, v5, v4
  v_mfma_f32_16x16x32_bf16 v[204:207], a[8:11], v[176:179], v[204:207]
  v_mov_b32 v3, v0
  v_mul_u32_u24 v4, 3277, v3
  v_mfma_f32_16x16x32_bf16 v[204:207], a[16:19], v[180:183], v[204:207]
  ds_read_b64_tr_b16 v[144:145], v244 offset:0
  ds_read_b64_tr_b16 v[146:147], v245 offset:0
  v_mfma_f32_16x16x32_bf16 v[204:207], a[24:27], v[184:187], v[204:207]
  buffer_load_dwordx4 v1, s[40:43], s10 offen offset:2048 sc1 lds
  v_mfma_f32_16x16x32_bf16 v[204:207], a[32:35], v[188:191], v[204:207]
  ds_read_b64_tr_b16 v[148:149], v244 offset:1024
  ds_read_b64_tr_b16 v[150:151], v245 offset:1024
  v_mfma_f32_16x16x32_bf16 v[224:227], a[36:39], v[188:191], v[224:227]
  v_lshrrev_b32 v4, 16, v4
  v_add_u32 v5, v3, v4
  v_mfma_f32_16x16x32_bf16 v[224:227], a[28:31], v[184:187], v[224:227]
  ds_read_b64_tr_b16 v[152:153], v246 offset:0
  ds_read_b64_tr_b16 v[154:155], v247 offset:0
  v_mfma_f32_16x16x32_bf16 v[224:227], a[20:23], v[180:183], v[224:227]
  buffer_load_dwordx4 v1, s[40:43], s10 offen offset:3072 sc1 lds
  v_mfma_f32_16x16x32_bf16 v[224:227], a[12:15], v[176:179], v[224:227]
  s_add_u32 s9, s8, 20480
  ds_read_b64_tr_b16 v[156:157], v246 offset:1024
  ds_read_b64_tr_b16 v[158:159], v247 offset:1024
  v_mfma_f32_16x16x32_bf16 v[228:231], a[40:43], v[176:179], v[228:231]
  s_add_u32 m0, s63, 65536
  v_lshl_add_u32 v109, v5, 4, s67
  v_mul_u32_u24 v4, 960, v4
  v_mfma_f32_16x16x32_bf16 v[228:231], a[44:47], v[180:183], v[228:231]
  s_waitcnt lgkmcnt(8)
  buffer_load_dwordx4 v1, s[40:43], s9 offen offset:0 sc1 lds
  v_mfma_f32_16x16x32_bf16 v[192:195], a[48:51], v[208:211], v[192:195]
  v_lshl_add_u32 v11, v3, 4, v4
  v_add_u32 v3, 64, v0
  v_mfma_f32_16x16x32_bf16 v[192:195], a[56:59], v[212:215], v[192:195]
  ds_read_b64_tr_b16 v[176:177], v240 offset:4096
  ds_read_b64_tr_b16 v[178:179], v241 offset:4096
  v_mfma_f32_16x16x32_bf16 v[192:195], a[64:67], v[216:219], v[192:195]
  v_mul_u32_u24 v4, 3277, v3
  v_lshrrev_b32 v4, 16, v4
  v_mfma_f32_16x16x32_bf16 v[192:195], a[72:75], v[220:223], v[192:195]
  ds_read_b64_tr_b16 v[180:181], v240 offset:5120
  ds_read_b64_tr_b16 v[182:183], v241 offset:5120
  v_mfma_f32_16x16x32_bf16 v[196:199], a[76:79], v[220:223], v[196:199]
  v_add_u32 v5, v3, v4
  v_lshl_add_u32 v110, v5, 4, s67
  v_mfma_f32_16x16x32_bf16 v[196:199], a[68:71], v[216:219], v[196:199]
  ds_read_b64_tr_b16 v[184:185], v242 offset:4096
  ds_read_b64_tr_b16 v[186:187], v243 offset:4096
  v_mfma_f32_16x16x32_bf16 v[196:199], a[60:63], v[212:215], v[196:199]
  buffer_load_dwordx4 v1, s[40:43], s9 offen offset:1024 sc1 lds
  v_mfma_f32_16x16x32_bf16 v[196:199], a[52:55], v[208:211], v[196:199]
  ds_read_b64_tr_b16 v[188:189], v242 offset:5120
  ds_read_b64_tr_b16 v[190:191], v243 offset:5120
  v_mfma_f32_16x16x32_bf16 v[200:203], a[80:83], v[208:211], v[200:203]
  v_mul_u32_u24 v4, 960, v4
  v_lshl_add_u32 v14, v3, 4, v4
  v_mfma_f32_16x16x32_bf16 v[200:203], a[84:87], v[212:215], v[200:203]
  s_waitcnt lgkmcnt(8)
  v_and_b32 v3, 31, v0
  v_add_u32 v3, 128, v3
  v_mfma_f32_16x16x32_bf16 v[204:207], a[48:51], v[144:147], v[204:207]
  v_mul_u32_u24 v4, 3277, v3
  v_lshrrev_b32 v4, 16, v4
  v_mfma_f32_16x16x32_bf16 v[204:207], a[56:59], v[148:151], v[204:207]
  ds_read_b64_tr_b16 v[208:209], v244 offset:4096
  ds_read_b64_tr_b16 v[210:211], v245 offset:4096
  v_mfma_f32_16x16x32_bf16 v[204:207], a[64:67], v[152:155], v[204:207]
  v_add_u32 v5, v3, v4
  v_lshl_add_u32 v111, v5, 4, s67
  v_mfma_f32_16x16x32_bf16 v[204:207], a[72:75], v[156:159], v[204:207]
  ds_read_b64_tr_b16 v[212:213], v244 offset:5120
  ds_read_b64_tr_b16 v[214:215], v245 offset:5120
  v_mfma_f32_16x16x32_bf16 v[224:227], a[76:79], v[156:159], v[224:227]
  buffer_load_dwordx4 v1, s[40:43], s9 offen offset:2048 sc1 lds
  v_mfma_f32_16x16x32_bf16 v[224:227], a[68:71], v[152:155], v[224:227]
  ds_read_b64_tr_b16 v[216:217], v246 offset:4096
  ds_read_b64_tr_b16 v[218:219], v247 offset:4096
  v_mfma_f32_16x16x32_bf16 v[224:227], a[60:63], v[148:151], v[224:227]
  v_mul_u32_u24 v4, 960, v4
  v_lshl_add_u32 v8, v3, 4, v4
  v_mfma_f32_16x16x32_bf16 v[224:227], a[52:55], v[144:147], v[224:227]
  ds_read_b64_tr_b16 v[220:221], v246 offset:5120
  ds_read_b64_tr_b16 v[222:223], v247 offset:5120
  v_mfma_f32_16x16x32_bf16 v[228:231], a[80:83], v[144:147], v[228:231]
  v_mov_b32 v3, 2147483392
  v_cndmask_b32 v8, v3, v8, vcc
  v_mfma_f32_16x16x32_bf16 v[228:231], a[84:87], v[148:151], v[228:231]
  s_waitcnt lgkmcnt(8)
  v_mfma_f32_16x16x32_bf16 v[192:195], a[88:91], v[176:179], v[192:195]
  buffer_store_dwordx4 v[112:115], v10, s[40:43], s73 offen offset:0 sc1
  v_mfma_f32_16x16x32_bf16 v[192:195], a[96:99], v[180:183], v[192:195]
  ds_read_b64_tr_b16 v[144:145], v240 offset:8192
  ds_read_b64_tr_b16 v[146:147], v241 offset:8192
  v_mfma_f32_16x16x32_bf16 v[192:195], a[104:107], v[184:187], v[192:195]
  buffer_load_dwordx4 v1, s[40:43], s9 offen offset:3072 sc1 lds
  v_mfma_f32_16x16x32_bf16 v[192:195], a[112:115], v[188:191], v[192:195]
  ds_read_b64_tr_b16 v[148:149], v240 offset:9216
  ds_read_b64_tr_b16 v[150:151], v241 offset:9216
  v_mfma_f32_16x16x32_bf16 v[196:199], a[116:119], v[188:191], v[196:199]
  v_mfma_f32_16x16x32_bf16 v[196:199], a[108:111], v[184:187], v[196:199]
  ds_read_b64_tr_b16 v[152:153], v242 offset:8192
  ds_read_b64_tr_b16 v[154:155], v243 offset:8192
  v_mfma_f32_16x16x32_bf16 v[196:199], a[100:103], v[180:183], v[196:199]
  v_mfma_f32_16x16x32_bf16 v[196:199], a[92:95], v[176:179], v[196:199]
  ds_read_b64_tr_b16 v[156:157], v242 offset:9216
  ds_read_b64_tr_b16 v[158:159], v243 offset:9216
  v_mfma_f32_16x16x32_bf16 v[200:203], a[120:123], v[176:179], v[200:203]
  buffer_store_dwordx4 v[116:119], v10, s[40:43], s73 offen offset:1024 sc1
  v_mfma_f32_16x16x32_bf16 v[200:203], a[124:127], v[180:183], v[200:203]
  s_waitcnt lgkmcnt(8)
  v_mfma_f32_16x16x32_bf16 v[204:207], a[88:91], v[208:211], v[204:207]
  s_add_u32 s10, s8, 544768
  v_mfma_f32_16x16x32_bf16 v[204:207], a[96:99], v[212:215], v[204:207]
  s_add_u32 m0, s63, 81920
  ds_read_b64_tr_b16 v[176:177], v244 offset:8192
  ds_read_b64_tr_b16 v[178:179], v245 offset:8192
  v_mfma_f32_16x16x32_bf16 v[204:207], a[104:107], v[216:219], v[204:207]
  buffer_load_dwordx4 v1, s[40:43], s10 offen offset:0 sc1 lds
  v_mfma_f32_16x16x32_bf16 v[204:207], a[112:115], v[220:223], v[204:207]
  ds_read_b64_tr_b16 v[180:181], v244 offset:9216
  ds_read_b64_tr_b16 v[182:183], v245 offset:9216
  v_mfma_f32_16x16x32_bf16 v[224:227], a[116:119], v[220:223], v[224:227]
  v_mfma_f32_16x16x32_bf16 v[224:227], a[108:111], v[216:219], v[224:227]
  ds_read_b64_tr_b16 v[184:185], v246 offset:8192
  ds_read_b64_tr_b16 v[186:187], v247 offset:8192
  v_mfma_f32_16x16x32_bf16 v[224:227], a[100:103], v[212:215], v[224:227]
  buffer_store_dwordx4 v[120:123], v10, s[40:43], s73 offen offset:2048 sc1
  v_mfma_f32_16x16x32_bf16 v[224:227], a[92:95], v[208:211], v[224:227]
  ds_read_b64_tr_b16 v[188:189], v246 offset:9216
  ds_read_b64_tr_b16 v[190:191], v247 offset:9216
  v_mfma_f32_16x16x32_bf16 v[228:231], a[120:123], v[208:211], v[228:231]
  s_waitcnt vmcnt(17)
  v_mfma_f32_16x16x32_bf16 v[228:231], a[124:127], v[212:215], v[228:231]
  s_waitcnt lgkmcnt(8)
  buffer_load_dwordx4 v1, s[40:43], s10 offen offset:1024 sc1 lds
  v_mfma_f32_16x16x32_bf16 v[192:195], a[128:131], v[144:147], v[192:195]
  v_mfma_f32_16x16x32_bf16 v[192:195], a[136:139], v[148:151], v[192:195]
  ds_read_b64_tr_b16 v[208:209], v244 offset:12288
  ds_read_b64_tr_b16 v[210:211], v245 offset:12288
  v_mfma_f32_16x16x32_bf16 v[192:195], v[128:131], v[152:155], v[192:195]
  v_mfma_f32_16x16x32_bf16 v[192:195], v[136:139], v[156:159], v[192:195]
  ds_read_b64_tr_b16 v[212:213], v244 offset:13312
  ds_read_b64_tr_b16 v[214:215], v245 offset:13312
  v_mfma_f32_16x16x32_bf16 v[196:199], v[140:143], v[156:159], v[196:199]
  buffer_store_dwordx4 v[124:127], v10, s[40:43], s73 offen offset:3072 sc1
  v_mfma_f32_16x16x32_bf16 v[196:199], v[132:135], v[152:155], v[196:199]
  ds_read_b64_tr_b16 v[216:217], v246 offset:12288
  ds_read_b64_tr_b16 v[218:219], v247 offset:12288
  v_mfma_f32_16x16x32_bf16 v[196:199], a[252:255], v[148:151], v[196:199]
  buffer_load_dwordx4 v1, s[40:43], s10 offen offset:2048 sc1 lds
  v_mfma_f32_16x16x32_bf16 v[196:199], a[132:135], v[144:147], v[196:199]
  ds_read_b64_tr_b16 v[220:221], v246 offset:13312
  ds_read_b64_tr_b16 v[222:223], v247 offset:13312
  v_mfma_f32_16x16x32_bf16 v[200:203], v[160:163], v[144:147], v[200:203]
  v_mfma_f32_16x16x32_bf16 v[200:203], v[164:167], v[148:151], v[200:203]
  s_waitcnt lgkmcnt(8)
  v_mfma_f32_16x16x32_bf16 v[204:207], a[128:131], v[176:179], v[204:207]
  v_mfma_f32_16x16x32_bf16 v[204:207], a[136:139], v[180:183], v[204:207]
  ds_read_b64_tr_b16 v[144:145], v240 offset:12288
  ds_read_b64_tr_b16 v[146:147], v241 offset:12288
  v_mfma_f32_16x16x32_bf16 v[204:207], v[128:131], v[184:187], v[204:207]
  v_mfma_f32_16x16x32_bf16 v[204:207], v[136:139], v[188:191], v[204:207]
  ds_read_b64_tr_b16 v[148:149], v240 offset:13312
  ds_read_b64_tr_b16 v[150:151], v241 offset:13312
  v_mfma_f32_16x16x32_bf16 v[224:227], v[140:143], v[188:191], v[224:227]
  buffer_load_dwordx4 v1, s[40:43], s10 offen offset:3072 sc1 lds
  v_mfma_f32_16x16x32_bf16 v[224:227], v[132:135], v[184:187], v[224:227]
  ds_read_b64_tr_b16 v[152:153], v242 offset:12288
  ds_read_b64_tr_b16 v[154:155], v243 offset:12288
  v_mfma_f32_16x16x32_bf16 v[224:227], a[252:255], v[180:183], v[224:227]
  v_mfma_f32_16x16x32_bf16 v[224:227], a[132:135], v[176:179], v[224:227]
  ds_read_b64_tr_b16 v[156:157], v242 offset:13312
  ds_read_b64_tr_b16 v[158:159], v243 offset:13312
  v_mfma_f32_16x16x32_bf16 v[228:231], v[160:163], v[176:179], v[228:231]
  s_waitcnt vmcnt(12)
  v_mfma_f32_16x16x32_bf16 v[228:231], v[164:167], v[180:183], v[228:231]
  s_waitcnt lgkmcnt(8)
  v_mfma_f32_16x16x32_bf16 v[228:231], v[60:63], v[212:215], v[228:231]
  s_barrier
  v_mfma_f32_16x16x32_bf16 v[228:231], v[56:59], v[208:211], v[228:231]
  ds_read_b64_tr_b16 v[176:177], v240 offset:32768
  ds_read_b64_tr_b16 v[178:179], v241 offset:32768
  v_mfma_f32_16x16x32_bf16 v[204:207], v[168:171], v[208:211], v[204:207]
  v_mfma_f32_16x16x32_bf16 v[204:207], v[32:35], v[212:215], v[204:207]
  ds_read_b64_tr_b16 v[180:181], v240 offset:33792
  ds_read_b64_tr_b16 v[182:183], v241 offset:33792
  v_mfma_f32_16x16x32_bf16 v[204:207], v[40:43], v[216:219], v[204:207]
  v_mfma_f32_16x16x32_bf16 v[204:207], v[48:51], v[220:223], v[204:207]
  ds_read_b64_tr_b16 v[184:185], v242 offset:32768
  ds_read_b64_tr_b16 v[186:187], v243 offset:32768
  v_mfma_f32_16x16x32_bf16 v[224:227], v[52:55], v[220:223], v[224:227]
  v_mfma_f32_16x16x32_bf16 v[224:227], v[44:47], v[216:219], v[224:227]
  ds_read_b64_tr_b16 v[188:189], v242 offset:33792
  ds_read_b64_tr_b16 v[190:191], v243 offset:33792
  v_mfma_f32_16x16x32_bf16 v[224:227], v[36:39], v[212:215], v[224:227]
  ds_write_b128 v104, v[228:231]
  v_mfma_f32_16x16x32_bf16 v[224:227], v[172:175], v[208:211], v[224:227]
  s_waitcnt lgkmcnt(9)
  v_mfma_f32_16x16x32_bf16 v[200:203], v[60:63], v[148:151], v[200:203]
  buffer_load_dword v6, v7, s[56:59], 0 offen offset:128 sc1
  v_mfma_f32_16x16x32_bf16 v[200:203], v[56:59], v[144:147], v[200:203]
  ds_read_b64_tr_b16 v[208:209], v244 offset:32768
  ds_read_b64_tr_b16 v[210:211], v245 offset:32768
  v_mfma_f32_16x16x32_bf16 v[192:195], v[168:171], v[144:147], v[192:195]
  v_mfma_f32_16x16x32_bf16 v[192:195], v[32:35], v[148:151], v[192:195]
  ds_read_b64_tr_b16 v[212:213], v244 offset:33792
  ds_read_b64_tr_b16 v[214:215], v245 offset:33792
  v_mfma_f32_16x16x32_bf16 v[192:195], v[40:43], v[152:155], v[192:195]
  v_cvt_pk_bf16_f32 v84, v204, v205
  v_cvt_pk_bf16_f32 v85, v206, v207
  v_mfma_f32_16x16x32_bf16 v[192:195], v[48:51], v[156:159], v[192:195]
  ds_read_b64_tr_b16 v[216:217], v246 offset:32768
  ds_read_b64_tr_b16 v[218:219], v247 offset:32768
  v_mfma_f32_16x16x32_bf16 v[196:199], v[52:55], v[156:159], v[196:199]
  v_cvt_pk_bf16_f32 v86, v224, v225
  v_cvt_pk_bf16_f32 v87, v226, v227
  v_mfma_f32_16x16x32_bf16 v[196:199], v[44:47], v[152:155], v[196:199]
  ds_read_b64_tr_b16 v[220:221], v246 offset:33792
  ds_read_b64_tr_b16 v[222:223], v247 offset:33792
  v_mfma_f32_16x16x32_bf16 v[196:199], v[36:39], v[148:151], v[196:199]
  s_waitcnt lgkmcnt(8)
  buffer_store_dwordx4 v[84:87], v1, s[4:7], s14 offen offset:1024 sc1
  v_mfma_f32_16x16x32_bf16 v[196:199], v[172:175], v[144:147], v[196:199]
  s_waitcnt lgkmcnt(9)
  v_mfma_f32_16x16x32_bf16 v[232:235], a[140:143], v[176:179], 0
  s_barrier
  ds_read_b128 v[92:95], v105
  v_mfma_f32_16x16x32_bf16 v[232:235], a[148:151], v[180:183], v[232:235]
  ds_read_b64_tr_b16 v[144:145], v240 offset:36864
  ds_read_b64_tr_b16 v[146:147], v241 offset:36864
  v_mfma_f32_16x16x32_bf16 v[232:235], a[156:159], v[184:187], v[232:235]
  v_cvt_pk_bf16_f32 v80, v192, v193
  v_cvt_pk_bf16_f32 v81, v194, v195
  v_mfma_f32_16x16x32_bf16 v[232:235], a[164:167], v[188:191], v[232:235]
  ds_read_b64_tr_b16 v[148:149], v240 offset:37888
  ds_read_b64_tr_b16 v[150:151], v241 offset:37888
  v_mfma_f32_16x16x32_bf16 v[236:239], a[168:171], v[188:191], 0
  v_cvt_pk_bf16_f32 v82, v196, v197
  v_cvt_pk_bf16_f32 v83, v198, v199
  v_mfma_f32_16x16x32_bf16 v[236:239], a[160:163], v[184:187], v[236:239]
  ds_read_b64_tr_b16 v[152:153], v242 offset:36864
  ds_read_b64_tr_b16 v[154:155], v243 offset:36864
  v_mfma_f32_16x16x32_bf16 v[236:239], a[152:155], v[180:183], v[236:239]
  buffer_store_dwordx4 v[80:83], v1, s[4:7], s14 offen offset:0 sc1
  v_mfma_f32_16x16x32_bf16 v[236:239], a[144:147], v[176:179], v[236:239]
  s_waitcnt lgkmcnt(6)
  ds_read_b64_tr_b16 v[156:157], v242 offset:37888
  ds_read_b64_tr_b16 v[158:159], v243 offset:37888
  v_mfma_f32_16x16x32_bf16 v[64:67], a[172:175], v[176:179], 0
  v_add_f32 v200, v200, v92
  v_add_f32 v201, v201, v93
  v_mfma_f32_16x16x32_bf16 v[64:67], a[176:179], v[180:183], v[64:67]
  s_waitcnt lgkmcnt(9)
  v_add_f32 v202, v202, v94
  v_add_f32 v203, v203, v95
  v_mfma_f32_16x16x32_bf16 v[68:71], a[140:143], v[208:211], 0
  v_cvt_pk_bf16_f32 v88, v200, v201
  v_cvt_pk_bf16_f32 v89, v202, v203
  v_mfma_f32_16x16x32_bf16 v[68:71], a[148:151], v[212:215], v[68:71]
  ds_read_b64_tr_b16 v[176:177], v244 offset:36864
  ds_read_b64_tr_b16 v[178:179], v245 offset:36864
  v_mfma_f32_16x16x32_bf16 v[68:71], a[156:159], v[216:219], v[68:71]
  s_waitcnt vmcnt(5)
  buffer_store_dwordx2 v[88:89], v9, s[4:7], s14 offen offset:2048 sc1
  v_mfma_f32_16x16x32_bf16 v[68:71], a[164:167], v[220:223], v[68:71]
  ds_read_b64_tr_b16 v[180:181], v244 offset:37888
  ds_read_b64_tr_b16 v[182:183], v245 offset:37888
  v_mfma_f32_16x16x32_bf16 v[72:75], a[168:171], v[220:223], 0
  buffer_store_dword v13, v12, s[56:59], s95 offen offset:256 sc1
  v_mfma_f32_16x16x32_bf16 v[72:75], a[160:163], v[216:219], v[72:75]
  ds_read_b64_tr_b16 v[184:185], v246 offset:36864
  ds_read_b64_tr_b16 v[186:187], v247 offset:36864
  v_mfma_f32_16x16x32_bf16 v[72:75], a[152:155], v[212:215], v[72:75]
  v_mfma_f32_16x16x32_bf16 v[72:75], a[144:147], v[208:211], v[72:75]
  ds_read_b64_tr_b16 v[188:189], v246 offset:37888
  ds_read_b64_tr_b16 v[190:191], v247 offset:37888
  v_mfma_f32_16x16x32_bf16 v[76:79], a[172:175], v[208:211], 0
  v_mfma_f32_16x16x32_bf16 v[76:79], a[176:179], v[212:215], v[76:79]
  s_waitcnt lgkmcnt(8)
  v_mfma_f32_16x16x32_bf16 v[232:235], a[180:183], v[144:147], v[232:235]
  s_waitcnt vmcnt(4)
  v_cmp_ne_u32 vcc, 1, v6
  v_mfma_f32_16x16x32_bf16 v[232:235], a[188:191], v[148:151], v[232:235]
  ds_read_b64_tr_b16 v[208:209], v240 offset:40960
  ds_read_b64_tr_b16 v[210:211], v241 offset:40960
  v_mfma_f32_16x16x32_bf16 v[232:235], a[196:199], v[152:155], v[232:235]
  s_cmp_eq_u64 vcc, 0
  v_mfma_f32_16x16x32_bf16 v[232:235], a[204:207], v[156:159], v[232:235]
  s_cbranch_scc0 L_spin_ob
L_back_ob:
  ds_read_b64_tr_b16 v[212:213], v240 offset:41984
  ds_read_b64_tr_b16 v[214:215], v241 offset:41984
  v_mfma_f32_16x16x32_bf16 v[236:239], a[208:211], v[156:159], v[236:239]
  s_add_u32 s9, s8, 8192
  v_mfma_f32_16x16x32_bf16 v[236:239], a[200:203], v[152:155], v[236:239]
  s_add_u32 m0, s63, 98304
  ds_read_b64_tr_b16 v[216:217], v242 offset:40960
  ds_read_b64_tr_b16 v[218:219], v243 offset:40960
  v_mfma_f32_16x16x32_bf16 v[236:239], a[192:195], v[148:151], v[236:239]
  buffer_load_dwordx4 v1, s[40:43], s9 offen offset:0 sc1 lds
  v_mfma_f32_16x16x32_bf16 v[236:239], a[184:187], v[144:147], v[236:239]
  ds_read_b64_tr_b16 v[220:221], v242 offset:41984
  ds_read_b64_tr_b16 v[222:223], v243 offset:41984
  v_mfma_f32_16x16x32_bf16 v[64:67], a[212:215], v[144:147], v[64:67]
  v_mfma_f32_16x16x32_bf16 v[64:67], a[216:219], v[148:151], v[64:67]
  s_waitcnt lgkmcnt(8)
  v_mfma_f32_16x16x32_bf16 v[68:71], a[180:183], v[176:179], v[68:71]
  v_mfma_f32_16x16x32_bf16 v[68:71], a[188:191], v[180:183], v[68:71]
  ds_read_b64_tr_b16 v[144:145], v244 offset:40960
  ds_read_b64_tr_b16 v[146:147], v245 offset:40960
  v_mfma_f32_16x16x32_bf16 v[68:71], a[196:199], v[184:187], v[68:71]
  v_mfma_f32_16x16x32_bf16 v[68:71], a[204:207], v[188:191], v[68:71]
  ds_read_b64_tr_b16 v[148:149], v244 offset:41984
  ds_read_b64_tr_b16 v[150:151], v245 offset:41984
  v_mfma_f32_16x16x32_bf16 v[72:75], a[208:211], v[188:191], v[72:75]
  buffer_load_dwordx4 v1, s[40:43], s9 offen offset:1024 sc1 lds
  v_mfma_f32_16x16x32_bf16 v[72:75], a[200:203], v[184:187], v[72:75]
  ds_read_b64_tr_b16 v[152:153], v246 offset:40960
  ds_read_b64_tr_b16 v[154:155], v247 offset:40960
  v_mfma_f32_16x16x32_bf16 v[72:75], a[192:195], v[180:183], v[72:75]
  v_mfma_f32_16x16x32_bf16 v[72:75], a[184:187], v[176:179], v[72:75]
  ds_read_b64_tr_b16 v[156:157], v246 offset:41984
  ds_read_b64_tr_b16 v[158:159], v247 offset:41984
  v_mfma_f32_16x16x32_bf16 v[76:79], a[212:215], v[176:179], v[76:79]
  v_mfma_f32_16x16x32_bf16 v[76:79], a[216:219], v[180:183], v[76:79]
  s_waitcnt lgkmcnt(8)
  v_mfma_f32_16x16x32_bf16 v[232:235], a[220:223], v[208:211], v[232:235]
  v_mfma_f32_16x16x32_bf16 v[232:235], a[228:231], v[212:215], v[232:235]
  ds_read_b64_tr_b16 v[176:177], v240 offset:45056
  ds_read_b64_tr_b16 v[178:179], v241 offset:45056
  v_mfma_f32_16x16x32_bf16 v[232:235], a[236:239], v[216:219], v[232:235]
  buffer_load_dwordx4 v1, s[40:43], s9 offen offset:2048 sc1 lds
  v_mfma_f32_16x16x32_bf16 v[232:235], a[244:247], v[220:223], v[232:235]
  ds_read_b64_tr_b16 v[180:181], v240 offset:46080
  ds_read_b64_tr_b16 v[182:183], v241 offset:46080
  v_mfma_f32_16x16x32_bf16 v[236:239], a[248:251], v[220:223], v[236:239]
  v_mfma_f32_16x16x32_bf16 v[236:239], a[240:243], v[216:219], v[236:239]
  ds_read_b64_tr_b16 v[184:185], v242 offset:45056
  ds_read_b64_tr_b16 v[186:187], v243 offset:45056
  v_mfma_f32_16x16x32_bf16 v[236:239], a[232:235], v[212:215], v[236:239]
  v_mfma_f32_16x16x32_bf16 v[236:239], a[224:227], v[208:211], v[236:239]
  ds_read_b64_tr_b16 v[188:189], v242 offset:46080
  ds_read_b64_tr_b16 v[190:191], v243 offset:46080
  v_mfma_f32_16x16x32_bf16 v[64:67], a[0:3], v[208:211], v[64:67]
  v_mfma_f32_16x16x32_bf16 v[64:67], a[4:7], v[212:215], v[64:67]
  s_waitcnt lgkmcnt(8)
  buffer_load_dwordx4 v1, s[40:43], s9 offen offset:3072 sc1 lds
  v_mfma_f32_16x16x32_bf16 v[68:71], a[220:223], v[144:147], v[68:71]
  v_mfma_f32_16x16x32_bf16 v[68:71], a[228:231], v[148:151], v[68:71]
  ds_read_b64_tr_b16 v[208:209], v244 offset:45056
  ds_read_b64_tr_b16 v[210:211], v245 offset:45056
  v_mfma_f32_16x16x32_bf16 v[68:71], a[236:239], v[152:155], v[68:71]
  v_mfma_f32_16x16x32_bf16 v[68:71], a[244:247], v[156:159], v[68:71]
  ds_read_b64_tr_b16 v[212:213], v244 offset:46080
  ds_read_b64_tr_b16 v[214:215], v245 offset:46080
  v_mfma_f32_16x16x32_bf16 v[72:75], a[248:251], v[156:159], v[72:75]
  v_mfma_f32_16x16x32_bf16 v[72:75], a[240:243], v[152:155], v[72:75]
  ds_read_b64_tr_b16 v[216:217], v246 offset:45056
  ds_read_b64_tr_b16 v[218:219], v247 offset:45056
  v_mfma_f32_16x16x32_bf16 v[72:75], a[232:235], v[148:151], v[72:75]
  s_add_u32 s10, s8, 532480
  v_mfma_f32_16x16x32_bf16 v[72:75], a[224:227], v[144:147], v[72:75]
  s_add_u32 m0, s63, 114688
  ds_read_b64_tr_b16 v[220:221], v246 offset:46080
  ds_read_b64_tr_b16 v[222:223], v247 offset:46080
  v_mfma_f32_16x16x32_bf16 v[76:79], a[0:3], v[144:147], v[76:79]
  s_waitcnt vmcnt(9)
  buffer_load_dwordx4 v1, s[40:43], s10 offen offset:0 sc1 lds
  v_mfma_f32_16x16x32_bf16 v[76:79], a[4:7], v[148:151], v[76:79]
  s_waitcnt lgkmcnt(8)
  v_mfma_f32_16x16x32_bf16 v[232:235], a[8:11], v[176:179], v[232:235]
  s_barrier
  v_mfma_f32_16x16x32_bf16 v[232:235], a[16:19], v[180:183], v[232:235]
  s_waitcnt vmcnt(6)
  ds_read_b64_tr_b16 v[144:145], v248 offset:0
  ds_read_b64_tr_b16 v[146:147], v249 offset:0
  v_mfma_f32_16x16x32_bf16 v[232:235], a[24:27], v[184:187], v[232:235]
  buffer_store_dword v13, v12, s[56:59], s0 offen sc1
  v_mfma_f32_16x16x32_bf16 v[232:235], a[32:35], v[188:191], v[232:235]
  ds_read_b64_tr_b16 v[148:149], v248 offset:1024
  ds_read_b64_tr_b16 v[150:151], v249 offset:1024
  v_mfma_f32_16x16x32_bf16 v[236:239], a[36:39], v[188:191], v[236:239]
  v_mfma_f32_16x16x32_bf16 v[236:239], a[28:31], v[184:187], v[236:239]
  ds_read_b64_tr_b16 v[152:153], v250 offset:0
  ds_read_b64_tr_b16 v[154:155], v251 offset:0
  v_mfma_f32_16x16x32_bf16 v[236:239], a[20:23], v[180:183], v[236:239]
  buffer_load_dwordx4 v1, s[40:43], s10 offen offset:1024 sc1 lds
  v_mfma_f32_16x16x32_bf16 v[236:239], a[12:15], v[176:179], v[236:239]
  ds_read_b64_tr_b16 v[156:157], v250 offset:1024
  ds_read_b64_tr_b16 v[158:159], v251 offset:1024
  v_mfma_f32_16x16x32_bf16 v[64:67], a[40:43], v[176:179], v[64:67]
  v_mfma_f32_16x16x32_bf16 v[64:67], a[44:47], v[180:183], v[64:67]
  s_waitcnt lgkmcnt(8)
  v_mfma_f32_16x16x32_bf16 v[68:71], a[8:11], v[208:211], v[68:71]
  v_mfma_f32_16x16x32_bf16 v[68:71], a[16:19], v[212:215], v[68:71]
  ds_read_b64_tr_b16 v[176:177], v252 offset:0
  ds_read_b64_tr_b16 v[178:179], v253 offset:0
  v_mfma_f32_16x16x32_bf16 v[68:71], a[24:27], v[216:219], v[68:71]
  v_mfma_f32_16x16x32_bf16 v[68:71], a[32:35], v[220:223], v[68:71]
  ds_read_b64_tr_b16 v[180:181], v252 offset:1024
  ds_read_b64_tr_b16 v[182:183], v253 offset:1024
  v_mfma_f32_16x16x32_bf16 v[72:75], a[36:39], v[220:223], v[72:75]
  buffer_load_dwordx4 v1, s[40:43], s10 offen offset:2048 sc1 lds
  v_mfma_f32_16x16x32_bf16 v[72:75], a[28:31], v[216:219], v[72:75]
  ds_read_b64_tr_b16 v[184:185], v254 offset:0
  ds_read_b64_tr_b16 v[186:187], v255 offset:0
  v_mfma_f32_16x16x32_bf16 v[72:75], a[20:23], v[212:215], v[72:75]
  v_mfma_f32_16x16x32_bf16 v[72:75], a[12:15], v[208:211], v[72:75]
  ds_read_b64_tr_b16 v[188:189], v254 offset:1024
  ds_read_b64_tr_b16 v[190:191], v255 offset:1024
  v_mfma_f32_16x16x32_bf16 v[76:79], a[40:43], v[208:211], v[76:79]
  v_mfma_f32_16x16x32_bf16 v[76:79], a[44:47], v[212:215], v[76:79]
  s_waitcnt lgkmcnt(8)
  v_mfma_f32_16x16x32_bf16 v[232:235], a[48:51], v[144:147], v[232:235]
  v_mfma_f32_16x16x32_bf16 v[232:235], a[56:59], v[148:151], v[232:235]
  ds_read_b64_tr_b16 v[208:209], v248 offset:4096
  ds_read_b64_tr_b16 v[210:211], v249 offset:4096
  v_mfma_f32_16x16x32_bf16 v[232:235], a[64:67], v[152:155], v[232:235]
  buffer_load_dwordx4 v1, s[40:43], s10 offen offset:3072 sc1 lds
  v_mfma_f32_16x16x32_bf16 v[232:235], a[72:75], v[156:159], v[232:235]
  s_add_u32 s9, s8, 24576
  ds_read_b64_tr_b16 v[212:213], v248 offset:5120
  ds_read_b64_tr_b16 v[214:215], v249 offset:5120
  v_mfma_f32_16x16x32_bf16 v[236:239], a[76:79], v[156:159], v[236:239]
  s_add_u32 m0, s63, 0
  v_mfma_f32_16x16x32_bf16 v[236:239], a[68:71], v[152:155], v[236:239]
  ds_read_b64_tr_b16 v[216:217], v250 offset:4096
  ds_read_b64_tr_b16 v[218:219], v251 offset:4096
  v_mfma_f32_16x16x32_bf16 v[236:239], a[60:63], v[148:151], v[236:239]
  buffer_load_dwordx4 v1, s[40:43], s9 offen offset:0 sc1 lds
  v_mfma_f32_16x16x32_bf16 v[236:239], a[52:55], v[144:147], v[236:239]
  ds_read_b64_tr_b16 v[220:221], v250 offset:5120
  ds_read_b64_tr_b16 v[222:223], v251 offset:5120
  v_mfma_f32_16x16x32_bf16 v[64:67], a[80:83], v[144:147], v[64:67]
  v_mfma_f32_16x16x32_bf16 v[64:67], a[84:87], v[148:151], v[64:67]
  s_waitcnt lgkmcnt(8)
  v_mfma_f32_16x16x32_bf16 v[68:71], a[48:51], v[176:179], v[68:71]
  v_mfma_f32_16x16x32_bf16 v[68:71], a[56:59], v[180:183], v[68:71]
  ds_read_b64_tr_b16 v[144:145], v252 offset:4096
  ds_read_b64_tr_b16 v[146:147], v253 offset:4096
  v_mfma_f32_16x16x32_bf16 v[68:71], a[64:67], v[184:187], v[68:71]
  v_mfma_f32_16x16x32_bf16 v[68:71], a[72:75], v[188:191], v[68:71]
  ds_read_b64_tr_b16 v[148:149], v252 offset:5120
  ds_read_b64_tr_b16 v[150:151], v253 offset:5120
  v_mfma_f32_16x16x32_bf16 v[72:75], a[76:79], v[188:191], v[72:75]
  buffer_load_dwordx4 v1, s[40:43], s9 offen offset:1024 sc1 lds
  v_mfma_f32_16x16x32_bf16 v[72:75], a[68:71], v[184:187], v[72:75]
  ds_read_b64_tr_b16 v[152:153], v254 offset:4096
  ds_read_b64_tr_b16 v[154:155], v255 offset:4096
  v_mfma_f32_16x16x32_bf16 v[72:75], a[60:63], v[180:183], v[72:75]
  v_mfma_f32_16x16x32_bf16 v[72:75], a[52:55], v[176:179], v[72:75]
  ds_read_b64_tr_b16 v[156:157], v254 offset:5120
  ds_read_b64_tr_b16 v[158:159], v255 offset:5120
  v_mfma_f32_16x16x32_bf16 v[76:79], a[80:83], v[176:179], v[76:79]
  v_mfma_f32_16x16x32_bf16 v[76:79], a[84:87], v[180:183], v[76:79]
  s_waitcnt lgkmcnt(8)
  v_mfma_f32_16x16x32_bf16 v[232:235], a[88:91], v[208:211], v[232:235]
  v_mfma_f32_16x16x32_bf16 v[232:235], a[96:99], v[212:215], v[232:235]
  ds_read_b64_tr_b16 v[176:177], v248 offset:8192
  ds_read_b64_tr_b16 v[178:179], v249 offset:8192
  v_mfma_f32_16x16x32_bf16 v[232:235], a[104:107], v[216:219], v[232:235]
  buffer_load_dwordx4 v1, s[40:43], s9 offen offset:2048 sc1 lds
  v_mfma_f32_16x16x32_bf16 v[232:235], a[112:115], v[220:223], v[232:235]
  ds_read_b64_tr_b16 v[180:181], v248 offset:9216
  ds_read_b64_tr_b16 v[182:183], v249 offset:9216
  v_mfma_f32_16x16x32_bf16 v[236:239], a[116:119], v[220:223], v[236:239]
  v_mfma_f32_16x16x32_bf16 v[236:239], a[108:111], v[216:219], v[236:239]
  ds_read_b64_tr_b16 v[184:185], v250 offset:8192
  ds_read_b64_tr_b16 v[186:187], v251 offset:8192
  v_mfma_f32_16x16x32_bf16 v[236:239], a[100:103], v[212:215], v[236:239]
  v_mfma_f32_16x16x32_bf16 v[236:239], a[92:95], v[208:211], v[236:239]
  ds_read_b64_tr_b16 v[188:189], v250 offset:9216
  ds_read_b64_tr_b16 v[190:191], v251 offset:9216
  v_mfma_f32_16x16x32_bf16 v[64:67], a[120:123], v[208:211], v[64:67]
  v_mfma_f32_16x16x32_bf16 v[64:67], a[124:127], v[212:215], v[64:67]
  s_waitcnt lgkmcnt(8)
  buffer_load_dwordx4 v1, s[40:43], s9 offen offset:3072 sc1 lds
  v_mfma_f32_16x16x32_bf16 v[68:71], a[88:91], v[144:147], v[68:71]
  v_mfma_f32_16x16x32_bf16 v[68:71], a[96:99], v[148:151], v[68:71]
  ds_read_b64_tr_b16 v[208:209], v252 offset:8192
  ds_read_b64_tr_b16 v[210:211], v253 offset:8192
  v_mfma_f32_16x16x32_bf16 v[68:71], a[104:107], v[152:155], v[68:71]
  v_mfma_f32_16x16x32_bf16 v[68:71], a[112:115], v[156:159], v[68:71]
  ds_read_b64_tr_b16 v[212:213], v252 offset:9216
  ds_read_b64_tr_b16 v[214:215], v253 offset:9216
  v_mfma_f32_16x16x32_bf16 v[72:75], a[116:119], v[156:159], v[72:75]
  v_mfma_f32_16x16x32_bf16 v[72:75], a[108:111], v[152:155], v[72:75]
  ds_read_b64_tr_b16 v[216:217], v254 offset:8192
  ds_read_b64_tr_b16 v[218:219], v255 offset:8192
  v_mfma_f32_16x16x32_bf16 v[72:75], a[100:103], v[148:151], v[72:75]
  s_add_u32 s10, s8, 548864
  v_mfma_f32_16x16x32_bf16 v[72:75], a[92:95], v[144:147], v[72:75]
  s_add_u32 m0, s63, 16384
  ds_read_b64_tr_b16 v[220:221], v254 offset:9216
  ds_read_b64_tr_b16 v[222:223], v255 offset:9216
  v_mfma_f32_16x16x32_bf16 v[76:79], a[120:123], v[144:147], v[76:79]
  buffer_load_dwordx4 v1, s[40:43], s10 offen offset:0 sc1 lds
  v_mfma_f32_16x16x32_bf16 v[76:79], a[124:127], v[148:151], v[76:79]
  s_waitcnt lgkmcnt(8)
  v_mfma_f32_16x16x32_bf16 v[232:235], a[128:131], v[176:179], v[232:235]
  v_mfma_f32_16x16x32_bf16 v[232:235], a[136:139], v[180:183], v[232:235]
  ds_read_b64_tr_b16 v[144:145], v252 offset:12288
  ds_read_b64_tr_b16 v[146:147], v253 offset:12288
  v_mfma_f32_16x16x32_bf16 v[232:235], v[128:131], v[184:187], v[232:235]
  v_mfma_f32_16x16x32_bf16 v[232:235], v[136:139], v[188:191], v[232:235]
  ds_read_b64_tr_b16 v[148:149], v252 offset:13312
  ds_read_b64_tr_b16 v[150:151], v253 offset:13312
  v_mfma_f32_16x16x32_bf16 v[236:239], v[140:143], v[188:191], v[236:239]
  v_mfma_f32_16x16x32_bf16 v[236:239], v[132:135], v[184:187], v[236:239]
  ds_read_b64_tr_b16 v[152:153], v254 offset:12288
  ds_read_b64_tr_b16 v[154:155], v255 offset:12288
  v_mfma_f32_16x16x32_bf16 v[236:239], a[252:255], v[180:183], v[236:239]
  buffer_load_dwordx4 v1, s[40:43], s10 offen offset:1024 sc1 lds
  v_mfma_f32_16x16x32_bf16 v[236:239], a[132:135], v[176:179], v[236:239]
L_hopb2:
  s_cbranch_execz L_hopback2
  ds_read_b64_tr_b16 v[156:157], v254 offset:13312
  ds_read_b64_tr_b16 v[158:159], v255 offset:13312
  v_mfma_f32_16x16x32_bf16 v[64:67], v[160:163], v[176:179], v[64:67]
  buffer_load_dword v6, v7, s[56:59], 0 offen offset:256 sc1
  v_mfma_f32_16x16x32_bf16 v[64:67], v[164:167], v[180:183], v[64:67]
  s_waitcnt lgkmcnt(8)
  v_mfma_f32_16x16x32_bf16 v[68:71], a[128:131], v[208:211], v[68:71]
  v_mfma_f32_16x16x32_bf16 v[68:71], a[136:139], v[212:215], v[68:71]
  ds_read_b64_tr_b16 v[176:177], v248 offset:12288
  ds_read_b64_tr_b16 v[178:179], v249 offset:12288
  v_mfma_f32_16x16x32_bf16 v[68:71], v[128:131], v[216:219], v[68:71]
  v_mfma_f32_16x16x32_bf16 v[68:71], v[136:139], v[220:223], v[68:71]
  ds_read_b64_tr_b16 v[180:181], v248 offset:13312
  ds_read_b64_tr_b16 v[182:183], v249 offset:13312
  v_mfma_f32_16x16x32_bf16 v[72:75], v[140:143], v[220:223], v[72:75]
  buffer_load_dwordx4 v1, s[40:43], s10 offen offset:2048 sc1 lds
  v_mfma_f32_16x16x32_bf16 v[72:75], v[132:135], v[216:219], v[72:75]
  ds_read_b64_tr_b16 v[184:185], v250 offset:12288
  ds_read_b64_tr_b16 v[186:187], v251 offset:12288
  v_mfma_f32_16x16x32_bf16 v[72:75], a[252:255], v[212:215], v[72:75]
  v_mfma_f32_16x16x32_bf16 v[72:75], a[132:135], v[208:211], v[72:75]
  ds_read_b64_tr_b16 v[188:189], v250 offset:13312
  ds_read_b64_tr_b16 v[190:191], v251 offset:13312
  v_mfma_f32_16x16x32_bf16 v[76:79], v[160:163], v[208:211], v[76:79]
  s_waitcnt vmcnt(8)
  v_mfma_f32_16x16x32_bf16 v[76:79], v[164:167], v[212:215], v[76:79]
  s_waitcnt lgkmcnt(8)
  v_mfma_f32_16x16x32_bf16 v[76:79], v[60:63], v[148:151], v[76:79]
  s_barrier
  v_mfma_f32_16x16x32_bf16 v[76:79], v[56:59], v[144:147], v[76:79]
  ds_read_b64_tr_b16 v[208:209], v248 offset:32768
  ds_read_b64_tr_b16 v[210:211], v249 offset:32768
  v_mfma_f32_16x16x32_bf16 v[68:71], v[168:171], v[144:147], v[68:71]
  buffer_load_dwordx4 v1, s[40:43], s10 offen offset:3072 sc1 lds
  v_mfma_f32_16x16x32_bf16 v[68:71], v[32:35], v[148:151], v[68:71]
  ds_read_b64_tr_b16 v[212:213], v248 offset:33792
  ds_read_b64_tr_b16 v[214:215], v249 offset:33792
  v_mfma_f32_16x16x32_bf16 v[68:71], v[40:43], v[152:155], v[68:71]
  v_mfma_f32_16x16x32_bf16 v[68:71], v[48:51], v[156:159], v[68:71]
  ds_read_b64_tr_b16 v[216:217], v250 offset:32768
  ds_read_b64_tr_b16 v[218:219], v251 offset:32768
  v_mfma_f32_16x16x32_bf16 v[72:75], v[52:55], v[156:159], v[72:75]
  v_mfma_f32_16x16x32_bf16 v[72:75], v[44:47], v[152:155], v[72:75]
  ds_read_b64_tr_b16 v[220:221], v250 offset:33792
  ds_read_b64_tr_b16 v[222:223], v251 offset:33792
  v_mfma_f32_16x16x32_bf16 v[72:75], v[36:39], v[148:151], v[72:75]
  ds_write_b128 v104, v[76:79]
  v_mfma_f32_16x16x32_bf16 v[72:75], v[172:175], v[144:147], v[72:75]
  s_waitcnt lgkmcnt(9)
  v_mfma_f32_16x16x32_bf16 v[64:67], v[60:63], v[180:183], v[64:67]
  v_mfma_f32_16x16x32_bf16 v[64:67], v[56:59], v[176:179], v[64:67]
  ds_read_b64_tr_b16 v[144:145], v252 offset:32768
  ds_read_b64_tr_b16 v[146:147], v253 offset:32768
  v_mfma_f32_16x16x32_bf16 v[232:235], v[168:171], v[176:179], v[232:235]
  v_mfma_f32_16x16x32_bf16 v[232:235], v[32:35], v[180:183], v[232:235]
  ds_read_b64_tr_b16 v[148:149], v252 offset:33792
  ds_read_b64_tr_b16 v[150:151], v253 offset:33792
  v_mfma_f32_16x16x32_bf16 v[232:235], v[40:43], v[184:187], v[232:235]
  v_cvt_pk_bf16_f32 v84, v68, v69
  v_cvt_pk_bf16_f32 v85, v70, v71
  v_mfma_f32_16x16x32_bf16 v[232:235], v[48:51], v[188:191], v[232:235]
  ds_read_b64_tr_b16 v[152:153], v254 offset:32768
  ds_read_b64_tr_b16 v[154:155], v255 offset:32768
  v_mfma_f32_16x16x32_bf16 v[236:239], v[52:55], v[188:191], v[236:239]
  v_cvt_pk_bf16_f32 v86, v72, v73
  v_cvt_pk_bf16_f32 v87, v74, v75
  v_mfma_f32_16x16x32_bf16 v[236:239], v[44:47], v[184:187], v[236:239]
  ds_read_b64_tr_b16 v[156:157], v254 offset:33792
  ds_read_b64_tr_b16 v[158:159], v255 offset:33792
  v_mfma_f32_16x16x32_bf16 v[236:239], v[36:39], v[180:183], v[236:239]
  s_waitcnt lgkmcnt(8)
  buffer_store_dwordx4 v[84:87], v1, s[4:7], s15 offen offset:1024 sc1
  v_mfma_f32_16x16x32_bf16 v[236:239], v[172:175], v[176:179], v[236:239]
  s_waitcnt lgkmcnt(9)
  v_mfma_f32_16x16x32_bf16 v[192:195], a[140:143], v[208:211], 0
  s_barrier
  ds_read_b128 v[92:95], v105
  v_mfma_f32_16x16x32_bf16 v[192:195], a[148:151], v[212:215], v[192:195]
  ds_read_b64_tr_b16 v[176:177], v248 offset:36864
  ds_read_b64_tr_b16 v[178:179], v249 offset:36864
  v_mfma_f32_16x16x32_bf16 v[192:195], a[156:159], v[216:219], v[192:195]
  v_cvt_pk_bf16_f32 v80, v232, v233
  v_cvt_pk_bf16_f32 v81, v234, v235
  v_mfma_f32_16x16x32_bf16 v[192:195], a[164:167], v[220:223], v[192:195]
  ds_read_b64_tr_b16 v[180:181], v248 offset:37888
  ds_read_b64_tr_b16 v[182:183], v249 offset:37888
  v_mfma_f32_16x16x32_bf16 v[196:199], a[168:171], v[220:223], 0
  v_cvt_pk_bf16_f32 v82, v236, v237
  v_cvt_pk_bf16_f32 v83, v238, v239
  v_mfma_f32_16x16x32_bf16 v[196:199], a[160:163], v[216:219], v[196:199]
  ds_read_b64_tr_b16 v[184:185], v250 offset:36864
  ds_read_b64_tr_b16 v[186:187], v251 offset:36864
  v_mfma_f32_16x16x32_bf16 v[196:199], a[152:155], v[212:215], v[196:199]
  buffer_store_dwordx4 v[80:83], v1, s[4:7], s15 offen offset:0 sc1
  v_mfma_f32_16x16x32_bf16 v[196:199], a[144:147], v[208:211], v[196:199]
  s_waitcnt lgkmcnt(6)
  ds_read_b64_tr_b16 v[188:189], v250 offset:37888
  ds_read_b64_tr_b16 v[190:191], v251 offset:37888
  v_mfma_f32_16x16x32_bf16 v[200:203], a[172:175], v[208:211], 0
  v_add_f32 v64, v64, v92
  v_add_f32 v65, v65, v93
  v_mfma_f32_16x16x32_bf16 v[200:203], a[176:179], v[212:215], v[200:203]
  s_waitcnt lgkmcnt(9)
  v_add_f32 v66, v66, v94
  v_add_f32 v67, v67, v95
  v_mfma_f32_16x16x32_bf16 v[204:207], a[140:143], v[144:147], 0
  v_cvt_pk_bf16_f32 v88, v64, v65
  v_cvt_pk_bf16_f32 v89, v66, v67
  v_mfma_f32_16x16x32_bf16 v[204:207], a[148:151], v[148:151], v[204:207]
  ds_read_b64_tr_b16 v[208:209], v252 offset:36864
  ds_read_b64_tr_b16 v[210:211], v253 offset:36864
  v_mfma_f32_16x16x32_bf16 v[204:207], a[156:159], v[152:155], v[204:207]
  buffer_store_dwordx2 v[88:89], v9, s[4:7], s15 offen offset:2048 sc1
  v_mfma_f32_16x16x32_bf16 v[204:207], a[164:167], v[156:159], v[204:207]
  ds_read_b64_tr_b16 v[212:213], v252 offset:37888
  ds_read_b64_tr_b16 v[214:215], v253 offset:37888
  v_mfma_f32_16x16x32_bf16 v[224:227], a[168:171], v[156:159], 0
  s_waitcnt vmcnt(5)
  v_cmp_ne_u32 vcc, 1, v6
  v_mfma_f32_16x16x32_bf16 v[224:227], a[160:163], v[152:155], v[224:227]
  ds_read_b64_tr_b16 v[216:217], v254 offset:36864
  ds_read_b64_tr_b16 v[218:219], v255 offset:36864
  v_mfma_f32_16x16x32_bf16 v[224:227], a[152:155], v[148:151], v[224:227]
  s_cmp_eq_u64 vcc, 0
  v_mfma_f32_16x16x32_bf16 v[224:227], a[144:147], v[144:147], v[224:227]
  s_cbranch_scc0 L_spin_oc
L_back_oc:
  ds_read_b64_tr_b16 v[220:221], v254 offset:37888
  ds_read_b64_tr_b16 v[222:223], v255 offset:37888
  v_mfma_f32_16x16x32_bf16 v[228:231], a[172:175], v[144:147], 0
  s_add_u32 s9, s8, 28672
  v_mfma_f32_16x16x32_bf16 v[228:231], a[176:179], v[148:151], v[228:231]
  s_waitcnt lgkmcnt(8)
  v_mfma_f32_16x16x32_bf16 v[192:195], a[180:183], v[176:179], v[192:195]
  s_add_u32 m0, s63, 32768
  v_mfma_f32_16x16x32_bf16 v[192:195], a[188:191], v[180:183], v[192:195]
  ds_read_b64_tr_b16 v[144:145], v248 offset:40960
  ds_read_b64_tr_b16 v[146:147], v249 offset:40960
  v_mfma_f32_16x16x32_bf16 v[192:195], a[196:199], v[184:187], v[192:195]
  buffer_load_dwordx4 v1, s[40:43], s9 offen offset:0 sc1 lds
  v_mfma_f32_16x16x32_bf16 v[192:195], a[204:207], v[188:191], v[192:195]
  ds_read_b64_tr_b16 v[148:149], v248 offset:41984
  ds_read_b64_tr_b16 v[150:151], v249 offset:41984
  v_mfma_f32_16x16x32_bf16 v[196:199], a[208:211], v[188:191], v[196:199]
  v_mfma_f32_16x16x32_bf16 v[196:199], a[200:203], v[184:187], v[196:199]
  ds_read_b64_tr_b16 v[152:153], v250 offset:40960
  ds_read_b64_tr_b16 v[154:155], v251 offset:40960
  v_mfma_f32_16x16x32_bf16 v[196:199], a[192:195], v[180:183], v[196:199]
  v_mfma_f32_16x16x32_bf16 v[196:199], a[184:187], v[176:179], v[196:199]
  ds_read_b64_tr_b16 v[156:157], v250 offset:41984
  ds_read_b64_tr_b16 v[158:159], v251 offset:41984
  v_mfma_f32_16x16x32_bf16 v[200:203], a[212:215], v[176:179], v[200:203]
  v_mfma_f32_16x16x32_bf16 v[200:203], a[216:219], v[180:183], v[200:203]
  s_waitcnt lgkmcnt(8)
  buffer_load_dwordx4 v1, s[40:43], s9 offen offset:1024 sc1 lds
  v_mfma_f32_16x16x32_bf16 v[204:207], a[180:183], v[208:211], v[204:207]
  v_mfma_f32_16x16x32_bf16 v[204:207], a[188:191], v[212:215], v[204:207]
  ds_read_b64_tr_b16 v[176:177], v252 offset:40960
  ds_read_b64_tr_b16 v[178:179], v253 offset:40960
  v_mfma_f32_16x16x32_bf16 v[204:207], a[196:199], v[216:219], v[204:207]
  v_mfma_f32_16x16x32_bf16 v[204:207], a[204:207], v[220:223], v[204:207]
  ds_read_b64_tr_b16 v[180:181], v252 offset:41984
  ds_read_b64_tr_b16 v[182:183], v253 offset:41984
  v_mfma_f32_16x16x32_bf16 v[224:227], a[208:211], v[220:223], v[224:227]
  v_mfma_f32_16x16x32_bf16 v[224:227], a[200:203], v[216:219], v[224:227]
  ds_read_b64_tr_b16 v[184:185], v254 offset:40960
  ds_read_b64_tr_b16 v[186:187], v255 offset:40960
  v_mfma_f32_16x16x32_bf16 v[224:227], a[192:195], v[212:215], v[224:227]
  buffer_load_dwordx4 v1, s[40:43], s9 offen offset:2048 sc1 lds
  v_mfma_f32_16x16x32_bf16 v[224:227], a[184:187], v[208:211], v[224:227]
  ds_read_b64_tr_b16 v[188:189], v254 offset:41984
  ds_read_b64_tr_b16 v[190:191], v255 offset:41984
  v_mfma_f32_16x16x32_bf16 v[228:231], a[212:215], v[208:211], v[228:231]
  v_mfma_f32_16x16x32_bf16 v[228:231], a[216:219], v[212:215], v[228:231]
  s_waitcnt lgkmcnt(8)
  v_mfma_f32_16x16x32_bf16 v[192:195], a[220:223], v[144:147], v[192:195]
  v_mfma_f32_16x16x32_bf16 v[192:195], a[228:231], v[148:151], v[192:195]
  ds_read_b64_tr_b16 v[208:209], v248 offset:45056
  ds_read_b64_tr_b16 v[210:211], v249 offset:45056
  v_mfma_f32_16x16x32_bf16 v[192:195], a[236:239], v[152:155], v[192:195]
  v_mfma_f32_16x16x32_bf16 v[192:195], a[244:247], v[156:159], v[192:195]
  ds_read_b64_tr_b16 v[212:213], v248 offset:46080
  ds_read_b64_tr_b16 v[214:215], v249 offset:46080
  v_mfma_f32_16x16x32_bf16 v[196:199], a[248:251], v[156:159], v[196:199]
  buffer_load_dwordx4 v1, s[40:43], s9 offen offset:3072 sc1 lds
  v_mfma_f32_16x16x32_bf16 v[196:199], a[240:243], v[152:155], v[196:199]
  ds_read_b64_tr_b16 v[216:217], v250 offset:45056
  ds_read_b64_tr_b16 v[218:219], v251 offset:45056
  v_mfma_f32_16x16x32_bf16 v[196:199], a[232:235], v[148:151], v[196:199]
  v_mfma_f32_16x16x32_bf16 v[196:199], a[224:227], v[144:147], v[196:199]
  ds_read_b64_tr_b16 v[220:221], v250 offset:46080
  ds_read_b64_tr_b16 v[222:223], v251 offset:46080
  v_mfma_f32_16x16x32_bf16 v[200:203], a[0:3], v[144:147], v[200:203]
  v_mfma_f32_16x16x32_bf16 v[200:203], a[4:7], v[148:151], v[200:203]
  s_waitcnt lgkmcnt(8)
  v_mfma_f32_16x16x32_bf16 v[204:207], a[220:223], v[176:179], v[204:207]
  v_mfma_f32_16x16x32_bf16 v[204:207], a[228:231], v[180:183], v[204:207]
  s_add_u32 s10, s8, 552960
  ds_read_b64_tr_b16 v[144:145], v252 offset:45056
  ds_read_b64_tr_b16 v[146:147], v253 offset:45056
  v_mfma_f32_16x16x32_bf16 v[204:207], a[236:239], v[184:187], v[204:207]
  s_add_u32 m0, s63, 49152
  v_mfma_f32_16x16x32_bf16 v[204:207], a[244:247], v[188:191], v[204:207]
  ds_read_b64_tr_b16 v[148:149], v252 offset:46080
  ds_read_b64_tr_b16 v[150:151], v253 offset:46080
  v_mfma_f32_16x16x32_bf16 v[224:227], a[248:251], v[188:191], v[224:227]
  buffer_load_dwordx4 v1, s[40:43], s10 offen offset:0 sc1 lds
  v_mfma_f32_16x16x32_bf16 v[224:227], a[240:243], v[184:187], v[224:227]
  ds_read_b64_tr_b16 v[152:153], v254 offset:45056
  ds_read_b64_tr_b16 v[154:155], v255 offset:45056
  v_mfma_f32_16x16x32_bf16 v[224:227], a[232:235], v[180:183], v[224:227]
  v_mfma_f32_16x16x32_bf16 v[224:227], a[224:227], v[176:179], v[224:227]
  ds_read_b64_tr_b16 v[156:157], v254 offset:46080
  ds_read_b64_tr_b16 v[158:159], v255 offset:46080
  v_mfma_f32_16x16x32_bf16 v[228:231], a[0:3], v[176:179], v[228:231]
  s_waitcnt vmcnt(8)
  v_mfma_f32_16x16x32_bf16 v[228:231], a[4:7], v[180:183], v[228:231]
  s_waitcnt lgkmcnt(8)
  v_mfma_f32_16x16x32_bf16 v[192:195], a[8:11], v[208:211], v[192:195]
  s_barrier
  v_mfma_f32_16x16x32_bf16 v[192:195], a[16:19], v[212:215], v[192:195]
  s_waitcnt vmcnt(5)
  ds_read_b64_tr_b16 v[176:177], v240 offset:0
  ds_read_b64_tr_b16 v[178:179], v241 offset:0
  v_mfma_f32_16x16x32_bf16 v[192:195], a[24:27], v[216:219], v[192:195]
  buffer_store_dword v13, v12, s[56:59], s1 offen sc1
  v_mfma_f32_16x16x32_bf16 v[192:195], a[32:35], v[220:223], v[192:195]
  ds_read_b64_tr_b16 v[180:181], v240 offset:1024
  ds_read_b64_tr_b16 v[182:183], v241 offset:1024
  v_mfma_f32_16x16x32_bf16 v[196:199], a[36:39], v[220:223], v[196:199]
  buffer_load_dwordx4 v1, s[40:43], s10 offen offset:1024 sc1 lds
  v_mfma_f32_16x16x32_bf16 v[196:199], a[28:31], v[216:219], v[196:199]
  ds_read_b64_tr_b16 v[184:185], v242 offset:0
  ds_read_b64_tr_b16 v[186:187], v243 offset:0
  v_mfma_f32_16x16x32_bf16 v[196:199], a[20:23], v[212:215], v[196:199]
  v_mfma_f32_16x16x32_bf16 v[196:199], a[12:15], v[208:211], v[196:199]
  ds_read_b64_tr_b16 v[188:189], v242 offset:1024
  ds_read_b64_tr_b16 v[190:191], v243 offset:1024
  v_mfma_f32_16x16x32_bf16 v[200:203], a[40:43], v[208:211], v[200:203]
  v_mfma_f32_16x16x32_bf16 v[200:203], a[44:47], v[212:215], v[200:203]
  s_waitcnt lgkmcnt(8)
  v_mfma_f32_16x16x32_bf16 v[204:207], a[8:11], v[144:147], v[204:207]
  v_mfma_f32_16x16x32_bf16 v[204:207], a[16:19], v[148:151], v[204:207]
  ds_read_b64_tr_b16 v[208:209], v244 offset:0
  ds_read_b64_tr_b16 v[210:211], v245 offset:0
  v_mfma_f32_16x16x32_bf16 v[204:207], a[24:27], v[152:155], v[204:207]
  buffer_load_dwordx4 v1, s[40:43], s10 offen offset:2048 sc1 lds
  v_mfma_f32_16x16x32_bf16 v[204:207], a[32:35], v[156:159], v[204:207]
  ds_read_b64_tr_b16 v[212:213], v244 offset:1024
  ds_read_b64_tr_b16 v[214:215], v245 offset:1024
  v_mfma_f32_16x16x32_bf16 v[224:227], a[36:39], v[156:159], v[224:227]
  v_mfma_f32_16x16x32_bf16 v[224:227], a[28:31], v[152:155], v[224:227]
  ds_read_b64_tr_b16 v[216:217], v246 offset:0
  ds_read_b64_tr_b16 v[218:219], v247 offset:0
  v_mfma_f32_16x16x32_bf16 v[224:227], a[20:23], v[148:151], v[224:227]
  v_mfma_f32_16x16x32_bf16 v[224:227], a[12:15], v[144:147], v[224:227]
  ds_read_b64_tr_b16 v[220:221], v246 offset:1024
  ds_read_b64_tr_b16 v[222:223], v247 offset:1024
  v_mfma_f32_16x16x32_bf16 v[228:231], a[40:43], v[144:147], v[228:231]
  v_mfma_f32_16x16x32_bf16 v[228:231], a[44:47], v[148:151], v[228:231]
  s_waitcnt lgkmcnt(8)
  buffer_load_dwordx4 v1, s[40:43], s10 offen offset:3072 sc1 lds
  v_mfma_f32_16x16x32_bf16 v[192:195], a[48:51], v[176:179], v[192:195]
  s_add_u32 s9, s8, 12288
  v_mfma_f32_16x16x32_bf16 v[192:195], a[56:59], v[180:183], v[192:195]
  s_add_u32 m0, s63, 65536
  ds_read_b64_tr_b16 v[144:145], v240 offset:4096
  ds_read_b64_tr_b16 v[146:147], v241 offset:4096
  v_mfma_f32_16x16x32_bf16 v[192:195], a[64:67], v[184:187], v[192:195]
  buffer_load_dwordx4 v1, s[40:43], s9 offen offset:0 sc1 lds
  v_mfma_f32_16x16x32_bf16 v[192:195], a[72:75], v[188:191], v[192:195]
  ds_read_b64_tr_b16 v[148:149], v240 offset:5120
  ds_read_b64_tr_b16 v[150:151], v241 offset:5120
  v_mfma_f32_16x16x32_bf16 v[196:199], a[76:79], v[188:191], v[196:199]
  v_mfma_f32_16x16x32_bf16 v[196:199], a[68:71], v[184:187], v[196:199]
  ds_read_b64_tr_b16 v[152:153], v242 offset:4096
  ds_read_b64_tr_b16 v[154:155], v243 offset:4096
  v_mfma_f32_16x16x32_bf16 v[196:199], a[60:63], v[180:183], v[196:199]
  v_mfma_f32_16x16x32_bf16 v[196:199], a[52:55], v[176:179], v[196:199]
  ds_read_b64_tr_b16 v[156:157], v242 offset:5120
  ds_read_b64_tr_b16 v[158:159], v243 offset:5120
  v_mfma_f32_16x16x32_bf16 v[200:203], a[80:83], v[176:179], v[200:203]
  v_mfma_f32_16x16x32_bf16 v[200:203], a[84:87], v[180:183], v[200:203]
  s_waitcnt lgkmcnt(8)
  buffer_load_dwordx4 v1, s[40:43], s9 offen offset:1024 sc1 lds
  v_mfma_f32_16x16x32_bf16 v[204:207], a[48:51], v[208:211], v[204:207]
  v_mfma_f32_16x16x32_bf16 v[204:207], a[56:59], v[212:215], v[204:207]
  ds_read_b64_tr_b16 v[176:177], v244 offset:4096
  ds_read_b64_tr_b16 v[178:179], v245 offset:4096
  v_mfma_f32_16x16x32_bf16 v[204:207], a[64:67], v[216:219], v[204:207]
  v_mfma_f32_16x16x32_bf16 v[204:207], a[72:75], v[220:223], v[204:207]
  ds_read_b64_tr_b16 v[180:181], v244 offset:5120
  ds_read_b64_tr_b16 v[182:183], v245 offset:5120
  v_mfma_f32_16x16x32_bf16 v[224:227], a[76:79], v[220:223], v[224:227]
  v_mfma_f32_16x16x32_bf16 v[224:227], a[68:71], v[216:219], v[224:227]
  ds_read_b64_tr_b16 v[184:185], v246 offset:4096
  ds_read_b64_tr_b16 v[186:187], v247 offset:4096
  v_mfma_f32_16x16x32_bf16 v[224:227], a[60:63], v[212:215], v[224:227]
  buffer_load_dwordx4 v1, s[40:43], s9 offen offset:2048 sc1 lds
  v_mfma_f32_16x16x32_bf16 v[224:227], a[52:55], v[208:211], v[224:227]
  ds_read_b64_tr_b16 v[188:189], v246 offset:5120
  ds_read_b64_tr_b16 v[190:191], v247 offset:5120
  v_mfma_f32_16x16x32_bf16 v[228:231], a[80:83], v[208:211], v[228:231]
  v_mfma_f32_16x16x32_bf16 v[228:231], a[84:87], v[212:215], v[228:231]
  s_waitcnt lgkmcnt(8)
  v_mfma_f32_16x16x32_bf16 v[192:195], a[88:91], v[144:147], v[192:195]
  v_mfma_f32_16x16x32_bf16 v[192:195], a[96:99], v[148:151], v[192:195]
  ds_read_b64_tr_b16 v[208:209], v240 offset:8192
  ds_read_b64_tr_b16 v[210:211], v241 offset:8192
  v_mfma_f32_16x16x32_bf16 v[192:195], a[104:107], v[152:155], v[192:195]
  v_mfma_f32_16x16x32_bf16 v[192:195], a[112:115], v[156:159], v[192:195]
  ds_read_b64_tr_b16 v[212:213], v240 offset:9216
  ds_read_b64_tr_b16 v[214:215], v241 offset:9216
  v_mfma_f32_16x16x32_bf16 v[196:199], a[116:119], v[156:159], v[196:199]
  buffer_load_dwordx4 v1, s[40:43], s9 offen offset:3072 sc1 lds
  v_mfma_f32_16x16x32_bf16 v[196:199], a[108:111], v[152:155], v[196:199]
  ds_read_b64_tr_b16 v[216:217], v242 offset:8192
  ds_read_b64_tr_b16 v[218:219], v243 offset:8192
  v_mfma_f32_16x16x32_bf16 v[196:199], a[100:103], v[148:151], v[196:199]
  v_mfma_f32_16x16x32_bf16 v[196:199], a[92:95], v[144:147], v[196:199]
  ds_read_b64_tr_b16 v[220:221], v242 offset:9216
  ds_read_b64_tr_b16 v[222:223], v243 offset:9216
  v_mfma_f32_16x16x32_bf16 v[200:203], a[120:123], v[144:147], v[200:203]
  v_mfma_f32_16x16x32_bf16 v[200:203], a[124:127], v[148:151], v[200:203]
  s_waitcnt lgkmcnt(8)
  v_mfma_f32_16x16x32_bf16 v[204:207], a[88:91], v[176:179], v[204:207]
  v_mfma_f32_16x16x32_bf16 v[204:207], a[96:99], v[180:183], v[204:207]
  s_add_u32 s10, s8, 536576
  ds_read_b64_tr_b16 v[144:145], v244 offset:8192
  ds_read_b64_tr_b16 v[146:147], v245 offset:8192
  v_mfma_f32_16x16x32_bf16 v[204:207], a[104:107], v[184:187], v[204:207]
  s_add_u32 m0, s63, 81920
  v_mfma_f32_16x16x32_bf16 v[204:207], a[112:115], v[188:191], v[204:207]
  ds_read_b64_tr_b16 v[148:149], v244 offset:9216
  ds_read_b64_tr_b16 v[150:151], v245 offset:9216
  v_mfma_f32_16x16x32_bf16 v[224:227], a[116:119], v[188:191], v[224:227]
  buffer_load_dwordx4 v1, s[40:43], s10 offen offset:0 sc1 lds
  v_mfma_f32_16x16x32_bf16 v[224:227], a[108:111], v[184:187], v[224:227]
  ds_read_b64_tr_b16 v[152:153], v246 offset:8192
  ds_read_b64_tr_b16 v[154:155], v247 offset:8192
  v_mfma_f32_16x16x32_bf16 v[224:227], a[100:103], v[180:183], v[224:227]
  v_mfma_f32_16x16x32_bf16 v[224:227], a[92:95], v[176:179], v[224:227]
  ds_read_b64_tr_b16 v[156:157], v246 offset:9216
  ds_read_b64_tr_b16 v[158:159], v247 offset:9216
  v_mfma_f32_16x16x32_bf16 v[228:231], a[120:123], v[176:179], v[228:231]
  v_mfma_f32_16x16x32_bf16 v[228:231], a[124:127], v[180:183], v[228:231]
  s_waitcnt lgkmcnt(8)
  v_mfma_f32_16x16x32_bf16 v[192:195], a[128:131], v[208:211], v[192:195]
  v_mfma_f32_16x16x32_bf16 v[192:195], a[136:139], v[212:215], v[192:195]
  ds_read_b64_tr_b16 v[176:177], v244 offset:12288
  ds_read_b64_tr_b16 v[178:179], v245 offset:12288
  v_mfma_f32_16x16x32_bf16 v[192:195], v[128:131], v[216:219], v[192:195]
  buffer_load_dwordx4 v1, s[40:43], s10 offen offset:1024 sc1 lds
  v_mfma_f32_16x16x32_bf16 v[192:195], v[136:139], v[220:223], v[192:195]
  ds_read_b64_tr_b16 v[180:181], v244 offset:13312
  ds_read_b64_tr_b16 v[182:183], v245 offset:13312
  v_mfma_f32_16x16x32_bf16 v[196:199], v[140:143], v[220:223], v[196:199]
  v_mfma_f32_16x16x32_bf16 v[196:199], v[132:135], v[216:219], v[196:199]
  ds_read_b64_tr_b16 v[184:185], v246 offset:12288
  ds_read_b64_tr_b16 v[186:187], v247 offset:12288
  v_mfma_f32_16x16x32_bf16 v[196:199], a[252:255], v[212:215], v[196:199]
  v_mfma_f32_16x16x32_bf16 v[196:199], a[132:135], v[208:211], v[196:199]
  ds_read_b64_tr_b16 v[188:189], v246 offset:13312
  ds_read_b64_tr_b16 v[190:191], v247 offset:13312
  v_mfma_f32_16x16x32_bf16 v[200:203], v[160:163], v[208:211], v[200:203]
  v_mfma_f32_16x16x32_bf16 v[200:203], v[164:167], v[212:215], v[200:203]
  s_waitcnt lgkmcnt(8)
  buffer_load_dwordx4 v1, s[40:43], s10 offen offset:2048 sc1 lds
  v_mfma_f32_16x16x32_bf16 v[204:207], a[128:131], v[144:147], v[204:207]
  buffer_load_dword v6, v2, s[56:59], 0 offen offset:0 sc1
  v_mfma_f32_16x16x32_bf16 v[204:207], a[136:139], v[148:151], v[204:207]
  ds_read_b64_tr_b16 v[208:209], v240 offset:12288
  ds_read_b64_tr_b16 v[210:211], v241 offset:12288
  v_mfma_f32_16x16x32_bf16 v[204:207], v[128:131], v[152:155], v[204:207]
  v_mfma_f32_16x16x32_bf16 v[204:207], v[136:139], v[156:159], v[204:207]
  ds_read_b64_tr_b16 v[212:213], v240 offset:13312
  ds_read_b64_tr_b16 v[214:215], v241 offset:13312
  v_mfma_f32_16x16x32_bf16 v[224:227], v[140:143], v[156:159], v[224:227]
  v_mfma_f32_16x16x32_bf16 v[224:227], v[132:135], v[152:155], v[224:227]
  ds_read_b64_tr_b16 v[216:217], v242 offset:12288
  ds_read_b64_tr_b16 v[218:219], v243 offset:12288
  v_mfma_f32_16x16x32_bf16 v[224:227], a[252:255], v[148:151], v[224:227]
  buffer_load_dwordx4 v1, s[40:43], s10 offen offset:3072 sc1 lds
  v_mfma_f32_16x16x32_bf16 v[224:227], a[132:135], v[144:147], v[224:227]
  ds_read_b64_tr_b16 v[220:221], v242 offset:13312
  ds_read_b64_tr_b16 v[222:223], v243 offset:13312
  v_mfma_f32_16x16x32_bf16 v[228:231], v[160:163], v[144:147], v[228:231]
  s_waitcnt vmcnt(9)
  v_mfma_f32_16x16x32_bf16 v[228:231], v[164:167], v[148:151], v[228:231]
  s_waitcnt lgkmcnt(8)
  v_mfma_f32_16x16x32_bf16 v[228:231], v[60:63], v[180:183], v[228:231]
  s_barrier
  v_mfma_f32_16x16x32_bf16 v[228:231], v[56:59], v[176:179], v[228:231]
  ds_read_b64_tr_b16 v[144:145], v240 offset:45056
  ds_read_b64_tr_b16 v[146:147], v241 offset:45056
  v_mfma_f32_16x16x32_bf16 v[204:207], v[168:171], v[176:179], v[204:207]
  v_mfma_f32_16x16x32_bf16 v[204:207], v[32:35], v[180:183], v[204:207]
  ds_read_b64_tr_b16 v[148:149], v240 offset:46080
  ds_read_b64_tr_b16 v[150:151], v241 offset:46080
  v_mfma_f32_16x16x32_bf16 v[204:207], v[40:43], v[184:187], v[204:207]
  v_mfma_f32_16x16x32_bf16 v[204:207], v[48:51], v[188:191], v[204:207]
  ds_read_b64_tr_b16 v[152:153], v242 offset:45056
  ds_read_b64_tr_b16 v[154:155], v243 offset:45056
  v_mfma_f32_16x16x32_bf16 v[224:227], v[52:55], v[188:191], v[224:227]
  v_mfma_f32_16x16x32_bf16 v[224:227], v[44:47], v[184:187], v[224:227]
  ds_read_b64_tr_b16 v[156:157], v242 offset:46080
  ds_read_b64_tr_b16 v[158:159], v243 offset:46080
  v_mfma_f32_16x16x32_bf16 v[224:227], v[36:39], v[180:183], v[224:227]
  ds_write_b128 v104, v[228:231]
  v_mfma_f32_16x16x32_bf16 v[224:227], v[172:175], v[176:179], v[224:227]
  s_waitcnt lgkmcnt(9)
  v_mfma_f32_16x16x32_bf16 v[200:203], v[60:63], v[212:215], v[200:203]
  v_mfma_f32_16x16x32_bf16 v[200:203], v[56:59], v[208:211], v[200:203]
  ds_read_b64_tr_b16 v[176:177], v244 offset:45056
  ds_read_b64_tr_b16 v[178:179], v245 offset:45056
  v_mfma_f32_16x16x32_bf16 v[192:195], v[168:171], v[208:211], v[192:195]
  v_mfma_f32_16x16x32_bf16 v[192:195], v[32:35], v[212:215], v[192:195]
  ds_read_b64_tr_b16 v[180:181], v244 offset:46080
  ds_read_b64_tr_b16 v[182:183], v245 offset:46080
  v_mfma_f32_16x16x32_bf16 v[192:195], v[40:43], v[216:219], v[192:195]
  v_cvt_pk_bf16_f32 v84, v204, v205
  v_cvt_pk_bf16_f32 v85, v206, v207
  v_mfma_f32_16x16x32_bf16 v[192:195], v[48:51], v[220:223], v[192:195]
  ds_read_b64_tr_b16 v[184:185], v246 offset:45056
  ds_read_b64_tr_b16 v[186:187], v247 offset:45056
  v_mfma_f32_16x16x32_bf16 v[196:199], v[52:55], v[220:223], v[196:199]
  v_cvt_pk_bf16_f32 v86, v224, v225
  v_cvt_pk_bf16_f32 v87, v226, v227
  v_mfma_f32_16x16x32_bf16 v[196:199], v[44:47], v[216:219], v[196:199]
  ds_read_b64_tr_b16 v[188:189], v246 offset:46080
  ds_read_b64_tr_b16 v[190:191], v247 offset:46080
  v_mfma_f32_16x16x32_bf16 v[196:199], v[36:39], v[212:215], v[196:199]
  s_waitcnt lgkmcnt(8)
  buffer_store_dwordx4 v[84:87], v1, s[4:7], s16 offen offset:1024 sc1
  v_mfma_f32_16x16x32_bf16 v[196:199], v[172:175], v[208:211], v[196:199]
  s_waitcnt lgkmcnt(9)
  v_mfma_f32_16x16x32_bf16 v[232:235], v[168:171], v[144:147], 0
  s_barrier
  ds_read_b128 v[92:95], v105
  v_mfma_f32_16x16x32_bf16 v[232:235], v[32:35], v[148:151], v[232:235]
  ds_read_b64_tr_b16 v[208:209], v240 offset:40960
  ds_read_b64_tr_b16 v[210:211], v241 offset:40960
  v_mfma_f32_16x16x32_bf16 v[232:235], v[40:43], v[152:155], v[232:235]
  v_cvt_pk_bf16_f32 v80, v192, v193
  v_cvt_pk_bf16_f32 v81, v194, v195
  v_mfma_f32_16x16x32_bf16 v[232:235], v[48:51], v[156:159], v[232:235]
  ds_read_b64_tr_b16 v[212:213], v240 offset:41984
  ds_read_b64_tr_b16 v[214:215], v241 offset:41984
  v_mfma_f32_16x16x32_bf16 v[236:239], v[52:55], v[156:159], 0
  v_cvt_pk_bf16_f32 v82, v196, v197
  v_cvt_pk_bf16_f32 v83, v198, v199
  v_mfma_f32_16x16x32_bf16 v[236:239], v[44:47], v[152:155], v[236:239]
  ds_read_b64_tr_b16 v[216:217], v242 offset:40960
  ds_read_b64_tr_b16 v[218:219], v243 offset:40960
  v_mfma_f32_16x16x32_bf16 v[236:239], v[36:39], v[148:151], v[236:239]
  buffer_store_dwordx4 v[80:83], v1, s[4:7], s16 offen offset:0 sc1
  v_mfma_f32_16x16x32_bf16 v[236:239], v[172:175], v[144:147], v[236:239]
  s_waitcnt lgkmcnt(6)
  ds_read_b64_tr_b16 v[220:221], v242 offset:41984
  ds_read_b64_tr_b16 v[222:223], v243 offset:41984
  v_mfma_f32_16x16x32_bf16 v[64:67], v[56:59], v[144:147], 0
  v_add_f32 v200, v200, v92
  v_add_f32 v201, v201, v93
  v_mfma_f32_16x16x32_bf16 v[64:67], v[60:63], v[148:151], v[64:67]
  s_waitcnt lgkmcnt(9)
  v_add_f32 v202, v202, v94
  v_add_f32 v203, v203, v95
  v_mfma_f32_16x16x32_bf16 v[68:71], v[168:171], v[176:179], 0
  v_cvt_pk_bf16_f32 v88, v200, v201
  v_cvt_pk_bf16_f32 v89, v202, v203
  v_mfma_f32_16x16x32_bf16 v[68:71], v[32:35], v[180:183], v[68:71]
  ds_read_b64_tr_b16 v[144:145], v244 offset:40960
  ds_read_b64_tr_b16 v[146:147], v245 offset:40960
  v_mfma_f32_16x16x32_bf16 v[68:71], v[40:43], v[184:187], v[68:71]
  buffer_store_dwordx2 v[88:89], v9, s[4:7], s16 offen offset:2048 sc1
  v_mfma_f32_16x16x32_bf16 v[68:71], v[48:51], v[188:191], v[68:71]
  ds_read_b64_tr_b16 v[148:149], v244 offset:41984
  ds_read_b64_tr_b16 v[150:151], v245 offset:41984
  v_mfma_f32_16x16x32_bf16 v[72:75], v[52:55], v[188:191], 0
  s_waitcnt vmcnt(4)
  v_cmp_ne_u32 vcc, 1, v6
  v_mfma_f32_16x16x32_bf16 v[72:75], v[44:47], v[184:187], v[72:75]
  ds_read_b64_tr_b16 v[152:153], v246 offset:40960
  ds_read_b64_tr_b16 v[154:155], v247 offset:40960
  v_mfma_f32_16x16x32_bf16 v[72:75], v[36:39], v[180:183], v[72:75]
  s_cmp_eq_u64 vcc, 0
  v_mfma_f32_16x16x32_bf16 v[72:75], v[172:175], v[176:179], v[72:75]
  s_cbranch_scc0 L_spin_pf0
L_back_pf0:
  ds_read_b64_tr_b16 v[156:157], v246 offset:41984
  ds_read_b64_tr_b16 v[158:159], v247 offset:41984
  v_mfma_f32_16x16x32_bf16 v[76:79], v[56:59], v[176:179], 0
  s_add_u32 s67, s68, 0
  v_mfma_f32_16x16x32_bf16 v[76:79], v[60:63], v[180:183], v[76:79]
  s_waitcnt lgkmcnt(8)
  buffer_load_dwordx4 v[16:19], v1, s[4:7], s67 offen offset:0 sc1
  v_mfma_f32_16x16x32_bf16 v[232:235], a[128:131], v[208:211], v[232:235]
  buffer_load_dwordx4 v[20:23], v1, s[4:7], s67 offen offset:1024 sc1
  v_mfma_f32_16x16x32_bf16 v[232:235], a[136:139], v[212:215], v[232:235]
  ds_read_b64_tr_b16 v[176:177], v240 offset:36864
  ds_read_b64_tr_b16 v[178:179], v241 offset:36864
  v_mfma_f32_16x16x32_bf16 v[232:235], v[128:131], v[216:219], v[232:235]
  buffer_load_dwordx2 v[24:25], v9, s[4:7], s67 offen offset:2048 sc1
  v_mfma_f32_16x16x32_bf16 v[232:235], v[136:139], v[220:223], v[232:235]
  s_add_u32 s67, s68, 12288
  ds_read_b64_tr_b16 v[180:181], v240 offset:37888
  ds_read_b64_tr_b16 v[182:183], v241 offset:37888
  v_mfma_f32_16x16x32_bf16 v[236:239], v[140:143], v[220:223], v[236:239]
  buffer_load_dwordx4 v[112:115], v1, s[4:7], s67 offen offset:0 sc1
  v_mfma_f32_16x16x32_bf16 v[236:239], v[132:135], v[216:219], v[236:239]
  ds_read_b64_tr_b16 v[184:185], v242 offset:36864
  ds_read_b64_tr_b16 v[186:187], v243 offset:36864
  v_mfma_f32_16x16x32_bf16 v[236:239], a[252:255], v[212:215], v[236:239]
  buffer_load_dwordx4 v[116:119], v1, s[4:7], s67 offen offset:1024 sc1
  v_mfma_f32_16x16x32_bf16 v[236:239], a[132:135], v[208:211], v[236:239]
  ds_read_b64_tr_b16 v[188:189], v242 offset:37888
  ds_read_b64_tr_b16 v[190:191], v243 offset:37888
  v_mfma_f32_16x16x32_bf16 v[64:67], v[160:163], v[208:211], v[64:67]
  buffer_load_dwordx2 v[120:121], v9, s[4:7], s67 offen offset:2048 sc1
  v_mfma_f32_16x16x32_bf16 v[64:67], v[164:167], v[212:215], v[64:67]
  s_waitcnt lgkmcnt(8)
  v_mfma_f32_16x16x32_bf16 v[68:71], a[128:131], v[144:147], v[68:71]
  v_mfma_f32_16x16x32_bf16 v[68:71], a[136:139], v[148:151], v[68:71]
  ds_read_b64_tr_b16 v[208:209], v244 offset:36864
  ds_read_b64_tr_b16 v[210:211], v245 offset:36864
  v_mfma_f32_16x16x32_bf16 v[68:71], v[128:131], v[152:155], v[68:71]
  v_mfma_f32_16x16x32_bf16 v[68:71], v[136:139], v[156:159], v[68:71]
  ds_read_b64_tr_b16 v[212:213], v244 offset:37888
  ds_read_b64_tr_b16 v[214:215], v245 offset:37888
  v_mfma_f32_16x16x32_bf16 v[72:75], v[140:143], v[156:159], v[72:75]
  v_mfma_f32_16x16x32_bf16 v[72:75], v[132:135], v[152:155], v[72:75]
  ds_read_b64_tr_b16 v[216:217], v246 offset:36864
  ds_read_b64_tr_b16 v[218:219], v247 offset:36864
  v_mfma_f32_16x16x32_bf16 v[72:75], a[252:255], v[148:151], v[72:75]
  v_mfma_f32_16x16x32_bf16 v[72:75], a[132:135], v[144:147], v[72:75]
  ds_read_b64_tr_b16 v[220:221], v246 offset:37888
  ds_read_b64_tr_b16 v[222:223], v247 offset:37888
  v_mfma_f32_16x16x32_bf16 v[76:79], v[160:163], v[144:147], v[76:79]
  v_mfma_f32_16x16x32_bf16 v[76:79], v[164:167], v[148:151], v[76:79]
  s_waitcnt lgkmcnt(8)
  v_mfma_f32_16x16x32_bf16 v[232:235], a[88:91], v[176:179], v[232:235]
L_hopb3:
  s_cbranch_execz L_hopback2
  v_mfma_f32_16x16x32_bf16 v[232:235], a[96:99], v[180:183], v[232:235]
  ds_read_b64_tr_b16 v[144:145], v240 offset:32768
  ds_read_b64_tr_b16 v[146:147], v241 offset:32768
  v_mfma_f32_16x16x32_bf16 v[232:235], a[104:107], v[184:187], v[232:235]
  v_mfma_f32_16x16x32_bf16 v[232:235], a[112:115], v[188:191], v[232:235]
  ds_read_b64_tr_b16 v[148:149], v240 offset:33792
  ds_read_b64_tr_b16 v[150:151], v241 offset:33792
  v_mfma_f32_16x16x32_bf16 v[236:239], a[116:119], v[188:191], v[236:239]
  v_mfma_f32_16x16x32_bf16 v[236:239], a[108:111], v[184:187], v[236:239]
  ds_read_b64_tr_b16 v[152:153], v242 offset:32768
  ds_read_b64_tr_b16 v[154:155], v243 offset:32768
  v_mfma_f32_16x16x32_bf16 v[236:239], a[100:103], v[180:183], v[236:239]
  v_mfma_f32_16x16x32_bf16 v[236:239], a[92:95], v[176:179], v[236:239]
  ds_read_b64_tr_b16 v[156:157], v242 offset:33792
  ds_read_b64_tr_b16 v[158:159], v243 offset:33792
  v_mfma_f32_16x16x32_bf16 v[64:67], a[120:123], v[176:179], v[64:67]
  v_mfma_f32_16x16x32_bf16 v[64:67], a[124:127], v[180:183], v[64:67]
  s_waitcnt lgkmcnt(8)
  v_mfma_f32_16x16x32_bf16 v[68:71], a[88:91], v[208:211], v[68:71]
  v_mfma_f32_16x16x32_bf16 v[68:71], a[96:99], v[212:215], v[68:71]
  ds_read_b64_tr_b16 v[176:177], v244 offset:32768
  ds_read_b64_tr_b16 v[178:179], v245 offset:32768
  v_mfma_f32_16x16x32_bf16 v[68:71], a[104:107], v[216:219], v[68:71]
  v_mfma_f32_16x16x32_bf16 v[68:71], a[112:115], v[220:223], v[68:71]
  ds_read_b64_tr_b16 v[180:181], v244 offset:33792
  ds_read_b64_tr_b16 v[182:183], v245 offset:33792
  v_mfma_f32_16x16x32_bf16 v[72:75], a[116:119], v[220:223], v[72:75]
  v_mfma_f32_16x16x32_bf16 v[72:75], a[108:111], v[216:219], v[72:75]
  ds_read_b64_tr_b16 v[184:185], v246 offset:32768
  ds_read_b64_tr_b16 v[186:187], v247 offset:32768
  v_mfma_f32_16x16x32_bf16 v[72:75], a[100:103], v[212:215], v[72:75]
  v_mfma_f32_16x16x32_bf16 v[72:75], a[92:95], v[208:211], v[72:75]
  ds_read_b64_tr_b16 v[188:189], v246 offset:33792
  ds_read_b64_tr_b16 v[190:191], v247 offset:33792
  v_mfma_f32_16x16x32_bf16 v[76:79], a[120:123], v[208:211], v[76:79]
  s_waitcnt vmcnt(9)
  v_mfma_f32_16x16x32_bf16 v[76:79], a[124:127], v[212:215], v[76:79]
  s_waitcnt lgkmcnt(8)
  v_mfma_f32_16x16x32_bf16 v[232:235], a[48:51], v[144:147], v[232:235]
  s_barrier
  v_mfma_f32_16x16x32_bf16 v[232:235], a[56:59], v[148:151], v[232:235]
  s_waitcnt vmcnt(6)
  ds_read_b64_tr_b16 v[208:209], v248 offset:12288
  ds_read_b64_tr_b16 v[210:211], v249 offset:12288
  v_mfma_f32_16x16x32_bf16 v[232:235], a[64:67], v[152:155], v[232:235]
  buffer_store_dword v13, v12, s[56:59], s2 offen sc1
  v_mfma_f32_16x16x32_bf16 v[232:235], a[72:75], v[156:159], v[232:235]
  ds_read_b64_tr_b16 v[212:213], v248 offset:13312
  ds_read_b64_tr_b16 v[214:215], v249 offset:13312
  v_mfma_f32_16x16x32_bf16 v[236:239], a[76:79], v[156:159], v[236:239]
  v_mfma_f32_16x16x32_bf16 v[236:239], a[68:71], v[152:155], v[236:239]
  ds_read_b64_tr_b16 v[216:217], v250 offset:12288
  ds_read_b64_tr_b16 v[218:219], v251 offset:12288
  v_mfma_f32_16x16x32_bf16 v[236:239], a[60:63], v[148:151], v[236:239]
  v_mfma_f32_16x16x32_bf16 v[236:239], a[52:55], v[144:147], v[236:239]
  ds_read_b64_tr_b16 v[220:221], v250 offset:13312
  ds_read_b64_tr_b16 v[222:223], v251 offset:13312
  v_mfma_f32_16x16x32_bf16 v[64:67], a[80:83], v[144:147], v[64:67]
  v_mfma_f32_16x16x32_bf16 v[64:67], a[84:87], v[148:151], v[64:67]
  s_waitcnt lgkmcnt(8)
  v_mfma_f32_16x16x32_bf16 v[68:71], a[48:51], v[176:179], v[68:71]
  v_mfma_f32_16x16x32_bf16 v[68:71], a[56:59], v[180:183], v[68:71]
  ds_read_b64_tr_b16 v[144:145], v252 offset:12288
  ds_read_b64_tr_b16 v[146:147], v253 offset:12288
  v_mfma_f32_16x16x32_bf16 v[68:71], a[64:67], v[184:187], v[68:71]
  v_mfma_f32_16x16x32_bf16 v[68:71], a[72:75], v[188:191], v[68:71]
  ds_read_b64_tr_b16 v[148:149], v252 offset:13312
  ds_read_b64_tr_b16 v[150:151], v253 offset:13312
  v_mfma_f32_16x16x32_bf16 v[72:75], a[76:79], v[188:191], v[72:75]
  v_mfma_f32_16x16x32_bf16 v[72:75], a[68:71], v[184:187], v[72:75]
  ds_read_b64_tr_b16 v[152:153], v254 offset:12288
  ds_read_b64_tr_b16 v[154:155], v255 offset:12288
  v_mfma_f32_16x16x32_bf16 v[72:75], a[60:63], v[180:183], v[72:75]
  s_waitcnt vmcnt(1)
  v_lshlrev_b32 v128, 16, v16
  v_and_b32 v129, 0xffff0000, v16
  v_mfma_f32_16x16x32_bf16 v[72:75], a[52:55], v[176:179], v[72:75]
  ds_read_b64_tr_b16 v[156:157], v254 offset:13312
  ds_read_b64_tr_b16 v[158:159], v255 offset:13312
  v_mfma_f32_16x16x32_bf16 v[76:79], a[80:83], v[176:179], v[76:79]
  v_lshlrev_b32 v130, 16, v17
  v_and_b32 v131, 0xffff0000, v17
  v_mfma_f32_16x16x32_bf16 v[76:79], a[84:87], v[180:183], v[76:79]
  s_waitcnt lgkmcnt(8)
  v_lshlrev_b32 v56, 16, v112
  v_and_b32 v57, 0xffff0000, v112
  v_mfma_f32_16x16x32_bf16 v[232:235], a[8:11], v[208:211], v[232:235]
  v_lshlrev_b32 v58, 16, v113
  v_and_b32 v59, 0xffff0000, v113
  v_mfma_f32_16x16x32_bf16 v[232:235], a[16:19], v[212:215], v[232:235]
  ds_read_b64_tr_b16 v[176:177], v248 offset:8192
  ds_read_b64_tr_b16 v[178:179], v249 offset:8192
  v_mfma_f32_16x16x32_bf16 v[232:235], a[24:27], v[216:219], v[232:235]
  v_add_f32 v128, v128, v56
  v_add_f32 v129, v129, v57
  v_mfma_f32_16x16x32_bf16 v[232:235], a[32:35], v[220:223], v[232:235]
  ds_read_b64_tr_b16 v[180:181], v248 offset:9216
  ds_read_b64_tr_b16 v[182:183], v249 offset:9216
  v_mfma_f32_16x16x32_bf16 v[236:239], a[36:39], v[220:223], v[236:239]
  v_add_f32 v130, v130, v58
  v_add_f32 v131, v131, v59
  v_mfma_f32_16x16x32_bf16 v[236:239], a[28:31], v[216:219], v[236:239]
  ds_read_b64_tr_b16 v[184:185], v250 offset:8192
  ds_read_b64_tr_b16 v[186:187], v251 offset:8192
  v_mfma_f32_16x16x32_bf16 v[236:239], a[20:23], v[212:215], v[236:239]
  v_lshlrev_b32 v132, 16, v18
  v_and_b32 v133, 0xffff0000, v18
  v_mfma_f32_16x16x32_bf16 v[236:239], a[12:15], v[208:211], v[236:239]
  ds_read_b64_tr_b16 v[188:189], v250 offset:9216
  ds_read_b64_tr_b16 v[190:191], v251 offset:9216
  v_mfma_f32_16x16x32_bf16 v[64:67], a[40:43], v[208:211], v[64:67]
  v_lshlrev_b32 v134, 16, v19
  v_and_b32 v135, 0xffff0000, v19
  v_mfma_f32_16x16x32_bf16 v[64:67], a[44:47], v[212:215], v[64:67]
  s_waitcnt lgkmcnt(8)
  v_lshlrev_b32 v56, 16, v114
  v_and_b32 v57, 0xffff0000, v114
  v_mfma_f32_16x16x32_bf16 v[68:71], a[8:11], v[144:147], v[68:71]
  v_lshlrev_b32 v58, 16, v115
  v_and_b32 v59, 0xffff0000, v115
  v_mfma_f32_16x16x32_bf16 v[68:71], a[16:19], v[148:151], v[68:71]
  ds_read_b64_tr_b16 v[208:209], v252 offset:8192
  ds_read_b64_tr_b16 v[210:211], v253 offset:8192
  v_mfma_f32_16x16x32_bf16 v[68:71], a[24:27], v[152:155], v[68:71]
  v_add_f32 v132, v132, v56
  v_add_f32 v133, v133, v57
  v_mfma_f32_16x16x32_bf16 v[68:71], a[32:35], v[156:159], v[68:71]
  ds_read_b64_tr_b16 v[212:213], v252 offset:9216
  ds_read_b64_tr_b16 v[214:215], v253 offset:9216
  v_mfma_f32_16x16x32_bf16 v[72:75], a[36:39], v[156:159], v[72:75]
  v_add_f32 v134, v134, v58
  v_add_f32 v135, v135, v59
  v_mfma_f32_16x16x32_bf16 v[72:75], a[28:31], v[152:155], v[72:75]
  ds_read_b64_tr_b16 v[216:217], v254 offset:8192
  ds_read_b64_tr_b16 v[218:219], v255 offset:8192
  v_mfma_f32_16x16x32_bf16 v[72:75], a[20:23], v[148:151], v[72:75]
  v_lshlrev_b32 v136, 16, v20
  v_and_b32 v137, 0xffff0000, v20
  v_mfma_f32_16x16x32_bf16 v[72:75], a[12:15], v[144:147], v[72:75]
  ds_read_b64_tr_b16 v[220:221], v254 offset:9216
  ds_read_b64_tr_b16 v[222:223], v255 offset:9216
  v_mfma_f32_16x16x32_bf16 v[76:79], a[40:43], v[144:147], v[76:79]
  v_lshlrev_b32 v138, 16, v21
  v_and_b32 v139, 0xffff0000, v21
  v_mfma_f32_16x16x32_bf16 v[76:79], a[44:47], v[148:151], v[76:79]
  s_waitcnt lgkmcnt(8)
  v_lshlrev_b32 v56, 16, v116
  v_and_b32 v57, 0xffff0000, v116
  v_mfma_f32_16x16x32_bf16 v[232:235], a[220:223], v[176:179], v[232:235]
  buffer_load_dword v6, v2, s[56:59], 0 offen offset:128 sc1
  v_mfma_f32_16x16x32_bf16 v[232:235], a[228:231], v[180:183], v[232:235]
  ds_read_b64_tr_b16 v[144:145], v248 offset:4096
  ds_read_b64_tr_b16 v[146:147], v249 offset:4096
  v_mfma_f32_16x16x32_bf16 v[232:235], a[236:239], v[184:187], v[232:235]
  v_lshlrev_b32 v58, 16, v117
  v_and_b32 v59, 0xffff0000, v117
  v_mfma_f32_16x16x32_bf16 v[232:235], a[244:247], v[188:191], v[232:235]
  ds_read_b64_tr_b16 v[148:149], v248 offset:5120
  ds_read_b64_tr_b16 v[150:151], v249 offset:5120
  v_mfma_f32_16x16x32_bf16 v[236:239], a[248:251], v[188:191], v[236:239]
  v_add_f32 v136, v136, v56
  v_add_f32 v137, v137, v57
  v_mfma_f32_16x16x32_bf16 v[236:239], a[240:243], v[184:187], v[236:239]
  ds_read_b64_tr_b16 v[152:153], v250 offset:4096
  ds_read_b64_tr_b16 v[154:155], v251 offset:4096
  v_mfma_f32_16x16x32_bf16 v[236:239], a[232:235], v[180:183], v[236:239]
  v_add_f32 v138, v138, v58
  v_add_f32 v139, v139, v59
  v_mfma_f32_16x16x32_bf16 v[236:239], a[224:227], v[176:179], v[236:239]
  ds_read_b64_tr_b16 v[156:157], v250 offset:5120
  ds_read_b64_tr_b16 v[158:159], v251 offset:5120
  v_mfma_f32_16x16x32_bf16 v[64:67], a[0:3], v[176:179], v[64:67]
  v_lshlrev_b32 v140, 16, v22
  v_and_b32 v141, 0xffff0000, v22
  v_mfma_f32_16x16x32_bf16 v[64:67], a[4:7], v[180:183], v[64:67]
  s_waitcnt lgkmcnt(8)
  v_lshlrev_b32 v142, 16, v23
  v_and_b32 v143, 0xffff0000, v23
  v_mfma_f32_16x16x32_bf16 v[68:71], a[220:223], v[208:211], v[68:71]
  v_lshlrev_b32 v56, 16, v118
  v_and_b32 v57, 0xffff0000, v118
  v_mfma_f32_16x16x32_bf16 v[68:71], a[228:231], v[212:215], v[68:71]
  ds_read_b64_tr_b16 v[176:177], v252 offset:4096
  ds_read_b64_tr_b16 v[178:179], v253 offset:4096
  v_mfma_f32_16x16x32_bf16 v[68:71], a[236:239], v[216:219], v[68:71]
  v_lshlrev_b32 v58, 16, v119
  v_and_b32 v59, 0xffff0000, v119
  v_mfma_f32_16x16x32_bf16 v[68:71], a[244:247], v[220:223], v[68:71]
  ds_read_b64_tr_b16 v[180:181], v252 offset:5120
  ds_read_b64_tr_b16 v[182:183], v253 offset:5120
  v_mfma_f32_16x16x32_bf16 v[72:75], a[248:251], v[220:223], v[72:75]
  v_add_f32 v140, v140, v56
  v_add_f32 v141, v141, v57
  v_mfma_f32_16x16x32_bf16 v[72:75], a[240:243], v[216:219], v[72:75]
  ds_read_b64_tr_b16 v[184:185], v254 offset:4096
  ds_read_b64_tr_b16 v[186:187], v255 offset:4096
  v_mfma_f32_16x16x32_bf16 v[72:75], a[232:235], v[212:215], v[72:75]
  v_add_f32 v142, v142, v58
  v_add_f32 v143, v143, v59
  v_mfma_f32_16x16x32_bf16 v[72:75], a[224:227], v[208:211], v[72:75]
  ds_read_b64_tr_b16 v[188:189], v254 offset:5120
  ds_read_b64_tr_b16 v[190:191], v255 offset:5120
  v_mfma_f32_16x16x32_bf16 v[76:79], a[0:3], v[208:211], v[76:79]
  v_lshlrev_b32 v160, 16, v24
  v_and_b32 v161, 0xffff0000, v24
  v_mfma_f32_16x16x32_bf16 v[76:79], a[4:7], v[212:215], v[76:79]
  s_waitcnt lgkmcnt(8)
  v_lshlrev_b32 v162, 16, v25
  v_and_b32 v163, 0xffff0000, v25
  v_mfma_f32_16x16x32_bf16 v[232:235], a[180:183], v[144:147], v[232:235]
  v_lshlrev_b32 v56, 16, v120
  v_and_b32 v57, 0xffff0000, v120
  v_mfma_f32_16x16x32_bf16 v[232:235], a[188:191], v[148:151], v[232:235]
  ds_read_b64_tr_b16 v[208:209], v252 offset:0
  ds_read_b64_tr_b16 v[210:211], v253 offset:0
  v_mfma_f32_16x16x32_bf16 v[232:235], a[196:199], v[152:155], v[232:235]
  v_lshlrev_b32 v58, 16, v121
  v_and_b32 v59, 0xffff0000, v121
  v_mfma_f32_16x16x32_bf16 v[232:235], a[204:207], v[156:159], v[232:235]
  ds_read_b64_tr_b16 v[212:213], v252 offset:1024
  ds_read_b64_tr_b16 v[214:215], v253 offset:1024
  v_mfma_f32_16x16x32_bf16 v[236:239], a[208:211], v[156:159], v[236:239]
  v_add_f32 v160, v160, v56
  v_add_f32 v161, v161, v57
  v_mfma_f32_16x16x32_bf16 v[236:239], a[200:203], v[152:155], v[236:239]
  ds_read_b64_tr_b16 v[216:217], v254 offset:0
  ds_read_b64_tr_b16 v[218:219], v255 offset:0
  v_mfma_f32_16x16x32_bf16 v[236:239], a[192:195], v[148:151], v[236:239]
  v_add_f32 v162, v162, v58
  v_add_f32 v163, v163, v59
  v_mfma_f32_16x16x32_bf16 v[236:239], a[184:187], v[144:147], v[236:239]
  ds_read_b64_tr_b16 v[220:221], v254 offset:1024
  ds_read_b64_tr_b16 v[222:223], v255 offset:1024
  v_mfma_f32_16x16x32_bf16 v[64:67], a[212:215], v[144:147], v[64:67]
  s_waitcnt vmcnt(0)
  v_cmp_ne_u32 vcc, 1, v6
  v_mfma_f32_16x16x32_bf16 v[64:67], a[216:219], v[148:151], v[64:67]
  s_waitcnt lgkmcnt(8)
  v_mfma_f32_16x16x32_bf16 v[68:71], a[180:183], v[176:179], v[68:71]
  s_cmp_eq_u64 vcc, 0
  v_mfma_f32_16x16x32_bf16 v[68:71], a[188:191], v[180:183], v[68:71]
  s_cselect_b32 s60, 1, 0
  ds_read_b64_tr_b16 v[144:145], v248 offset:0
  ds_read_b64_tr_b16 v[146:147], v249 offset:0
  v_mfma_f32_16x16x32_bf16 v[68:71], a[196:199], v[184:187], v[68:71]
  s_cbranch_scc0 L_skip_p
  s_add_u32 s67, s68, 24576
  buffer_load_dwordx4 v[164:167], v1, s[4:7], s67 offen offset:0 sc1
  buffer_load_dwordx4 v[168:171], v1, s[4:7], s67 offen offset:1024 sc1
  buffer_load_dwordx2 v[172:173], v9, s[4:7], s67 offen offset:2048 sc1
L_skip_p:
  v_mfma_f32_16x16x32_bf16 v[68:71], a[204:207], v[188:191], v[68:71]
  ds_read_b64_tr_b16 v[148:149], v248 offset:1024
  ds_read_b64_tr_b16 v[150:151], v249 offset:1024
  v_mfma_f32_16x16x32_bf16 v[72:75], a[208:211], v[188:191], v[72:75]
  v_mfma_f32_16x16x32_bf16 v[72:75], a[200:203], v[184:187], v[72:75]
  ds_read_b64_tr_b16 v[152:153], v250 offset:0
  ds_read_b64_tr_b16 v[154:155], v251 offset:0
  v_mfma_f32_16x16x32_bf16 v[72:75], a[192:195], v[180:183], v[72:75]
  v_mfma_f32_16x16x32_bf16 v[72:75], a[184:187], v[176:179], v[72:75]
  ds_read_b64_tr_b16 v[156:157], v250 offset:1024
  ds_read_b64_tr_b16 v[158:159], v251 offset:1024
  v_mfma_f32_16x16x32_bf16 v[76:79], a[212:215], v[176:179], v[76:79]
  v_mfma_f32_16x16x32_bf16 v[76:79], a[216:219], v[180:183], v[76:79]
  s_waitcnt lgkmcnt(8)
  v_mfma_f32_16x16x32_bf16 v[76:79], a[176:179], v[212:215], v[76:79]
  v_mfma_f32_16x16x32_bf16 v[76:79], a[172:175], v[208:211], v[76:79]
  v_mfma_f32_16x16x32_bf16 v[68:71], a[140:143], v[208:211], v[68:71]
  v_mfma_f32_16x16x32_bf16 v[68:71], a[148:151], v[212:215], v[68:71]
  v_mfma_f32_16x16x32_bf16 v[68:71], a[156:159], v[216:219], v[68:71]
  v_mfma_f32_16x16x32_bf16 v[68:71], a[164:167], v[220:223], v[68:71]
  v_mfma_f32_16x16x32_bf16 v[72:75], a[168:171], v[220:223], v[72:75]
  v_mfma_f32_16x16x32_bf16 v[72:75], a[160:163], v[216:219], v[72:75]
  v_mfma_f32_16x16x32_bf16 v[72:75], a[152:155], v[212:215], v[72:75]
  v_mfma_f32_16x16x32_bf16 v[72:75], a[144:147], v[208:211], v[72:75]
  s_waitcnt lgkmcnt(0)
  ds_write_b128 v104, v[76:79]
  v_mfma_f32_16x16x32_bf16 v[64:67], a[176:179], v[148:151], v[64:67]
  v_mfma_f32_16x16x32_bf16 v[64:67], a[172:175], v[144:147], v[64:67]
  v_mfma_f32_16x16x32_bf16 v[232:235], a[140:143], v[144:147], v[232:235]
  v_mfma_f32_16x16x32_bf16 v[232:235], a[148:151], v[148:151], v[232:235]
  v_mfma_f32_16x16x32_bf16 v[232:235], a[156:159], v[152:155], v[232:235]
  v_mfma_f32_16x16x32_bf16 v[232:235], a[164:167], v[156:159], v[232:235]
  s_waitcnt lgkmcnt(0)
  v_mfma_f32_16x16x32_bf16 v[236:239], a[168:171], v[156:159], v[236:239]
  s_barrier
  ds_read_b128 v[92:95], v105
  v_mfma_f32_16x16x32_bf16 v[236:239], a[160:163], v[152:155], v[236:239]
  v_mfma_f32_16x16x32_bf16 v[236:239], a[152:155], v[148:151], v[236:239]
  v_mfma_f32_16x16x32_bf16 v[236:239], a[144:147], v[144:147], v[236:239]
  v_add_f32 v68, v68, v136
  v_add_f32 v69, v69, v137
  v_add_f32 v70, v70, v138
  v_add_f32 v71, v71, v139
  v_add_f32 v72, v72, v140
  v_add_f32 v73, v73, v141
  v_add_f32 v74, v74, v142
  v_add_f32 v75, v75, v143
  s_waitcnt lgkmcnt(0)
  v_add_f32 v64, v64, v92
  v_add_f32 v65, v65, v93
  v_add_f32 v66, v66, v94
  v_add_f32 v67, v67, v95
  v_add_f32 v64, v64, v160
  v_add_f32 v65, v65, v161
  v_add_f32 v66, v66, v162
  v_add_f32 v67, v67, v163
  v_add_f32 v232, v232, v128
  v_add_f32 v233, v233, v129
  v_add_f32 v234, v234, v130
  v_add_f32 v235, v235, v131
  v_add_f32 v236, v236, v132
  v_add_f32 v237, v237, v133
  v_add_f32 v238, v238, v134
  v_add_f32 v239, v239, v135
  s_cmp_eq_u32 s60, 0
  s_cbranch_scc1 L_late_p
L_late_p_back:
  s_waitcnt vmcnt(0)
  v_lshlrev_b32 v56, 16, v168
  v_and_b32 v57, 0xffff0000, v168
  v_lshlrev_b32 v58, 16, v169
  v_and_b32 v59, 0xffff0000, v169
  v_add_f32 v68, v68, v56
  v_add_f32 v69, v69, v57
  v_add_f32 v70, v70, v58
  v_add_f32 v71, v71, v59
  v_cvt_pk_bf16_f32 v84, v68, v69
  v_cvt_pk_bf16_f32 v85, v70, v71
  v_lshlrev_b32 v56, 16, v170
  v_and_b32 v57, 0xffff0000, v170
  v_lshlrev_b32 v58, 16, v171
  v_and_b32 v59, 0xffff0000, v171
  v_add_f32 v72, v72, v56
  v_add_f32 v73, v73, v57
  v_add_f32 v74, v74, v58
  v_add_f32 v75, v75, v59
  v_cvt_pk_bf16_f32 v86, v72, v73
  v_cvt_pk_bf16_f32 v87, v74, v75
  v_lshlrev_b32 v56, 16, v172
  v_and_b32 v57, 0xffff0000, v172
  v_lshlrev_b32 v58, 16, v173
  v_and_b32 v59, 0xffff0000, v173
  v_add_f32 v64, v64, v56
  v_add_f32 v65, v65, v57
  v_add_f32 v66, v66, v58
  v_add_f32 v67, v67, v59
  v_cvt_pk_bf16_f32 v88, v64, v65
  v_cvt_pk_bf16_f32 v89, v66, v67
  v_lshlrev_b32 v56, 16, v164
  v_and_b32 v57, 0xffff0000, v164
  v_lshlrev_b32 v58, 16, v165
  v_and_b32 v59, 0xffff0000, v165
  v_add_f32 v232, v232, v56
  v_add_f32 v233, v233, v57
  v_add_f32 v234, v234, v58
  v_add_f32 v235, v235, v59
  v_cvt_pk_bf16_f32 v80, v232, v233
  v_cvt_pk_bf16_f32 v81, v234, v235
  v_lshlrev_b32 v56, 16, v166
  v_and_b32 v57, 0xffff0000, v166
  v_lshlrev_b32 v58, 16, v167
  v_and_b32 v59, 0xffff0000, v167
  v_add_f32 v236, v236, v56
  v_add_f32 v237, v237, v57
  v_add_f32 v238, v238, v58
  v_add_f32 v239, v239, v59
  v_cvt_pk_bf16_f32 v82, v236, v237
  v_cvt_pk_bf16_f32 v83, v238, v239
  ds_write_b64 v107, v[84:85] offset:0
  ds_write_b64 v107, v[86:87] offset:32
  ds_write_b64 v108, v[88:89] offset:0
  ds_write_b64 v106, v[80:81] offset:0
  ds_write_b64 v106, v[82:83] offset:32
  s_waitcnt lgkmcnt(0)
  s_barrier
  ds_read_b128 v[144:147], v109
  ds_read_b128 v[176:179], v110
  ds_read_b128 v[208:211], v111
  s_waitcnt lgkmcnt(2)
  buffer_store_dwordx4 v[144:147], v11, s[48:51], s17 offen sc1
  s_waitcnt lgkmcnt(1)
  buffer_store_dwordx4 v[176:179], v14, s[48:51], s17 offen sc1
  s_waitcnt lgkmcnt(0)
  buffer_store_dwordx4 v[208:211], v8, s[48:51], s17 offen sc1
L_end:
  s_endpgm
L_spin_ini:
  s_mov_b32 s3, 0
L_spin_ini_l:
  buffer_load_dword v73, v72, s[52:55], 0 offen sc1
  s_waitcnt vmcnt(0)
  v_cmp_ne_u32 vcc, 1, v73
  s_nop 1
  s_cmp_eq_u64 vcc, 0
  s_cbranch_scc1 L_back_ini
  s_add_u32 s3, s3, 1
  s_cmp_lt_u32 s3, 0x40000
  s_cbranch_scc1 L_spin_ini_l
  s_branch L_back_ini
L_late_o:
  buffer_load_dword v6, v7, s[56:59], 0 offen offset:0 sc1
  s_waitcnt vmcnt(0)
  v_cmp_ne_u32 vcc, 1, v6
  s_nop 1
  s_cmp_eq_u64 vcc, 0
  s_cbranch_scc1 L_late_o_go
  buffer_load_dword v6, v7, s[56:59], 0 offen offset:0 sc1
  s_waitcnt vmcnt(0)
  v_cmp_ne_u32 vcc, 1, v6
  s_nop 1
  s_cmp_eq_u64 vcc, 0
  s_cbranch_scc1 L_late_o_go
  buffer_load_dword v6, v7, s[56:59], 0 offen offset:0 sc1
  s_waitcnt vmcnt(0)
  v_cmp_ne_u32 vcc, 1, v6
  s_nop 1
  s_cmp_eq_u64 vcc, 0
  s_cbranch_scc1 L_late_o_go
  buffer_store_dwordx4 v[16:19], v10, s[40:43], s72 offen offset:0 sc1
  buffer_store_dwordx4 v[20:23], v10, s[40:43], s72 offen offset:1024 sc1
  buffer_store_dwordx4 v[24:27], v10, s[40:43], s72 offen offset:2048 sc1
  buffer_store_dwordx4 v[28:31], v10, s[40:43], s72 offen offset:3072 sc1
  buffer_store_dwordx4 v[112:115], v10, s[40:43], s73 offen offset:0 sc1
  buffer_store_dwordx4 v[116:119], v10, s[40:43], s73 offen offset:1024 sc1
  buffer_store_dwordx4 v[120:123], v10, s[40:43], s73 offen offset:2048 sc1
  buffer_store_dwordx4 v[124:127], v10, s[40:43], s73 offen offset:3072 sc1
  v_mov_b32 v10, 2147483392
  s_waitcnt vmcnt(0)
  buffer_store_dword v13, v12, s[56:59], s95 offen offset:128 sc1
  buffer_store_dword v13, v12, s[56:59], s95 offen offset:256 sc1
L_late_o_s:
  s_mov_b32 s3, 0
L_late_o_s_l:
  buffer_load_dword v6, v7, s[56:59], 0 offen offset:0 sc1
  s_waitcnt vmcnt(0)
  v_cmp_ne_u32 vcc, 1, v6
  s_nop 1
  s_cmp_eq_u64 vcc, 0
  s_cbranch_scc1 L_late_o_go
  s_add_u32 s3, s3, 1
  s_cmp_lt_u32 s3, 0x40000
  s_cbranch_scc1 L_late_o_s_l
  s_branch L_late_o_go
L_late_o_go:
  s_add_u32 s9, s8, 0
  s_add_u32 m0, s63, 98304
  s_nop 0
  buffer_load_dwordx4 v1, s[40:43], s9 offen offset:0 sc1 lds
  buffer_load_dwordx4 v1, s[40:43], s9 offen offset:1024 sc1 lds
  buffer_load_dwordx4 v1, s[40:43], s9 offen offset:2048 sc1 lds
  buffer_load_dwordx4 v1, s[40:43], s9 offen offset:3072 sc1 lds
  s_add_u32 s10, s8, 524288
  s_add_u32 m0, s63, 114688
  s_nop 0
  buffer_load_dwordx4 v1, s[40:43], s10 offen offset:0 sc1 lds
  buffer_load_dwordx4 v1, s[40:43], s10 offen offset:1024 sc1 lds
  buffer_load_dwordx4 v1, s[40:43], s10 offen offset:2048 sc1 lds
  buffer_load_dwordx4 v1, s[40:43], s10 offen offset:3072 sc1 lds
  s_add_u32 s9, s8, 16384
  s_add_u32 m0, s63, 0
  s_nop 0
  buffer_load_dwordx4 v1, s[40:43], s9 offen offset:0 sc1 lds
  buffer_load_dwordx4 v1, s[40:43], s9 offen offset:1024 sc1 lds
  buffer_load_dwordx4 v1, s[40:43], s9 offen offset:2048 sc1 lds
  buffer_load_dwordx4 v1, s[40:43], s9 offen offset:3072 sc1 lds
  buffer_store_dwordx4 v[16:19], v10, s[40:43], s72 offen offset:0 sc1
  buffer_store_dwordx4 v[20:23], v10, s[40:43], s72 offen offset:1024 sc1
  buffer_store_dwordx4 v[24:27], v10, s[40:43], s72 offen offset:2048 sc1
  buffer_store_dwordx4 v[28:31], v10, s[40:43], s72 offen offset:3072 sc1
  s_waitcnt vmcnt(8)
  s_branch L_late_o_back
L_spin_oa:
  s_mov_b32 s3, 0
L_spin_oa_l:
  buffer_load_dword v6, v7, s[56:59], 0 offen offset:384 sc1
  s_waitcnt vmcnt(0)
  v_cmp_ne_u32 vcc, 1, v6
  s_nop 1
  s_cmp_eq_u64 vcc, 0
  s_cbranch_scc1 L_back_oa
  s_add_u32 s3, s3, 1
  s_cmp_lt_u32 s3, 0x40000
  s_cbranch_scc1 L_spin_oa_l
  s_branch L_back_oa
L_spin_ob:
  s_mov_b32 s3, 0
L_spin_ob_l:
  buffer_load_dword v6, v7, s[56:59], 0 offen offset:128 sc1
  s_waitcnt vmcnt(0)
  v_cmp_ne_u32 vcc, 1, v6
  s_nop 1
  s_cmp_eq_u64 vcc, 0
  s_cbranch_scc1 L_back_ob
  s_add_u32 s3, s3, 1
  s_cmp_lt_u32 s3, 0x40000
  s_cbranch_scc1 L_spin_ob_l
  s_branch L_back_ob
L_spin_oc:
  s_mov_b32 s3, 0
L_spin_oc_l:
  buffer_load_dword v6, v7, s[56:59], 0 offen offset:256 sc1
  s_waitcnt vmcnt(0)
  v_cmp_ne_u32 vcc, 1, v6
  s_nop 1
  s_cmp_eq_u64 vcc, 0
  s_cbranch_scc1 L_back_oc
  s_add_u32 s3, s3, 1
  s_cmp_lt_u32 s3, 0x40000
  s_cbranch_scc1 L_spin_oc_l
  s_branch L_back_oc
L_spin_pf0:
  s_mov_b32 s3, 0
L_spin_pf0_l:
  buffer_load_dword v6, v2, s[56:59], 0 offen offset:0 sc1
  s_waitcnt vmcnt(0)
  v_cmp_ne_u32 vcc, 1, v6
  s_nop 1
  s_cmp_eq_u64 vcc, 0
  s_cbranch_scc1 L_back_pf0
  s_add_u32 s3, s3, 1
  s_cmp_lt_u32 s3, 0x40000
  s_cbranch_scc1 L_spin_pf0_l
  s_branch L_back_pf0
L_late_p:
L_late_p_s:
  s_mov_b32 s3, 0
L_late_p_s_l:
  buffer_load_dword v6, v2, s[56:59], 0 offen offset:128 sc1
  s_waitcnt vmcnt(0)
  v_cmp_ne_u32 vcc, 1, v6
  s_nop 1
  s_cmp_eq_u64 vcc, 0
  s_cbranch_scc1 L_late_p_go
  s_add_u32 s3, s3, 1
  s_cmp_lt_u32 s3, 0x40000
  s_cbranch_scc1 L_late_p_s_l
  s_branch L_late_p_go
L_late_p_go:
  s_add_u32 s67, s68, 24576
  s_nop 0
  buffer_load_dwordx4 v[164:167], v1, s[4:7], s67 offen offset:0 sc1
  buffer_load_dwordx4 v[168:171], v1, s[4:7], s67 offen offset:1024 sc1
  buffer_load_dwordx2 v[172:173], v9, s[4:7], s67 offen offset:2048 sc1
  s_waitcnt vmcnt(0)
  s_branch L_late_p_back
L_spin_cnt:
  s_mov_b32 s3, 0
L_spin_cnt_l:
  buffer_load_dword v8, v3, s[56:59], 0 offen sc1
  s_waitcnt vmcnt(0)
  v_cmp_ne_u32 vcc, 1, v8
  s_nop 1
  s_cmp_eq_u64 vcc, 0
  s_cbranch_scc1 L_back_cnt
  s_add_u32 s3, s3, 1
  s_cmp_lt_u32 s3, 0x40000
  s_cbranch_scc1 L_spin_cnt_l
  s_branch L_back_cnt
L_slow:
  s_nop 15
  s_waitcnt vmcnt(0) lgkmcnt(0)
  s_barrier
  v_mov_b32 v2, 0xff7fffff
  v_mov_b32 v6, 0
  v_mov_b32 v3, 0xff7fffff
  v_mov_b32 v7, 0
  v_mov_b32 v4, 0xff7fffff
  v_mov_b32 v8, 0
  v_mov_b32 v5, 0xff7fffff
  v_mov_b32 v9, 0
  v_mov_b32 v144, 0
  v_mov_b32 v145, 0
  v_mov_b32 v146, 0
  v_mov_b32 v147, 0
  v_mov_b32 v148, 0
  v_mov_b32 v149, 0
  v_mov_b32 v150, 0
  v_mov_b32 v151, 0
  v_accvgpr_write_b32 a0, 0
  v_accvgpr_write_b32 a1, 0
  v_accvgpr_write_b32 a2, 0
  v_accvgpr_write_b32 a3, 0
  v_accvgpr_write_b32 a4, 0
  v_accvgpr_write_b32 a5, 0
  v_accvgpr_write_b32 a6, 0
  v_accvgpr_write_b32 a7, 0
  v_mov_b32 v152, 0
  v_mov_b32 v153, 0
  v_mov_b32 v154, 0
  v_mov_b32 v155, 0
  v_mov_b32 v156, 0
  v_mov_b32 v157, 0
  v_mov_b32 v158, 0
  v_mov_b32 v159, 0
  v_accvgpr_write_b32 a8, 0
  v_accvgpr_write_b32 a9, 0
  v_accvgpr_write_b32 a10, 0
  v_accvgpr_write_b32 a11, 0
  v_accvgpr_write_b32 a12, 0
  v_accvgpr_write_b32 a13, 0
  v_accvgpr_write_b32 a14, 0
  v_accvgpr_write_b32 a15, 0
  v_mov_b32 v176, 0
  v_mov_b32 v177, 0
  v_mov_b32 v178, 0
  v_mov_b32 v179, 0
  v_mov_b32 v180, 0
  v_mov_b32 v181, 0
  v_mov_b32 v182, 0
  v_mov_b32 v183, 0
  v_accvgpr_write_b32 a16, 0
  v_accvgpr_write_b32 a17, 0
  v_accvgpr_write_b32 a18, 0
  v_accvgpr_write_b32 a19, 0
  v_accvgpr_write_b32 a20, 0
  v_accvgpr_write_b32 a21, 0
  v_accvgpr_write_b32 a22, 0
  v_accvgpr_write_b32 a23, 0
  v_mov_b32 v184, 0
  v_mov_b32 v185, 0
  v_mov_b32 v186, 0
  v_mov_b32 v187, 0
  v_mov_b32 v188, 0
  v_mov_b32 v189, 0
  v_mov_b32 v190, 0
  v_mov_b32 v191, 0
  v_accvgpr_write_b32 a24, 0
  v_accvgpr_write_b32 a25, 0
  v_accvgpr_write_b32 a26, 0
  v_accvgpr_write_b32 a27, 0
  v_accvgpr_write_b32 a28, 0
  v_accvgpr_write_b32 a29, 0
  v_accvgpr_write_b32 a30, 0
  v_accvgpr_write_b32 a31, 0
  v_mov_b32 v208, 0
  v_mov_b32 v209, 0
  v_mov_b32 v210, 0
  v_mov_b32 v211, 0
  v_mov_b32 v212, 0
  v_mov_b32 v213, 0
  v_mov_b32 v214, 0
  v_mov_b32 v215, 0
  v_accvgpr_write_b32 a32, 0
  v_accvgpr_write_b32 a33, 0
  v_accvgpr_write_b32 a34, 0
  v_accvgpr_write_b32 a35, 0
  v_accvgpr_write_b32 a36, 0
  v_accvgpr_write_b32 a37, 0
  v_accvgpr_write_b32 a38, 0
  v_accvgpr_write_b32 a39, 0
  v_mov_b32 v216, 0
  v_mov_b32 v217, 0
  v_mov_b32 v218, 0
  v_mov_b32 v219, 0
  v_mov_b32 v220, 0
  v_mov_b32 v221, 0
  v_mov_b32 v222, 0
  v_mov_b32 v223, 0
  v_accvgpr_write_b32 a40, 0
  v_accvgpr_write_b32 a41, 0
  v_accvgpr_write_b32 a42, 0
  v_accvgpr_write_b32 a43, 0
  v_accvgpr_write_b32 a44, 0
  v_accvgpr_write_b32 a45, 0
  v_accvgpr_write_b32 a46, 0
  v_accvgpr_write_b32 a47, 0
  v_mov_b32 v240, 0
  v_mov_b32 v241, 0
  v_mov_b32 v242, 0
  v_mov_b32 v243, 0
  v_mov_b32 v244, 0
  v_mov_b32 v245, 0
  v_mov_b32 v246, 0
  v_mov_b32 v247, 0
  v_accvgpr_write_b32 a48, 0
  v_accvgpr_write_b32 a49, 0
  v_accvgpr_write_b32 a50, 0
  v_accvgpr_write_b32 a51, 0
  v_accvgpr_write_b32 a52, 0
  v_accvgpr_write_b32 a53, 0
  v_accvgpr_write_b32 a54, 0
  v_accvgpr_write_b32 a55, 0
  v_mov_b32 v248, 0
  v_mov_b32 v249, 0
  v_mov_b32 v250, 0
  v_mov_b32 v251, 0
  v_mov_b32 v252, 0
  v_mov_b32 v253, 0
  v_mov_b32 v254, 0
  v_mov_b32 v255, 0
  v_accvgpr_write_b32 a56, 0
  v_accvgpr_write_b32 a57, 0
  v_accvgpr_write_b32 a58, 0
  v_accvgpr_write_b32 a59, 0
  v_accvgpr_write_b32 a60, 0
  v_accvgpr_write_b32 a61, 0
  v_accvgpr_write_b32 a62, 0
  v_accvgpr_write_b32 a63, 0
  v_and_b32 v13, 48, v0
  s_mov_b32 s68, 0
L_slow_l:
  s_mov_b32 s67, 0
  s_bfe_u32 s65, s68, 65536
  s_lshl_b32 s65, s65, 12
  s_or_b32 s67, s67, s65
  s_bfe_u32 s65, s68, 65537
  s_lshl_b32 s65, s65, 14
  s_or_b32 s67, s67, s65
  s_bfe_u32 s65, s68, 65538
  s_lshl_b32 s65, s65, 15
  s_or_b32 s67, s67, s65
  s_bfe_u32 s65, s68, 65539
  s_lshl_b32 s65, s65, 17
  s_or_b32 s67, s67, s65
  s_add_u32 m0, s63, 0
  s_add_u32 s65, s67, 0
  buffer_load_dwordx4 v28, s[28:31], s65 offen offset:0 lds
  s_add_u32 m0, s63, 1024
  s_add_u32 s65, s67, 1024
  buffer_load_dwordx4 v28, s[28:31], s65 offen offset:0 lds
  s_add_u32 m0, s63, 2048
  s_add_u32 s65, s67, 2048
  buffer_load_dwordx4 v28, s[28:31], s65 offen offset:0 lds
  s_add_u32 m0, s63, 3072
  s_add_u32 s65, s67, 3072
  buffer_load_dwordx4 v28, s[28:31], s65 offen offset:0 lds
  s_add_u32 m0, s63, 65536
  s_add_u32 s65, s67, 0
  buffer_load_dwordx4 v29, s[32:35], s65 offen offset:0 lds
  s_add_u32 m0, s63, 66560
  s_add_u32 s65, s67, 1024
  buffer_load_dwordx4 v29, s[32:35], s65 offen offset:0 lds
  s_add_u32 m0, s63, 67584
  s_add_u32 s65, s67, 2048
  buffer_load_dwordx4 v29, s[32:35], s65 offen offset:0 lds
  s_add_u32 m0, s63, 68608
  s_add_u32 s65, s67, 3072
  buffer_load_dwordx4 v29, s[32:35], s65 offen offset:0 lds
  s_waitcnt vmcnt(0)
  s_barrier
  ds_read_b128 a[64:67], v16 offset:0
  ds_read_b128 a[68:71], v17 offset:0
  ds_read_b128 a[72:75], v18 offset:0
  ds_read_b128 a[76:79], v19 offset:0
  s_waitcnt lgkmcnt(0)
  v_mfma_f32_16x16x32_bf16 v[64:67], a[64:67], v[128:131], 0
  v_mfma_f32_16x16x32_bf16 v[64:67], a[68:71], v[160:163], v[64:67]
  v_mfma_f32_16x16x32_bf16 v[64:67], a[72:75], v[192:195], v[64:67]
  v_mfma_f32_16x16x32_bf16 v[64:67], a[76:79], v[224:227], v[64:67]
  v_mfma_f32_16x16x32_bf16 v[80:83], a[64:67], v[132:135], 0
  v_mfma_f32_16x16x32_bf16 v[80:83], a[68:71], v[164:167], v[80:83]
  v_mfma_f32_16x16x32_bf16 v[80:83], a[72:75], v[196:199], v[80:83]
  v_mfma_f32_16x16x32_bf16 v[80:83], a[76:79], v[228:231], v[80:83]
  v_mfma_f32_16x16x32_bf16 v[96:99], a[64:67], v[136:139], 0
  v_mfma_f32_16x16x32_bf16 v[96:99], a[68:71], v[168:171], v[96:99]
  v_mfma_f32_16x16x32_bf16 v[96:99], a[72:75], v[200:203], v[96:99]
  v_mfma_f32_16x16x32_bf16 v[96:99], a[76:79], v[232:235], v[96:99]
  v_mfma_f32_16x16x32_bf16 v[112:115], a[64:67], v[140:143], 0
  v_mfma_f32_16x16x32_bf16 v[112:115], a[68:71], v[172:175], v[112:115]
  v_mfma_f32_16x16x32_bf16 v[112:115], a[72:75], v[204:207], v[112:115]
  v_mfma_f32_16x16x32_bf16 v[112:115], a[76:79], v[236:239], v[112:115]
  ds_read_b128 a[80:83], v16 offset:1024
  ds_read_b128 a[84:87], v17 offset:1024
  ds_read_b128 a[88:91], v18 offset:1024
  ds_read_b128 a[92:95], v19 offset:1024
  s_waitcnt lgkmcnt(0)
  v_mfma_f32_16x16x32_bf16 v[68:71], a[80:83], v[128:131], 0
  v_mfma_f32_16x16x32_bf16 v[68:71], a[84:87], v[160:163], v[68:71]
  v_mfma_f32_16x16x32_bf16 v[68:71], a[88:91], v[192:195], v[68:71]
  v_mfma_f32_16x16x32_bf16 v[68:71], a[92:95], v[224:227], v[68:71]
  v_mfma_f32_16x16x32_bf16 v[84:87], a[80:83], v[132:135], 0
  v_mfma_f32_16x16x32_bf16 v[84:87], a[84:87], v[164:167], v[84:87]
  v_mfma_f32_16x16x32_bf16 v[84:87], a[88:91], v[196:199], v[84:87]
  v_mfma_f32_16x16x32_bf16 v[84:87], a[92:95], v[228:231], v[84:87]
  v_mfma_f32_16x16x32_bf16 v[100:103], a[80:83], v[136:139], 0
  v_mfma_f32_16x16x32_bf16 v[100:103], a[84:87], v[168:171], v[100:103]
  v_mfma_f32_16x16x32_bf16 v[100:103], a[88:91], v[200:203], v[100:103]
  v_mfma_f32_16x16x32_bf16 v[100:103], a[92:95], v[232:235], v[100:103]
  v_mfma_f32_16x16x32_bf16 v[116:119], a[80:83], v[140:143], 0
  v_mfma_f32_16x16x32_bf16 v[116:119], a[84:87], v[172:175], v[116:119]
  v_mfma_f32_16x16x32_bf16 v[116:119], a[88:91], v[204:207], v[116:119]
  v_mfma_f32_16x16x32_bf16 v[116:119], a[92:95], v[236:239], v[116:119]
  ds_read_b128 a[64:67], v16 offset:2048
  ds_read_b128 a[68:71], v17 offset:2048
  ds_read_b128 a[72:75], v18 offset:2048
  ds_read_b128 a[76:79], v19 offset:2048
  s_waitcnt lgkmcnt(0)
  v_mfma_f32_16x16x32_bf16 v[72:75], a[64:67], v[128:131], 0
  v_mfma_f32_16x16x32_bf16 v[72:75], a[68:71], v[160:163], v[72:75]
  v_mfma_f32_16x16x32_bf16 v[72:75], a[72:75], v[192:195], v[72:75]
  v_mfma_f32_16x16x32_bf16 v[72:75], a[76:79], v[224:227], v[72:75]
  v_mfma_f32_16x16x32_bf16 v[88:91], a[64:67], v[132:135], 0
  v_mfma_f32_16x16x32_bf16 v[88:91], a[68:71], v[164:167], v[88:91]
  v_mfma_f32_16x16x32_bf16 v[88:91], a[72:75], v[196:199], v[88:91]
  v_mfma_f32_16x16x32_bf16 v[88:91], a[76:79], v[228:231], v[88:91]
  v_mfma_f32_16x16x32_bf16 v[104:107], a[64:67], v[136:139], 0
  v_mfma_f32_16x16x32_bf16 v[104:107], a[68:71], v[168:171], v[104:107]
  v_mfma_f32_16x16x32_bf16 v[104:107], a[72:75], v[200:203], v[104:107]
  v_mfma_f32_16x16x32_bf16 v[104:107], a[76:79], v[232:235], v[104:107]
  v_mfma_f32_16x16x32_bf16 v[120:123], a[64:67], v[140:143], 0
  v_mfma_f32_16x16x32_bf16 v[120:123], a[68:71], v[172:175], v[120:123]
  v_mfma_f32_16x16x32_bf16 v[120:123], a[72:75], v[204:207], v[120:123]
  v_mfma_f32_16x16x32_bf16 v[120:123], a[76:79], v[236:239], v[120:123]
  ds_read_b128 a[80:83], v16 offset:3072
  ds_read_b128 a[84:87], v17 offset:3072
  ds_read_b128 a[88:91], v18 offset:3072
  ds_read_b128 a[92:95], v19 offset:3072
  s_waitcnt lgkmcnt(0)
  v_mfma_f32_16x16x32_bf16 v[76:79], a[80:83], v[128:131], 0
  v_mfma_f32_16x16x32_bf16 v[76:79], a[84:87], v[160:163], v[76:79]
  v_mfma_f32_16x16x32_bf16 v[76:79], a[88:91], v[192:195], v[76:79]
  v_mfma_f32_16x16x32_bf16 v[76:79], a[92:95], v[224:227], v[76:79]
  v_mfma_f32_16x16x32_bf16 v[92:95], a[80:83], v[132:135], 0
  v_mfma_f32_16x16x32_bf16 v[92:95], a[84:87], v[164:167], v[92:95]
  v_mfma_f32_16x16x32_bf16 v[92:95], a[88:91], v[196:199], v[92:95]
  v_mfma_f32_16x16x32_bf16 v[92:95], a[92:95], v[228:231], v[92:95]
  v_mfma_f32_16x16x32_bf16 v[108:111], a[80:83], v[136:139], 0
  v_mfma_f32_16x16x32_bf16 v[108:111], a[84:87], v[168:171], v[108:111]
  v_mfma_f32_16x16x32_bf16 v[108:111], a[88:91], v[200:203], v[108:111]
  v_mfma_f32_16x16x32_bf16 v[108:111], a[92:95], v[232:235], v[108:111]
  v_mfma_f32_16x16x32_bf16 v[124:127], a[80:83], v[140:143], 0
  v_mfma_f32_16x16x32_bf16 v[124:127], a[84:87], v[172:175], v[124:127]
  v_mfma_f32_16x16x32_bf16 v[124:127], a[88:91], v[204:207], v[124:127]
  v_mfma_f32_16x16x32_bf16 v[124:127], a[92:95], v[236:239], v[124:127]
  s_nop 7
  v_max3_f32 v10, v64, v65, v2
  v_max3_f32 v10, v66, v67, v10
  v_max3_f32 v10, v68, v69, v10
  v_max3_f32 v10, v70, v71, v10
  v_max3_f32 v10, v72, v73, v10
  v_max3_f32 v10, v74, v75, v10
  v_max3_f32 v10, v76, v77, v10
  v_max3_f32 v10, v78, v79, v10
  v_mov_b32 v11, v10
  s_nop 1
  v_permlane32_swap_b32 v10, v11
  v_max_f32 v10, v10, v11
  v_mov_b32 v11, v10
  s_nop 1
  v_permlane16_swap_b32 v10, v11
  v_max_f32 v10, v10, v11
  v_sub_f32 v11, v2, v10
  v_exp_f32 v11, v11
  v_mov_b32 v2, v10
  v_mul_f32 v6, v6, v11
  v_sub_f32 v64, v64, v10
  v_exp_f32 v64, v64
  v_sub_f32 v65, v65, v10
  v_exp_f32 v65, v65
  v_sub_f32 v66, v66, v10
  v_exp_f32 v66, v66
  v_sub_f32 v67, v67, v10
  v_exp_f32 v67, v67
  v_sub_f32 v68, v68, v10
  v_exp_f32 v68, v68
  v_sub_f32 v69, v69, v10
  v_exp_f32 v69, v69
  v_sub_f32 v70, v70, v10
  v_exp_f32 v70, v70
  v_sub_f32 v71, v71, v10
  v_exp_f32 v71, v71
  v_sub_f32 v72, v72, v10
  v_exp_f32 v72, v72
  v_sub_f32 v73, v73, v10
  v_exp_f32 v73, v73
  v_sub_f32 v74, v74, v10
  v_exp_f32 v74, v74
  v_sub_f32 v75, v75, v10
  v_exp_f32 v75, v75
  v_sub_f32 v76, v76, v10
  v_exp_f32 v76, v76
  v_sub_f32 v77, v77, v10
  v_exp_f32 v77, v77
  v_sub_f32 v78, v78, v10
  v_exp_f32 v78, v78
  v_sub_f32 v79, v79, v10
  v_exp_f32 v79, v79
  s_nop 0
  v_add_f32 v6, v6, v64
  v_add_f32 v6, v6, v65
  v_add_f32 v6, v6, v66
  v_add_f32 v6, v6, v67
  v_add_f32 v6, v6, v68
  v_add_f32 v6, v6, v69
  v_add_f32 v6, v6, v70
  v_add_f32 v6, v6, v71
  v_add_f32 v6, v6, v72
  v_add_f32 v6, v6, v73
  v_add_f32 v6, v6, v74
  v_add_f32 v6, v6, v75
  v_add_f32 v6, v6, v76
  v_add_f32 v6, v6, v77
  v_add_f32 v6, v6, v78
  v_add_f32 v6, v6, v79
  v_cvt_pk_bf16_f32 v32, v64, v65
  v_cvt_pk_bf16_f32 v33, v66, v67
  v_cvt_pk_bf16_f32 v34, v68, v69
  v_cvt_pk_bf16_f32 v35, v70, v71
  v_cvt_pk_bf16_f32 v36, v72, v73
  v_cvt_pk_bf16_f32 v37, v74, v75
  v_cvt_pk_bf16_f32 v38, v76, v77
  v_cvt_pk_bf16_f32 v39, v78, v79
  ds_bpermute_b32 v64, v13, v11 offset:0
  ds_bpermute_b32 v65, v13, v11 offset:4
  ds_bpermute_b32 v66, v13, v11 offset:8
  ds_bpermute_b32 v67, v13, v11 offset:12
  s_waitcnt lgkmcnt(0)
  v_mul_f32 v144, v144, v64
  v_mul_f32 v145, v145, v65
  v_mul_f32 v146, v146, v66
  v_mul_f32 v147, v147, v67
  v_mul_f32 v152, v152, v64
  v_mul_f32 v153, v153, v65
  v_mul_f32 v154, v154, v66
  v_mul_f32 v155, v155, v67
  v_mul_f32 v176, v176, v64
  v_mul_f32 v177, v177, v65
  v_mul_f32 v178, v178, v66
  v_mul_f32 v179, v179, v67
  v_mul_f32 v184, v184, v64
  v_mul_f32 v185, v185, v65
  v_mul_f32 v186, v186, v66
  v_mul_f32 v187, v187, v67
  v_mul_f32 v208, v208, v64
  v_mul_f32 v209, v209, v65
  v_mul_f32 v210, v210, v66
  v_mul_f32 v211, v211, v67
  v_mul_f32 v216, v216, v64
  v_mul_f32 v217, v217, v65
  v_mul_f32 v218, v218, v66
  v_mul_f32 v219, v219, v67
  v_mul_f32 v240, v240, v64
  v_mul_f32 v241, v241, v65
  v_mul_f32 v242, v242, v66
  v_mul_f32 v243, v243, v67
  v_mul_f32 v248, v248, v64
  v_mul_f32 v249, v249, v65
  v_mul_f32 v250, v250, v66
  v_mul_f32 v251, v251, v67
  v_max3_f32 v10, v80, v81, v3
  v_max3_f32 v10, v82, v83, v10
  v_max3_f32 v10, v84, v85, v10
  v_max3_f32 v10, v86, v87, v10
  v_max3_f32 v10, v88, v89, v10
  v_max3_f32 v10, v90, v91, v10
  v_max3_f32 v10, v92, v93, v10
  v_max3_f32 v10, v94, v95, v10
  v_mov_b32 v11, v10
  s_nop 1
  v_permlane32_swap_b32 v10, v11
  v_max_f32 v10, v10, v11
  v_mov_b32 v11, v10
  s_nop 1
  v_permlane16_swap_b32 v10, v11
  v_max_f32 v10, v10, v11
  v_sub_f32 v11, v3, v10
  v_exp_f32 v11, v11
  v_mov_b32 v3, v10
  v_mul_f32 v7, v7, v11
  v_sub_f32 v80, v80, v10
  v_exp_f32 v80, v80
  v_sub_f32 v81, v81, v10
  v_exp_f32 v81, v81
  v_sub_f32 v82, v82, v10
  v_exp_f32 v82, v82
  v_sub_f32 v83, v83, v10
  v_exp_f32 v83, v83
  v_sub_f32 v84, v84, v10
  v_exp_f32 v84, v84
  v_sub_f32 v85, v85, v10
  v_exp_f32 v85, v85
  v_sub_f32 v86, v86, v10
  v_exp_f32 v86, v86
  v_sub_f32 v87, v87, v10
  v_exp_f32 v87, v87
  v_sub_f32 v88, v88, v10
  v_exp_f32 v88, v88
  v_sub_f32 v89, v89, v10
  v_exp_f32 v89, v89
  v_sub_f32 v90, v90, v10
  v_exp_f32 v90, v90
  v_sub_f32 v91, v91, v10
  v_exp_f32 v91, v91
  v_sub_f32 v92, v92, v10
  v_exp_f32 v92, v92
  v_sub_f32 v93, v93, v10
  v_exp_f32 v93, v93
  v_sub_f32 v94, v94, v10
  v_exp_f32 v94, v94
  v_sub_f32 v95, v95, v10
  v_exp_f32 v95, v95
  s_nop 0
  v_add_f32 v7, v7, v80
  v_add_f32 v7, v7, v81
  v_add_f32 v7, v7, v82
  v_add_f32 v7, v7, v83
  v_add_f32 v7, v7, v84
  v_add_f32 v7, v7, v85
  v_add_f32 v7, v7, v86
  v_add_f32 v7, v7, v87
  v_add_f32 v7, v7, v88
  v_add_f32 v7, v7, v89
  v_add_f32 v7, v7, v90
  v_add_f32 v7, v7, v91
  v_add_f32 v7, v7, v92
  v_add_f32 v7, v7, v93
  v_add_f32 v7, v7, v94
  v_add_f32 v7, v7, v95
  v_cvt_pk_bf16_f32 v40, v80, v81
  v_cvt_pk_bf16_f32 v41, v82, v83
  v_cvt_pk_bf16_f32 v42, v84, v85
  v_cvt_pk_bf16_f32 v43, v86, v87
  v_cvt_pk_bf16_f32 v44, v88, v89
  v_cvt_pk_bf16_f32 v45, v90, v91
  v_cvt_pk_bf16_f32 v46, v92, v93
  v_cvt_pk_bf16_f32 v47, v94, v95
  ds_bpermute_b32 v80, v13, v11 offset:0
  ds_bpermute_b32 v81, v13, v11 offset:4
  ds_bpermute_b32 v82, v13, v11 offset:8
  ds_bpermute_b32 v83, v13, v11 offset:12
  s_waitcnt lgkmcnt(0)
  v_mul_f32 v148, v148, v80
  v_mul_f32 v149, v149, v81
  v_mul_f32 v150, v150, v82
  v_mul_f32 v151, v151, v83
  v_mul_f32 v156, v156, v80
  v_mul_f32 v157, v157, v81
  v_mul_f32 v158, v158, v82
  v_mul_f32 v159, v159, v83
  v_mul_f32 v180, v180, v80
  v_mul_f32 v181, v181, v81
  v_mul_f32 v182, v182, v82
  v_mul_f32 v183, v183, v83
  v_mul_f32 v188, v188, v80
  v_mul_f32 v189, v189, v81
  v_mul_f32 v190, v190, v82
  v_mul_f32 v191, v191, v83
  v_mul_f32 v212, v212, v80
  v_mul_f32 v213, v213, v81
  v_mul_f32 v214, v214, v82
  v_mul_f32 v215, v215, v83
  v_mul_f32 v220, v220, v80
  v_mul_f32 v221, v221, v81
  v_mul_f32 v222, v222, v82
  v_mul_f32 v223, v223, v83
  v_mul_f32 v244, v244, v80
  v_mul_f32 v245, v245, v81
  v_mul_f32 v246, v246, v82
  v_mul_f32 v247, v247, v83
  v_mul_f32 v252, v252, v80
  v_mul_f32 v253, v253, v81
  v_mul_f32 v254, v254, v82
  v_mul_f32 v255, v255, v83
  v_max3_f32 v10, v96, v97, v4
  v_max3_f32 v10, v98, v99, v10
  v_max3_f32 v10, v100, v101, v10
  v_max3_f32 v10, v102, v103, v10
  v_max3_f32 v10, v104, v105, v10
  v_max3_f32 v10, v106, v107, v10
  v_max3_f32 v10, v108, v109, v10
  v_max3_f32 v10, v110, v111, v10
  v_mov_b32 v11, v10
  s_nop 1
  v_permlane32_swap_b32 v10, v11
  v_max_f32 v10, v10, v11
  v_mov_b32 v11, v10
  s_nop 1
  v_permlane16_swap_b32 v10, v11
  v_max_f32 v10, v10, v11
  v_sub_f32 v11, v4, v10
  v_exp_f32 v11, v11
  v_mov_b32 v4, v10
  v_mul_f32 v8, v8, v11
  v_sub_f32 v96, v96, v10
  v_exp_f32 v96, v96
  v_sub_f32 v97, v97, v10
  v_exp_f32 v97, v97
  v_sub_f32 v98, v98, v10
  v_exp_f32 v98, v98
  v_sub_f32 v99, v99, v10
  v_exp_f32 v99, v99
  v_sub_f32 v100, v100, v10
  v_exp_f32 v100, v100
  v_sub_f32 v101, v101, v10
  v_exp_f32 v101, v101
  v_sub_f32 v102, v102, v10
  v_exp_f32 v102, v102
  v_sub_f32 v103, v103, v10
  v_exp_f32 v103, v103
  v_sub_f32 v104, v104, v10
  v_exp_f32 v104, v104
  v_sub_f32 v105, v105, v10
  v_exp_f32 v105, v105
  v_sub_f32 v106, v106, v10
  v_exp_f32 v106, v106
  v_sub_f32 v107, v107, v10
  v_exp_f32 v107, v107
  v_sub_f32 v108, v108, v10
  v_exp_f32 v108, v108
  v_sub_f32 v109, v109, v10
  v_exp_f32 v109, v109
  v_sub_f32 v110, v110, v10
  v_exp_f32 v110, v110
  v_sub_f32 v111, v111, v10
  v_exp_f32 v111, v111
  s_nop 0
  v_add_f32 v8, v8, v96
  v_add_f32 v8, v8, v97
  v_add_f32 v8, v8, v98
  v_add_f32 v8, v8, v99
  v_add_f32 v8, v8, v100
  v_add_f32 v8, v8, v101
  v_add_f32 v8, v8, v102
  v_add_f32 v8, v8, v103
  v_add_f32 v8, v8, v104
  v_add_f32 v8, v8, v105
  v_add_f32 v8, v8, v106
  v_add_f32 v8, v8, v107
  v_add_f32 v8, v8, v108
  v_add_f32 v8, v8, v109
  v_add_f32 v8, v8, v110
  v_add_f32 v8, v8, v111
  v_cvt_pk_bf16_f32 v48, v96, v97
  v_cvt_pk_bf16_f32 v49, v98, v99
  v_cvt_pk_bf16_f32 v50, v100, v101
  v_cvt_pk_bf16_f32 v51, v102, v103
  v_cvt_pk_bf16_f32 v52, v104, v105
  v_cvt_pk_bf16_f32 v53, v106, v107
  v_cvt_pk_bf16_f32 v54, v108, v109
  v_cvt_pk_bf16_f32 v55, v110, v111
  ds_bpermute_b32 v96, v13, v11 offset:0
  ds_bpermute_b32 v97, v13, v11 offset:4
  ds_bpermute_b32 v98, v13, v11 offset:8
  ds_bpermute_b32 v99, v13, v11 offset:12
  s_waitcnt lgkmcnt(0)
  v_accvgpr_read_b32 v12, a0
  v_mul_f32 v12, v12, v96
  v_accvgpr_write_b32 a0, v12
  v_accvgpr_read_b32 v12, a1
  v_mul_f32 v12, v12, v97
  v_accvgpr_write_b32 a1, v12
  v_accvgpr_read_b32 v12, a2
  v_mul_f32 v12, v12, v98
  v_accvgpr_write_b32 a2, v12
  v_accvgpr_read_b32 v12, a3
  v_mul_f32 v12, v12, v99
  v_accvgpr_write_b32 a3, v12
  v_accvgpr_read_b32 v12, a8
  v_mul_f32 v12, v12, v96
  v_accvgpr_write_b32 a8, v12
  v_accvgpr_read_b32 v12, a9
  v_mul_f32 v12, v12, v97
  v_accvgpr_write_b32 a9, v12
  v_accvgpr_read_b32 v12, a10
  v_mul_f32 v12, v12, v98
  v_accvgpr_write_b32 a10, v12
  v_accvgpr_read_b32 v12, a11
  v_mul_f32 v12, v12, v99
  v_accvgpr_write_b32 a11, v12
  v_accvgpr_read_b32 v12, a16
  v_mul_f32 v12, v12, v96
  v_accvgpr_write_b32 a16, v12
  v_accvgpr_read_b32 v12, a17
  v_mul_f32 v12, v12, v97
  v_accvgpr_write_b32 a17, v12
  v_accvgpr_read_b32 v12, a18
  v_mul_f32 v12, v12, v98
  v_accvgpr_write_b32 a18, v12
  v_accvgpr_read_b32 v12, a19
  v_mul_f32 v12, v12, v99
  v_accvgpr_write_b32 a19, v12
  v_accvgpr_read_b32 v12, a24
  v_mul_f32 v12, v12, v96
  v_accvgpr_write_b32 a24, v12
  v_accvgpr_read_b32 v12, a25
  v_mul_f32 v12, v12, v97
  v_accvgpr_write_b32 a25, v12
  v_accvgpr_read_b32 v12, a26
  v_mul_f32 v12, v12, v98
  v_accvgpr_write_b32 a26, v12
  v_accvgpr_read_b32 v12, a27
  v_mul_f32 v12, v12, v99
  v_accvgpr_write_b32 a27, v12
  v_accvgpr_read_b32 v12, a32
  v_mul_f32 v12, v12, v96
  v_accvgpr_write_b32 a32, v12
  v_accvgpr_read_b32 v12, a33
  v_mul_f32 v12, v12, v97
  v_accvgpr_write_b32 a33, v12
  v_accvgpr_read_b32 v12, a34
  v_mul_f32 v12, v12, v98
  v_accvgpr_write_b32 a34, v12
  v_accvgpr_read_b32 v12, a35
  v_mul_f32 v12, v12, v99
  v_accvgpr_write_b32 a35, v12
  v_accvgpr_read_b32 v12, a40
  v_mul_f32 v12, v12, v96
  v_accvgpr_write_b32 a40, v12
  v_accvgpr_read_b32 v12, a41
  v_mul_f32 v12, v12, v97
  v_accvgpr_write_b32 a41, v12
  v_accvgpr_read_b32 v12, a42
  v_mul_f32 v12, v12, v98
  v_accvgpr_write_b32 a42, v12
  v_accvgpr_read_b32 v12, a43
  v_mul_f32 v12, v12, v99
  v_accvgpr_write_b32 a43, v12
  v_accvgpr_read_b32 v12, a48
  v_mul_f32 v12, v12, v96
  v_accvgpr_write_b32 a48, v12
  v_accvgpr_read_b32 v12, a49
  v_mul_f32 v12, v12, v97
  v_accvgpr_write_b32 a49, v12
  v_accvgpr_read_b32 v12, a50
  v_mul_f32 v12, v12, v98
  v_accvgpr_write_b32 a50, v12
  v_accvgpr_read_b32 v12, a51
  v_mul_f32 v12, v12, v99
  v_accvgpr_write_b32 a51, v12
  v_accvgpr_read_b32 v12, a56
  v_mul_f32 v12, v12, v96
  v_accvgpr_write_b32 a56, v12
  v_accvgpr_read_b32 v12, a57
  v_mul_f32 v12, v12, v97
  v_accvgpr_write_b32 a57, v12
  v_accvgpr_read_b32 v12, a58
  v_mul_f32 v12, v12, v98
  v_accvgpr_write_b32 a58, v12
  v_accvgpr_read_b32 v12, a59
  v_mul_f32 v12, v12, v99
  v_accvgpr_write_b32 a59, v12
  v_max3_f32 v10, v112, v113, v5
  v_max3_f32 v10, v114, v115, v10
  v_max3_f32 v10, v116, v117, v10
  v_max3_f32 v10, v118, v119, v10
  v_max3_f32 v10, v120, v121, v10
  v_max3_f32 v10, v122, v123, v10
  v_max3_f32 v10, v124, v125, v10
  v_max3_f32 v10, v126, v127, v10
  v_mov_b32 v11, v10
  s_nop 1
  v_permlane32_swap_b32 v10, v11
  v_max_f32 v10, v10, v11
  v_mov_b32 v11, v10
  s_nop 1
  v_permlane16_swap_b32 v10, v11
  v_max_f32 v10, v10, v11
  v_sub_f32 v11, v5, v10
  v_exp_f32 v11, v11
  v_mov_b32 v5, v10
  v_mul_f32 v9, v9, v11
  v_sub_f32 v112, v112, v10
  v_exp_f32 v112, v112
  v_sub_f32 v113, v113, v10
  v_exp_f32 v113, v113
  v_sub_f32 v114, v114, v10
  v_exp_f32 v114, v114
  v_sub_f32 v115, v115, v10
  v_exp_f32 v115, v115
  v_sub_f32 v116, v116, v10
  v_exp_f32 v116, v116
  v_sub_f32 v117, v117, v10
  v_exp_f32 v117, v117
  v_sub_f32 v118, v118, v10
  v_exp_f32 v118, v118
  v_sub_f32 v119, v119, v10
  v_exp_f32 v119, v119
  v_sub_f32 v120, v120, v10
  v_exp_f32 v120, v120
  v_sub_f32 v121, v121, v10
  v_exp_f32 v121, v121
  v_sub_f32 v122, v122, v10
  v_exp_f32 v122, v122
  v_sub_f32 v123, v123, v10
  v_exp_f32 v123, v123
  v_sub_f32 v124, v124, v10
  v_exp_f32 v124, v124
  v_sub_f32 v125, v125, v10
  v_exp_f32 v125, v125
  v_sub_f32 v126, v126, v10
  v_exp_f32 v126, v126
  v_sub_f32 v127, v127, v10
  v_exp_f32 v127, v127
  s_nop 0
  v_add_f32 v9, v9, v112
  v_add_f32 v9, v9, v113
  v_add_f32 v9, v9, v114
  v_add_f32 v9, v9, v115
  v_add_f32 v9, v9, v116
  v_add_f32 v9, v9, v117
  v_add_f32 v9, v9, v118
  v_add_f32 v9, v9, v119
  v_add_f32 v9, v9, v120
  v_add_f32 v9, v9, v121
  v_add_f32 v9, v9, v122
  v_add_f32 v9, v9, v123
  v_add_f32 v9, v9, v124
  v_add_f32 v9, v9, v125
  v_add_f32 v9, v9, v126
  v_add_f32 v9, v9, v127
  v_cvt_pk_bf16_f32 v56, v112, v113
  v_cvt_pk_bf16_f32 v57, v114, v115
  v_cvt_pk_bf16_f32 v58, v116, v117
  v_cvt_pk_bf16_f32 v59, v118, v119
  v_cvt_pk_bf16_f32 v60, v120, v121
  v_cvt_pk_bf16_f32 v61, v122, v123
  v_cvt_pk_bf16_f32 v62, v124, v125
  v_cvt_pk_bf16_f32 v63, v126, v127
  ds_bpermute_b32 v112, v13, v11 offset:0
  ds_bpermute_b32 v113, v13, v11 offset:4
  ds_bpermute_b32 v114, v13, v11 offset:8
  ds_bpermute_b32 v115, v13, v11 offset:12
  s_waitcnt lgkmcnt(0)
  v_accvgpr_read_b32 v12, a4
  v_mul_f32 v12, v12, v112
  v_accvgpr_write_b32 a4, v12
  v_accvgpr_read_b32 v12, a5
  v_mul_f32 v12, v12, v113
  v_accvgpr_write_b32 a5, v12
  v_accvgpr_read_b32 v12, a6
  v_mul_f32 v12, v12, v114
  v_accvgpr_write_b32 a6, v12
  v_accvgpr_read_b32 v12, a7
  v_mul_f32 v12, v12, v115
  v_accvgpr_write_b32 a7, v12
  v_accvgpr_read_b32 v12, a12
  v_mul_f32 v12, v12, v112
  v_accvgpr_write_b32 a12, v12
  v_accvgpr_read_b32 v12, a13
  v_mul_f32 v12, v12, v113
  v_accvgpr_write_b32 a13, v12
  v_accvgpr_read_b32 v12, a14
  v_mul_f32 v12, v12, v114
  v_accvgpr_write_b32 a14, v12
  v_accvgpr_read_b32 v12, a15
  v_mul_f32 v12, v12, v115
  v_accvgpr_write_b32 a15, v12
  v_accvgpr_read_b32 v12, a20
  v_mul_f32 v12, v12, v112
  v_accvgpr_write_b32 a20, v12
  v_accvgpr_read_b32 v12, a21
  v_mul_f32 v12, v12, v113
  v_accvgpr_write_b32 a21, v12
  v_accvgpr_read_b32 v12, a22
  v_mul_f32 v12, v12, v114
  v_accvgpr_write_b32 a22, v12
  v_accvgpr_read_b32 v12, a23
  v_mul_f32 v12, v12, v115
  v_accvgpr_write_b32 a23, v12
  v_accvgpr_read_b32 v12, a28
  v_mul_f32 v12, v12, v112
  v_accvgpr_write_b32 a28, v12
  v_accvgpr_read_b32 v12, a29
  v_mul_f32 v12, v12, v113
  v_accvgpr_write_b32 a29, v12
  v_accvgpr_read_b32 v12, a30
  v_mul_f32 v12, v12, v114
  v_accvgpr_write_b32 a30, v12
  v_accvgpr_read_b32 v12, a31
  v_mul_f32 v12, v12, v115
  v_accvgpr_write_b32 a31, v12
  v_accvgpr_read_b32 v12, a36
  v_mul_f32 v12, v12, v112
  v_accvgpr_write_b32 a36, v12
  v_accvgpr_read_b32 v12, a37
  v_mul_f32 v12, v12, v113
  v_accvgpr_write_b32 a37, v12
  v_accvgpr_read_b32 v12, a38
  v_mul_f32 v12, v12, v114
  v_accvgpr_write_b32 a38, v12
  v_accvgpr_read_b32 v12, a39
  v_mul_f32 v12, v12, v115
  v_accvgpr_write_b32 a39, v12
  v_accvgpr_read_b32 v12, a44
  v_mul_f32 v12, v12, v112
  v_accvgpr_write_b32 a44, v12
  v_accvgpr_read_b32 v12, a45
  v_mul_f32 v12, v12, v113
  v_accvgpr_write_b32 a45, v12
  v_accvgpr_read_b32 v12, a46
  v_mul_f32 v12, v12, v114
  v_accvgpr_write_b32 a46, v12
  v_accvgpr_read_b32 v12, a47
  v_mul_f32 v12, v12, v115
  v_accvgpr_write_b32 a47, v12
  v_accvgpr_read_b32 v12, a52
  v_mul_f32 v12, v12, v112
  v_accvgpr_write_b32 a52, v12
  v_accvgpr_read_b32 v12, a53
  v_mul_f32 v12, v12, v113
  v_accvgpr_write_b32 a53, v12
  v_accvgpr_read_b32 v12, a54
  v_mul_f32 v12, v12, v114
  v_accvgpr_write_b32 a54, v12
  v_accvgpr_read_b32 v12, a55
  v_mul_f32 v12, v12, v115
  v_accvgpr_write_b32 a55, v12
  v_accvgpr_read_b32 v12, a60
  v_mul_f32 v12, v12, v112
  v_accvgpr_write_b32 a60, v12
  v_accvgpr_read_b32 v12, a61
  v_mul_f32 v12, v12, v113
  v_accvgpr_write_b32 a61, v12
  v_accvgpr_read_b32 v12, a62
  v_mul_f32 v12, v12, v114
  v_accvgpr_write_b32 a62, v12
  v_accvgpr_read_b32 v12, a63
  v_mul_f32 v12, v12, v115
  v_accvgpr_write_b32 a63, v12
  ds_read_b64_tr_b16 a[96:97], v20 offset:0
  ds_read_b64_tr_b16 a[98:99], v20 offset:1024
  ds_read_b64_tr_b16 a[100:101], v20 offset:2048
  ds_read_b64_tr_b16 a[102:103], v20 offset:3072
  s_waitcnt lgkmcnt(0)
  v_mfma_f32_16x16x32_bf16 v[144:147], v[32:35], a[96:99], v[144:147]
  v_mfma_f32_16x16x32_bf16 v[144:147], v[36:39], a[100:103], v[144:147]
  v_mfma_f32_16x16x32_bf16 v[148:151], v[40:43], a[96:99], v[148:151]
  v_mfma_f32_16x16x32_bf16 v[148:151], v[44:47], a[100:103], v[148:151]
  v_mfma_f32_16x16x32_bf16 a[0:3], v[48:51], a[96:99], a[0:3]
  v_mfma_f32_16x16x32_bf16 a[0:3], v[52:55], a[100:103], a[0:3]
  v_mfma_f32_16x16x32_bf16 a[4:7], v[56:59], a[96:99], a[4:7]
  v_mfma_f32_16x16x32_bf16 a[4:7], v[60:63], a[100:103], a[4:7]
  ds_read_b64_tr_b16 a[104:105], v21 offset:0
  ds_read_b64_tr_b16 a[106:107], v21 offset:1024
  ds_read_b64_tr_b16 a[108:109], v21 offset:2048
  ds_read_b64_tr_b16 a[110:111], v21 offset:3072
  s_waitcnt lgkmcnt(0)
  v_mfma_f32_16x16x32_bf16 v[152:155], v[32:35], a[104:107], v[152:155]
  v_mfma_f32_16x16x32_bf16 v[152:155], v[36:39], a[108:111], v[152:155]
  v_mfma_f32_16x16x32_bf16 v[156:159], v[40:43], a[104:107], v[156:159]
  v_mfma_f32_16x16x32_bf16 v[156:159], v[44:47], a[108:111], v[156:159]
  v_mfma_f32_16x16x32_bf16 a[8:11], v[48:51], a[104:107], a[8:11]
  v_mfma_f32_16x16x32_bf16 a[8:11], v[52:55], a[108:111], a[8:11]
  v_mfma_f32_16x16x32_bf16 a[12:15], v[56:59], a[104:107], a[12:15]
  v_mfma_f32_16x16x32_bf16 a[12:15], v[60:63], a[108:111], a[12:15]
  ds_read_b64_tr_b16 a[112:113], v22 offset:0
  ds_read_b64_tr_b16 a[114:115], v22 offset:1024
  ds_read_b64_tr_b16 a[116:117], v22 offset:2048
  ds_read_b64_tr_b16 a[118:119], v22 offset:3072
  s_waitcnt lgkmcnt(0)
  v_mfma_f32_16x16x32_bf16 v[176:179], v[32:35], a[112:115], v[176:179]
  v_mfma_f32_16x16x32_bf16 v[176:179], v[36:39], a[116:119], v[176:179]
  v_mfma_f32_16x16x32_bf16 v[180:183], v[40:43], a[112:115], v[180:183]
  v_mfma_f32_16x16x32_bf16 v[180:183], v[44:47], a[116:119], v[180:183]
  v_mfma_f32_16x16x32_bf16 a[16:19], v[48:51], a[112:115], a[16:19]
  v_mfma_f32_16x16x32_bf16 a[16:19], v[52:55], a[116:119], a[16:19]
  v_mfma_f32_16x16x32_bf16 a[20:23], v[56:59], a[112:115], a[20:23]
  v_mfma_f32_16x16x32_bf16 a[20:23], v[60:63], a[116:119], a[20:23]
  ds_read_b64_tr_b16 a[120:121], v23 offset:0
  ds_read_b64_tr_b16 a[122:123], v23 offset:1024
  ds_read_b64_tr_b16 a[124:125], v23 offset:2048
  ds_read_b64_tr_b16 a[126:127], v23 offset:3072
  s_waitcnt lgkmcnt(0)
  v_mfma_f32_16x16x32_bf16 v[184:187], v[32:35], a[120:123], v[184:187]
  v_mfma_f32_16x16x32_bf16 v[184:187], v[36:39], a[124:127], v[184:187]
  v_mfma_f32_16x16x32_bf16 v[188:191], v[40:43], a[120:123], v[188:191]
  v_mfma_f32_16x16x32_bf16 v[188:191], v[44:47], a[124:127], v[188:191]
  v_mfma_f32_16x16x32_bf16 a[24:27], v[48:51], a[120:123], a[24:27]
  v_mfma_f32_16x16x32_bf16 a[24:27], v[52:55], a[124:127], a[24:27]
  v_mfma_f32_16x16x32_bf16 a[28:31], v[56:59], a[120:123], a[28:31]
  v_mfma_f32_16x16x32_bf16 a[28:31], v[60:63], a[124:127], a[28:31]
  ds_read_b64_tr_b16 a[96:97], v24 offset:0
  ds_read_b64_tr_b16 a[98:99], v24 offset:1024
  ds_read_b64_tr_b16 a[100:101], v24 offset:2048
  ds_read_b64_tr_b16 a[102:103], v24 offset:3072
  s_waitcnt lgkmcnt(0)
  v_mfma_f32_16x16x32_bf16 v[208:211], v[32:35], a[96:99], v[208:211]
  v_mfma_f32_16x16x32_bf16 v[208:211], v[36:39], a[100:103], v[208:211]
  v_mfma_f32_16x16x32_bf16 v[212:215], v[40:43], a[96:99], v[212:215]
  v_mfma_f32_16x16x32_bf16 v[212:215], v[44:47], a[100:103], v[212:215]
  v_mfma_f32_16x16x32_bf16 a[32:35], v[48:51], a[96:99], a[32:35]
  v_mfma_f32_16x16x32_bf16 a[32:35], v[52:55], a[100:103], a[32:35]
  v_mfma_f32_16x16x32_bf16 a[36:39], v[56:59], a[96:99], a[36:39]
  v_mfma_f32_16x16x32_bf16 a[36:39], v[60:63], a[100:103], a[36:39]
  ds_read_b64_tr_b16 a[104:105], v25 offset:0
  ds_read_b64_tr_b16 a[106:107], v25 offset:1024
  ds_read_b64_tr_b16 a[108:109], v25 offset:2048
  ds_read_b64_tr_b16 a[110:111], v25 offset:3072
  s_waitcnt lgkmcnt(0)
  v_mfma_f32_16x16x32_bf16 v[216:219], v[32:35], a[104:107], v[216:219]
  v_mfma_f32_16x16x32_bf16 v[216:219], v[36:39], a[108:111], v[216:219]
  v_mfma_f32_16x16x32_bf16 v[220:223], v[40:43], a[104:107], v[220:223]
  v_mfma_f32_16x16x32_bf16 v[220:223], v[44:47], a[108:111], v[220:223]
  v_mfma_f32_16x16x32_bf16 a[40:43], v[48:51], a[104:107], a[40:43]
  v_mfma_f32_16x16x32_bf16 a[40:43], v[52:55], a[108:111], a[40:43]
  v_mfma_f32_16x16x32_bf16 a[44:47], v[56:59], a[104:107], a[44:47]
  v_mfma_f32_16x16x32_bf16 a[44:47], v[60:63], a[108:111], a[44:47]
  ds_read_b64_tr_b16 a[112:113], v26 offset:0
  ds_read_b64_tr_b16 a[114:115], v26 offset:1024
  ds_read_b64_tr_b16 a[116:117], v26 offset:2048
  ds_read_b64_tr_b16 a[118:119], v26 offset:3072
  s_waitcnt lgkmcnt(0)
  v_mfma_f32_16x16x32_bf16 v[240:243], v[32:35], a[112:115], v[240:243]
  v_mfma_f32_16x16x32_bf16 v[240:243], v[36:39], a[116:119], v[240:243]
  v_mfma_f32_16x16x32_bf16 v[244:247], v[40:43], a[112:115], v[244:247]
  v_mfma_f32_16x16x32_bf16 v[244:247], v[44:47], a[116:119], v[244:247]
  v_mfma_f32_16x16x32_bf16 a[48:51], v[48:51], a[112:115], a[48:51]
  v_mfma_f32_16x16x32_bf16 a[48:51], v[52:55], a[116:119], a[48:51]
  v_mfma_f32_16x16x32_bf16 a[52:55], v[56:59], a[112:115], a[52:55]
  v_mfma_f32_16x16x32_bf16 a[52:55], v[60:63], a[116:119], a[52:55]
  ds_read_b64_tr_b16 a[120:121], v27 offset:0
  ds_read_b64_tr_b16 a[122:123], v27 offset:1024
  ds_read_b64_tr_b16 a[124:125], v27 offset:2048
  ds_read_b64_tr_b16 a[126:127], v27 offset:3072
  s_waitcnt lgkmcnt(0)
  v_mfma_f32_16x16x32_bf16 v[248:251], v[32:35], a[120:123], v[248:251]
  v_mfma_f32_16x16x32_bf16 v[248:251], v[36:39], a[124:127], v[248:251]
  v_mfma_f32_16x16x32_bf16 v[252:255], v[40:43], a[120:123], v[252:255]
  v_mfma_f32_16x16x32_bf16 v[252:255], v[44:47], a[124:127], v[252:255]
  v_mfma_f32_16x16x32_bf16 a[56:59], v[48:51], a[120:123], a[56:59]
  v_mfma_f32_16x16x32_bf16 a[56:59], v[52:55], a[124:127], a[56:59]
  v_mfma_f32_16x16x32_bf16 a[60:63], v[56:59], a[120:123], a[60:63]
  v_mfma_f32_16x16x32_bf16 a[60:63], v[60:63], a[124:127], a[60:63]
  s_nop 7
  s_barrier
  s_add_u32 s68, s68, 1
  s_cmp_lt_u32 s68, 16
  s_cbranch_scc1 L_slow_l
  v_mov_b32 v10, v6
  s_nop 1
  v_permlane32_swap_b32 v6, v10
  v_add_f32 v6, v6, v10
  v_mov_b32 v10, v6
  s_nop 1
  v_permlane16_swap_b32 v6, v10
  v_add_f32 v6, v6, v10
  v_rcp_f32 v6, v6
  v_mov_b32 v10, v7
  s_nop 1
  v_permlane32_swap_b32 v7, v10
  v_add_f32 v7, v7, v10
  v_mov_b32 v10, v7
  s_nop 1
  v_permlane16_swap_b32 v7, v10
  v_add_f32 v7, v7, v10
  v_rcp_f32 v7, v7
  v_mov_b32 v10, v8
  s_nop 1
  v_permlane32_swap_b32 v8, v10
  v_add_f32 v8, v8, v10
  v_mov_b32 v10, v8
  s_nop 1
  v_permlane16_swap_b32 v8, v10
  v_add_f32 v8, v8, v10
  v_rcp_f32 v8, v8
  v_mov_b32 v10, v9
  s_nop 1
  v_permlane32_swap_b32 v9, v10
  v_add_f32 v9, v9, v10
  v_mov_b32 v10, v9
  s_nop 1
  v_permlane16_swap_b32 v9, v10
  v_add_f32 v9, v9, v10
  v_rcp_f32 v9, v9
  s_nop 0
  ds_bpermute_b32 v64, v13, v6 offset:0
  ds_bpermute_b32 v65, v13, v6 offset:4
  ds_bpermute_b32 v66, v13, v6 offset:8
  ds_bpermute_b32 v67, v13, v6 offset:12
  ds_bpermute_b32 v68, v13, v7 offset:0
  ds_bpermute_b32 v69, v13, v7 offset:4
  ds_bpermute_b32 v70, v13, v7 offset:8
  ds_bpermute_b32 v71, v13, v7 offset:12
  ds_bpermute_b32 v72, v13, v8 offset:0
  ds_bpermute_b32 v73, v13, v8 offset:4
  ds_bpermute_b32 v74, v13, v8 offset:8
  ds_bpermute_b32 v75, v13, v8 offset:12
  ds_bpermute_b32 v76, v13, v9 offset:0
  ds_bpermute_b32 v77, v13, v9 offset:4
  ds_bpermute_b32 v78, v13, v9 offset:8
  ds_bpermute_b32 v79, v13, v9 offset:12
  v_and_b32 v10, 3, v0
  v_cmp_eq_u32 vcc, 0, v10
  s_waitcnt lgkmcnt(0)
  s_nop 0
  v_cndmask_b32 v2, v64, v68, vcc
  v_cndmask_b32 v3, v65, v69, vcc
  v_cndmask_b32 v4, v66, v70, vcc
  v_cndmask_b32 v5, v67, v71, vcc
  v_cndmask_b32 v104, v72, v76, vcc
  v_cndmask_b32 v105, v73, v77, vcc
  v_cndmask_b32 v106, v74, v78, vcc
  v_cndmask_b32 v107, v75, v79, vcc
  v_lshrrev_b32 v9, 4, v0
  v_lshlrev_b32 v9, 6, v9
  v_xor_b32 v11, v9, v1
  v_mul_f32_dpp v144, v2, v144 quad_perm:[1,1,1,1] row_mask:0xf bank_mask:0xf
  v_mul_f32_dpp v152, v2, v152 quad_perm:[1,1,1,1] row_mask:0xf bank_mask:0xf
  v_mul_f32_dpp v145, v3, v145 quad_perm:[1,1,1,1] row_mask:0xf bank_mask:0xf
  v_mul_f32_dpp v153, v3, v153 quad_perm:[1,1,1,1] row_mask:0xf bank_mask:0xf
  v_mul_f32_dpp v146, v4, v146 quad_perm:[1,1,1,1] row_mask:0xf bank_mask:0xf
  v_mul_f32_dpp v154, v4, v154 quad_perm:[1,1,1,1] row_mask:0xf bank_mask:0xf
  v_mul_f32_dpp v147, v5, v147 quad_perm:[1,1,1,1] row_mask:0xf bank_mask:0xf
  v_mul_f32_dpp v155, v5, v155 quad_perm:[1,1,1,1] row_mask:0xf bank_mask:0xf
  v_cvt_pk_bf16_f32 v144, v144, v145
  v_cvt_pk_bf16_f32 v145, v146, v147
  v_cvt_pk_bf16_f32 v146, v152, v153
  v_cvt_pk_bf16_f32 v147, v154, v155
  buffer_store_dwordx4 v[144:147], v11, s[40:43], s70 offen offset:0 sc1
  v_mul_f32_dpp v148, v2, v148 quad_perm:[0,0,0,0] row_mask:0xf bank_mask:0xf
  v_mul_f32_dpp v156, v2, v156 quad_perm:[0,0,0,0] row_mask:0xf bank_mask:0xf
  v_mul_f32_dpp v149, v3, v149 quad_perm:[0,0,0,0] row_mask:0xf bank_mask:0xf
  v_mul_f32_dpp v157, v3, v157 quad_perm:[0,0,0,0] row_mask:0xf bank_mask:0xf
  v_mul_f32_dpp v150, v4, v150 quad_perm:[0,0,0,0] row_mask:0xf bank_mask:0xf
  v_mul_f32_dpp v158, v4, v158 quad_perm:[0,0,0,0] row_mask:0xf bank_mask:0xf
  v_mul_f32_dpp v151, v5, v151 quad_perm:[0,0,0,0] row_mask:0xf bank_mask:0xf
  v_mul_f32_dpp v159, v5, v159 quad_perm:[0,0,0,0] row_mask:0xf bank_mask:0xf
  v_cvt_pk_bf16_f32 v148, v148, v149
  v_cvt_pk_bf16_f32 v149, v150, v151
  v_cvt_pk_bf16_f32 v150, v156, v157
  v_cvt_pk_bf16_f32 v151, v158, v159
  buffer_store_dwordx4 v[148:151], v11, s[40:43], s71 offen offset:0 sc1
  v_accvgpr_read_b32 v192, a0
  v_accvgpr_read_b32 v193, a1
  v_accvgpr_read_b32 v194, a2
  v_accvgpr_read_b32 v195, a3
  v_accvgpr_read_b32 v196, a8
  v_accvgpr_read_b32 v197, a9
  v_accvgpr_read_b32 v198, a10
  v_accvgpr_read_b32 v199, a11
  v_mul_f32_dpp v192, v104, v192 quad_perm:[1,1,1,1] row_mask:0xf bank_mask:0xf
  v_mul_f32_dpp v196, v104, v196 quad_perm:[1,1,1,1] row_mask:0xf bank_mask:0xf
  v_mul_f32_dpp v193, v105, v193 quad_perm:[1,1,1,1] row_mask:0xf bank_mask:0xf
  v_mul_f32_dpp v197, v105, v197 quad_perm:[1,1,1,1] row_mask:0xf bank_mask:0xf
  v_mul_f32_dpp v194, v106, v194 quad_perm:[1,1,1,1] row_mask:0xf bank_mask:0xf
  v_mul_f32_dpp v198, v106, v198 quad_perm:[1,1,1,1] row_mask:0xf bank_mask:0xf
  v_mul_f32_dpp v195, v107, v195 quad_perm:[1,1,1,1] row_mask:0xf bank_mask:0xf
  v_mul_f32_dpp v199, v107, v199 quad_perm:[1,1,1,1] row_mask:0xf bank_mask:0xf
  v_cvt_pk_bf16_f32 v16, v192, v193
  v_cvt_pk_bf16_f32 v17, v194, v195
  v_cvt_pk_bf16_f32 v18, v196, v197
  v_cvt_pk_bf16_f32 v19, v198, v199
  v_accvgpr_read_b32 v200, a4
  v_accvgpr_read_b32 v201, a5
  v_accvgpr_read_b32 v202, a6
  v_accvgpr_read_b32 v203, a7
  v_accvgpr_read_b32 v204, a12
  v_accvgpr_read_b32 v205, a13
  v_accvgpr_read_b32 v206, a14
  v_accvgpr_read_b32 v207, a15
  v_mul_f32_dpp v200, v104, v200 quad_perm:[0,0,0,0] row_mask:0xf bank_mask:0xf
  v_mul_f32_dpp v204, v104, v204 quad_perm:[0,0,0,0] row_mask:0xf bank_mask:0xf
  v_mul_f32_dpp v201, v105, v201 quad_perm:[0,0,0,0] row_mask:0xf bank_mask:0xf
  v_mul_f32_dpp v205, v105, v205 quad_perm:[0,0,0,0] row_mask:0xf bank_mask:0xf
  v_mul_f32_dpp v202, v106, v202 quad_perm:[0,0,0,0] row_mask:0xf bank_mask:0xf
  v_mul_f32_dpp v206, v106, v206 quad_perm:[0,0,0,0] row_mask:0xf bank_mask:0xf
  v_mul_f32_dpp v203, v107, v203 quad_perm:[0,0,0,0] row_mask:0xf bank_mask:0xf
  v_mul_f32_dpp v207, v107, v207 quad_perm:[0,0,0,0] row_mask:0xf bank_mask:0xf
  v_cvt_pk_bf16_f32 v112, v200, v201
  v_cvt_pk_bf16_f32 v113, v202, v203
  v_cvt_pk_bf16_f32 v114, v204, v205
  v_cvt_pk_bf16_f32 v115, v206, v207
  v_mul_f32_dpp v176, v2, v176 quad_perm:[1,1,1,1] row_mask:0xf bank_mask:0xf
  v_mul_f32_dpp v184, v2, v184 quad_perm:[1,1,1,1] row_mask:0xf bank_mask:0xf
  v_mul_f32_dpp v177, v3, v177 quad_perm:[1,1,1,1] row_mask:0xf bank_mask:0xf
  v_mul_f32_dpp v185, v3, v185 quad_perm:[1,1,1,1] row_mask:0xf bank_mask:0xf
  v_mul_f32_dpp v178, v4, v178 quad_perm:[1,1,1,1] row_mask:0xf bank_mask:0xf
  v_mul_f32_dpp v186, v4, v186 quad_perm:[1,1,1,1] row_mask:0xf bank_mask:0xf
  v_mul_f32_dpp v179, v5, v179 quad_perm:[1,1,1,1] row_mask:0xf bank_mask:0xf
  v_mul_f32_dpp v187, v5, v187 quad_perm:[1,1,1,1] row_mask:0xf bank_mask:0xf
  v_cvt_pk_bf16_f32 v176, v176, v177
  v_cvt_pk_bf16_f32 v177, v178, v179
  v_cvt_pk_bf16_f32 v178, v184, v185
  v_cvt_pk_bf16_f32 v179, v186, v187
  buffer_store_dwordx4 v[176:179], v11, s[40:43], s70 offen offset:1024 sc1
  v_mul_f32_dpp v180, v2, v180 quad_perm:[0,0,0,0] row_mask:0xf bank_mask:0xf
  v_mul_f32_dpp v188, v2, v188 quad_perm:[0,0,0,0] row_mask:0xf bank_mask:0xf
  v_mul_f32_dpp v181, v3, v181 quad_perm:[0,0,0,0] row_mask:0xf bank_mask:0xf
  v_mul_f32_dpp v189, v3, v189 quad_perm:[0,0,0,0] row_mask:0xf bank_mask:0xf
  v_mul_f32_dpp v182, v4, v182 quad_perm:[0,0,0,0] row_mask:0xf bank_mask:0xf
  v_mul_f32_dpp v190, v4, v190 quad_perm:[0,0,0,0] row_mask:0xf bank_mask:0xf
  v_mul_f32_dpp v183, v5, v183 quad_perm:[0,0,0,0] row_mask:0xf bank_mask:0xf
  v_mul_f32_dpp v191, v5, v191 quad_perm:[0,0,0,0] row_mask:0xf bank_mask:0xf
  v_cvt_pk_bf16_f32 v180, v180, v181
  v_cvt_pk_bf16_f32 v181, v182, v183
  v_cvt_pk_bf16_f32 v182, v188, v189
  v_cvt_pk_bf16_f32 v183, v190, v191
  buffer_store_dwordx4 v[180:183], v11, s[40:43], s71 offen offset:1024 sc1
  v_accvgpr_read_b32 v224, a16
  v_accvgpr_read_b32 v225, a17
  v_accvgpr_read_b32 v226, a18
  v_accvgpr_read_b32 v227, a19
  v_accvgpr_read_b32 v228, a24
  v_accvgpr_read_b32 v229, a25
  v_accvgpr_read_b32 v230, a26
  v_accvgpr_read_b32 v231, a27
  v_mul_f32_dpp v224, v104, v224 quad_perm:[1,1,1,1] row_mask:0xf bank_mask:0xf
  v_mul_f32_dpp v228, v104, v228 quad_perm:[1,1,1,1] row_mask:0xf bank_mask:0xf
  v_mul_f32_dpp v225, v105, v225 quad_perm:[1,1,1,1] row_mask:0xf bank_mask:0xf
  v_mul_f32_dpp v229, v105, v229 quad_perm:[1,1,1,1] row_mask:0xf bank_mask:0xf
  v_mul_f32_dpp v226, v106, v226 quad_perm:[1,1,1,1] row_mask:0xf bank_mask:0xf
  v_mul_f32_dpp v230, v106, v230 quad_perm:[1,1,1,1] row_mask:0xf bank_mask:0xf
  v_mul_f32_dpp v227, v107, v227 quad_perm:[1,1,1,1] row_mask:0xf bank_mask:0xf
  v_mul_f32_dpp v231, v107, v231 quad_perm:[1,1,1,1] row_mask:0xf bank_mask:0xf
  v_cvt_pk_bf16_f32 v20, v224, v225
  v_cvt_pk_bf16_f32 v21, v226, v227
  v_cvt_pk_bf16_f32 v22, v228, v229
  v_cvt_pk_bf16_f32 v23, v230, v231
  v_accvgpr_read_b32 v232, a20
  v_accvgpr_read_b32 v233, a21
  v_accvgpr_read_b32 v234, a22
  v_accvgpr_read_b32 v235, a23
  v_accvgpr_read_b32 v236, a28
  v_accvgpr_read_b32 v237, a29
  v_accvgpr_read_b32 v238, a30
  v_accvgpr_read_b32 v239, a31
  v_mul_f32_dpp v232, v104, v232 quad_perm:[0,0,0,0] row_mask:0xf bank_mask:0xf
  v_mul_f32_dpp v236, v104, v236 quad_perm:[0,0,0,0] row_mask:0xf bank_mask:0xf
  v_mul_f32_dpp v233, v105, v233 quad_perm:[0,0,0,0] row_mask:0xf bank_mask:0xf
  v_mul_f32_dpp v237, v105, v237 quad_perm:[0,0,0,0] row_mask:0xf bank_mask:0xf
  v_mul_f32_dpp v234, v106, v234 quad_perm:[0,0,0,0] row_mask:0xf bank_mask:0xf
  v_mul_f32_dpp v238, v106, v238 quad_perm:[0,0,0,0] row_mask:0xf bank_mask:0xf
  v_mul_f32_dpp v235, v107, v235 quad_perm:[0,0,0,0] row_mask:0xf bank_mask:0xf
  v_mul_f32_dpp v239, v107, v239 quad_perm:[0,0,0,0] row_mask:0xf bank_mask:0xf
  v_cvt_pk_bf16_f32 v116, v232, v233
  v_cvt_pk_bf16_f32 v117, v234, v235
  v_cvt_pk_bf16_f32 v118, v236, v237
  v_cvt_pk_bf16_f32 v119, v238, v239
  v_mul_f32_dpp v208, v2, v208 quad_perm:[1,1,1,1] row_mask:0xf bank_mask:0xf
  v_mul_f32_dpp v216, v2, v216 quad_perm:[1,1,1,1] row_mask:0xf bank_mask:0xf
  v_mul_f32_dpp v209, v3, v209 quad_perm:[1,1,1,1] row_mask:0xf bank_mask:0xf
  v_mul_f32_dpp v217, v3, v217 quad_perm:[1,1,1,1] row_mask:0xf bank_mask:0xf
  v_mul_f32_dpp v210, v4, v210 quad_perm:[1,1,1,1] row_mask:0xf bank_mask:0xf
  v_mul_f32_dpp v218, v4, v218 quad_perm:[1,1,1,1] row_mask:0xf bank_mask:0xf
  v_mul_f32_dpp v211, v5, v211 quad_perm:[1,1,1,1] row_mask:0xf bank_mask:0xf
  v_mul_f32_dpp v219, v5, v219 quad_perm:[1,1,1,1] row_mask:0xf bank_mask:0xf
  v_cvt_pk_bf16_f32 v208, v208, v209
  v_cvt_pk_bf16_f32 v209, v210, v211
  v_cvt_pk_bf16_f32 v210, v216, v217
  v_cvt_pk_bf16_f32 v211, v218, v219
  buffer_store_dwordx4 v[208:211], v11, s[40:43], s70 offen offset:2048 sc1
  v_mul_f32_dpp v212, v2, v212 quad_perm:[0,0,0,0] row_mask:0xf bank_mask:0xf
  v_mul_f32_dpp v220, v2, v220 quad_perm:[0,0,0,0] row_mask:0xf bank_mask:0xf
  v_mul_f32_dpp v213, v3, v213 quad_perm:[0,0,0,0] row_mask:0xf bank_mask:0xf
  v_mul_f32_dpp v221, v3, v221 quad_perm:[0,0,0,0] row_mask:0xf bank_mask:0xf
  v_mul_f32_dpp v214, v4, v214 quad_perm:[0,0,0,0] row_mask:0xf bank_mask:0xf
  v_mul_f32_dpp v222, v4, v222 quad_perm:[0,0,0,0] row_mask:0xf bank_mask:0xf
  v_mul_f32_dpp v215, v5, v215 quad_perm:[0,0,0,0] row_mask:0xf bank_mask:0xf
  v_mul_f32_dpp v223, v5, v223 quad_perm:[0,0,0,0] row_mask:0xf bank_mask:0xf
  v_cvt_pk_bf16_f32 v212, v212, v213
  v_cvt_pk_bf16_f32 v213, v214, v215
  v_cvt_pk_bf16_f32 v214, v220, v221
  v_cvt_pk_bf16_f32 v215, v222, v223
  buffer_store_dwordx4 v[212:215], v11, s[40:43], s71 offen offset:2048 sc1
  v_accvgpr_read_b32 v192, a32
  v_accvgpr_read_b32 v193, a33
  v_accvgpr_read_b32 v194, a34
  v_accvgpr_read_b32 v195, a35
  v_accvgpr_read_b32 v196, a40
  v_accvgpr_read_b32 v197, a41
  v_accvgpr_read_b32 v198, a42
  v_accvgpr_read_b32 v199, a43
  v_mul_f32_dpp v192, v104, v192 quad_perm:[1,1,1,1] row_mask:0xf bank_mask:0xf
  v_mul_f32_dpp v196, v104, v196 quad_perm:[1,1,1,1] row_mask:0xf bank_mask:0xf
  v_mul_f32_dpp v193, v105, v193 quad_perm:[1,1,1,1] row_mask:0xf bank_mask:0xf
  v_mul_f32_dpp v197, v105, v197 quad_perm:[1,1,1,1] row_mask:0xf bank_mask:0xf
  v_mul_f32_dpp v194, v106, v194 quad_perm:[1,1,1,1] row_mask:0xf bank_mask:0xf
  v_mul_f32_dpp v198, v106, v198 quad_perm:[1,1,1,1] row_mask:0xf bank_mask:0xf
  v_mul_f32_dpp v195, v107, v195 quad_perm:[1,1,1,1] row_mask:0xf bank_mask:0xf
  v_mul_f32_dpp v199, v107, v199 quad_perm:[1,1,1,1] row_mask:0xf bank_mask:0xf
  v_cvt_pk_bf16_f32 v24, v192, v193
  v_cvt_pk_bf16_f32 v25, v194, v195
  v_cvt_pk_bf16_f32 v26, v196, v197
  v_cvt_pk_bf16_f32 v27, v198, v199
  v_accvgpr_read_b32 v200, a36
  v_accvgpr_read_b32 v201, a37
  v_accvgpr_read_b32 v202, a38
  v_accvgpr_read_b32 v203, a39
  v_accvgpr_read_b32 v204, a44
  v_accvgpr_read_b32 v205, a45
  v_accvgpr_read_b32 v206, a46
  v_accvgpr_read_b32 v207, a47
  v_mul_f32_dpp v200, v104, v200 quad_perm:[0,0,0,0] row_mask:0xf bank_mask:0xf
  v_mul_f32_dpp v204, v104, v204 quad_perm:[0,0,0,0] row_mask:0xf bank_mask:0xf
  v_mul_f32_dpp v201, v105, v201 quad_perm:[0,0,0,0] row_mask:0xf bank_mask:0xf
  v_mul_f32_dpp v205, v105, v205 quad_perm:[0,0,0,0] row_mask:0xf bank_mask:0xf
  v_mul_f32_dpp v202, v106, v202 quad_perm:[0,0,0,0] row_mask:0xf bank_mask:0xf
  v_mul_f32_dpp v206, v106, v206 quad_perm:[0,0,0,0] row_mask:0xf bank_mask:0xf
  v_mul_f32_dpp v203, v107, v203 quad_perm:[0,0,0,0] row_mask:0xf bank_mask:0xf
  v_mul_f32_dpp v207, v107, v207 quad_perm:[0,0,0,0] row_mask:0xf bank_mask:0xf
  v_cvt_pk_bf16_f32 v120, v200, v201
  v_cvt_pk_bf16_f32 v121, v202, v203
  v_cvt_pk_bf16_f32 v122, v204, v205
  v_cvt_pk_bf16_f32 v123, v206, v207
  v_mul_f32_dpp v240, v2, v240 quad_perm:[1,1,1,1] row_mask:0xf bank_mask:0xf
  v_mul_f32_dpp v248, v2, v248 quad_perm:[1,1,1,1] row_mask:0xf bank_mask:0xf
  v_mul_f32_dpp v241, v3, v241 quad_perm:[1,1,1,1] row_mask:0xf bank_mask:0xf
  v_mul_f32_dpp v249, v3, v249 quad_perm:[1,1,1,1] row_mask:0xf bank_mask:0xf
  v_mul_f32_dpp v242, v4, v242 quad_perm:[1,1,1,1] row_mask:0xf bank_mask:0xf
  v_mul_f32_dpp v250, v4, v250 quad_perm:[1,1,1,1] row_mask:0xf bank_mask:0xf
  v_mul_f32_dpp v243, v5, v243 quad_perm:[1,1,1,1] row_mask:0xf bank_mask:0xf
  v_mul_f32_dpp v251, v5, v251 quad_perm:[1,1,1,1] row_mask:0xf bank_mask:0xf
  v_cvt_pk_bf16_f32 v240, v240, v241
  v_cvt_pk_bf16_f32 v241, v242, v243
  v_cvt_pk_bf16_f32 v242, v248, v249
  v_cvt_pk_bf16_f32 v243, v250, v251
  buffer_store_dwordx4 v[240:243], v11, s[40:43], s70 offen offset:3072 sc1
  v_mul_f32_dpp v244, v2, v244 quad_perm:[0,0,0,0] row_mask:0xf bank_mask:0xf
  v_mul_f32_dpp v252, v2, v252 quad_perm:[0,0,0,0] row_mask:0xf bank_mask:0xf
  v_mul_f32_dpp v245, v3, v245 quad_perm:[0,0,0,0] row_mask:0xf bank_mask:0xf
  v_mul_f32_dpp v253, v3, v253 quad_perm:[0,0,0,0] row_mask:0xf bank_mask:0xf
  v_mul_f32_dpp v246, v4, v246 quad_perm:[0,0,0,0] row_mask:0xf bank_mask:0xf
  v_mul_f32_dpp v254, v4, v254 quad_perm:[0,0,0,0] row_mask:0xf bank_mask:0xf
  v_mul_f32_dpp v247, v5, v247 quad_perm:[0,0,0,0] row_mask:0xf bank_mask:0xf
  v_mul_f32_dpp v255, v5, v255 quad_perm:[0,0,0,0] row_mask:0xf bank_mask:0xf
  v_cvt_pk_bf16_f32 v244, v244, v245
  v_cvt_pk_bf16_f32 v245, v246, v247
  v_cvt_pk_bf16_f32 v246, v252, v253
  v_cvt_pk_bf16_f32 v247, v254, v255
  buffer_store_dwordx4 v[244:247], v11, s[40:43], s71 offen offset:3072 sc1
  v_accvgpr_read_b32 v224, a48
  v_accvgpr_read_b32 v225, a49
  v_accvgpr_read_b32 v226, a50
  v_accvgpr_read_b32 v227, a51
  v_accvgpr_read_b32 v228, a56
  v_accvgpr_read_b32 v229, a57
  v_accvgpr_read_b32 v230, a58
  v_accvgpr_read_b32 v231, a59
  v_mul_f32_dpp v224, v104, v224 quad_perm:[1,1,1,1] row_mask:0xf bank_mask:0xf
  v_mul_f32_dpp v228, v104, v228 quad_perm:[1,1,1,1] row_mask:0xf bank_mask:0xf
  v_mul_f32_dpp v225, v105, v225 quad_perm:[1,1,1,1] row_mask:0xf bank_mask:0xf
  v_mul_f32_dpp v229, v105, v229 quad_perm:[1,1,1,1] row_mask:0xf bank_mask:0xf
  v_mul_f32_dpp v226, v106, v226 quad_perm:[1,1,1,1] row_mask:0xf bank_mask:0xf
  v_mul_f32_dpp v230, v106, v230 quad_perm:[1,1,1,1] row_mask:0xf bank_mask:0xf
  v_mul_f32_dpp v227, v107, v227 quad_perm:[1,1,1,1] row_mask:0xf bank_mask:0xf
  v_mul_f32_dpp v231, v107, v231 quad_perm:[1,1,1,1] row_mask:0xf bank_mask:0xf
  v_cvt_pk_bf16_f32 v28, v224, v225
  v_cvt_pk_bf16_f32 v29, v226, v227
  v_cvt_pk_bf16_f32 v30, v228, v229
  v_cvt_pk_bf16_f32 v31, v230, v231
  v_accvgpr_read_b32 v232, a52
  v_accvgpr_read_b32 v233, a53
  v_accvgpr_read_b32 v234, a54
  v_accvgpr_read_b32 v235, a55
  v_accvgpr_read_b32 v236, a60
  v_accvgpr_read_b32 v237, a61
  v_accvgpr_read_b32 v238, a62
  v_accvgpr_read_b32 v239, a63
  v_mul_f32_dpp v232, v104, v232 quad_perm:[0,0,0,0] row_mask:0xf bank_mask:0xf
  v_mul_f32_dpp v236, v104, v236 quad_perm:[0,0,0,0] row_mask:0xf bank_mask:0xf
  v_mul_f32_dpp v233, v105, v233 quad_perm:[0,0,0,0] row_mask:0xf bank_mask:0xf
  v_mul_f32_dpp v237, v105, v237 quad_perm:[0,0,0,0] row_mask:0xf bank_mask:0xf
  v_mul_f32_dpp v234, v106, v234 quad_perm:[0,0,0,0] row_mask:0xf bank_mask:0xf
  v_mul_f32_dpp v238, v106, v238 quad_perm:[0,0,0,0] row_mask:0xf bank_mask:0xf
  v_mul_f32_dpp v235, v107, v235 quad_perm:[0,0,0,0] row_mask:0xf bank_mask:0xf
  v_mul_f32_dpp v239, v107, v239 quad_perm:[0,0,0,0] row_mask:0xf bank_mask:0xf
  v_cvt_pk_bf16_f32 v124, v232, v233
  v_cvt_pk_bf16_f32 v125, v234, v235
  v_cvt_pk_bf16_f32 v126, v236, v237
  v_cvt_pk_bf16_f32 v127, v238, v239
  s_add_u32 s87, s18, 28672
  s_add_u32 m0, s63, 131072
  s_nop 0
  buffer_load_dwordx4 v1, s[44:47], s87 offen offset:0 sc1 lds
  buffer_load_dwordx4 v1, s[44:47], s87 offen offset:1024 sc1 lds
  buffer_load_dwordx4 v1, s[44:47], s87 offen offset:2048 sc1 lds
  buffer_load_dwordx4 v1, s[44:47], s87 offen offset:3072 sc1 lds
  s_add_u32 s88, s18, 32768
  s_add_u32 m0, s63, 147456
  s_nop 0
  buffer_load_dwordx4 v1, s[44:47], s88 offen offset:0 sc1 lds
  buffer_load_dwordx4 v1, s[44:47], s88 offen offset:1024 sc1 lds
  buffer_load_dwordx4 v1, s[44:47], s88 offen offset:2048 sc1 lds
  buffer_load_dwordx4 v1, s[44:47], s88 offen offset:3072 sc1 lds
  s_add_u32 s89, s18, 36864
  s_add_u32 m0, s63, 0
  s_nop 0
  buffer_load_dwordx4 v1, s[44:47], s89 offen offset:0 sc1 lds
  buffer_load_dwordx4 v1, s[44:47], s89 offen offset:1024 sc1 lds
  buffer_load_dwordx4 v1, s[44:47], s89 offen offset:2048 sc1 lds
  buffer_load_dwordx4 v1, s[44:47], s89 offen offset:3072 sc1 lds
  s_add_u32 s80, s18, 40960
  s_add_u32 m0, s63, 16384
  s_nop 0
  buffer_load_dwordx4 v1, s[44:47], s80 offen offset:0 sc1 lds
  buffer_load_dwordx4 v1, s[44:47], s80 offen offset:1024 sc1 lds
  buffer_load_dwordx4 v1, s[44:47], s80 offen offset:2048 sc1 lds
  buffer_load_dwordx4 v1, s[44:47], s80 offen offset:3072 sc1 lds
  s_add_u32 s81, s18, 45056
  s_add_u32 m0, s63, 65536
  s_nop 0
  buffer_load_dwordx4 v1, s[44:47], s81 offen offset:0 sc1 lds
  buffer_load_dwordx4 v1, s[44:47], s81 offen offset:1024 sc1 lds
  buffer_load_dwordx4 v1, s[44:47], s81 offen offset:2048 sc1 lds
  buffer_load_dwordx4 v1, s[44:47], s81 offen offset:3072 sc1 lds
  s_add_u32 s82, s18, 49152
  s_add_u32 m0, s63, 32768
  s_nop 0
  buffer_load_dwordx4 v1, s[44:47], s82 offen offset:0 sc1 lds
  buffer_load_dwordx4 v1, s[44:47], s82 offen offset:1024 sc1 lds
  buffer_load_dwordx4 v1, s[44:47], s82 offen offset:2048 sc1 lds
  buffer_load_dwordx4 v1, s[44:47], s82 offen offset:3072 sc1 lds
  s_add_u32 s83, s18, 53248
  s_add_u32 m0, s63, 81920
  s_nop 0
  buffer_load_dwordx4 v1, s[44:47], s83 offen offset:0 sc1 lds
  buffer_load_dwordx4 v1, s[44:47], s83 offen offset:1024 sc1 lds
  buffer_load_dwordx4 v1, s[44:47], s83 offen offset:2048 sc1 lds
  buffer_load_dwordx4 v1, s[44:47], s83 offen offset:3072 sc1 lds
  s_add_u32 s84, s18, 57344
  s_add_u32 m0, s63, 49152
  s_nop 0
  buffer_load_dwordx4 v1, s[44:47], s84 offen offset:0 sc1 lds
  buffer_load_dwordx4 v1, s[44:47], s84 offen offset:1024 sc1 lds
  buffer_load_dwordx4 v1, s[44:47], s84 offen offset:2048 sc1 lds
  buffer_load_dwordx4 v1, s[44:47], s84 offen offset:3072 sc1 lds
  s_add_u32 s88, s18, 73728
  s_nop 0
  buffer_load_dwordx4 v[32:35], v1, s[44:47], s88 offen offset:0 sc1
  buffer_load_dwordx4 v[36:39], v1, s[44:47], s88 offen offset:1024 sc1
  buffer_load_dwordx4 v[40:43], v1, s[44:47], s88 offen offset:2048 sc1
  buffer_load_dwordx4 v[44:47], v1, s[44:47], s88 offen offset:3072 sc1
  s_add_u32 s89, s18, 77824
  s_nop 0
  buffer_load_dwordx4 v[48:51], v1, s[44:47], s89 offen offset:0 sc1
  buffer_load_dwordx4 v[52:55], v1, s[44:47], s89 offen offset:1024 sc1
  buffer_load_dwordx4 v[56:59], v1, s[44:47], s89 offen offset:2048 sc1
  buffer_load_dwordx4 v[60:63], v1, s[44:47], s89 offen offset:3072 sc1
  s_lshl_b32 s65, s92, 5
  s_add_u32 s65, s65, s19
  s_lshl_b32 s65, s65, 10
  s_add_u32 s65, s65, 2097152
  v_cmp_eq_u32 vcc, 0, v0
  v_mov_b32 v12, 2147483392
  v_min_u32 v7, 3, v0
  v_cndmask_b32 v12, v12, 0, vcc
  v_lshl_add_u32 v7, v7, 9, s65
  v_mov_b32 v13, 1
  s_mov_b32 s60, 0
  s_waitcnt vmcnt(0)
  buffer_store_dword v13, v12, s[56:59], s95 offen sc1
  s_branch L_join
.section .rodata,"a"
.p2align 6
.amdhsa_kernel standalone__mha_block_cached__near_ridge_kernel
  .amdhsa_next_free_vgpr 512
  .amdhsa_next_free_sgpr 102
  .amdhsa_accum_offset 256
  .amdhsa_group_segment_fixed_size 0
  .amdhsa_kernarg_size 64
  .amdhsa_user_sgpr_count 2
  .amdhsa_user_sgpr_kernarg_segment_ptr 1
  .amdhsa_system_sgpr_workgroup_id_x 1
.end_amdhsa_kernel
```
